```python
import torch

def _softmax(x, axis=-1):
    return torch.softmax(x, dim=axis)

def _gelu(x):
    return torch.nn.functional.gelu(x, approximate='tanh')

def _silu(x):
    return torch.nn.functional.silu(x)

def _sigmoid(x):
    return torch.sigmoid(x)

def _layernorm(x, axis=-1, eps=1e-05):
    m = x.mean(dim=axis, keepdim=True)
    v = x.var(dim=axis, keepdim=True, unbiased=False)
    return (x - m) / torch.sqrt(v + eps)

def _scatter_add(tgt, idx, src, axis=0):
    return tgt.clone().index_add_(axis, idx, src)

def _segment_sum(src, seg, n):
    out = torch.zeros((n,) + src.shape[1:], dtype=src.dtype)
    return out.index_add_(0, seg, src)

def _pad(x, pw):
    flat = tuple((v for pair in reversed(pw) for v in pair))
    return torch.nn.functional.pad(x, flat)
kernel_name = 'parallel_sum__memory_aug_recurrent_mem_tr__dense_activation_mish__prompt'

def setup_inputs():

    _w = lambda a: (lambda t: t.to(torch.bfloat16) if t.is_floating_point() else t)(torch.as_tensor(a))

    def _A_setup():
        B, S, Dm = (1, 2048, 640)
        H, Dh = (32, 128)
        M, seg = (8, 32)
        seg = min(seg, S)
        S = S // seg * seg
        return {'x': _w((lambda *s: torch.randn(*s, dtype=torch.bfloat16) * 0.05)(B, S, Dm)), 'mem0': _w((lambda *s: torch.randn(*s, dtype=torch.bfloat16) * 0.2)(B, M, Dm)), 'Wq': _w((lambda *s: torch.randn(*s, dtype=torch.bfloat16) * 1.6)(Dm, H, Dh) * Dm ** (-0.5)), 'Wk': _w((lambda *s: torch.randn(*s, dtype=torch.bfloat16) * 1.6)(Dm, H, Dh) * Dm ** (-0.5)), 'Wv': _w((lambda *s: torch.randn(*s, dtype=torch.bfloat16) * 0.2)(Dm, H, Dh) * Dm ** (-0.5)), 'Wo': _w((lambda *s: torch.randn(*s, dtype=torch.bfloat16) * 0.2)(H, Dh, Dm) * (H * Dh) ** (-0.5)), 'seg_len': seg}
    _A_in = _A_setup()

    def _B_setup():
        B, S, D, F = (1, 2048, 640, 1728)
        return {'x': _w((lambda *s: torch.randn(*s, dtype=torch.bfloat16) * 0.05)(B, S, D)), 'w1': _w((lambda *s: torch.randn(*s, dtype=torch.bfloat16) * 0.8)(D, F) * D ** (-0.5)), 'b1': _w((lambda *s: torch.randn(*s, dtype=torch.bfloat16) * 0.2)(F)), 'w2': _w((lambda *s: torch.randn(*s, dtype=torch.bfloat16) * 0.1)(F, D) * F ** (-0.5))}
    _B_in = _B_setup()
    return {'A_x': _A_in['x'], 'A_mem0': _A_in['mem0'], 'A_Wq': _A_in['Wq'], 'A_Wk': _A_in['Wk'], 'A_Wv': _A_in['Wv'], 'A_Wo': _A_in['Wo'], 'A_seg_len': _A_in['seg_len'], 'B_x': _B_in['x'], 'B_w1': _B_in['w1'], 'B_b1': _B_in['b1'], 'B_w2': _B_in['w2']}

def reference(A_x, A_mem0, A_Wq, A_Wk, A_Wv, A_Wo, A_seg_len, B_x, B_w1, B_b1, B_w2):

    def _A_ref(x, mem0, Wq, Wk, Wv, Wo, seg_len):
        B, S, Dm = x.shape
        H, Dh = (Wq.shape[1], Wq.shape[2])
        M = mem0.shape[1]
        scale = Dh ** (-0.5)
        n_seg = S // seg_len
        L = M + seg_len
        idx = torch.arange(L)
        mask = (idx[:, None] < M) | (idx[:, None] >= idx[None, :])
        mem = mem0
        outs = []
        for s in range(n_seg):
            xs = x[:, s * seg_len:(s + 1) * seg_len, :].clone()
            h = torch.concatenate([mem, xs], axis=1)
            q = torch.einsum('btd,dhe->bhte', h, Wq)
            k = torch.einsum('btd,dhe->bhte', h, Wk)
            v = torch.einsum('btd,dhe->bhte', h, Wv)
            scores = torch.einsum('bhqe,bhke->bhqk', q, k) * scale
            scores = torch.where(mask[None, None], scores, -1000000000.0)
            p = _softmax(scores, axis=-1)
            o = torch.einsum('bhqk,bhke->bhqe', p, v)
            o = torch.einsum('bhte,hed->btd', o, Wo)
            mem = o[:, :M, :].clone()
            outs.append(o[:, M:, :])
        return torch.concatenate(outs, axis=1)

    def _B_ref(x, w1, b1, w2):
        h = torch.einsum('bsd,df->bsf', x, w1) + b1
        sp = torch.log1p(torch.exp(-torch.abs(h))) + torch.where(h > 0, h, torch.zeros_like(h))
        act = h * torch.tanh(sp)
        return torch.einsum('bsf,fd->bsd', act, w2)
    x = A_x
    xn = _layernorm(x, axis=-1)
    return x + _A_ref(xn, A_mem0, A_Wq, A_Wk, A_Wv, A_Wo, A_seg_len) + _B_ref(xn, B_w1, B_b1, B_w2)
```

```asm
; @launch grid=(256,1,1) block=(256,1,1) lds=163840
.amdgcn_target "amdgcn-amd-amdhsa--gfx950"
.text
.globl parallel_sum__memory_aug_recurrent_mem_tr__dense_activation_mish__prompt_kernel
.p2align 8
.type parallel_sum__memory_aug_recurrent_mem_tr__dense_activation_mish__prompt_kernel,@function
parallel_sum__memory_aug_recurrent_mem_tr__dense_activation_mish__prompt_kernel:
  s_cmp_ge_u32 s2, 256
  s_cbranch_scc1 L_END
  s_load_dwordx2 s[76:77], s[0:1], 96
  s_load_dwordx2 s[78:79], s[0:1], 104
  v_lshrrev_b32 v8, 6, v0
  s_nop 1
  v_readfirstlane_b32 s13, v8
  s_waitcnt lgkmcnt(0)
  s_mov_b32 s4, s78
  s_and_b32 s5, s79, 0xffff
  s_mov_b32 s6, 268435456
  s_mov_b32 s7, 0x20000
  s_mov_b32 s74, 0x400000
  s_cmp_lg_u32 s2, 0
  s_cbranch_scc1 NZ_1
  v_lshlrev_b32 v1, 4, v0
  v_mov_b32 v4, 0
  v_mov_b32 v5, 0
  v_mov_b32 v6, 0
  v_mov_b32 v7, 0
  s_mov_b32 s47, 0
  buffer_store_dwordx4 v[4:7], v1, s[4:7], s47 offen sc1
  s_mov_b32 s47, 4096
  buffer_store_dwordx4 v[4:7], v1, s[4:7], s47 offen sc1
  s_mov_b32 s47, 8192
  buffer_store_dwordx4 v[4:7], v1, s[4:7], s47 offen sc1
  s_mov_b32 s47, 12288
  buffer_store_dwordx4 v[4:7], v1, s[4:7], s47 offen sc1
  s_mov_b32 s47, 16384
  buffer_store_dwordx4 v[4:7], v1, s[4:7], s47 offen sc1
  s_mov_b32 s47, 20480
  buffer_store_dwordx4 v[4:7], v1, s[4:7], s47 offen sc1
  s_mov_b32 s47, 24576
  buffer_store_dwordx4 v[4:7], v1, s[4:7], s47 offen sc1
  s_mov_b32 s47, 28672
  buffer_store_dwordx4 v[4:7], v1, s[4:7], s47 offen sc1
  s_waitcnt vmcnt(0)
  s_barrier
NZ_1:
  s_mov_b32 s8, s76
  s_and_b32 s9, s77, 0xffff
  s_mov_b32 s10, 256
  s_mov_b32 s11, 0x20000
  s_getreg_b32 s84, hwreg(HW_REG_XCC_ID, 0, 4)
  s_and_b32 s47, s84, 3
  s_lshl_b32 s47, s47, 2
  s_lshr_b32 s48, s84, 2
  s_lshl_b32 s48, s48, 7
  s_add_u32 s47, s47, s48
  s_min_u32 s47, s47, 252
  s_cmp_lg_u32 s13, 0
  s_cbranch_scc1 RW_2
  v_mov_b32 v4, s47
  v_mov_b32 v5, 1
  s_mov_b64 exec, 1
  buffer_atomic_add v5, v4, s[8:11], 0 offen sc0
  s_waitcnt vmcnt(0)
  s_mov_b64 exec, -1
  v_mov_b32 v6, 0
  s_mov_b64 exec, 1
  ds_write_b32 v6, v5
  s_mov_b64 exec, -1
  s_waitcnt lgkmcnt(0)
RW_2:
  s_barrier
  v_mov_b32 v6, 0
  ds_read_b32 v5, v6
  s_waitcnt lgkmcnt(0)
  v_readfirstlane_b32 s85, v5
  s_barrier
  s_lshl_b32 s2, s84, 8
  s_or_b32 s2, s2, s85
  s_mov_b32 s3, 0
  s_mov_b32 s86, 1
  s_cmp_lt_u32 s85, 32
  s_cselect_b32 s88, 1, 0
  s_cmp_lt_u32 s84, 8
  s_cselect_b32 s88, s88, 0
  s_cmp_eq_u32 s88, 1
  s_cbranch_scc1 L_DISPATCH
  s_cmp_eq_u32 s3, 0
  s_cbranch_scc1 L_CF1
L_CR1:
L_DISPATCH:
  s_load_dwordx2 s[56:57], s[0:1], 0
  s_load_dwordx2 s[58:59], s[0:1], 16
  s_load_dwordx2 s[60:61], s[0:1], 24
  s_load_dwordx2 s[62:63], s[0:1], 32
  s_load_dwordx2 s[64:65], s[0:1], 40
  s_load_dwordx2 s[66:67], s[0:1], 64
  s_load_dwordx2 s[68:69], s[0:1], 72
  s_load_dwordx2 s[70:71], s[0:1], 80
  s_load_dwordx2 s[72:73], s[0:1], 88
  s_load_dwordx2 s[80:81], s[0:1], 8
  s_waitcnt lgkmcnt(0)
  s_add_u32 s84, s84, 5
  s_and_b32 s84, s84, 7
  s_cmp_lg_u32 s84, 0
  s_cbranch_scc1 WORKER_3
  s_mov_b32 s12, s85
  s_mov_b64 s[82:83], s[64:65]
  s_mov_b64 s[56:57], s[58:59]
  s_mov_b64 s[58:59], s[60:61]
  s_mov_b64 s[60:61], s[62:63]
  s_mov_b64 s[62:63], s[82:83]
  s_mov_b64 s[64:65], s[80:81]
  s_cmp_eq_u32 s86, 0
  s_cbranch_scc1 CSLOW_4
  s_mul_i32 s42, s13, 2560
  s_lshl_b32 s43, s13, 9
  s_lshl_b32 s46, s13, 11
  s_add_u32 s44, s46, 24576
  s_lshl_b32 s47, s12, 2
  s_add_u32 s47, s47, s13
  s_mul_i32 s47, s47, 18432
  s_add_u32 s45, s47, 524288
  s_add_u32 s90, s45, 0
  s_add_u32 s91, s45, 4096
  s_add_u32 s92, s45, 8192
  s_add_u32 s93, s45, 12288
  s_add_u32 s94, s45, 16384
  s_lshl_b32 s47, s12, 8
  s_lshl_b32 s48, s13, 16
  s_add_u32 s19, s47, s48
  s_add_u32 s19, s19, 65536
  s_add_u32 s20, s19, 32768
  s_lshl_b32 s48, s13, 14
  s_add_u32 s21, s47, s48
  s_add_u32 s21, s21, 327680
  s_lshl_b32 s26, s12, 7
  s_add_u32 s26, s26, 4096
  s_mov_b32 s24, 0
  s_cmp_eq_u32 s13, 0
  s_cselect_b32 s24, 1, 0
  s_cmp_lt_u32 s12, 8
  s_cselect_b32 s48, 1, 0
  s_cmp_eq_u32 s13, 1
  s_cselect_b32 s48, s48, 0
  s_or_b32 s24, s24, s48
  s_add_u32 s49, s12, 32
  s_cmp_eq_u32 s13, 0
  s_cselect_b32 s49, s12, s49
  s_min_u32 s49, s49, 39
  s_lshl_b32 s22, s49, 13
  s_add_u32 s22, s22, 65536
  s_lshr_b32 s47, s49, 3
  s_mul_i32 s47, s47, 20
  s_bfe_u32 s48, s49, 0x10002
  s_lshl_b32 s48, s48, 3
  s_add_u32 s47, s47, s48
  s_bfe_u32 s48, s49, 0x10001
  s_lshl_b32 s48, s48, 2
  s_add_u32 s47, s47, s48
  s_sub_u32 s48, s49, 32
  s_lshr_b32 s48, s48, 1
  s_mul_i32 s48, s48, 20
  s_add_u32 s48, s48, 16
  s_cmp_lt_u32 s49, 32
  s_cselect_b32 s47, s47, s48
  s_lshl_b32 s47, s47, 7
  s_and_b32 s48, s49, 1
  s_lshl_b32 s48, s48, 6
  s_add_u32 s23, s47, s48
  s_mov_b32 s38, 0x3e0293ee
  s_mov_b32 s39, 0x3f803f80
  s_mov_b32 s40, 0x3f003f00
  s_mov_b32 s41, 0xfffffffe
  v_and_b32 v8, 63, v0
  v_and_b32 v9, 15, v8
  v_lshrrev_b32 v10, 4, v8
  v_lshlrev_b32 v0, 4, v8
  v_and_b32 v11, 7, v9
  v_lshl_add_u32 v11, v10, 3, v11
  v_lshlrev_b32 v1, 4, v11
  v_mov_b32 v12, 0x4444
  v_mov_b32 v13, 0xeeee
  v_cmp_gt_u32 vcc, 8, v9
  s_nop 1
  v_cndmask_b32 v2, v13, v12, vcc
  v_lshrrev_b32 v11, 2, v9
  v_lshl_add_u32 v11, v10, 3, v11
  v_lshlrev_b32 v11, 4, v11
  v_and_b32 v12, 1, v9
  v_lshl_add_u32 v3, v12, 3, v11
  v_lshrrev_b32 v11, 1, v10
  v_lshl_add_u32 v11, v11, 4, v9
  s_lshl_b32 s47, s13, 5
  v_add_u32 v11, s47, v11
  v_lshlrev_b32 v11, 4, v11
  v_and_b32 v12, 1, v10
  v_lshl_add_u32 v4, v12, 3, v11
  v_lshlrev_b32 v11, 13, v10
  v_lshl_add_u32 v5, v9, 4, v11
  v_bfe_u32 v11, v9, 1, 2
  v_cmp_eq_u32 s[28:29], 0, v11
  v_cmp_eq_u32 s[30:31], 1, v11
  v_cmp_eq_u32 s[32:33], 2, v11
  v_cmp_eq_u32 s[34:35], 3, v11
  v_cmp_gt_u32 s[36:37], 32, v8
  v_cmp_le_u32 s[52:53], 32, v8
  v_add_u32 v6, s44, v0
  v_lshrrev_b32 v11, 4, v0
  v_lshrrev_b32 v20, 4, v11
  v_and_b32 v21, 15, v11
  v_lshlrev_b32 v8, 13, v20
  v_lshl_add_u32 v8, v21, 4, v8
  s_movk_i32 s47, 1280
  v_mul_lo_u32 v9, v20, s47
  v_lshl_add_u32 v9, v21, 4, v9
  v_lshrrev_b32 v22, 2, v21
  v_and_b32 v23, 1, v22
  v_lshl_add_u32 v23, v20, 2, v23
  v_lshlrev_b32 v23, 8, v23
  v_lshrrev_b32 v22, 1, v22
  v_lshl_add_u32 v23, v22, 5, v23
  v_and_b32 v22, 3, v21
  v_lshl_add_u32 v23, v22, 3, v23
  s_lshl_b32 s47, s13, 6
  v_add_u32 v10, s47, v23
  s_lshl_b32 s47, s13, 15
  s_lshl_b32 s48, s12, 8
  s_add_u32 s96, s47, s48
  s_lshl_b32 s47, s12, 7
  s_lshl_b32 s48, s13, 2
  s_add_u32 s47, s47, s48
  s_mul_i32 s97, s47, 1280
  s_mov_b32 s8, s56
  s_and_b32 s9, s57, 0xffff
  s_mov_b32 s10, 5242880
  s_mov_b32 s11, 0x20000
  s_add_u32 s47, s96, 131072
  s_add_u32 m0, s46, 65536
  s_nop 0
  buffer_load_dwordx4 v8, s[8:11], s47 offen nt lds
  s_add_u32 s47, s96, 1179648
  s_add_u32 m0, s46, 66560
  s_nop 0
  buffer_load_dwordx4 v8, s[8:11], s47 offen nt lds
  s_add_u32 s47, s96, 2097152
  s_add_u32 m0, s46, 73728
  s_nop 0
  buffer_load_dwordx4 v8, s[8:11], s47 offen nt lds
  s_add_u32 s47, s96, 3145728
  s_add_u32 m0, s46, 74752
  s_nop 0
  buffer_load_dwordx4 v8, s[8:11], s47 offen nt lds
  s_add_u32 s47, s96, 2228224
  s_add_u32 m0, s46, 81920
  s_nop 0
  buffer_load_dwordx4 v8, s[8:11], s47 offen nt lds
  s_add_u32 s47, s96, 3276800
  s_add_u32 m0, s46, 82944
  s_nop 0
  buffer_load_dwordx4 v8, s[8:11], s47 offen nt lds
  s_add_u32 s47, s96, 4194304
  s_add_u32 m0, s46, 90112
  s_nop 0
  buffer_load_dwordx4 v8, s[8:11], s47 offen nt lds
  s_add_u32 s47, s96, 4325376
  s_add_u32 m0, s46, 91136
  s_nop 0
  buffer_load_dwordx4 v8, s[8:11], s47 offen nt lds
  s_add_u32 s47, s96, 262144
  s_add_u32 m0, s46, 98304
  s_nop 0
  buffer_load_dwordx4 v8, s[8:11], s47 offen nt lds
  s_add_u32 s47, s96, 1310720
  s_add_u32 m0, s46, 99328
  s_nop 0
  buffer_load_dwordx4 v8, s[8:11], s47 offen nt lds
  s_add_u32 s47, s96, 2359296
  s_add_u32 m0, s46, 106496
  s_nop 0
  buffer_load_dwordx4 v8, s[8:11], s47 offen nt lds
  s_add_u32 s47, s96, 3407872
  s_add_u32 m0, s46, 107520
  s_nop 0
  buffer_load_dwordx4 v8, s[8:11], s47 offen nt lds
  s_add_u32 s47, s96, 2490368
  s_add_u32 m0, s46, 114688
  s_nop 0
  buffer_load_dwordx4 v8, s[8:11], s47 offen nt lds
  s_add_u32 s47, s96, 3538944
  s_add_u32 m0, s46, 115712
  s_nop 0
  buffer_load_dwordx4 v8, s[8:11], s47 offen nt lds
  s_add_u32 s47, s96, 4456448
  s_add_u32 m0, s46, 122880
  s_nop 0
  buffer_load_dwordx4 v8, s[8:11], s47 offen nt lds
  s_add_u32 s47, s96, 4587520
  s_add_u32 m0, s46, 123904
  s_nop 0
  buffer_load_dwordx4 v8, s[8:11], s47 offen nt lds
  s_add_u32 s47, s96, 524288
  s_add_u32 m0, s46, 131072
  s_nop 0
  buffer_load_dwordx4 v8, s[8:11], s47 offen nt lds
  s_add_u32 s47, s96, 1572864
  s_add_u32 m0, s46, 132096
  s_nop 0
  buffer_load_dwordx4 v8, s[8:11], s47 offen nt lds
  s_add_u32 s47, s96, 655360
  s_add_u32 m0, s46, 139264
  s_nop 0
  buffer_load_dwordx4 v8, s[8:11], s47 offen nt lds
  s_add_u32 s47, s96, 1703936
  s_add_u32 m0, s46, 140288
  s_nop 0
  buffer_load_dwordx4 v8, s[8:11], s47 offen nt lds
  s_add_u32 s47, s96, 2621440
  s_add_u32 m0, s46, 147456
  s_nop 0
  buffer_load_dwordx4 v8, s[8:11], s47 offen nt lds
  s_add_u32 s47, s96, 3670016
  s_add_u32 m0, s46, 148480
  s_nop 0
  buffer_load_dwordx4 v8, s[8:11], s47 offen nt lds
  s_add_u32 s47, s96, 4718592
  s_add_u32 m0, s46, 155648
  s_nop 0
  buffer_load_dwordx4 v8, s[8:11], s47 offen nt lds
  s_add_u32 s47, s96, 4849664
  s_add_u32 m0, s46, 156672
  s_nop 0
  buffer_load_dwordx4 v8, s[8:11], s47 offen nt lds
  s_add_u32 s47, s96, 786432
  s_add_u32 m0, s46, 24576
  s_nop 0
  buffer_load_dwordx4 v8, s[8:11], s47 offen nt lds
  s_add_u32 s47, s96, 1835008
  s_add_u32 m0, s46, 25600
  s_nop 0
  buffer_load_dwordx4 v8, s[8:11], s47 offen nt lds
  s_add_u32 s47, s96, 917504
  s_add_u32 m0, s46, 32768
  s_nop 0
  buffer_load_dwordx4 v8, s[8:11], s47 offen nt lds
  s_add_u32 s47, s96, 1966080
  s_add_u32 m0, s46, 33792
  s_nop 0
  buffer_load_dwordx4 v8, s[8:11], s47 offen nt lds
  s_add_u32 s47, s96, 2883584
  s_add_u32 m0, s46, 40960
  s_nop 0
  buffer_load_dwordx4 v8, s[8:11], s47 offen nt lds
  s_add_u32 s47, s96, 3932160
  s_add_u32 m0, s46, 41984
  s_nop 0
  buffer_load_dwordx4 v8, s[8:11], s47 offen nt lds
  s_add_u32 s47, s96, 4980736
  s_add_u32 m0, s46, 49152
  s_nop 0
  buffer_load_dwordx4 v8, s[8:11], s47 offen nt lds
  s_add_u32 s47, s96, 5111808
  s_add_u32 m0, s46, 50176
  s_nop 0
  buffer_load_dwordx4 v8, s[8:11], s47 offen nt lds
  s_mov_b32 s8, s58
  s_and_b32 s9, s59, 0xffff
  s_mov_b32 s10, 5242880
  s_mov_b32 s11, 0x20000
  s_add_u32 s47, s96, 131072
  s_add_u32 m0, s46, 57344
  s_nop 0
  buffer_load_dwordx4 v8, s[8:11], s47 offen nt lds
  s_add_u32 s47, s96, 1179648
  s_add_u32 m0, s46, 58368
  s_nop 0
  buffer_load_dwordx4 v8, s[8:11], s47 offen nt lds
  s_waitcnt vmcnt(32)
  s_barrier
  v_add_u32 v11, 65536, v10
  ds_read_b64_tr_b16 a[0:1], v11 offset:0
  ds_read_b64_tr_b16 a[2:3], v11 offset:512
  ds_read_b64_tr_b16 a[4:5], v11 offset:4096
  ds_read_b64_tr_b16 a[6:7], v11 offset:4608
  s_waitcnt lgkmcnt(0)
  s_mov_b32 s80, s64
  s_and_b32 s81, s65, 0xffff
  s_mov_b32 s82, 10240
  s_mov_b32 s83, 0x20000
  v_lshrrev_b32 v53, 4, v0
  s_lshl_b32 s47, s13, 6
  v_add_u32 v53, s47, v53
  s_mov_b32 s48, 13108
  v_add_u32 v28, 0, v53
  v_lshrrev_b32 v44, 4, v28
  v_lshrrev_b32 v45, 2, v44
  v_and_b32 v46, 3, v44
  v_mul_u32_u24 v47, s48, v45
  v_lshrrev_b32 v47, 16, v47
  v_mul_u32_u24 v48, 5, v47
  v_sub_u32 v48, v45, v48
  v_and_b32 v49, 1, v28
  v_lshrrev_b32 v50, 1, v48
  v_lshlrev_b32 v50, 8, v50
  v_and_b32 v51, 1, v48
  v_lshl_add_u32 v50, v51, 4, v50
  v_lshlrev_b32 v51, 7, v49
  v_lshlrev_b32 v52, 4, v49
  v_cmp_eq_u32 vcc, 4, v48
  s_nop 1
  v_cndmask_b32 v51, v51, v52, vcc
  v_add_u32 v50, v50, v51
  v_lshl_add_u32 v50, v47, 5, v50
  v_lshl_add_u32 v50, v46, 2, v50
  v_bfe_u32 v51, v28, 1, 3
  s_movk_i32 s49, 1280
  v_mul_lo_u32 v51, v51, s49
  v_lshl_add_u32 v51, v50, 1, v51
  buffer_load_dwordx2 v[34:35], v51, s[80:83], 0 offen
  v_lshlrev_b32 v28, 3, v28
  v_add_u32 v29, 256, v53
  v_lshrrev_b32 v44, 4, v29
  v_lshrrev_b32 v45, 2, v44
  v_and_b32 v46, 3, v44
  v_mul_u32_u24 v47, s48, v45
  v_lshrrev_b32 v47, 16, v47
  v_mul_u32_u24 v48, 5, v47
  v_sub_u32 v48, v45, v48
  v_and_b32 v49, 1, v29
  v_lshrrev_b32 v50, 1, v48
  v_lshlrev_b32 v50, 8, v50
  v_and_b32 v51, 1, v48
  v_lshl_add_u32 v50, v51, 4, v50
  v_lshlrev_b32 v51, 7, v49
  v_lshlrev_b32 v52, 4, v49
  v_cmp_eq_u32 vcc, 4, v48
  s_nop 1
  v_cndmask_b32 v51, v51, v52, vcc
  v_add_u32 v50, v50, v51
  v_lshl_add_u32 v50, v47, 5, v50
  v_lshl_add_u32 v50, v46, 2, v50
  v_bfe_u32 v51, v29, 1, 3
  s_movk_i32 s49, 1280
  v_mul_lo_u32 v51, v51, s49
  v_lshl_add_u32 v51, v50, 1, v51
  buffer_load_dwordx2 v[36:37], v51, s[80:83], 0 offen
  v_lshlrev_b32 v29, 3, v29
  v_add_u32 v30, 512, v53
  v_lshrrev_b32 v44, 4, v30
  v_lshrrev_b32 v45, 2, v44
  v_and_b32 v46, 3, v44
  v_mul_u32_u24 v47, s48, v45
  v_lshrrev_b32 v47, 16, v47
  v_mul_u32_u24 v48, 5, v47
  v_sub_u32 v48, v45, v48
  v_and_b32 v49, 1, v30
  v_lshrrev_b32 v50, 1, v48
  v_lshlrev_b32 v50, 8, v50
  v_and_b32 v51, 1, v48
  v_lshl_add_u32 v50, v51, 4, v50
  v_lshlrev_b32 v51, 7, v49
  v_lshlrev_b32 v52, 4, v49
  v_cmp_eq_u32 vcc, 4, v48
  s_nop 1
  v_cndmask_b32 v51, v51, v52, vcc
  v_add_u32 v50, v50, v51
  v_lshl_add_u32 v50, v47, 5, v50
  v_lshl_add_u32 v50, v46, 2, v50
  v_bfe_u32 v51, v30, 1, 3
  s_movk_i32 s49, 1280
  v_mul_lo_u32 v51, v51, s49
  v_lshl_add_u32 v51, v50, 1, v51
  buffer_load_dwordx2 v[38:39], v51, s[80:83], 0 offen
  v_lshlrev_b32 v30, 3, v30
  v_add_u32 v31, 768, v53
  v_lshrrev_b32 v44, 4, v31
  v_lshrrev_b32 v45, 2, v44
  v_and_b32 v46, 3, v44
  v_mul_u32_u24 v47, s48, v45
  v_lshrrev_b32 v47, 16, v47
  v_mul_u32_u24 v48, 5, v47
  v_sub_u32 v48, v45, v48
  v_and_b32 v49, 1, v31
  v_lshrrev_b32 v50, 1, v48
  v_lshlrev_b32 v50, 8, v50
  v_and_b32 v51, 1, v48
  v_lshl_add_u32 v50, v51, 4, v50
  v_lshlrev_b32 v51, 7, v49
  v_lshlrev_b32 v52, 4, v49
  v_cmp_eq_u32 vcc, 4, v48
  s_nop 1
  v_cndmask_b32 v51, v51, v52, vcc
  v_add_u32 v50, v50, v51
  v_lshl_add_u32 v50, v47, 5, v50
  v_lshl_add_u32 v50, v46, 2, v50
  v_bfe_u32 v51, v31, 1, 3
  s_movk_i32 s49, 1280
  v_mul_lo_u32 v51, v51, s49
  v_lshl_add_u32 v51, v50, 1, v51
  buffer_load_dwordx2 v[40:41], v51, s[80:83], 0 offen
  v_lshlrev_b32 v31, 3, v31
  v_add_u32 v32, 1024, v53
  v_lshrrev_b32 v44, 4, v32
  v_lshrrev_b32 v45, 2, v44
  v_and_b32 v46, 3, v44
  v_mul_u32_u24 v47, s48, v45
  v_lshrrev_b32 v47, 16, v47
  v_mul_u32_u24 v48, 5, v47
  v_sub_u32 v48, v45, v48
  v_and_b32 v49, 1, v32
  v_lshrrev_b32 v50, 1, v48
  v_lshlrev_b32 v50, 8, v50
  v_and_b32 v51, 1, v48
  v_lshl_add_u32 v50, v51, 4, v50
  v_lshlrev_b32 v51, 7, v49
  v_lshlrev_b32 v52, 4, v49
  v_cmp_eq_u32 vcc, 4, v48
  s_nop 1
  v_cndmask_b32 v51, v51, v52, vcc
  v_add_u32 v50, v50, v51
  v_lshl_add_u32 v50, v47, 5, v50
  v_lshl_add_u32 v50, v46, 2, v50
  v_bfe_u32 v51, v32, 1, 3
  s_movk_i32 s49, 1280
  v_mul_lo_u32 v51, v51, s49
  v_lshl_add_u32 v51, v50, 1, v51
  buffer_load_dwordx2 v[42:43], v51, s[80:83], 0 offen
  v_lshlrev_b32 v32, 3, v32
  s_waitcnt vmcnt(35)
  s_barrier
  s_add_u32 s47, s96, 2228224
  s_add_u32 m0, s46, 65536
  s_nop 0
  buffer_load_dwordx4 v8, s[8:11], s47 offen nt lds
  s_add_u32 s47, s96, 3276800
  s_add_u32 m0, s46, 66560
  s_nop 0
  buffer_load_dwordx4 v8, s[8:11], s47 offen nt lds
  v_add_u32 v11, 73728, v10
  ds_read_b64_tr_b16 a[8:9], v11 offset:0
  ds_read_b64_tr_b16 a[10:11], v11 offset:512
  ds_read_b64_tr_b16 a[12:13], v11 offset:4096
  ds_read_b64_tr_b16 a[14:15], v11 offset:4608
  s_waitcnt lgkmcnt(0)
  s_waitcnt vmcnt(35)
  s_barrier
  s_add_u32 s47, s96, 262144
  s_add_u32 m0, s46, 73728
  s_nop 0
  buffer_load_dwordx4 v8, s[8:11], s47 offen nt lds
  s_add_u32 s47, s96, 1310720
  s_add_u32 m0, s46, 74752
  s_nop 0
  buffer_load_dwordx4 v8, s[8:11], s47 offen nt lds
  v_add_u32 v11, 81920, v10
  ds_read_b64_tr_b16 a[16:17], v11 offset:0
  ds_read_b64_tr_b16 a[18:19], v11 offset:512
  ds_read_b64_tr_b16 a[20:21], v11 offset:4096
  ds_read_b64_tr_b16 a[22:23], v11 offset:4608
  s_waitcnt lgkmcnt(0)
  s_waitcnt vmcnt(35)
  s_barrier
  s_add_u32 s47, s96, 4456448
  s_add_u32 m0, s46, 81920
  s_nop 0
  buffer_load_dwordx4 v8, s[8:11], s47 offen nt lds
  s_add_u32 s47, s96, 4587520
  s_add_u32 m0, s46, 82944
  s_nop 0
  buffer_load_dwordx4 v8, s[8:11], s47 offen nt lds
  v_add_u32 v11, 90112, v10
  ds_read_b64_tr_b16 a[24:25], v11 offset:0
  ds_read_b64_tr_b16 a[26:27], v11 offset:512
  ds_read_b64_tr_b16 a[28:29], v11 offset:4096
  ds_read_b64_tr_b16 a[30:31], v11 offset:4608
  s_waitcnt lgkmcnt(0)
  s_waitcnt vmcnt(35)
  s_barrier
  s_add_u32 s47, s96, 655360
  s_add_u32 m0, s46, 90112
  s_nop 0
  buffer_load_dwordx4 v8, s[8:11], s47 offen nt lds
  s_add_u32 s47, s96, 1703936
  s_add_u32 m0, s46, 91136
  s_nop 0
  buffer_load_dwordx4 v8, s[8:11], s47 offen nt lds
  v_add_u32 v11, 98304, v10
  ds_read_b64_tr_b16 a[32:33], v11 offset:0
  ds_read_b64_tr_b16 a[34:35], v11 offset:512
  ds_read_b64_tr_b16 a[36:37], v11 offset:4096
  ds_read_b64_tr_b16 a[38:39], v11 offset:4608
  s_waitcnt lgkmcnt(0)
  s_waitcnt vmcnt(35)
  s_barrier
  s_add_u32 s47, s96, 2752512
  s_add_u32 m0, s46, 98304
  s_nop 0
  buffer_load_dwordx4 v8, s[8:11], s47 offen nt lds
  s_add_u32 s47, s96, 3801088
  s_add_u32 m0, s46, 99328
  s_nop 0
  buffer_load_dwordx4 v8, s[8:11], s47 offen nt lds
  v_add_u32 v11, 106496, v10
  ds_read_b64_tr_b16 a[40:41], v11 offset:0
  ds_read_b64_tr_b16 a[42:43], v11 offset:512
  ds_read_b64_tr_b16 a[44:45], v11 offset:4096
  ds_read_b64_tr_b16 a[46:47], v11 offset:4608
  s_waitcnt lgkmcnt(0)
  s_waitcnt vmcnt(35)
  s_barrier
  s_add_u32 s47, s96, 2883584
  s_add_u32 m0, s46, 106496
  s_nop 0
  buffer_load_dwordx4 v8, s[8:11], s47 offen nt lds
  s_add_u32 s47, s96, 3932160
  s_add_u32 m0, s46, 107520
  s_nop 0
  buffer_load_dwordx4 v8, s[8:11], s47 offen nt lds
  v_add_u32 v11, 114688, v10
  ds_read_b64_tr_b16 a[48:49], v11 offset:0
  ds_read_b64_tr_b16 a[50:51], v11 offset:512
  ds_read_b64_tr_b16 a[52:53], v11 offset:4096
  ds_read_b64_tr_b16 a[54:55], v11 offset:4608
  s_waitcnt lgkmcnt(0)
  s_waitcnt vmcnt(35)
  s_barrier
  s_add_u32 s47, s96, 3014656
  s_add_u32 m0, s46, 114688
  s_nop 0
  buffer_load_dwordx4 v8, s[8:11], s47 offen nt lds
  s_add_u32 s47, s96, 4063232
  s_add_u32 m0, s46, 115712
  s_nop 0
  buffer_load_dwordx4 v8, s[8:11], s47 offen nt lds
  v_add_u32 v11, 122880, v10
  ds_read_b64_tr_b16 a[56:57], v11 offset:0
  ds_read_b64_tr_b16 a[58:59], v11 offset:512
  ds_read_b64_tr_b16 a[60:61], v11 offset:4096
  ds_read_b64_tr_b16 a[62:63], v11 offset:4608
  s_waitcnt lgkmcnt(0)
  s_waitcnt vmcnt(35)
  s_barrier
  s_mov_b32 s8, s60
  s_and_b32 s9, s61, 0xffff
  s_mov_b32 s10, 5242880
  s_mov_b32 s11, 0x20000
  s_add_u32 s47, s96, 0
  s_add_u32 m0, s46, 122880
  s_nop 0
  buffer_load_dwordx4 v8, s[8:11], s47 offen nt lds
  s_add_u32 s47, s96, 1048576
  s_add_u32 m0, s46, 123904
  s_nop 0
  buffer_load_dwordx4 v8, s[8:11], s47 offen nt lds
  v_add_u32 v11, 131072, v10
  ds_read_b64_tr_b16 a[64:65], v11 offset:0
  ds_read_b64_tr_b16 a[66:67], v11 offset:512
  ds_read_b64_tr_b16 a[68:69], v11 offset:4096
  ds_read_b64_tr_b16 a[70:71], v11 offset:4608
  s_waitcnt lgkmcnt(0)
  s_waitcnt vmcnt(35)
  s_barrier
  s_add_u32 s47, s96, 131072
  s_add_u32 m0, s46, 131072
  s_nop 0
  buffer_load_dwordx4 v8, s[8:11], s47 offen nt lds
  s_add_u32 s47, s96, 1179648
  s_add_u32 m0, s46, 132096
  s_nop 0
  buffer_load_dwordx4 v8, s[8:11], s47 offen nt lds
  v_add_u32 v11, 139264, v10
  ds_read_b64_tr_b16 a[72:73], v11 offset:0
  ds_read_b64_tr_b16 a[74:75], v11 offset:512
  ds_read_b64_tr_b16 a[76:77], v11 offset:4096
  ds_read_b64_tr_b16 a[78:79], v11 offset:4608
  s_waitcnt lgkmcnt(0)
  s_waitcnt vmcnt(35)
  s_barrier
  s_add_u32 s47, s96, 2097152
  s_add_u32 m0, s46, 139264
  s_nop 0
  buffer_load_dwordx4 v8, s[8:11], s47 offen nt lds
  s_add_u32 s47, s96, 3145728
  s_add_u32 m0, s46, 140288
  s_nop 0
  buffer_load_dwordx4 v8, s[8:11], s47 offen nt lds
  v_add_u32 v11, 147456, v10
  ds_read_b64_tr_b16 a[80:81], v11 offset:0
  ds_read_b64_tr_b16 a[82:83], v11 offset:512
  ds_read_b64_tr_b16 a[84:85], v11 offset:4096
  ds_read_b64_tr_b16 a[86:87], v11 offset:4608
  s_waitcnt lgkmcnt(0)
  s_waitcnt vmcnt(35)
  s_barrier
  s_add_u32 s47, s96, 2228224
  s_add_u32 m0, s46, 147456
  s_nop 0
  buffer_load_dwordx4 v8, s[8:11], s47 offen nt lds
  s_add_u32 s47, s96, 3276800
  s_add_u32 m0, s46, 148480
  s_nop 0
  buffer_load_dwordx4 v8, s[8:11], s47 offen nt lds
  v_add_u32 v11, 155648, v10
  ds_read_b64_tr_b16 a[88:89], v11 offset:0
  ds_read_b64_tr_b16 a[90:91], v11 offset:512
  ds_read_b64_tr_b16 a[92:93], v11 offset:4096
  ds_read_b64_tr_b16 a[94:95], v11 offset:4608
  s_waitcnt lgkmcnt(0)
  s_waitcnt vmcnt(26)
  ds_write_b64 v28, v[34:35] offset:0
  s_waitcnt vmcnt(25)
  ds_write_b64 v29, v[36:37] offset:0
  s_waitcnt vmcnt(24)
  ds_write_b64 v30, v[38:39] offset:0
  s_waitcnt vmcnt(23)
  ds_write_b64 v31, v[40:41] offset:0
  s_waitcnt vmcnt(22)
  ds_write_b64 v32, v[42:43] offset:0
  s_barrier
  s_add_u32 s47, s96, 4194304
  s_add_u32 m0, s46, 155648
  s_nop 0
  buffer_load_dwordx4 v8, s[8:11], s47 offen nt lds
  s_add_u32 s47, s96, 4325376
  s_add_u32 m0, s46, 156672
  s_nop 0
  buffer_load_dwordx4 v8, s[8:11], s47 offen nt lds
  v_add_u32 v11, 24576, v10
  ds_read_b64_tr_b16 a[96:97], v11 offset:0
  ds_read_b64_tr_b16 a[98:99], v11 offset:512
  ds_read_b64_tr_b16 a[100:101], v11 offset:4096
  ds_read_b64_tr_b16 a[102:103], v11 offset:4608
  s_waitcnt lgkmcnt(0)
  s_barrier
  s_add_u32 s47, s96, 262144
  s_add_u32 m0, s46, 24576
  s_nop 0
  buffer_load_dwordx4 v8, s[8:11], s47 offen nt lds
  s_add_u32 s47, s96, 1310720
  s_add_u32 m0, s46, 25600
  s_nop 0
  buffer_load_dwordx4 v8, s[8:11], s47 offen nt lds
  v_add_u32 v11, 32768, v10
  ds_read_b64_tr_b16 a[104:105], v11 offset:0
  ds_read_b64_tr_b16 a[106:107], v11 offset:512
  ds_read_b64_tr_b16 a[108:109], v11 offset:4096
  ds_read_b64_tr_b16 a[110:111], v11 offset:4608
  s_waitcnt lgkmcnt(0)
  s_barrier
  s_add_u32 s47, s96, 393216
  s_add_u32 m0, s46, 32768
  s_nop 0
  buffer_load_dwordx4 v8, s[8:11], s47 offen nt lds
  s_add_u32 s47, s96, 1441792
  s_add_u32 m0, s46, 33792
  s_nop 0
  buffer_load_dwordx4 v8, s[8:11], s47 offen nt lds
  v_add_u32 v11, 40960, v10
  ds_read_b64_tr_b16 a[112:113], v11 offset:0
  ds_read_b64_tr_b16 a[114:115], v11 offset:512
  ds_read_b64_tr_b16 a[116:117], v11 offset:4096
  ds_read_b64_tr_b16 a[118:119], v11 offset:4608
  s_waitcnt lgkmcnt(0)
  s_barrier
  s_add_u32 s47, s96, 2359296
  s_add_u32 m0, s46, 40960
  s_nop 0
  buffer_load_dwordx4 v8, s[8:11], s47 offen nt lds
  s_add_u32 s47, s96, 3407872
  s_add_u32 m0, s46, 41984
  s_nop 0
  buffer_load_dwordx4 v8, s[8:11], s47 offen nt lds
  v_add_u32 v11, 49152, v10
  ds_read_b64_tr_b16 a[120:121], v11 offset:0
  ds_read_b64_tr_b16 a[122:123], v11 offset:512
  ds_read_b64_tr_b16 a[124:125], v11 offset:4096
  ds_read_b64_tr_b16 a[126:127], v11 offset:4608
  s_waitcnt lgkmcnt(0)
  s_barrier
  s_add_u32 s47, s96, 2490368
  s_add_u32 m0, s46, 49152
  s_nop 0
  buffer_load_dwordx4 v8, s[8:11], s47 offen nt lds
  s_add_u32 s47, s96, 3538944
  s_add_u32 m0, s46, 50176
  s_nop 0
  buffer_load_dwordx4 v8, s[8:11], s47 offen nt lds
  v_add_u32 v11, 57344, v10
  ds_read_b64_tr_b16 a[128:129], v11 offset:0
  ds_read_b64_tr_b16 a[130:131], v11 offset:512
  ds_read_b64_tr_b16 a[132:133], v11 offset:4096
  ds_read_b64_tr_b16 a[134:135], v11 offset:4608
  s_waitcnt lgkmcnt(0)
  s_waitcnt vmcnt(30)
  s_barrier
  s_add_u32 s47, s96, 4456448
  s_add_u32 m0, s46, 57344
  s_nop 0
  buffer_load_dwordx4 v8, s[8:11], s47 offen nt lds
  s_add_u32 s47, s96, 4587520
  s_add_u32 m0, s46, 58368
  s_nop 0
  buffer_load_dwordx4 v8, s[8:11], s47 offen nt lds
  v_add_u32 v11, 65536, v10
  ds_read_b64_tr_b16 a[136:137], v11 offset:0
  ds_read_b64_tr_b16 a[138:139], v11 offset:512
  ds_read_b64_tr_b16 a[140:141], v11 offset:4096
  ds_read_b64_tr_b16 a[142:143], v11 offset:4608
  s_waitcnt lgkmcnt(0)
  s_waitcnt vmcnt(30)
  s_barrier
  s_add_u32 s47, s96, 524288
  s_add_u32 m0, s46, 65536
  s_nop 0
  buffer_load_dwordx4 v8, s[8:11], s47 offen nt lds
  s_add_u32 s47, s96, 1572864
  s_add_u32 m0, s46, 66560
  s_nop 0
  buffer_load_dwordx4 v8, s[8:11], s47 offen nt lds
  v_add_u32 v11, 73728, v10
  ds_read_b64_tr_b16 a[144:145], v11 offset:0
  ds_read_b64_tr_b16 a[146:147], v11 offset:512
  ds_read_b64_tr_b16 a[148:149], v11 offset:4096
  ds_read_b64_tr_b16 a[150:151], v11 offset:4608
  s_waitcnt lgkmcnt(0)
  s_waitcnt vmcnt(30)
  s_barrier
  s_add_u32 s47, s96, 655360
  s_add_u32 m0, s46, 73728
  s_nop 0
  buffer_load_dwordx4 v8, s[8:11], s47 offen nt lds
  s_add_u32 s47, s96, 1703936
  s_add_u32 m0, s46, 74752
  s_nop 0
  buffer_load_dwordx4 v8, s[8:11], s47 offen nt lds
  v_add_u32 v11, 81920, v10
  ds_read_b64_tr_b16 a[152:153], v11 offset:0
  ds_read_b64_tr_b16 a[154:155], v11 offset:512
  ds_read_b64_tr_b16 a[156:157], v11 offset:4096
  ds_read_b64_tr_b16 a[158:159], v11 offset:4608
  s_waitcnt lgkmcnt(0)
  s_waitcnt vmcnt(30)
  s_barrier
  s_add_u32 s47, s96, 2621440
  s_add_u32 m0, s46, 81920
  s_nop 0
  buffer_load_dwordx4 v8, s[8:11], s47 offen nt lds
  s_add_u32 s47, s96, 3670016
  s_add_u32 m0, s46, 82944
  s_nop 0
  buffer_load_dwordx4 v8, s[8:11], s47 offen nt lds
  v_add_u32 v11, 90112, v10
  ds_read_b64_tr_b16 a[160:161], v11 offset:0
  ds_read_b64_tr_b16 a[162:163], v11 offset:512
  ds_read_b64_tr_b16 a[164:165], v11 offset:4096
  ds_read_b64_tr_b16 a[166:167], v11 offset:4608
  s_waitcnt lgkmcnt(0)
  s_waitcnt vmcnt(30)
  s_barrier
  s_add_u32 s47, s96, 2752512
  s_add_u32 m0, s46, 90112
  s_nop 0
  buffer_load_dwordx4 v8, s[8:11], s47 offen nt lds
  s_add_u32 s47, s96, 3801088
  s_add_u32 m0, s46, 91136
  s_nop 0
  buffer_load_dwordx4 v8, s[8:11], s47 offen nt lds
  v_add_u32 v11, 98304, v10
  ds_read_b64_tr_b16 a[168:169], v11 offset:0
  ds_read_b64_tr_b16 a[170:171], v11 offset:512
  ds_read_b64_tr_b16 a[172:173], v11 offset:4096
  ds_read_b64_tr_b16 a[174:175], v11 offset:4608
  s_waitcnt lgkmcnt(0)
  s_load_dwordx4 s[64:67], s[76:77], 0
  s_load_dwordx4 s[68:71], s[76:77], 128
  s_waitcnt lgkmcnt(0)
  s_mov_b32 s88, 1
  s_cmp_eq_u32 s64, 32
  s_cselect_b32 s88, s88, 0
  s_cmp_eq_u32 s68, 32
  s_cselect_b32 s88, s88, 0
  s_cmp_eq_u32 s65, 32
  s_cselect_b32 s88, s88, 0
  s_cmp_eq_u32 s69, 32
  s_cselect_b32 s88, s88, 0
  s_cmp_eq_u32 s66, 32
  s_cselect_b32 s88, s88, 0
  s_cmp_eq_u32 s70, 32
  s_cselect_b32 s88, s88, 0
  s_cmp_eq_u32 s67, 32
  s_cselect_b32 s88, s88, 0
  s_cmp_eq_u32 s71, 32
  s_cselect_b32 s88, s88, 0
  s_or_b32 s3, s3, s88
  s_cmp_eq_u32 s3, 0
  s_cbranch_scc1 L_CF2
L_CR2:
  v_mov_b32 v54, 1
  v_mov_b32 v55, 1
  v_mov_b32 v56, 1
  v_mov_b32 v57, 1
  buffer_store_dwordx4 v[54:57], v5, s[4:7], s19 offen
  buffer_store_dwordx4 v[54:57], v5, s[4:7], s20 offen
  v_bfe_u32 v59, v5, 14, 1
  v_and_b32 v58, 0x20f0, v5
  v_lshl_or_b32 v58, v59, 3, v58
  buffer_store_dwordx2 v[54:55], v58, s[4:7], s21 offen
  s_cmp_eq_u32 s24, 0
  s_cbranch_scc1 IX_5
  v_lshrrev_b32 v58, 8, v0
  v_lshlrev_b32 v58, 7, v58
  v_and_b32 v59, 0x30, v0
  v_add_u32 v58, v58, v59
  v_bfe_u32 v59, v0, 6, 1
  v_lshl_add_u32 v58, v59, 3, v58
  v_mov_b32 v60, -1
  v_mov_b32 v61, -1
  s_add_u32 s47, s23, 458752
  buffer_store_dwordx2 v[60:61], v58, s[4:7], s47 offen
  s_add_u32 s47, s23, 468992
  buffer_store_dwordx2 v[60:61], v58, s[4:7], s47 offen
  s_add_u32 s47, s23, 479232
  buffer_store_dwordx2 v[60:61], v58, s[4:7], s47 offen
  s_add_u32 s47, s23, 489472
  buffer_store_dwordx2 v[60:61], v58, s[4:7], s47 offen
IX_5:
  s_waitcnt vmcnt(33)
  s_barrier
  s_add_u32 s47, s96, 4718592
  s_add_u32 m0, s46, 98304
  s_nop 0
  buffer_load_dwordx4 v8, s[8:11], s47 offen nt lds
  s_add_u32 s47, s96, 4849664
  s_add_u32 m0, s46, 99328
  s_nop 0
  buffer_load_dwordx4 v8, s[8:11], s47 offen nt lds
  v_add_u32 v11, 106496, v10
  ds_read_b64_tr_b16 a[176:177], v11 offset:0
  ds_read_b64_tr_b16 a[178:179], v11 offset:512
  ds_read_b64_tr_b16 a[180:181], v11 offset:4096
  ds_read_b64_tr_b16 a[182:183], v11 offset:4608
  s_waitcnt lgkmcnt(0)
  s_waitcnt vmcnt(33)
  s_barrier
  s_add_u32 s47, s96, 786432
  s_add_u32 m0, s46, 106496
  s_nop 0
  buffer_load_dwordx4 v8, s[8:11], s47 offen nt lds
  s_add_u32 s47, s96, 1835008
  s_add_u32 m0, s46, 107520
  s_nop 0
  buffer_load_dwordx4 v8, s[8:11], s47 offen nt lds
  v_add_u32 v11, 114688, v10
  ds_read_b64_tr_b16 a[184:185], v11 offset:0
  ds_read_b64_tr_b16 a[186:187], v11 offset:512
  ds_read_b64_tr_b16 a[188:189], v11 offset:4096
  ds_read_b64_tr_b16 a[190:191], v11 offset:4608
  s_waitcnt lgkmcnt(0)
  s_waitcnt vmcnt(33)
  s_barrier
  s_add_u32 s47, s96, 917504
  s_add_u32 m0, s46, 114688
  s_nop 0
  buffer_load_dwordx4 v8, s[8:11], s47 offen nt lds
  s_add_u32 s47, s96, 1966080
  s_add_u32 m0, s46, 115712
  s_nop 0
  buffer_load_dwordx4 v8, s[8:11], s47 offen nt lds
  v_add_u32 v11, 122880, v10
  ds_read_b64_tr_b16 a[192:193], v11 offset:0
  ds_read_b64_tr_b16 a[194:195], v11 offset:512
  ds_read_b64_tr_b16 a[196:197], v11 offset:4096
  ds_read_b64_tr_b16 a[198:199], v11 offset:4608
  s_waitcnt lgkmcnt(0)
  s_waitcnt vmcnt(33)
  s_barrier
  s_add_u32 s47, s96, 2883584
  s_add_u32 m0, s46, 122880
  s_nop 0
  buffer_load_dwordx4 v8, s[8:11], s47 offen nt lds
  s_add_u32 s47, s96, 3932160
  s_add_u32 m0, s46, 123904
  s_nop 0
  buffer_load_dwordx4 v8, s[8:11], s47 offen nt lds
  v_add_u32 v11, 131072, v10
  ds_read_b64_tr_b16 a[200:201], v11 offset:0
  ds_read_b64_tr_b16 a[202:203], v11 offset:512
  ds_read_b64_tr_b16 a[204:205], v11 offset:4096
  ds_read_b64_tr_b16 a[206:207], v11 offset:4608
  s_waitcnt lgkmcnt(0)
  s_waitcnt vmcnt(33)
  s_barrier
  s_add_u32 s47, s96, 3014656
  s_add_u32 m0, s46, 131072
  s_nop 0
  buffer_load_dwordx4 v8, s[8:11], s47 offen nt lds
  s_add_u32 s47, s96, 4063232
  s_add_u32 m0, s46, 132096
  s_nop 0
  buffer_load_dwordx4 v8, s[8:11], s47 offen nt lds
  v_add_u32 v11, 139264, v10
  ds_read_b64_tr_b16 a[208:209], v11 offset:0
  ds_read_b64_tr_b16 a[210:211], v11 offset:512
  ds_read_b64_tr_b16 a[212:213], v11 offset:4096
  ds_read_b64_tr_b16 a[214:215], v11 offset:4608
  s_waitcnt lgkmcnt(0)
  s_waitcnt vmcnt(33)
  s_barrier
  s_add_u32 s47, s96, 4980736
  s_add_u32 m0, s46, 139264
  s_nop 0
  buffer_load_dwordx4 v8, s[8:11], s47 offen nt lds
  s_add_u32 s47, s96, 5111808
  s_add_u32 m0, s46, 140288
  s_nop 0
  buffer_load_dwordx4 v8, s[8:11], s47 offen nt lds
  v_add_u32 v11, 147456, v10
  ds_read_b64_tr_b16 a[216:217], v11 offset:0
  ds_read_b64_tr_b16 a[218:219], v11 offset:512
  ds_read_b64_tr_b16 a[220:221], v11 offset:4096
  ds_read_b64_tr_b16 a[222:223], v11 offset:4608
  s_waitcnt lgkmcnt(0)
  s_waitcnt vmcnt(33)
  s_barrier
  s_mov_b32 s8, s62
  s_and_b32 s9, s63, 0xffff
  s_mov_b32 s10, 5242880
  s_mov_b32 s11, 0x20000
  s_add_u32 s47, s97, 0
  s_add_u32 m0, s46, 147456
  s_nop 0
  buffer_load_dwordx4 v9, s[8:11], s47 offen nt lds
  s_add_u32 s47, s97, 20480
  s_add_u32 m0, s46, 148480
  s_nop 0
  buffer_load_dwordx4 v9, s[8:11], s47 offen nt lds
  v_add_u32 v11, 155648, v10
  ds_read_b64_tr_b16 a[224:225], v11 offset:0
  ds_read_b64_tr_b16 a[226:227], v11 offset:512
  ds_read_b64_tr_b16 a[228:229], v11 offset:4096
  ds_read_b64_tr_b16 a[230:231], v11 offset:4608
  s_waitcnt lgkmcnt(0)
  s_waitcnt vmcnt(33)
  s_barrier
  s_add_u32 s47, s97, 81920
  s_add_u32 m0, s46, 155648
  s_nop 0
  buffer_load_dwordx4 v9, s[8:11], s47 offen nt lds
  s_add_u32 s47, s97, 102400
  s_add_u32 m0, s46, 156672
  s_nop 0
  buffer_load_dwordx4 v9, s[8:11], s47 offen nt lds
  v_add_u32 v11, 24576, v10
  ds_read_b64_tr_b16 a[232:233], v11 offset:0
  ds_read_b64_tr_b16 a[234:235], v11 offset:512
  ds_read_b64_tr_b16 a[236:237], v11 offset:4096
  ds_read_b64_tr_b16 a[238:239], v11 offset:4608
  s_waitcnt lgkmcnt(0)
  s_waitcnt vmcnt(33)
  s_barrier
  s_add_u32 s47, s97, 256
  s_add_u32 m0, s46, 24576
  s_nop 0
  buffer_load_dwordx4 v9, s[8:11], s47 offen nt lds
  s_add_u32 s47, s97, 20736
  s_add_u32 m0, s46, 25600
  s_nop 0
  buffer_load_dwordx4 v9, s[8:11], s47 offen nt lds
  v_add_u32 v11, 32768, v10
  ds_read_b64_tr_b16 a[240:241], v11 offset:0
  ds_read_b64_tr_b16 a[242:243], v11 offset:512
  ds_read_b64_tr_b16 a[244:245], v11 offset:4096
  ds_read_b64_tr_b16 a[246:247], v11 offset:4608
  s_waitcnt lgkmcnt(0)
  s_waitcnt vmcnt(33)
  s_barrier
  s_add_u32 s47, s97, 82176
  s_add_u32 m0, s46, 32768
  s_nop 0
  buffer_load_dwordx4 v9, s[8:11], s47 offen nt lds
  s_add_u32 s47, s97, 102656
  s_add_u32 m0, s46, 33792
  s_nop 0
  buffer_load_dwordx4 v9, s[8:11], s47 offen nt lds
  v_add_u32 v11, 40960, v10
  ds_read_b64_tr_b16 a[248:249], v11 offset:0
  ds_read_b64_tr_b16 a[250:251], v11 offset:512
  ds_read_b64_tr_b16 a[252:253], v11 offset:4096
  ds_read_b64_tr_b16 a[254:255], v11 offset:4608
  s_waitcnt lgkmcnt(0)
  s_waitcnt vmcnt(33)
  s_barrier
  s_add_u32 s47, s97, 512
  s_add_u32 m0, s46, 40960
  s_nop 0
  buffer_load_dwordx4 v9, s[8:11], s47 offen nt lds
  s_add_u32 s47, s97, 20992
  s_add_u32 m0, s46, 41984
  s_nop 0
  buffer_load_dwordx4 v9, s[8:11], s47 offen nt lds
  v_add_u32 v11, 49152, v10
  ds_read_b64_tr_b16 v[72:73], v11 offset:0
  ds_read_b64_tr_b16 v[74:75], v11 offset:512
  ds_read_b64_tr_b16 v[76:77], v11 offset:4096
  ds_read_b64_tr_b16 v[78:79], v11 offset:4608
  s_waitcnt lgkmcnt(0)
  s_waitcnt vmcnt(33)
  s_barrier
  s_add_u32 s47, s97, 82432
  s_add_u32 m0, s46, 49152
  s_nop 0
  buffer_load_dwordx4 v9, s[8:11], s47 offen nt lds
  s_add_u32 s47, s97, 102912
  s_add_u32 m0, s46, 50176
  s_nop 0
  buffer_load_dwordx4 v9, s[8:11], s47 offen nt lds
  v_add_u32 v11, 57344, v10
  ds_read_b64_tr_b16 v[80:81], v11 offset:0
  ds_read_b64_tr_b16 v[82:83], v11 offset:512
  ds_read_b64_tr_b16 v[84:85], v11 offset:4096
  ds_read_b64_tr_b16 v[86:87], v11 offset:4608
  s_waitcnt lgkmcnt(0)
  s_waitcnt vmcnt(33)
  s_barrier
  s_add_u32 s47, s97, 768
  s_add_u32 m0, s46, 57344
  s_nop 0
  buffer_load_dwordx4 v9, s[8:11], s47 offen nt lds
  s_add_u32 s47, s97, 21248
  s_add_u32 m0, s46, 58368
  s_nop 0
  buffer_load_dwordx4 v9, s[8:11], s47 offen nt lds
  v_add_u32 v11, 65536, v10
  ds_read_b64_tr_b16 v[88:89], v11 offset:0
  ds_read_b64_tr_b16 v[90:91], v11 offset:512
  ds_read_b64_tr_b16 v[92:93], v11 offset:4096
  ds_read_b64_tr_b16 v[94:95], v11 offset:4608
  s_waitcnt lgkmcnt(0)
  s_waitcnt vmcnt(33)
  s_barrier
  s_add_u32 s47, s97, 82688
  s_add_u32 m0, s46, 65536
  s_nop 0
  buffer_load_dwordx4 v9, s[8:11], s47 offen nt lds
  s_add_u32 s47, s97, 103168
  s_add_u32 m0, s46, 66560
  s_nop 0
  buffer_load_dwordx4 v9, s[8:11], s47 offen nt lds
  v_add_u32 v11, 73728, v10
  ds_read_b64_tr_b16 v[96:97], v11 offset:0
  ds_read_b64_tr_b16 v[98:99], v11 offset:512
  ds_read_b64_tr_b16 v[100:101], v11 offset:4096
  ds_read_b64_tr_b16 v[102:103], v11 offset:4608
  s_waitcnt lgkmcnt(0)
  s_waitcnt vmcnt(33)
  s_barrier
  s_add_u32 s47, s97, 1024
  s_add_u32 m0, s46, 73728
  s_nop 0
  buffer_load_dwordx4 v9, s[8:11], s47 offen nt lds
  s_add_u32 s47, s97, 21504
  s_add_u32 m0, s46, 74752
  s_nop 0
  buffer_load_dwordx4 v9, s[8:11], s47 offen nt lds
  v_add_u32 v11, 81920, v10
  ds_read_b64_tr_b16 v[104:105], v11 offset:0
  ds_read_b64_tr_b16 v[106:107], v11 offset:512
  ds_read_b64_tr_b16 v[108:109], v11 offset:4096
  ds_read_b64_tr_b16 v[110:111], v11 offset:4608
  s_waitcnt lgkmcnt(0)
  s_waitcnt vmcnt(33)
  s_barrier
  s_add_u32 s47, s97, 82944
  s_add_u32 m0, s46, 81920
  s_nop 0
  buffer_load_dwordx4 v9, s[8:11], s47 offen nt lds
  s_add_u32 s47, s97, 103424
  s_add_u32 m0, s46, 82944
  s_nop 0
  buffer_load_dwordx4 v9, s[8:11], s47 offen nt lds
  v_add_u32 v11, 90112, v10
  ds_read_b64_tr_b16 v[112:113], v11 offset:0
  ds_read_b64_tr_b16 v[114:115], v11 offset:512
  ds_read_b64_tr_b16 v[116:117], v11 offset:4096
  ds_read_b64_tr_b16 v[118:119], v11 offset:4608
  s_waitcnt lgkmcnt(0)
  s_waitcnt vmcnt(30)
  s_barrier
  s_add_u32 s47, s97, 123904
  s_add_u32 m0, s46, 90112
  s_nop 0
  buffer_load_dwordx4 v9, s[8:11], s47 offen nt lds
  s_add_u32 s47, s97, 144384
  s_add_u32 m0, s46, 91136
  s_nop 0
  buffer_load_dwordx4 v9, s[8:11], s47 offen nt lds
  v_add_u32 v11, 98304, v10
  ds_read_b64_tr_b16 v[120:121], v11 offset:0
  ds_read_b64_tr_b16 v[122:123], v11 offset:512
  ds_read_b64_tr_b16 v[124:125], v11 offset:4096
  ds_read_b64_tr_b16 v[126:127], v11 offset:4608
  s_waitcnt lgkmcnt(0)
  s_waitcnt vmcnt(30)
  s_barrier
  s_mov_b32 s8, s56
  s_and_b32 s9, s57, 0xffff
  s_mov_b32 s10, 5242880
  s_mov_b32 s11, 0x20000
  s_add_u32 s47, s96, 0
  s_add_u32 m0, s46, 98304
  s_nop 0
  buffer_load_dwordx4 v8, s[8:11], s47 offen nt lds
  s_add_u32 s47, s96, 1048576
  s_add_u32 m0, s46, 99328
  s_nop 0
  buffer_load_dwordx4 v8, s[8:11], s47 offen nt lds
  v_add_u32 v11, 106496, v10
  ds_read_b64_tr_b16 v[128:129], v11 offset:0
  ds_read_b64_tr_b16 v[130:131], v11 offset:512
  ds_read_b64_tr_b16 v[132:133], v11 offset:4096
  ds_read_b64_tr_b16 v[134:135], v11 offset:4608
  s_waitcnt lgkmcnt(0)
  s_waitcnt vmcnt(30)
  s_barrier
  s_mov_b32 s8, s58
  s_and_b32 s9, s59, 0xffff
  s_mov_b32 s10, 5242880
  s_mov_b32 s11, 0x20000
  s_add_u32 s47, s96, 0
  s_add_u32 m0, s46, 106496
  s_nop 0
  buffer_load_dwordx4 v8, s[8:11], s47 offen nt lds
  s_add_u32 s47, s96, 1048576
  s_add_u32 m0, s46, 107520
  s_nop 0
  buffer_load_dwordx4 v8, s[8:11], s47 offen nt lds
  v_add_u32 v11, 114688, v10
  ds_read_b64_tr_b16 v[136:137], v11 offset:0
  ds_read_b64_tr_b16 v[138:139], v11 offset:512
  ds_read_b64_tr_b16 v[140:141], v11 offset:4096
  ds_read_b64_tr_b16 v[142:143], v11 offset:4608
  s_waitcnt lgkmcnt(0)
  s_cmp_lg_u32 s13, 0
  s_cbranch_scc1 TBs_6
  s_lshl_b32 s47, s12, 2
  v_mov_b32 v36, s47
  v_mov_b32 v37, 1
  buffer_store_dword v37, v36, s[4:7], 0 offen offset:1024
TBs_6:
  s_waitcnt vmcnt(30)
  s_barrier
  s_mov_b32 s8, s56
  s_and_b32 s9, s57, 0xffff
  s_mov_b32 s10, 5242880
  s_mov_b32 s11, 0x20000
  s_add_u32 s47, s96, 393216
  s_add_u32 m0, s46, 114688
  s_nop 0
  buffer_load_dwordx4 v8, s[8:11], s47 offen nt lds
  s_add_u32 s47, s96, 1441792
  s_add_u32 m0, s46, 115712
  s_nop 0
  buffer_load_dwordx4 v8, s[8:11], s47 offen nt lds
  v_add_u32 v11, 122880, v10
  ds_read_b64_tr_b16 v[144:145], v11 offset:0
  ds_read_b64_tr_b16 v[146:147], v11 offset:512
  ds_read_b64_tr_b16 v[148:149], v11 offset:4096
  ds_read_b64_tr_b16 v[150:151], v11 offset:4608
  s_waitcnt lgkmcnt(0)
  s_waitcnt vmcnt(30)
  s_barrier
  s_mov_b32 s8, s58
  s_and_b32 s9, s59, 0xffff
  s_mov_b32 s10, 5242880
  s_mov_b32 s11, 0x20000
  s_add_u32 s47, s96, 2359296
  s_add_u32 m0, s46, 122880
  s_nop 0
  buffer_load_dwordx4 v8, s[8:11], s47 offen nt lds
  s_add_u32 s47, s96, 3407872
  s_add_u32 m0, s46, 123904
  s_nop 0
  buffer_load_dwordx4 v8, s[8:11], s47 offen nt lds
  v_add_u32 v11, 131072, v10
  ds_read_b64_tr_b16 v[152:153], v11 offset:0
  ds_read_b64_tr_b16 v[154:155], v11 offset:512
  ds_read_b64_tr_b16 v[156:157], v11 offset:4096
  ds_read_b64_tr_b16 v[158:159], v11 offset:4608
  s_waitcnt lgkmcnt(0)
  s_waitcnt vmcnt(30)
  s_barrier
  s_mov_b32 s8, s56
  s_and_b32 s9, s57, 0xffff
  s_mov_b32 s10, 5242880
  s_mov_b32 s11, 0x20000
  s_add_u32 s47, s96, 2752512
  s_add_u32 m0, s46, 131072
  s_nop 0
  buffer_load_dwordx4 v8, s[8:11], s47 offen nt lds
  s_add_u32 s47, s96, 3801088
  s_add_u32 m0, s46, 132096
  s_nop 0
  buffer_load_dwordx4 v8, s[8:11], s47 offen nt lds
  v_add_u32 v11, 139264, v10
  ds_read_b64_tr_b16 v[160:161], v11 offset:0
  ds_read_b64_tr_b16 v[162:163], v11 offset:512
  ds_read_b64_tr_b16 v[164:165], v11 offset:4096
  ds_read_b64_tr_b16 v[166:167], v11 offset:4608
  s_waitcnt lgkmcnt(0)
  s_waitcnt vmcnt(30)
  s_barrier
  s_mov_b32 s8, s58
  s_and_b32 s9, s59, 0xffff
  s_mov_b32 s10, 5242880
  s_mov_b32 s11, 0x20000
  s_add_u32 s47, s96, 786432
  s_add_u32 m0, s46, 139264
  s_nop 0
  buffer_load_dwordx4 v8, s[8:11], s47 offen nt lds
  s_add_u32 s47, s96, 1835008
  s_add_u32 m0, s46, 140288
  s_nop 0
  buffer_load_dwordx4 v8, s[8:11], s47 offen nt lds
  v_add_u32 v11, 147456, v10
  ds_read_b64_tr_b16 v[168:169], v11 offset:0
  ds_read_b64_tr_b16 v[170:171], v11 offset:512
  ds_read_b64_tr_b16 v[172:173], v11 offset:4096
  ds_read_b64_tr_b16 v[174:175], v11 offset:4608
  s_waitcnt lgkmcnt(0)
  s_waitcnt vmcnt(30)
  s_barrier
  s_mov_b32 s8, s56
  s_and_b32 s9, s57, 0xffff
  s_mov_b32 s10, 5242880
  s_mov_b32 s11, 0x20000
  s_add_u32 s47, s96, 3014656
  s_add_u32 m0, s46, 147456
  s_nop 0
  buffer_load_dwordx4 v8, s[8:11], s47 offen nt lds
  s_add_u32 s47, s96, 4063232
  s_add_u32 m0, s46, 148480
  s_nop 0
  buffer_load_dwordx4 v8, s[8:11], s47 offen nt lds
  v_add_u32 v11, 155648, v10
  ds_read_b64_tr_b16 v[176:177], v11 offset:0
  ds_read_b64_tr_b16 v[178:179], v11 offset:512
  ds_read_b64_tr_b16 v[180:181], v11 offset:4096
  ds_read_b64_tr_b16 v[182:183], v11 offset:4608
  s_waitcnt lgkmcnt(0)
  s_waitcnt vmcnt(30)
  s_barrier
  s_mov_b32 s8, s58
  s_and_b32 s9, s59, 0xffff
  s_mov_b32 s10, 5242880
  s_mov_b32 s11, 0x20000
  s_add_u32 s47, s96, 4980736
  s_add_u32 m0, s46, 155648
  s_nop 0
  buffer_load_dwordx4 v8, s[8:11], s47 offen nt lds
  s_add_u32 s47, s96, 5111808
  s_add_u32 m0, s46, 156672
  s_nop 0
  buffer_load_dwordx4 v8, s[8:11], s47 offen nt lds
  v_add_u32 v11, 24576, v10
  ds_read_b64_tr_b16 v[184:185], v11 offset:0
  ds_read_b64_tr_b16 v[186:187], v11 offset:512
  ds_read_b64_tr_b16 v[188:189], v11 offset:4096
  ds_read_b64_tr_b16 v[190:191], v11 offset:4608
  s_waitcnt lgkmcnt(0)
  s_waitcnt vmcnt(30)
  s_barrier
  s_add_u32 s47, s96, 2097152
  s_add_u32 m0, s46, 24576
  s_nop 0
  buffer_load_dwordx4 v8, s[8:11], s47 offen nt lds
  s_add_u32 s47, s96, 3145728
  s_add_u32 m0, s46, 25600
  s_nop 0
  buffer_load_dwordx4 v8, s[8:11], s47 offen nt lds
  v_add_u32 v11, 32768, v10
  ds_read_b64_tr_b16 v[192:193], v11 offset:0
  ds_read_b64_tr_b16 v[194:195], v11 offset:512
  ds_read_b64_tr_b16 v[196:197], v11 offset:4096
  ds_read_b64_tr_b16 v[198:199], v11 offset:4608
  s_waitcnt lgkmcnt(0)
  s_waitcnt vmcnt(30)
  s_barrier
  s_add_u32 s47, s96, 4194304
  s_add_u32 m0, s46, 32768
  s_nop 0
  buffer_load_dwordx4 v8, s[8:11], s47 offen nt lds
  s_add_u32 s47, s96, 4325376
  s_add_u32 m0, s46, 33792
  s_nop 0
  buffer_load_dwordx4 v8, s[8:11], s47 offen nt lds
  v_add_u32 v11, 40960, v10
  ds_read_b64_tr_b16 v[200:201], v11 offset:0
  ds_read_b64_tr_b16 v[202:203], v11 offset:512
  ds_read_b64_tr_b16 v[204:205], v11 offset:4096
  ds_read_b64_tr_b16 v[206:207], v11 offset:4608
  s_waitcnt lgkmcnt(0)
  s_waitcnt vmcnt(30)
  s_barrier
  s_add_u32 s47, s96, 393216
  s_add_u32 m0, s46, 40960
  s_nop 0
  buffer_load_dwordx4 v8, s[8:11], s47 offen nt lds
  s_add_u32 s47, s96, 1441792
  s_add_u32 m0, s46, 41984
  s_nop 0
  buffer_load_dwordx4 v8, s[8:11], s47 offen nt lds
  v_add_u32 v11, 49152, v10
  ds_read_b64_tr_b16 v[208:209], v11 offset:0
  ds_read_b64_tr_b16 v[210:211], v11 offset:512
  ds_read_b64_tr_b16 v[212:213], v11 offset:4096
  ds_read_b64_tr_b16 v[214:215], v11 offset:4608
  s_waitcnt lgkmcnt(0)
  s_waitcnt vmcnt(30)
  s_barrier
  s_add_u32 s47, s96, 2490368
  s_add_u32 m0, s46, 49152
  s_nop 0
  buffer_load_dwordx4 v8, s[8:11], s47 offen nt lds
  s_add_u32 s47, s96, 3538944
  s_add_u32 m0, s46, 50176
  s_nop 0
  buffer_load_dwordx4 v8, s[8:11], s47 offen nt lds
  v_add_u32 v11, 57344, v10
  ds_read_b64_tr_b16 v[216:217], v11 offset:0
  ds_read_b64_tr_b16 v[218:219], v11 offset:512
  ds_read_b64_tr_b16 v[220:221], v11 offset:4096
  ds_read_b64_tr_b16 v[222:223], v11 offset:4608
  s_waitcnt lgkmcnt(0)
  s_waitcnt vmcnt(30)
  s_barrier
  s_add_u32 s47, s96, 524288
  s_add_u32 m0, s46, 57344
  s_nop 0
  buffer_load_dwordx4 v8, s[8:11], s47 offen nt lds
  s_add_u32 s47, s96, 1572864
  s_add_u32 m0, s46, 58368
  s_nop 0
  buffer_load_dwordx4 v8, s[8:11], s47 offen nt lds
  v_add_u32 v11, 65536, v10
  ds_read_b64_tr_b16 v[224:225], v11 offset:0
  ds_read_b64_tr_b16 v[226:227], v11 offset:512
  ds_read_b64_tr_b16 v[228:229], v11 offset:4096
  ds_read_b64_tr_b16 v[230:231], v11 offset:4608
  s_waitcnt lgkmcnt(0)
  s_waitcnt vmcnt(30)
  s_barrier
  s_add_u32 s47, s96, 2621440
  s_add_u32 m0, s46, 65536
  s_nop 0
  buffer_load_dwordx4 v8, s[8:11], s47 offen nt lds
  s_add_u32 s47, s96, 3670016
  s_add_u32 m0, s46, 66560
  s_nop 0
  buffer_load_dwordx4 v8, s[8:11], s47 offen nt lds
  v_add_u32 v11, 73728, v10
  ds_read_b64_tr_b16 v[232:233], v11 offset:0
  ds_read_b64_tr_b16 v[234:235], v11 offset:512
  ds_read_b64_tr_b16 v[236:237], v11 offset:4096
  ds_read_b64_tr_b16 v[238:239], v11 offset:4608
  s_waitcnt lgkmcnt(0)
  s_waitcnt vmcnt(30)
  s_barrier
  s_add_u32 s47, s96, 4718592
  s_add_u32 m0, s46, 73728
  s_nop 0
  buffer_load_dwordx4 v8, s[8:11], s47 offen nt lds
  s_add_u32 s47, s96, 4849664
  s_add_u32 m0, s46, 74752
  s_nop 0
  buffer_load_dwordx4 v8, s[8:11], s47 offen nt lds
  v_add_u32 v11, 81920, v10
  ds_read_b64_tr_b16 v[240:241], v11 offset:0
  ds_read_b64_tr_b16 v[242:243], v11 offset:512
  ds_read_b64_tr_b16 v[244:245], v11 offset:4096
  ds_read_b64_tr_b16 v[246:247], v11 offset:4608
  s_waitcnt lgkmcnt(0)
  s_waitcnt vmcnt(30)
  s_barrier
  s_add_u32 s47, s96, 917504
  s_add_u32 m0, s46, 81920
  s_nop 0
  buffer_load_dwordx4 v8, s[8:11], s47 offen nt lds
  s_add_u32 s47, s96, 1966080
  s_add_u32 m0, s46, 82944
  s_nop 0
  buffer_load_dwordx4 v8, s[8:11], s47 offen nt lds
  v_add_u32 v11, 90112, v10
  ds_read_b64_tr_b16 v[248:249], v11 offset:0
  ds_read_b64_tr_b16 v[250:251], v11 offset:512
  ds_read_b64_tr_b16 v[252:253], v11 offset:4096
  ds_read_b64_tr_b16 v[254:255], v11 offset:4608
  s_waitcnt lgkmcnt(0)
  s_waitcnt vmcnt(30)
  s_barrier
  s_mov_b32 s8, s62
  s_and_b32 s9, s63, 0xffff
  s_mov_b32 s10, 5242880
  s_mov_b32 s11, 0x20000
  s_add_u32 s47, s97, 40960
  s_add_u32 m0, s46, 90112
  s_nop 0
  buffer_load_dwordx4 v9, s[8:11], s47 offen nt lds
  s_add_u32 s47, s97, 61440
  s_add_u32 m0, s46, 91136
  s_nop 0
  buffer_load_dwordx4 v9, s[8:11], s47 offen nt lds
  v_add_u32 v11, 98304, v10
  ds_read_b64_tr_b16 v[40:41], v11 offset:0
  ds_read_b64_tr_b16 v[42:43], v11 offset:512
  ds_read_b64_tr_b16 v[44:45], v11 offset:4096
  ds_read_b64_tr_b16 v[46:47], v11 offset:4608
  s_waitcnt lgkmcnt(0)
  s_add_u32 s48, s45, 0
  buffer_store_dwordx4 v[40:43], v0, s[4:7], s48 offen
  buffer_store_dwordx4 v[44:47], v0, s[4:7], s48 offen offset:1024
  s_waitcnt vmcnt(32)
  s_barrier
  s_add_u32 s47, s97, 122880
  s_add_u32 m0, s46, 98304
  s_nop 0
  buffer_load_dwordx4 v9, s[8:11], s47 offen nt lds
  s_add_u32 s47, s97, 143360
  s_add_u32 m0, s46, 99328
  s_nop 0
  buffer_load_dwordx4 v9, s[8:11], s47 offen nt lds
  v_add_u32 v11, 106496, v10
  ds_read_b64_tr_b16 v[48:49], v11 offset:0
  ds_read_b64_tr_b16 v[50:51], v11 offset:512
  ds_read_b64_tr_b16 v[52:53], v11 offset:4096
  ds_read_b64_tr_b16 v[54:55], v11 offset:4608
  s_waitcnt lgkmcnt(0)
  s_add_u32 s48, s45, 2048
  buffer_store_dwordx4 v[48:51], v0, s[4:7], s48 offen
  buffer_store_dwordx4 v[52:55], v0, s[4:7], s48 offen offset:1024
  s_waitcnt vmcnt(34)
  s_barrier
  s_add_u32 s47, s97, 41216
  s_add_u32 m0, s46, 106496
  s_nop 0
  buffer_load_dwordx4 v9, s[8:11], s47 offen nt lds
  s_add_u32 s47, s97, 61696
  s_add_u32 m0, s46, 107520
  s_nop 0
  buffer_load_dwordx4 v9, s[8:11], s47 offen nt lds
  v_add_u32 v11, 114688, v10
  ds_read_b64_tr_b16 v[56:57], v11 offset:0
  ds_read_b64_tr_b16 v[58:59], v11 offset:512
  ds_read_b64_tr_b16 v[60:61], v11 offset:4096
  ds_read_b64_tr_b16 v[62:63], v11 offset:4608
  s_waitcnt lgkmcnt(0)
  s_add_u32 s48, s45, 4096
  buffer_store_dwordx4 v[56:59], v0, s[4:7], s48 offen
  buffer_store_dwordx4 v[60:63], v0, s[4:7], s48 offen offset:1024
  s_waitcnt vmcnt(36)
  s_barrier
  s_add_u32 s47, s97, 123136
  s_add_u32 m0, s46, 114688
  s_nop 0
  buffer_load_dwordx4 v9, s[8:11], s47 offen nt lds
  s_add_u32 s47, s97, 143616
  s_add_u32 m0, s46, 115712
  s_nop 0
  buffer_load_dwordx4 v9, s[8:11], s47 offen nt lds
  v_add_u32 v11, 122880, v10
  ds_read_b64_tr_b16 v[12:13], v11 offset:0
  ds_read_b64_tr_b16 v[14:15], v11 offset:512
  ds_read_b64_tr_b16 v[16:17], v11 offset:4096
  ds_read_b64_tr_b16 v[18:19], v11 offset:4608
  s_waitcnt lgkmcnt(0)
  s_add_u32 s48, s45, 6144
  buffer_store_dwordx4 v[12:15], v0, s[4:7], s48 offen
  buffer_store_dwordx4 v[16:19], v0, s[4:7], s48 offen offset:1024
  s_waitcnt vmcnt(38)
  s_barrier
  s_add_u32 s47, s97, 41472
  s_add_u32 m0, s46, 122880
  s_nop 0
  buffer_load_dwordx4 v9, s[8:11], s47 offen nt lds
  s_add_u32 s47, s97, 61952
  s_add_u32 m0, s46, 123904
  s_nop 0
  buffer_load_dwordx4 v9, s[8:11], s47 offen nt lds
  v_add_u32 v11, 131072, v10
  ds_read_b64_tr_b16 v[20:21], v11 offset:0
  ds_read_b64_tr_b16 v[22:23], v11 offset:512
  ds_read_b64_tr_b16 v[24:25], v11 offset:4096
  ds_read_b64_tr_b16 v[26:27], v11 offset:4608
  s_waitcnt lgkmcnt(0)
  s_add_u32 s48, s45, 8192
  buffer_store_dwordx4 v[20:23], v0, s[4:7], s48 offen
  buffer_store_dwordx4 v[24:27], v0, s[4:7], s48 offen offset:1024
  s_waitcnt vmcnt(40)
  s_barrier
  s_add_u32 s47, s97, 123392
  s_add_u32 m0, s46, 131072
  s_nop 0
  buffer_load_dwordx4 v9, s[8:11], s47 offen nt lds
  s_add_u32 s47, s97, 143872
  s_add_u32 m0, s46, 132096
  s_nop 0
  buffer_load_dwordx4 v9, s[8:11], s47 offen nt lds
  v_add_u32 v11, 139264, v10
  ds_read_b64_tr_b16 v[12:13], v11 offset:0
  ds_read_b64_tr_b16 v[14:15], v11 offset:512
  ds_read_b64_tr_b16 v[16:17], v11 offset:4096
  ds_read_b64_tr_b16 v[18:19], v11 offset:4608
  s_waitcnt lgkmcnt(0)
  s_add_u32 s48, s45, 10240
  buffer_store_dwordx4 v[12:15], v0, s[4:7], s48 offen
  buffer_store_dwordx4 v[16:19], v0, s[4:7], s48 offen offset:1024
  s_waitcnt vmcnt(42)
  s_barrier
  s_add_u32 s47, s97, 41728
  s_add_u32 m0, s46, 139264
  s_nop 0
  buffer_load_dwordx4 v9, s[8:11], s47 offen nt lds
  s_add_u32 s47, s97, 62208
  s_add_u32 m0, s46, 140288
  s_nop 0
  buffer_load_dwordx4 v9, s[8:11], s47 offen nt lds
  v_add_u32 v11, 147456, v10
  ds_read_b64_tr_b16 v[20:21], v11 offset:0
  ds_read_b64_tr_b16 v[22:23], v11 offset:512
  ds_read_b64_tr_b16 v[24:25], v11 offset:4096
  ds_read_b64_tr_b16 v[26:27], v11 offset:4608
  s_waitcnt lgkmcnt(0)
  s_add_u32 s48, s45, 12288
  buffer_store_dwordx4 v[20:23], v0, s[4:7], s48 offen
  buffer_store_dwordx4 v[24:27], v0, s[4:7], s48 offen offset:1024
  s_waitcnt vmcnt(44)
  s_barrier
  s_add_u32 s47, s97, 123648
  s_add_u32 m0, s46, 147456
  s_nop 0
  buffer_load_dwordx4 v9, s[8:11], s47 offen nt lds
  s_add_u32 s47, s97, 144128
  s_add_u32 m0, s46, 148480
  s_nop 0
  buffer_load_dwordx4 v9, s[8:11], s47 offen nt lds
  v_add_u32 v11, 155648, v10
  ds_read_b64_tr_b16 v[12:13], v11 offset:0
  ds_read_b64_tr_b16 v[14:15], v11 offset:512
  ds_read_b64_tr_b16 v[16:17], v11 offset:4096
  ds_read_b64_tr_b16 v[18:19], v11 offset:4608
  s_waitcnt lgkmcnt(0)
  s_add_u32 s48, s45, 14336
  buffer_store_dwordx4 v[12:15], v0, s[4:7], s48 offen
  buffer_store_dwordx4 v[16:19], v0, s[4:7], s48 offen offset:1024
  s_waitcnt vmcnt(46)
  s_barrier
  s_add_u32 s47, s97, 41984
  s_add_u32 m0, s46, 155648
  s_nop 0
  buffer_load_dwordx4 v9, s[8:11], s47 offen nt lds
  s_add_u32 s47, s97, 62464
  s_add_u32 m0, s46, 156672
  s_nop 0
  buffer_load_dwordx4 v9, s[8:11], s47 offen nt lds
  v_add_u32 v11, 24576, v10
  ds_read_b64_tr_b16 v[20:21], v11 offset:0
  ds_read_b64_tr_b16 v[22:23], v11 offset:512
  ds_read_b64_tr_b16 v[24:25], v11 offset:4096
  ds_read_b64_tr_b16 v[26:27], v11 offset:4608
  s_waitcnt lgkmcnt(0)
  v_lshlrev_b32 v28, 3, v0
  s_add_u32 s47, s45, 6144
  buffer_load_dword v31, v28, s[4:7], s47 offen
  s_add_u32 s47, s45, 14336
  s_mov_b64 exec, 0xffff
  buffer_load_dword v32, v28, s[4:7], s47 offen
  s_mov_b64 exec, -1
  s_lshl_b32 s47, s12, 12
  s_add_u32 s47, s47, 67108864
  buffer_load_dword v33, v0, s[4:7], s47 offen sc1
  s_getpc_b64 s[48:49]
PC_7:
  s_add_u32 s48, s48, CF_TOP-PC_7
  s_addc_u32 s49, s49, 0
  global_load_dword v34, v28, s[48:49]
  s_waitcnt vmcnt(50)
  s_barrier
  v_add_u32 v11, s44, v0
  v_add_u32 v11, 0, v11
  ds_write_b128 v11, v[20:23]
  ds_write_b128 v11, v[24:27] offset:1024
  v_add_u32 v11, 32768, v10
  ds_read_b64_tr_b16 v[12:13], v11 offset:0
  ds_read_b64_tr_b16 v[14:15], v11 offset:512
  ds_read_b64_tr_b16 v[16:17], v11 offset:4096
  ds_read_b64_tr_b16 v[18:19], v11 offset:4608
  s_waitcnt lgkmcnt(0)
  s_waitcnt vmcnt(48)
  s_barrier
  v_add_u32 v11, s44, v0
  v_add_u32 v11, 8192, v11
  ds_write_b128 v11, v[12:15]
  ds_write_b128 v11, v[16:19] offset:1024
  v_add_u32 v11, 40960, v10
  ds_read_b64_tr_b16 v[20:21], v11 offset:0
  ds_read_b64_tr_b16 v[22:23], v11 offset:512
  ds_read_b64_tr_b16 v[24:25], v11 offset:4096
  ds_read_b64_tr_b16 v[26:27], v11 offset:4608
  s_waitcnt lgkmcnt(0)
  s_waitcnt vmcnt(46)
  s_barrier
  v_add_u32 v11, s44, v0
  v_add_u32 v11, 16384, v11
  ds_write_b128 v11, v[20:23]
  ds_write_b128 v11, v[24:27] offset:1024
  v_add_u32 v11, 49152, v10
  ds_read_b64_tr_b16 v[12:13], v11 offset:0
  ds_read_b64_tr_b16 v[14:15], v11 offset:512
  ds_read_b64_tr_b16 v[16:17], v11 offset:4096
  ds_read_b64_tr_b16 v[18:19], v11 offset:4608
  s_waitcnt lgkmcnt(0)
  s_waitcnt vmcnt(44)
  s_barrier
  v_add_u32 v11, s44, v0
  v_add_u32 v11, 24576, v11
  ds_write_b128 v11, v[12:15]
  ds_write_b128 v11, v[16:19] offset:1024
  v_add_u32 v11, 57344, v10
  ds_read_b64_tr_b16 v[20:21], v11 offset:0
  ds_read_b64_tr_b16 v[22:23], v11 offset:512
  ds_read_b64_tr_b16 v[24:25], v11 offset:4096
  ds_read_b64_tr_b16 v[26:27], v11 offset:4608
  s_waitcnt lgkmcnt(0)
  s_waitcnt vmcnt(42)
  s_barrier
  v_add_u32 v11, s44, v0
  v_add_u32 v11, 32768, v11
  ds_write_b128 v11, v[20:23]
  ds_write_b128 v11, v[24:27] offset:1024
  v_add_u32 v11, 65536, v10
  ds_read_b64_tr_b16 v[12:13], v11 offset:0
  ds_read_b64_tr_b16 v[14:15], v11 offset:512
  ds_read_b64_tr_b16 v[16:17], v11 offset:4096
  ds_read_b64_tr_b16 v[18:19], v11 offset:4608
  s_waitcnt lgkmcnt(0)
  s_waitcnt vmcnt(40)
  s_barrier
  v_add_u32 v11, s44, v0
  v_add_u32 v11, 40960, v11
  ds_write_b128 v11, v[12:15]
  ds_write_b128 v11, v[16:19] offset:1024
  v_add_u32 v11, 73728, v10
  ds_read_b64_tr_b16 v[20:21], v11 offset:0
  ds_read_b64_tr_b16 v[22:23], v11 offset:512
  ds_read_b64_tr_b16 v[24:25], v11 offset:4096
  ds_read_b64_tr_b16 v[26:27], v11 offset:4608
  s_waitcnt lgkmcnt(0)
  s_waitcnt vmcnt(38)
  s_barrier
  v_add_u32 v11, s44, v0
  v_add_u32 v11, 49152, v11
  ds_write_b128 v11, v[20:23]
  ds_write_b128 v11, v[24:27] offset:1024
  v_add_u32 v11, 81920, v10
  ds_read_b64_tr_b16 v[12:13], v11 offset:0
  ds_read_b64_tr_b16 v[14:15], v11 offset:512
  ds_read_b64_tr_b16 v[16:17], v11 offset:4096
  ds_read_b64_tr_b16 v[18:19], v11 offset:4608
  s_waitcnt lgkmcnt(0)
  s_waitcnt vmcnt(36)
  s_barrier
  v_add_u32 v11, s44, v0
  v_add_u32 v11, 57344, v11
  ds_write_b128 v11, v[12:15]
  ds_write_b128 v11, v[16:19] offset:1024
  v_add_u32 v11, 90112, v10
  ds_read_b64_tr_b16 v[20:21], v11 offset:0
  ds_read_b64_tr_b16 v[22:23], v11 offset:512
  ds_read_b64_tr_b16 v[24:25], v11 offset:4096
  ds_read_b64_tr_b16 v[26:27], v11 offset:4608
  s_waitcnt lgkmcnt(0)
  s_waitcnt vmcnt(32)
  s_barrier
  v_add_u32 v11, s44, v0
  v_add_u32 v11, 65536, v11
  ds_write_b128 v11, v[20:23]
  ds_write_b128 v11, v[24:27] offset:1024
  v_add_u32 v11, 98304, v10
  ds_read_b64_tr_b16 v[12:13], v11 offset:0
  ds_read_b64_tr_b16 v[14:15], v11 offset:512
  ds_read_b64_tr_b16 v[16:17], v11 offset:4096
  ds_read_b64_tr_b16 v[18:19], v11 offset:4608
  s_waitcnt lgkmcnt(0)
  s_lshr_b32 s48, s12, 1
  s_lshl_b32 s48, s48, 2
  s_add_u32 s51, s48, 0
  v_bfe_u32 v35, v0, 8, 1
  v_lshlrev_b32 v35, 8, v35
  v_add_u32 v35, s51, v35
  buffer_load_dword v7, v35, s[4:7], 0 offen sc1
  v_lshlrev_b32 v28, 3, v0
  s_lshl_b32 s47, s12, 13
  s_lshl_b32 s48, s13, 11
  s_add_u32 s47, s47, s48
  s_add_u32 s48, s47, 16777216
  s_add_u32 s47, s47, 33554432
  s_mov_b64 exec, 0xffff
  buffer_load_dword v29, v28, s[4:7], s48 offen sc1
  buffer_load_dword v30, v28, s[4:7], s47 offen sc1
  s_mov_b64 exec, -1
  v_lshrrev_b32 v36, 2, v0
  v_and_b32 v36, 0x7c, v36
  buffer_load_dword v37, v36, s[4:7], 0 offen offset:1024 sc1
  s_waitcnt vmcnt(32)
  s_barrier
  v_add_u32 v11, s44, v0
  v_add_u32 v11, 73728, v11
  ds_write_b128 v11, v[12:15]
  ds_write_b128 v11, v[16:19] offset:1024
  v_add_u32 v11, 106496, v10
  ds_read_b64_tr_b16 v[20:21], v11 offset:0
  ds_read_b64_tr_b16 v[22:23], v11 offset:512
  ds_read_b64_tr_b16 v[24:25], v11 offset:4096
  ds_read_b64_tr_b16 v[26:27], v11 offset:4608
  s_waitcnt lgkmcnt(0)
  s_waitcnt vmcnt(28)
  s_barrier
  v_add_u32 v11, s44, v0
  v_add_u32 v11, 81920, v11
  ds_write_b128 v11, v[20:23]
  ds_write_b128 v11, v[24:27] offset:1024
  v_add_u32 v11, 114688, v10
  ds_read_b64_tr_b16 v[12:13], v11 offset:0
  ds_read_b64_tr_b16 v[14:15], v11 offset:512
  ds_read_b64_tr_b16 v[16:17], v11 offset:4096
  ds_read_b64_tr_b16 v[18:19], v11 offset:4608
  s_waitcnt lgkmcnt(0)
  s_waitcnt vmcnt(24)
  s_barrier
  v_add_u32 v11, s44, v0
  v_add_u32 v11, 90112, v11
  ds_write_b128 v11, v[12:15]
  ds_write_b128 v11, v[16:19] offset:1024
  v_add_u32 v11, 122880, v10
  ds_read_b64_tr_b16 v[20:21], v11 offset:0
  ds_read_b64_tr_b16 v[22:23], v11 offset:512
  ds_read_b64_tr_b16 v[24:25], v11 offset:4096
  ds_read_b64_tr_b16 v[26:27], v11 offset:4608
  s_waitcnt lgkmcnt(0)
  s_waitcnt vmcnt(20)
  s_barrier
  v_add_u32 v11, s44, v0
  v_add_u32 v11, 98304, v11
  ds_write_b128 v11, v[20:23]
  ds_write_b128 v11, v[24:27] offset:1024
  v_add_u32 v11, 131072, v10
  ds_read_b64_tr_b16 v[12:13], v11 offset:0
  ds_read_b64_tr_b16 v[14:15], v11 offset:512
  ds_read_b64_tr_b16 v[16:17], v11 offset:4096
  ds_read_b64_tr_b16 v[18:19], v11 offset:4608
  s_waitcnt lgkmcnt(0)
  s_waitcnt vmcnt(16)
  s_barrier
  v_add_u32 v11, s44, v0
  v_add_u32 v11, 106496, v11
  ds_write_b128 v11, v[12:15]
  ds_write_b128 v11, v[16:19] offset:1024
  v_add_u32 v11, 139264, v10
  ds_read_b64_tr_b16 v[20:21], v11 offset:0
  ds_read_b64_tr_b16 v[22:23], v11 offset:512
  ds_read_b64_tr_b16 v[24:25], v11 offset:4096
  ds_read_b64_tr_b16 v[26:27], v11 offset:4608
  s_waitcnt lgkmcnt(0)
  s_waitcnt vmcnt(12)
  s_barrier
  v_add_u32 v11, s44, v0
  v_add_u32 v11, 114688, v11
  ds_write_b128 v11, v[20:23]
  ds_write_b128 v11, v[24:27] offset:1024
  v_add_u32 v11, 147456, v10
  ds_read_b64_tr_b16 v[12:13], v11 offset:0
  ds_read_b64_tr_b16 v[14:15], v11 offset:512
  ds_read_b64_tr_b16 v[16:17], v11 offset:4096
  ds_read_b64_tr_b16 v[18:19], v11 offset:4608
  s_waitcnt lgkmcnt(0)
  s_waitcnt vmcnt(8)
  s_barrier
  v_add_u32 v11, s44, v0
  v_add_u32 v11, 122880, v11
  ds_write_b128 v11, v[12:15]
  ds_write_b128 v11, v[16:19] offset:1024
  v_add_u32 v11, 155648, v10
  ds_read_b64_tr_b16 v[20:21], v11 offset:0
  ds_read_b64_tr_b16 v[22:23], v11 offset:512
  ds_read_b64_tr_b16 v[24:25], v11 offset:4096
  ds_read_b64_tr_b16 v[26:27], v11 offset:4608
  s_waitcnt lgkmcnt(0)
  s_barrier
  v_add_u32 v11, s44, v0
  v_add_u32 v11, 131072, v11
  ds_write_b128 v11, v[20:23]
  ds_write_b128 v11, v[24:27] offset:1024
  s_waitcnt vmcnt(0) lgkmcnt(0)
  s_mov_b32 s14, 0
  s_mov_b32 s15, 0
  v_cmp_eq_u32 vcc, 0, v7
  s_nop 0
  s_cbranch_vccz W0K_9
W0_8:
  buffer_load_dword v7, v35, s[4:7], 0 offen sc1
  s_sub_u32 s74, s74, 1
  s_cbranch_scc1 L_TIMEOUT
  s_waitcnt vmcnt(0)
  v_cmp_eq_u32 vcc, 0, v7
  s_nop 0
  s_cbranch_vccnz W0_8
  v_lshlrev_b32 v28, 3, v0
  s_lshl_b32 s47, s12, 13
  s_lshl_b32 s48, s13, 11
  s_add_u32 s47, s47, s48
  s_add_u32 s48, s47, 16777216
  s_add_u32 s47, s47, 33554432
  s_mov_b64 exec, 0xffff
  buffer_load_dword v29, v28, s[4:7], s48 offen sc1
  buffer_load_dword v30, v28, s[4:7], s47 offen sc1
  s_mov_b64 exec, -1
  s_waitcnt vmcnt(0)
W0K_9:
  s_lshl_b32 s47, s14, 5
  s_add_u32 s47, s47, s12
  s_lshl_b32 s48, s47, 12
  s_lshl_b32 s49, s13, 10
  s_add_u32 s48, s48, s49
  s_add_u32 s75, s48, 67108864
  s_lshl_b32 s48, s47, 13
  s_add_u32 s48, s48, s46
  s_add_u32 s54, s48, 33554432
  s_sub_u32 s55, s54, 16777216
  s_lshl_b32 s48, s47, 13
  s_add_u32 s72, s48, 17039360
  s_add_u32 s73, s72, 0
  s_add_u32 s49, s72, 16777216
  s_cmp_lt_u32 s13, 2
  s_cselect_b32 s73, s73, s49
  s_and_b32 s49, s13, 1
  s_lshl_b32 s49, s49, 12
  s_add_u32 s73, s73, s49
  s_mov_b32 s96, s51
  s_add_u32 s47, s14, 1
  s_lshr_b32 s47, s47, 4
  s_min_u32 s47, s47, 3
  s_lshl_b32 s47, s47, 6
  s_lshr_b32 s48, s12, 1
  s_lshl_b32 s48, s48, 2
  s_add_u32 s51, s47, s48
  s_add_u32 s51, s51, 0
  s_and_b32 s47, s14, 3
  s_mul_i32 s47, s47, 10240
  s_add_u32 s16, s47, s42
  s_add_u32 s16, s16, 458752
  s_add_u32 s17, s47, s23
  s_add_u32 s17, s17, 458752
  s_add_u32 s47, s14, 2
  s_and_b32 s47, s47, 3
  s_mul_i32 s47, s47, 10240
  s_add_u32 s18, s47, s23
  s_add_u32 s18, s18, 458752
TB_10:
  v_cmp_eq_u32 vcc, 0, v37
  s_nop 0
  s_cbranch_vccz TBk_11
  buffer_load_dword v37, v36, s[4:7], 0 offen offset:1024 sc1
  s_sub_u32 s74, s74, 1
  s_cbranch_scc1 L_TIMEOUT
  s_waitcnt vmcnt(0)
  s_branch TB_10
TBk_11:
  v_and_b32 v32, 0x1f0, v0
  v_add_u32 v33, s42, v0
  v_add_u32 v34, s42, v32
  v_mov_b64 v[8:9], 0
  v_mov_b64 v[10:11], 0
  v_mov_b64 v[12:13], 0
  v_mov_b64 v[14:15], 0
  v_mov_b64 v[16:17], 0
  v_mov_b64 v[18:19], 0
  v_bfe_u32 v36, v0, 8, 1
  v_lshlrev_b32 v36, 8, v36
  v_add_u32 v36, s51, v36
  v_lshlrev_b32 v37, 3, v0
  v_add_u32 v37, s73, v37
  v_cndmask_b32 v7, v36, v37, s[36:37]
  s_waitcnt vmcnt(0) lgkmcnt(0)
  s_branch CF_ENTRY
  .p2align 6
CF_TOP:
  v_and_b32 v32, 0x1f0, v0
  v_add_u32 v33, s42, v0
  v_add_u32 v34, s42, v32
  v_mov_b64 v[8:9], 0
  v_mov_b64 v[10:11], 0
  v_mov_b64 v[12:13], 0
  v_mov_b64 v[14:15], 0
  v_mov_b64 v[16:17], 0
  v_mov_b64 v[18:19], 0
  v_bfe_u32 v36, v0, 8, 1
  v_lshlrev_b32 v36, 8, v36
  v_add_u32 v36, s51, v36
  v_lshlrev_b32 v37, 3, v0
  v_add_u32 v37, s73, v37
  v_cndmask_b32 v7, v36, v37, s[36:37]
  buffer_load_dwordx4 v[20:23], v0, s[4:7], s16 offen sc1
  buffer_load_dwordx4 v[24:27], v0, s[4:7], s16 offen offset:1024 sc1
  buffer_load_dwordx4 v[28:31], v32, s[4:7], s16 offen offset:2048 sc1
  s_barrier
  buffer_load_dwordx4 v[40:43], v0, s[4:7], s90 offen offset:0
  buffer_load_dwordx4 v[44:47], v0, s[4:7], s90 offen offset:1024
  buffer_load_dwordx4 v[48:51], v0, s[4:7], s90 offen offset:2048
  buffer_load_dwordx4 v[52:55], v0, s[4:7], s90 offen offset:3072
  s_waitcnt vmcnt(4)
  v_max3_u32 v35, v21, v23, v25
  v_max3_u32 v35, v35, v27, v29
  v_max_u32 v35, v35, v31
  v_cmp_eq_u32 vcc, -1, v35
  s_nop 0
  s_cbranch_vccnz PMR_12
PMK_13:
  ds_write_b128 v33, v[20:23] offset:0
  ds_write_b128 v33, v[24:27] offset:1024
  ds_write_b128 v34, v[28:31] offset:2048
  buffer_load_dwordx4 v[56:59], v0, s[4:7], s91 offen offset:0
  buffer_load_dwordx4 v[60:63], v0, s[4:7], s91 offen offset:1024
CF_ENTRY:
  s_waitcnt lgkmcnt(0)
  s_barrier
  ds_read_b128 v[20:23], v1 offset:0
  ds_read_b128 v[24:27], v1 offset:512
  ds_read_b128 v[32:35], v6 offset:0
  ds_read_b128 v[36:39], v6 offset:1024
  s_waitcnt vmcnt(2) lgkmcnt(3)
  v_smfmac_f32_16x16x64_bf16 v[8:11], v[20:23], v[40:47], v2
  ds_read_b128 v[28:31], v1 offset:1024
  buffer_load_dwordx4 v[64:67], v0, s[4:7], s91 offen offset:2048
  v_smfmac_f32_16x16x64_bf16 v[12:15], v[20:23], v[48:55], v2
  v_smfmac_f32_16x16x64_bf16 v[16:19], v[20:23], a[192:199], v2
  s_waitcnt lgkmcnt(3)
  v_smfmac_f32_16x16x64_bf16 v[8:11], v[24:27], a[0:7], v2
  ds_read_b128 v[20:23], v1 offset:1536
  buffer_load_dwordx4 v[68:71], v0, s[4:7], s91 offen offset:3072
  v_smfmac_f32_16x16x64_bf16 v[12:15], v[24:27], a[128:135], v2
  v_smfmac_f32_16x16x64_bf16 v[16:19], v[24:27], a[200:207], v2
  s_waitcnt lgkmcnt(1)
  v_smfmac_f32_16x16x64_bf16 v[8:11], v[28:31], a[8:15], v2
  ds_read_b128 v[24:27], v1 offset:2048
  v_smfmac_f32_16x16x64_bf16 v[12:15], v[28:31], v[32:39], v2
  ds_read_b128 v[32:35], v6 offset:8192
  ds_read_b128 v[36:39], v6 offset:9216
  v_smfmac_f32_16x16x64_bf16 v[16:19], v[28:31], a[208:215], v2
  s_waitcnt lgkmcnt(3)
  v_smfmac_f32_16x16x64_bf16 v[8:11], v[20:23], a[16:23], v2
  ds_read_b128 v[28:31], v1 offset:2560
  buffer_load_dwordx4 v[40:43], v0, s[4:7], s92 offen offset:0
  v_smfmac_f32_16x16x64_bf16 v[12:15], v[20:23], a[136:143], v2
  v_smfmac_f32_16x16x64_bf16 v[16:19], v[20:23], a[216:223], v2
  s_waitcnt lgkmcnt(1)
  v_smfmac_f32_16x16x64_bf16 v[8:11], v[24:27], a[24:31], v2
  ds_read_b128 v[20:23], v1 offset:3072
  buffer_load_dwordx4 v[44:47], v0, s[4:7], s92 offen offset:1024
  v_smfmac_f32_16x16x64_bf16 v[12:15], v[24:27], v[32:39], v2
  ds_read_b128 v[32:35], v6 offset:16384
  ds_read_b128 v[36:39], v6 offset:17408
  v_smfmac_f32_16x16x64_bf16 v[16:19], v[24:27], a[224:231], v2
  s_waitcnt lgkmcnt(3)
  v_smfmac_f32_16x16x64_bf16 v[8:11], v[28:31], a[32:39], v2
  ds_read_b128 v[24:27], v1 offset:3584
  buffer_load_dwordx4 v[48:51], v0, s[4:7], s92 offen offset:2048
  v_smfmac_f32_16x16x64_bf16 v[12:15], v[28:31], a[144:151], v2
  v_smfmac_f32_16x16x64_bf16 v[16:19], v[28:31], a[232:239], v2
  s_waitcnt vmcnt(5) lgkmcnt(1)
  v_smfmac_f32_16x16x64_bf16 v[8:11], v[20:23], v[56:63], v2
  ds_read_b128 v[28:31], v1 offset:4096
  v_smfmac_f32_16x16x64_bf16 v[12:15], v[20:23], v[32:39], v2
  ds_read_b128 v[32:35], v6 offset:24576
  ds_read_b128 v[36:39], v6 offset:25600
  v_smfmac_f32_16x16x64_bf16 v[16:19], v[20:23], a[240:247], v2
  s_waitcnt vmcnt(3) lgkmcnt(3)
  v_smfmac_f32_16x16x64_bf16 v[8:11], v[24:27], a[40:47], v2
  ds_read_b128 v[20:23], v1 offset:4608
  buffer_load_dwordx4 v[52:55], v0, s[4:7], s92 offen offset:3072
  v_smfmac_f32_16x16x64_bf16 v[12:15], v[24:27], v[64:71], v2
  v_smfmac_f32_16x16x64_bf16 v[16:19], v[24:27], a[248:255], v2
  s_waitcnt lgkmcnt(1)
  v_smfmac_f32_16x16x64_bf16 v[8:11], v[28:31], a[48:55], v2
  ds_read_b128 v[24:27], v1 offset:5120
  buffer_load_dwordx4 v[56:59], v0, s[4:7], s93 offen offset:0
  v_smfmac_f32_16x16x64_bf16 v[12:15], v[28:31], v[32:39], v2
  ds_read_b128 v[32:35], v6 offset:32768
  ds_read_b128 v[36:39], v6 offset:33792
  v_smfmac_f32_16x16x64_bf16 v[16:19], v[28:31], v[72:79], v2
  s_waitcnt lgkmcnt(3)
  v_smfmac_f32_16x16x64_bf16 v[8:11], v[20:23], a[56:63], v2
  ds_read_b128 v[28:31], v1 offset:5632
  buffer_load_dwordx4 v[60:63], v0, s[4:7], s93 offen offset:1024
  v_smfmac_f32_16x16x64_bf16 v[12:15], v[20:23], a[152:159], v2
  v_smfmac_f32_16x16x64_bf16 v[16:19], v[20:23], v[80:87], v2
  s_waitcnt lgkmcnt(1)
  v_smfmac_f32_16x16x64_bf16 v[8:11], v[24:27], a[64:71], v2
  ds_read_b128 v[20:23], v1 offset:6144
  v_smfmac_f32_16x16x64_bf16 v[12:15], v[24:27], v[32:39], v2
  ds_read_b128 v[32:35], v6 offset:40960
  ds_read_b128 v[36:39], v6 offset:41984
  v_smfmac_f32_16x16x64_bf16 v[16:19], v[24:27], v[88:95], v2
  s_waitcnt lgkmcnt(3)
  v_smfmac_f32_16x16x64_bf16 v[8:11], v[28:31], a[72:79], v2
  ds_read_b128 v[24:27], v1 offset:6656
  buffer_load_dwordx4 v[64:67], v0, s[4:7], s93 offen offset:2048
  v_smfmac_f32_16x16x64_bf16 v[12:15], v[28:31], a[160:167], v2
  v_smfmac_f32_16x16x64_bf16 v[16:19], v[28:31], v[96:103], v2
  s_waitcnt lgkmcnt(1)
  v_smfmac_f32_16x16x64_bf16 v[8:11], v[20:23], a[80:87], v2
  ds_read_b128 v[28:31], v1 offset:7168
  buffer_load_dwordx4 v[68:71], v0, s[4:7], s93 offen offset:3072
  v_smfmac_f32_16x16x64_bf16 v[12:15], v[20:23], v[32:39], v2
  ds_read_b128 v[32:35], v6 offset:49152
  ds_read_b128 v[36:39], v6 offset:50176
  v_smfmac_f32_16x16x64_bf16 v[16:19], v[20:23], v[104:111], v2
  s_waitcnt vmcnt(6) lgkmcnt(3)
  v_smfmac_f32_16x16x64_bf16 v[8:11], v[24:27], v[40:47], v2
  ds_read_b128 v[20:23], v1 offset:7680
  v_smfmac_f32_16x16x64_bf16 v[12:15], v[24:27], a[168:175], v2
  v_smfmac_f32_16x16x64_bf16 v[16:19], v[24:27], v[112:119], v2
  s_waitcnt lgkmcnt(1)
  v_smfmac_f32_16x16x64_bf16 v[8:11], v[28:31], a[88:95], v2
  ds_read_b128 v[24:27], v1 offset:8192
  s_add_u32 m0, s46, 16384
  s_nop 0
  buffer_load_dwordx4 v0, s[4:7], s55 offen offset:0 sc1 nt lds
  v_smfmac_f32_16x16x64_bf16 v[12:15], v[28:31], v[32:39], v2
  ds_read_b128 v[32:35], v6 offset:57344
  ds_read_b128 v[36:39], v6 offset:58368
  v_smfmac_f32_16x16x64_bf16 v[16:19], v[28:31], v[120:127], v2
  s_waitcnt vmcnt(5) lgkmcnt(3)
  v_smfmac_f32_16x16x64_bf16 v[8:11], v[20:23], a[96:103], v2
  ds_read_b128 v[28:31], v1 offset:8704
  buffer_load_dwordx4 v0, s[4:7], s55 offen offset:1024 sc1 nt lds
  v_smfmac_f32_16x16x64_bf16 v[12:15], v[20:23], v[48:55], v2
  v_smfmac_f32_16x16x64_bf16 v[16:19], v[20:23], v[128:135], v2
  s_waitcnt lgkmcnt(1)
  v_smfmac_f32_16x16x64_bf16 v[8:11], v[24:27], a[104:111], v2
  ds_read_b128 v[20:23], v1 offset:9216
  v_smfmac_f32_16x16x64_bf16 v[12:15], v[24:27], v[32:39], v2
  v_smfmac_f32_16x16x64_bf16 v[16:19], v[24:27], v[136:143], v2
  s_waitcnt lgkmcnt(1)
  v_smfmac_f32_16x16x64_bf16 v[8:11], v[28:31], a[112:119], v2
  ds_read_b128 v[24:27], v1 offset:9728
  v_smfmac_f32_16x16x64_bf16 v[12:15], v[28:31], a[176:183], v2
  v_smfmac_f32_16x16x64_bf16 v[16:19], v[28:31], v[144:151], v2
  s_waitcnt vmcnt(4) lgkmcnt(1)
  v_smfmac_f32_16x16x64_bf16 v[8:11], v[20:23], v[56:63], v2
  v_smfmac_f32_16x16x64_bf16 v[12:15], v[20:23], a[184:191], v2
  s_waitcnt vmcnt(2) lgkmcnt(0)
  v_smfmac_f32_16x16x64_bf16 v[8:11], v[24:27], a[120:127], v2
  v_smfmac_f32_16x16x64_bf16 v[12:15], v[24:27], v[64:71], v2
  v_smfmac_f32_16x16x64_bf16 v[16:19], v[20:23], v[152:159], v2
  v_smfmac_f32_16x16x64_bf16 v[16:19], v[24:27], v[160:167], v2
  v_mov_b32 v38, s14
  v_mov_b32 v39, 0
  s_nop 2
  v_cvt_pk_bf16_f32 v34, v8, v9
  v_cvt_pk_bf16_f32 v35, v10, v11
  ds_write_b64 v4, v[34:35] offset:10240
  v_cvt_pk_bf16_f32 v32, v12, v13
  v_cvt_pk_bf16_f32 v33, v14, v15
  ds_write_b64 v4, v[32:33] offset:12288
  buffer_load_dwordx4 v[8:11], v0, s[4:7], s54 offen sc1 nt
  buffer_load_dwordx4 v[12:15], v0, s[4:7], s54 offen offset:1024 sc1 nt
  v_cvt_pk_bf16_f32 v34, v16, v17
  v_cvt_pk_bf16_f32 v35, v18, v19
  s_cmp_eq_u32 s14, 63
  s_cbranch_scc1 CF_EXIT
  v_cndmask_b32 v16, 0, v34, s[36:37]
  v_cndmask_b32 v17, 0, v35, s[36:37]
  v_cndmask_b32 v18, 0, v34, s[52:53]
  v_cndmask_b32 v19, 0, v35, s[52:53]
  s_waitcnt vmcnt(2) lgkmcnt(0)
  s_barrier
  ds_read_b64_tr_b16 v[40:41], v3 offset:10240
  ds_read_b64_tr_b16 v[42:43], v3 offset:10304
  ds_read_b128 v[48:51], v0 offset:16384
  ds_read_b128 v[52:55], v0 offset:20480
  ds_read_b64_tr_b16 v[44:45], v3 offset:12288
  ds_read_b64_tr_b16 v[46:47], v3 offset:12352
  ds_read_b64_tr_b16 v[56:57], v3 offset:10752
  ds_read_b64_tr_b16 v[58:59], v3 offset:10816
  ds_read_b128 v[64:67], v0 offset:17408
  ds_read_b128 v[68:71], v0 offset:21504
  ds_read_b64_tr_b16 v[60:61], v3 offset:12800
  ds_read_b64_tr_b16 v[62:63], v3 offset:12864
  buffer_store_dwordx4 v[32:35], v0, s[4:7], s75 offen sc1
  buffer_store_dword v38, v39, s[4:7], s26 offen sc1
  s_waitcnt lgkmcnt(9)
  v_mfma_f32_16x16x32_bf16 v[20:23], v[48:51], v[40:43], 0
  ds_read_b128 v[48:51], v0 offset:18432
  s_waitcnt lgkmcnt(9)
  v_mfma_f32_16x16x32_bf16 v[24:27], v[52:55], v[40:43], 0
  ds_read_b128 v[52:55], v0 offset:22528
  s_waitcnt lgkmcnt(8)
  v_mfma_f32_16x16x32_bf16 v[28:31], v[44:47], v[40:43], 0
  ds_read_b64_tr_b16 v[40:41], v3 offset:11264
  ds_read_b64_tr_b16 v[42:43], v3 offset:11328
  s_waitcnt lgkmcnt(7)
  v_mfma_f32_16x16x32_bf16 v[20:23], v[64:67], v[56:59], v[20:23]
  ds_read_b128 v[64:67], v0 offset:19456
  ds_read_b64_tr_b16 v[44:45], v3 offset:13312
  ds_read_b64_tr_b16 v[46:47], v3 offset:13376
  s_waitcnt lgkmcnt(9)
  v_mfma_f32_16x16x32_bf16 v[24:27], v[68:71], v[56:59], v[24:27]
  ds_read_b128 v[68:71], v0 offset:23552
  s_waitcnt lgkmcnt(8)
  v_mfma_f32_16x16x32_bf16 v[28:31], v[60:63], v[56:59], v[28:31]
  ds_read_b64_tr_b16 v[56:57], v3 offset:11776
  ds_read_b64_tr_b16 v[58:59], v3 offset:11840
  s_waitcnt lgkmcnt(6)
  v_mfma_f32_16x16x32_bf16 v[20:23], v[48:51], v[40:43], v[20:23]
  ds_read_b64_tr_b16 v[60:61], v3 offset:13824
  ds_read_b64_tr_b16 v[62:63], v3 offset:13888
  v_mfma_f32_16x16x32_bf16 v[24:27], v[52:55], v[40:43], v[24:27]
  s_waitcnt lgkmcnt(5)
  v_mfma_f32_16x16x32_bf16 v[28:31], v[44:47], v[40:43], v[28:31]
  s_waitcnt lgkmcnt(2)
  v_mfma_f32_16x16x32_bf16 v[20:23], v[64:67], v[56:59], v[20:23]
  v_mfma_f32_16x16x32_bf16 v[24:27], v[68:71], v[56:59], v[24:27]
  s_waitcnt lgkmcnt(0)
  v_mfma_f32_16x16x32_bf16 v[28:31], v[60:63], v[56:59], v[28:31]
  buffer_load_dword v7, v7, s[4:7], 0 offen sc1
  v_add_u32 v38, 0x10000, v6
  ds_read_b128 v[48:51], v38 offset:0
  ds_read_b128 v[52:55], v38 offset:1024
  ds_read_b128 v[56:59], v38 offset:8192
  ds_read_b128 v[60:63], v38 offset:9216
  ds_read_b128 v[64:67], v38 offset:16384
  ds_read_b128 v[68:71], v38 offset:17408
  v_max3_f32 v36, v20, v21, v22
  v_max3_f32 v37, v23, v24, v25
  v_max3_f32 v36, v36, v26, v27
  v_max3_f32 v37, v37, v28, v29
  v_max3_f32 v36, v36, v30, v31
  v_max_f32 v36, v36, v37
  v_mov_b32 v37, v36
  s_nop 1
  v_permlane32_swap_b32 v36, v37
  v_max_f32 v36, v36, v37
  v_mov_b32 v37, v36
  s_nop 1
  v_permlane16_swap_b32 v36, v37
  v_max_f32 v36, v36, v37
  v_mul_f32 v36, s38, v36
  v_pk_fma_f32 v[20:21], v[20:21], s[38:39], v[36:37] op_sel_hi:[1,0,0] neg_lo:[0,0,1] neg_hi:[0,0,1]
  v_pk_fma_f32 v[22:23], v[22:23], s[38:39], v[36:37] op_sel_hi:[1,0,0] neg_lo:[0,0,1] neg_hi:[0,0,1]
  v_pk_fma_f32 v[24:25], v[24:25], s[38:39], v[36:37] op_sel_hi:[1,0,0] neg_lo:[0,0,1] neg_hi:[0,0,1]
  v_pk_fma_f32 v[26:27], v[26:27], s[38:39], v[36:37] op_sel_hi:[1,0,0] neg_lo:[0,0,1] neg_hi:[0,0,1]
  v_pk_fma_f32 v[28:29], v[28:29], s[38:39], v[36:37] op_sel_hi:[1,0,0] neg_lo:[0,0,1] neg_hi:[0,0,1]
  v_pk_fma_f32 v[30:31], v[30:31], s[38:39], v[36:37] op_sel_hi:[1,0,0] neg_lo:[0,0,1] neg_hi:[0,0,1]
  v_exp_f32 v20, v20
  v_exp_f32 v21, v21
  v_exp_f32 v22, v22
  v_exp_f32 v23, v23
  v_exp_f32 v24, v24
  v_exp_f32 v25, v25
  v_exp_f32 v26, v26
  v_exp_f32 v27, v27
  v_exp_f32 v28, v28
  v_exp_f32 v29, v29
  v_exp_f32 v30, v30
  v_exp_f32 v31, v31
  v_cvt_pk_bf16_f32 v20, v20, v21
  v_cvt_pk_bf16_f32 v21, v22, v23
  v_cvt_pk_bf16_f32 v22, v24, v25
  v_cvt_pk_bf16_f32 v23, v26, v27
  v_cvt_pk_bf16_f32 v28, v28, v29
  v_cvt_pk_bf16_f32 v29, v30, v31
  s_waitcnt vmcnt(3)
  v_mfma_f32_16x16x32_bf16 v[24:27], v[8:11], v[20:23], 0
  v_dot2_f32_bf16 v36, v28, s40, 0
  v_dot2_f32_bf16 v37, v20, s39, 0
  v_mfma_f32_16x16x32_bf16 v[32:35], v[12:15], v[20:23], 0
  v_dot2_f32_bf16 v36, v29, s40, v36
  v_dot2_f32_bf16 v37, v21, s39, v37
  v_mfma_f32_16x16x16_bf16 v[24:27], v[16:17], v[28:29], v[24:27]
  v_dot2_f32_bf16 v36, v22, s39, v36
  v_dot2_f32_bf16 v37, v23, s39, v37
  v_mfma_f32_16x16x16_bf16 v[32:35], v[18:19], v[28:29], v[32:35]
  v_add_u32 v39, s43, v1
  v_add_u32 v44, 73728, v6
  v_add_f32 v36, v36, v37
  v_mov_b32 v37, v36
  s_nop 1
  v_permlane32_swap_b32 v36, v37
  v_add_f32 v36, v36, v37
  v_mov_b32 v37, v36
  s_nop 1
  v_permlane16_swap_b32 v36, v37
  v_add_f32 v36, v36, v37
  v_rcp_f32 v36, v36
  v_bfe_u32 v46, v5, 14, 1
  v_and_b32 v45, 0x20f0, v5
  v_lshl_or_b32 v45, v46, 3, v45
  v_pk_mul_f32 v[24:25], v[24:25], v[36:37] op_sel_hi:[1,0]
  v_pk_mul_f32 v[26:27], v[26:27], v[36:37] op_sel_hi:[1,0]
  v_pk_mul_f32 v[32:33], v[32:33], v[36:37] op_sel_hi:[1,0]
  v_pk_mul_f32 v[34:35], v[34:35], v[36:37] op_sel_hi:[1,0]
  v_cvt_pk_bf16_f32 v24, v24, v25
  v_cvt_pk_bf16_f32 v25, v26, v27
  v_cvt_pk_bf16_f32 v26, v32, v33
  v_cvt_pk_bf16_f32 v27, v34, v35
  ds_write_b128 v39, v[24:27] offset:14336
  v_mov_b64 v[8:9], 0
  v_mov_b64 v[10:11], 0
  v_mov_b64 v[12:13], 0
  v_mov_b64 v[14:15], 0
  v_mov_b64 v[16:17], 0
  v_mov_b64 v[18:19], 0
  v_mov_b64 v[20:21], 0
  v_mov_b64 v[22:23], 0
  s_waitcnt lgkmcnt(0)
  s_barrier
  ds_read_b128 v[28:31], v1 offset:14336
  ds_read_b128 v[32:35], v1 offset:14848
  ds_read_b128 v[36:39], v1 offset:15360
  ds_read_b128 v[40:43], v1 offset:15872
  v_mov_b64 v[24:25], 0
  v_mov_b64 v[26:27], 0
  s_waitcnt lgkmcnt(3)
  v_smfmac_f32_16x16x64_bf16 v[8:11], v[28:31], v[168:175], v2
  s_waitcnt lgkmcnt(2)
  v_smfmac_f32_16x16x64_bf16 v[8:11], v[32:35], v[48:55], v2
  ds_read_b128 v[48:51], v44 offset:16384
  ds_read_b128 v[52:55], v44 offset:17408
  s_waitcnt lgkmcnt(3)
  v_smfmac_f32_16x16x64_bf16 v[8:11], v[36:39], v[176:183], v2
  s_waitcnt lgkmcnt(2)
  v_smfmac_f32_16x16x64_bf16 v[8:11], v[40:43], v[56:63], v2
  ds_read_b128 v[56:59], v44 offset:24576
  ds_read_b128 v[60:63], v44 offset:25600
  v_smfmac_f32_16x16x64_bf16 v[12:15], v[28:31], v[184:191], v2
  v_smfmac_f32_16x16x64_bf16 v[12:15], v[32:35], v[64:71], v2
  ds_read_b128 v[64:67], v44 offset:32768
  ds_read_b128 v[68:71], v44 offset:33792
  v_smfmac_f32_16x16x64_bf16 v[12:15], v[36:39], v[192:199], v2
  s_waitcnt lgkmcnt(4)
  v_smfmac_f32_16x16x64_bf16 v[12:15], v[40:43], v[48:55], v2
  ds_read_b128 v[48:51], v44 offset:40960
  ds_read_b128 v[52:55], v44 offset:41984
  v_smfmac_f32_16x16x64_bf16 v[16:19], v[28:31], v[200:207], v2
  s_waitcnt lgkmcnt(4)
  v_smfmac_f32_16x16x64_bf16 v[16:19], v[32:35], v[56:63], v2
  ds_read_b128 v[56:59], v44 offset:49152
  ds_read_b128 v[60:63], v44 offset:50176
  v_smfmac_f32_16x16x64_bf16 v[16:19], v[36:39], v[208:215], v2
  v_cvt_pk_bf16_f32 v8, v8, v9
  v_cvt_pk_bf16_f32 v9, v10, v11
  s_waitcnt lgkmcnt(4)
  v_smfmac_f32_16x16x64_bf16 v[16:19], v[40:43], v[64:71], v2
  ds_read_b128 v[64:67], v44 offset:57344
  ds_read_b128 v[68:71], v44 offset:58368
  v_smfmac_f32_16x16x64_bf16 v[20:23], v[28:31], v[216:223], v2
  v_cvt_pk_bf16_f32 v10, v12, v13
  v_cvt_pk_bf16_f32 v11, v14, v15
  s_waitcnt lgkmcnt(4)
  v_smfmac_f32_16x16x64_bf16 v[20:23], v[32:35], v[48:55], v2
  v_bfi_b32 v8, 1, s15, v8
  v_bfi_b32 v10, 1, s15, v10
  v_smfmac_f32_16x16x64_bf16 v[20:23], v[36:39], v[224:231], v2
  buffer_store_dwordx4 v[8:11], v5, s[4:7], s19 offen
  s_waitcnt lgkmcnt(2)
  v_smfmac_f32_16x16x64_bf16 v[20:23], v[40:43], v[56:63], v2
  v_smfmac_f32_16x16x64_bf16 v[24:27], v[28:31], v[232:239], v2
  s_waitcnt lgkmcnt(0)
  v_smfmac_f32_16x16x64_bf16 v[24:27], v[32:35], v[64:71], v2
  v_cvt_pk_bf16_f32 v16, v16, v17
  v_cvt_pk_bf16_f32 v17, v18, v19
  v_smfmac_f32_16x16x64_bf16 v[24:27], v[36:39], v[240:247], v2
  s_nop 1
  v_cvt_pk_bf16_f32 v18, v20, v21
  v_cvt_pk_bf16_f32 v19, v22, v23
  v_smfmac_f32_16x16x64_bf16 v[24:27], v[40:43], v[248:255], v2
  v_bfi_b32 v16, 1, s15, v16
  v_bfi_b32 v18, 1, s15, v18
  buffer_store_dwordx4 v[16:19], v5, s[4:7], s20 offen
  s_nop 4
  v_cvt_pk_bf16_f32 v24, v24, v25
  v_cvt_pk_bf16_f32 v25, v26, v27
  v_bfi_b32 v24, 1, s15, v24
  buffer_store_dwordx2 v[24:25], v45, s[4:7], s21 offen
  s_add_u32 s14, s14, 1
  s_lshl_b32 s47, s14, 5
  s_add_u32 s47, s47, s12
  s_lshl_b32 s48, s47, 12
  s_lshl_b32 s49, s13, 10
  s_add_u32 s48, s48, s49
  s_add_u32 s75, s48, 67108864
  s_lshl_b32 s48, s47, 13
  s_add_u32 s48, s48, s46
  s_add_u32 s54, s48, 33554432
  s_sub_u32 s55, s54, 16777216
  s_lshl_b32 s48, s47, 13
  s_add_u32 s72, s48, 17039360
  s_add_u32 s73, s72, 0
  s_add_u32 s49, s72, 16777216
  s_cmp_lt_u32 s13, 2
  s_cselect_b32 s73, s73, s49
  s_and_b32 s49, s13, 1
  s_lshl_b32 s49, s49, 12
  s_add_u32 s73, s73, s49
  s_mov_b32 s96, s51
  s_add_u32 s47, s14, 1
  s_lshr_b32 s47, s47, 4
  s_min_u32 s47, s47, 3
  s_lshl_b32 s47, s47, 6
  s_lshr_b32 s48, s12, 1
  s_lshl_b32 s48, s48, 2
  s_add_u32 s51, s47, s48
  s_add_u32 s51, s51, 0
  s_and_b32 s47, s14, 3
  s_mul_i32 s47, s47, 10240
  s_add_u32 s16, s47, s42
  s_add_u32 s16, s16, 458752
  s_add_u32 s17, s47, s23
  s_add_u32 s17, s17, 458752
  s_add_u32 s47, s14, 2
  s_and_b32 s47, s47, 3
  s_mul_i32 s47, s47, 10240
  s_add_u32 s18, s47, s23
  s_add_u32 s18, s18, 458752
  s_cmp_eq_u32 s24, 0
  s_cbranch_scc1 NR_14
  s_add_u32 s48, s22, 4096
  s_sleep 2
  v_mov_b32 v54, 0x3f80
  v_mov_b32 v55, 0x3f800000
  v_bfe_u32 v49, v0, 4, 1
  v_cmp_eq_u32 vcc, 1, v49
  s_nop 1
  v_cndmask_b32 v54, v54, v55, vcc
  v_cndmask_b32 v40, 0, v54, s[28:29]
  v_cndmask_b32 v41, 0, v54, s[30:31]
  v_cndmask_b32 v42, 0, v54, s[32:33]
  v_cndmask_b32 v43, 0, v54, s[34:35]
  v_lshrrev_b32 v48, 8, v0
  v_lshlrev_b32 v48, 7, v48
  v_and_b32 v54, 0x30, v0
  v_add_u32 v48, v48, v54
  v_bfe_u32 v54, v0, 6, 1
  v_lshl_add_u32 v48, v54, 3, v48
  v_mov_b32 v52, -1
  v_mov_b32 v53, -1
  buffer_load_dwordx4 v[8:11], v0, s[4:7], s22 offen offset:0 sc1
  buffer_load_dwordx4 v[12:15], v0, s[4:7], s22 offen offset:1024 sc1
  buffer_load_dwordx4 v[16:19], v0, s[4:7], s22 offen offset:2048 sc1
  buffer_load_dwordx4 v[20:23], v0, s[4:7], s22 offen offset:3072 sc1
  buffer_load_dwordx4 v[24:27], v0, s[4:7], s48 offen offset:0 sc1
  buffer_load_dwordx4 v[28:31], v0, s[4:7], s48 offen offset:1024 sc1
  buffer_load_dwordx4 v[32:35], v0, s[4:7], s48 offen offset:2048 sc1
  buffer_load_dwordx4 v[36:39], v0, s[4:7], s48 offen offset:3072 sc1
  s_cmp_eq_u32 s15, 1
  s_cbranch_scc1 RO_15
  v_mov_b32 v49, 0
  s_waitcnt vmcnt(7)
  v_or3_b32 v49, v49, v8, v10
  v_mfma_f32_16x16x32_bf16 v[44:47], v[8:11], v[40:43], 0
  s_waitcnt vmcnt(6)
  v_or3_b32 v49, v49, v12, v14
  v_mfma_f32_16x16x32_bf16 v[44:47], v[12:15], v[40:43], v[44:47]
  s_waitcnt vmcnt(5)
  v_or3_b32 v49, v49, v16, v18
  v_mfma_f32_16x16x32_bf16 v[44:47], v[16:19], v[40:43], v[44:47]
  s_waitcnt vmcnt(4)
  v_or3_b32 v49, v49, v20, v22
  v_mfma_f32_16x16x32_bf16 v[44:47], v[20:23], v[40:43], v[44:47]
  s_waitcnt vmcnt(3)
  v_or3_b32 v49, v49, v24, v26
  v_mfma_f32_16x16x32_bf16 v[44:47], v[24:27], v[40:43], v[44:47]
  s_waitcnt vmcnt(2)
  v_or3_b32 v49, v49, v28, v30
  v_mfma_f32_16x16x32_bf16 v[44:47], v[28:31], v[40:43], v[44:47]
  s_waitcnt vmcnt(1)
  v_or3_b32 v49, v49, v32, v34
  v_mfma_f32_16x16x32_bf16 v[44:47], v[32:35], v[40:43], v[44:47]
  s_waitcnt vmcnt(0)
  v_or3_b32 v49, v49, v36, v38
  v_mfma_f32_16x16x32_bf16 v[44:47], v[36:39], v[40:43], v[44:47]
  v_and_b32 v49, 1, v49
  v_cmp_ne_u32 vcc, 0, v49
  s_nop 0
  s_cbranch_vccnz RR_17
RK_18:
  s_branch RF_16
RO_15:
  v_mov_b32 v49, -1
  s_waitcnt vmcnt(7)
  v_and_b32 v49, v49, v8
  v_and_b32 v49, v49, v10
  v_mfma_f32_16x16x32_bf16 v[44:47], v[8:11], v[40:43], 0
  s_waitcnt vmcnt(6)
  v_and_b32 v49, v49, v12
  v_and_b32 v49, v49, v14
  v_mfma_f32_16x16x32_bf16 v[44:47], v[12:15], v[40:43], v[44:47]
  s_waitcnt vmcnt(5)
  v_and_b32 v49, v49, v16
  v_and_b32 v49, v49, v18
  v_mfma_f32_16x16x32_bf16 v[44:47], v[16:19], v[40:43], v[44:47]
  s_waitcnt vmcnt(4)
  v_and_b32 v49, v49, v20
  v_and_b32 v49, v49, v22
  v_mfma_f32_16x16x32_bf16 v[44:47], v[20:23], v[40:43], v[44:47]
  s_waitcnt vmcnt(3)
  v_and_b32 v49, v49, v24
  v_and_b32 v49, v49, v26
  v_mfma_f32_16x16x32_bf16 v[44:47], v[24:27], v[40:43], v[44:47]
  s_waitcnt vmcnt(2)
  v_and_b32 v49, v49, v28
  v_and_b32 v49, v49, v30
  v_mfma_f32_16x16x32_bf16 v[44:47], v[28:31], v[40:43], v[44:47]
  s_waitcnt vmcnt(1)
  v_and_b32 v49, v49, v32
  v_and_b32 v49, v49, v34
  v_mfma_f32_16x16x32_bf16 v[44:47], v[32:35], v[40:43], v[44:47]
  s_waitcnt vmcnt(0)
  v_and_b32 v49, v49, v36
  v_and_b32 v49, v49, v38
  v_mfma_f32_16x16x32_bf16 v[44:47], v[36:39], v[40:43], v[44:47]
  v_and_b32 v49, 1, v49
  v_cmp_ne_u32 vcc, 1, v49
  s_nop 0
  s_cbranch_vccnz RR_19
RK_20:
RF_16:
  s_nop 3
  v_cvt_pk_bf16_f32 v50, v44, v45
  v_cvt_pk_bf16_f32 v51, v46, v47
  v_min_u32 v51, s41, v51
  buffer_store_dwordx2 v[50:51], v48, s[4:7], s17 offen
  buffer_store_dwordx2 v[52:53], v48, s[4:7], s18 offen
NR_14:
  s_waitcnt vmcnt(3)
  v_readlane_b32 s95, v7, 32
  v_readlane_b32 s71, v7, 48
FS_22:
  s_nop 0
  s_min_u32 s47, s95, s71
  s_and_b32 s48, s14, 15
  s_cmp_gt_u32 s47, s48
  s_cbranch_scc1 FK_21
  v_bfe_u32 v56, v0, 8, 1
  v_lshlrev_b32 v56, 8, v56
  v_add_u32 v56, s96, v56
  buffer_load_dword v57, v56, s[4:7], 0 offen sc1
  s_sub_u32 s74, s74, 1
  s_cbranch_scc1 L_TIMEOUT
  s_waitcnt vmcnt(0)
  v_readlane_b32 s95, v57, 0
  v_readlane_b32 s71, v57, 16
  s_branch FS_22
FK_21:
  s_barrier
  s_xor_b32 s15, s15, 1
  s_branch CF_TOP
PMR_12:
  buffer_load_dwordx4 v[20:23], v0, s[4:7], s16 offen sc1
  buffer_load_dwordx4 v[24:27], v0, s[4:7], s16 offen offset:1024 sc1
  buffer_load_dwordx4 v[28:31], v32, s[4:7], s16 offen offset:2048 sc1
  s_sub_u32 s74, s74, 1
  s_cbranch_scc1 L_TIMEOUT
  s_waitcnt vmcnt(0)
  v_max3_u32 v35, v21, v23, v25
  v_max3_u32 v35, v35, v27, v29
  v_max_u32 v35, v35, v31
  v_cmp_eq_u32 vcc, -1, v35
  s_nop 0
  s_cbranch_vccnz PMR_12
  s_branch PMK_13
RR_17:
  buffer_load_dwordx4 v[8:11], v0, s[4:7], s22 offen offset:0 sc1
  buffer_load_dwordx4 v[12:15], v0, s[4:7], s22 offen offset:1024 sc1
  buffer_load_dwordx4 v[16:19], v0, s[4:7], s22 offen offset:2048 sc1
  buffer_load_dwordx4 v[20:23], v0, s[4:7], s22 offen offset:3072 sc1
  buffer_load_dwordx4 v[24:27], v0, s[4:7], s48 offen offset:0 sc1
  buffer_load_dwordx4 v[28:31], v0, s[4:7], s48 offen offset:1024 sc1
  buffer_load_dwordx4 v[32:35], v0, s[4:7], s48 offen offset:2048 sc1
  buffer_load_dwordx4 v[36:39], v0, s[4:7], s48 offen offset:3072 sc1
  s_sub_u32 s74, s74, 1
  s_cbranch_scc1 L_TIMEOUT
  v_mov_b32 v49, 0
  s_waitcnt vmcnt(7)
  v_or3_b32 v49, v49, v8, v10
  v_mfma_f32_16x16x32_bf16 v[44:47], v[8:11], v[40:43], 0
  s_waitcnt vmcnt(6)
  v_or3_b32 v49, v49, v12, v14
  v_mfma_f32_16x16x32_bf16 v[44:47], v[12:15], v[40:43], v[44:47]
  s_waitcnt vmcnt(5)
  v_or3_b32 v49, v49, v16, v18
  v_mfma_f32_16x16x32_bf16 v[44:47], v[16:19], v[40:43], v[44:47]
  s_waitcnt vmcnt(4)
  v_or3_b32 v49, v49, v20, v22
  v_mfma_f32_16x16x32_bf16 v[44:47], v[20:23], v[40:43], v[44:47]
  s_waitcnt vmcnt(3)
  v_or3_b32 v49, v49, v24, v26
  v_mfma_f32_16x16x32_bf16 v[44:47], v[24:27], v[40:43], v[44:47]
  s_waitcnt vmcnt(2)
  v_or3_b32 v49, v49, v28, v30
  v_mfma_f32_16x16x32_bf16 v[44:47], v[28:31], v[40:43], v[44:47]
  s_waitcnt vmcnt(1)
  v_or3_b32 v49, v49, v32, v34
  v_mfma_f32_16x16x32_bf16 v[44:47], v[32:35], v[40:43], v[44:47]
  s_waitcnt vmcnt(0)
  v_or3_b32 v49, v49, v36, v38
  v_mfma_f32_16x16x32_bf16 v[44:47], v[36:39], v[40:43], v[44:47]
  v_and_b32 v49, 1, v49
  v_cmp_ne_u32 vcc, 0, v49
  s_nop 0
  s_cbranch_vccnz RR_17
  s_branch RK_18
RR_19:
  buffer_load_dwordx4 v[8:11], v0, s[4:7], s22 offen offset:0 sc1
  buffer_load_dwordx4 v[12:15], v0, s[4:7], s22 offen offset:1024 sc1
  buffer_load_dwordx4 v[16:19], v0, s[4:7], s22 offen offset:2048 sc1
  buffer_load_dwordx4 v[20:23], v0, s[4:7], s22 offen offset:3072 sc1
  buffer_load_dwordx4 v[24:27], v0, s[4:7], s48 offen offset:0 sc1
  buffer_load_dwordx4 v[28:31], v0, s[4:7], s48 offen offset:1024 sc1
  buffer_load_dwordx4 v[32:35], v0, s[4:7], s48 offen offset:2048 sc1
  buffer_load_dwordx4 v[36:39], v0, s[4:7], s48 offen offset:3072 sc1
  s_sub_u32 s74, s74, 1
  s_cbranch_scc1 L_TIMEOUT
  v_mov_b32 v49, -1
  s_waitcnt vmcnt(7)
  v_and_b32 v49, v49, v8
  v_and_b32 v49, v49, v10
  v_mfma_f32_16x16x32_bf16 v[44:47], v[8:11], v[40:43], 0
  s_waitcnt vmcnt(6)
  v_and_b32 v49, v49, v12
  v_and_b32 v49, v49, v14
  v_mfma_f32_16x16x32_bf16 v[44:47], v[12:15], v[40:43], v[44:47]
  s_waitcnt vmcnt(5)
  v_and_b32 v49, v49, v16
  v_and_b32 v49, v49, v18
  v_mfma_f32_16x16x32_bf16 v[44:47], v[16:19], v[40:43], v[44:47]
  s_waitcnt vmcnt(4)
  v_and_b32 v49, v49, v20
  v_and_b32 v49, v49, v22
  v_mfma_f32_16x16x32_bf16 v[44:47], v[20:23], v[40:43], v[44:47]
  s_waitcnt vmcnt(3)
  v_and_b32 v49, v49, v24
  v_and_b32 v49, v49, v26
  v_mfma_f32_16x16x32_bf16 v[44:47], v[24:27], v[40:43], v[44:47]
  s_waitcnt vmcnt(2)
  v_and_b32 v49, v49, v28
  v_and_b32 v49, v49, v30
  v_mfma_f32_16x16x32_bf16 v[44:47], v[28:31], v[40:43], v[44:47]
  s_waitcnt vmcnt(1)
  v_and_b32 v49, v49, v32
  v_and_b32 v49, v49, v34
  v_mfma_f32_16x16x32_bf16 v[44:47], v[32:35], v[40:43], v[44:47]
  s_waitcnt vmcnt(0)
  v_and_b32 v49, v49, v36
  v_and_b32 v49, v49, v38
  v_mfma_f32_16x16x32_bf16 v[44:47], v[36:39], v[40:43], v[44:47]
  v_and_b32 v49, 1, v49
  v_cmp_ne_u32 vcc, 1, v49
  s_nop 0
  s_cbranch_vccnz RR_19
  s_branch RK_20
CF_EXIT:
  buffer_store_dwordx4 v[32:35], v0, s[4:7], s75 offen sc1
  v_mov_b32 v38, 63
  v_mov_b32 v39, 0
  buffer_store_dword v38, v39, s[4:7], s26 offen sc1
  s_waitcnt vmcnt(0) lgkmcnt(0)
  s_barrier
  s_lshl_b32 s47, s12, 7
  s_add_u32 s47, s47, 4096
  v_mov_b32 v43, 64
  v_mov_b32 v40, 0
  buffer_store_dword v43, v40, s[4:7], s47 offen sc1
  s_waitcnt vmcnt(0)
  s_branch L_DONE
CSLOW_4:
  s_mul_i32 s42, s13, 2560
  s_lshl_b32 s43, s13, 9
  s_lshl_b32 s46, s13, 11
  s_add_u32 s44, s46, 24576
  s_lshl_b32 s47, s12, 2
  s_add_u32 s47, s47, s13
  s_mul_i32 s47, s47, 18432
  s_add_u32 s45, s47, 524288
  s_add_u32 s90, s45, 0
  s_add_u32 s91, s45, 4096
  s_add_u32 s92, s45, 8192
  s_add_u32 s93, s45, 12288
  s_add_u32 s94, s45, 16384
  s_lshl_b32 s47, s12, 8
  s_lshl_b32 s48, s13, 16
  s_add_u32 s19, s47, s48
  s_add_u32 s19, s19, 65536
  s_add_u32 s20, s19, 32768
  s_lshl_b32 s48, s13, 14
  s_add_u32 s21, s47, s48
  s_add_u32 s21, s21, 327680
  s_lshl_b32 s26, s12, 7
  s_add_u32 s26, s26, 4096
  s_mov_b32 s24, 0
  s_cmp_eq_u32 s13, 0
  s_cselect_b32 s24, 1, 0
  s_cmp_lt_u32 s12, 8
  s_cselect_b32 s48, 1, 0
  s_cmp_eq_u32 s13, 1
  s_cselect_b32 s48, s48, 0
  s_or_b32 s24, s24, s48
  s_add_u32 s49, s12, 32
  s_cmp_eq_u32 s13, 0
  s_cselect_b32 s49, s12, s49
  s_min_u32 s49, s49, 39
  s_lshl_b32 s22, s49, 13
  s_add_u32 s22, s22, 65536
  s_lshr_b32 s47, s49, 3
  s_mul_i32 s47, s47, 20
  s_bfe_u32 s48, s49, 0x10002
  s_lshl_b32 s48, s48, 3
  s_add_u32 s47, s47, s48
  s_bfe_u32 s48, s49, 0x10001
  s_lshl_b32 s48, s48, 2
  s_add_u32 s47, s47, s48
  s_sub_u32 s48, s49, 32
  s_lshr_b32 s48, s48, 1
  s_mul_i32 s48, s48, 20
  s_add_u32 s48, s48, 16
  s_cmp_lt_u32 s49, 32
  s_cselect_b32 s47, s47, s48
  s_lshl_b32 s47, s47, 7
  s_and_b32 s48, s49, 1
  s_lshl_b32 s48, s48, 6
  s_add_u32 s23, s47, s48
  s_mov_b32 s38, 0x3e0293ee
  s_mov_b32 s39, 0x3f803f80
  s_mov_b32 s40, 0x3f003f00
  s_mov_b32 s41, 0xfffffffe
  v_and_b32 v8, 63, v0
  v_and_b32 v9, 15, v8
  v_lshrrev_b32 v10, 4, v8
  v_lshlrev_b32 v0, 4, v8
  v_and_b32 v11, 7, v9
  v_lshl_add_u32 v11, v10, 3, v11
  v_lshlrev_b32 v1, 4, v11
  v_mov_b32 v12, 0x4444
  v_mov_b32 v13, 0xeeee
  v_cmp_gt_u32 vcc, 8, v9
  s_nop 1
  v_cndmask_b32 v2, v13, v12, vcc
  v_lshrrev_b32 v11, 2, v9
  v_lshl_add_u32 v11, v10, 3, v11
  v_lshlrev_b32 v11, 4, v11
  v_and_b32 v12, 1, v9
  v_lshl_add_u32 v3, v12, 3, v11
  v_lshrrev_b32 v11, 1, v10
  v_lshl_add_u32 v11, v11, 4, v9
  s_lshl_b32 s47, s13, 5
  v_add_u32 v11, s47, v11
  v_lshlrev_b32 v11, 4, v11
  v_and_b32 v12, 1, v10
  v_lshl_add_u32 v4, v12, 3, v11
  v_lshlrev_b32 v11, 13, v10
  v_lshl_add_u32 v5, v9, 4, v11
  v_bfe_u32 v11, v9, 1, 2
  v_cmp_eq_u32 s[28:29], 0, v11
  v_cmp_eq_u32 s[30:31], 1, v11
  v_cmp_eq_u32 s[32:33], 2, v11
  v_cmp_eq_u32 s[34:35], 3, v11
  v_cmp_gt_u32 s[36:37], 32, v8
  v_cmp_le_u32 s[52:53], 32, v8
  v_add_u32 v6, s44, v0
  v_lshrrev_b32 v11, 4, v0
  v_lshrrev_b32 v20, 4, v11
  v_and_b32 v21, 15, v11
  v_lshlrev_b32 v8, 13, v20
  v_lshl_add_u32 v8, v21, 4, v8
  s_movk_i32 s47, 1280
  v_mul_lo_u32 v9, v20, s47
  v_lshl_add_u32 v9, v21, 4, v9
  v_lshrrev_b32 v22, 2, v21
  v_and_b32 v23, 1, v22
  v_lshl_add_u32 v23, v20, 2, v23
  v_lshlrev_b32 v23, 8, v23
  v_lshrrev_b32 v22, 1, v22
  v_lshl_add_u32 v23, v22, 5, v23
  v_and_b32 v22, 3, v21
  v_lshl_add_u32 v23, v22, 3, v23
  s_lshl_b32 s47, s13, 6
  v_add_u32 v10, s47, v23
  s_lshl_b32 s47, s13, 15
  s_lshl_b32 s48, s12, 8
  s_add_u32 s96, s47, s48
  s_lshl_b32 s47, s12, 7
  s_lshl_b32 s48, s13, 2
  s_add_u32 s47, s47, s48
  s_mul_i32 s97, s47, 1280
  s_mov_b32 s8, s56
  s_and_b32 s9, s57, 0xffff
  s_mov_b32 s10, 5242880
  s_mov_b32 s11, 0x20000
  s_add_u32 s47, s96, 131072
  s_add_u32 m0, s46, 65536
  s_nop 0
  buffer_load_dwordx4 v8, s[8:11], s47 offen nt lds
  s_add_u32 s47, s96, 1179648
  s_add_u32 m0, s46, 66560
  s_nop 0
  buffer_load_dwordx4 v8, s[8:11], s47 offen nt lds
  s_add_u32 s47, s96, 2097152
  s_add_u32 m0, s46, 73728
  s_nop 0
  buffer_load_dwordx4 v8, s[8:11], s47 offen nt lds
  s_add_u32 s47, s96, 3145728
  s_add_u32 m0, s46, 74752
  s_nop 0
  buffer_load_dwordx4 v8, s[8:11], s47 offen nt lds
  s_add_u32 s47, s96, 2228224
  s_add_u32 m0, s46, 81920
  s_nop 0
  buffer_load_dwordx4 v8, s[8:11], s47 offen nt lds
  s_add_u32 s47, s96, 3276800
  s_add_u32 m0, s46, 82944
  s_nop 0
  buffer_load_dwordx4 v8, s[8:11], s47 offen nt lds
  s_add_u32 s47, s96, 4194304
  s_add_u32 m0, s46, 90112
  s_nop 0
  buffer_load_dwordx4 v8, s[8:11], s47 offen nt lds
  s_add_u32 s47, s96, 4325376
  s_add_u32 m0, s46, 91136
  s_nop 0
  buffer_load_dwordx4 v8, s[8:11], s47 offen nt lds
  s_add_u32 s47, s96, 262144
  s_add_u32 m0, s46, 98304
  s_nop 0
  buffer_load_dwordx4 v8, s[8:11], s47 offen nt lds
  s_add_u32 s47, s96, 1310720
  s_add_u32 m0, s46, 99328
  s_nop 0
  buffer_load_dwordx4 v8, s[8:11], s47 offen nt lds
  s_add_u32 s47, s96, 2359296
  s_add_u32 m0, s46, 106496
  s_nop 0
  buffer_load_dwordx4 v8, s[8:11], s47 offen nt lds
  s_add_u32 s47, s96, 3407872
  s_add_u32 m0, s46, 107520
  s_nop 0
  buffer_load_dwordx4 v8, s[8:11], s47 offen nt lds
  s_add_u32 s47, s96, 2490368
  s_add_u32 m0, s46, 114688
  s_nop 0
  buffer_load_dwordx4 v8, s[8:11], s47 offen nt lds
  s_add_u32 s47, s96, 3538944
  s_add_u32 m0, s46, 115712
  s_nop 0
  buffer_load_dwordx4 v8, s[8:11], s47 offen nt lds
  s_add_u32 s47, s96, 4456448
  s_add_u32 m0, s46, 122880
  s_nop 0
  buffer_load_dwordx4 v8, s[8:11], s47 offen nt lds
  s_add_u32 s47, s96, 4587520
  s_add_u32 m0, s46, 123904
  s_nop 0
  buffer_load_dwordx4 v8, s[8:11], s47 offen nt lds
  s_add_u32 s47, s96, 524288
  s_add_u32 m0, s46, 131072
  s_nop 0
  buffer_load_dwordx4 v8, s[8:11], s47 offen nt lds
  s_add_u32 s47, s96, 1572864
  s_add_u32 m0, s46, 132096
  s_nop 0
  buffer_load_dwordx4 v8, s[8:11], s47 offen nt lds
  s_add_u32 s47, s96, 655360
  s_add_u32 m0, s46, 139264
  s_nop 0
  buffer_load_dwordx4 v8, s[8:11], s47 offen nt lds
  s_add_u32 s47, s96, 1703936
  s_add_u32 m0, s46, 140288
  s_nop 0
  buffer_load_dwordx4 v8, s[8:11], s47 offen nt lds
  s_add_u32 s47, s96, 2621440
  s_add_u32 m0, s46, 147456
  s_nop 0
  buffer_load_dwordx4 v8, s[8:11], s47 offen nt lds
  s_add_u32 s47, s96, 3670016
  s_add_u32 m0, s46, 148480
  s_nop 0
  buffer_load_dwordx4 v8, s[8:11], s47 offen nt lds
  s_add_u32 s47, s96, 4718592
  s_add_u32 m0, s46, 155648
  s_nop 0
  buffer_load_dwordx4 v8, s[8:11], s47 offen nt lds
  s_add_u32 s47, s96, 4849664
  s_add_u32 m0, s46, 156672
  s_nop 0
  buffer_load_dwordx4 v8, s[8:11], s47 offen nt lds
  s_add_u32 s47, s96, 786432
  s_add_u32 m0, s46, 24576
  s_nop 0
  buffer_load_dwordx4 v8, s[8:11], s47 offen nt lds
  s_add_u32 s47, s96, 1835008
  s_add_u32 m0, s46, 25600
  s_nop 0
  buffer_load_dwordx4 v8, s[8:11], s47 offen nt lds
  s_add_u32 s47, s96, 917504
  s_add_u32 m0, s46, 32768
  s_nop 0
  buffer_load_dwordx4 v8, s[8:11], s47 offen nt lds
  s_add_u32 s47, s96, 1966080
  s_add_u32 m0, s46, 33792
  s_nop 0
  buffer_load_dwordx4 v8, s[8:11], s47 offen nt lds
  s_add_u32 s47, s96, 2883584
  s_add_u32 m0, s46, 40960
  s_nop 0
  buffer_load_dwordx4 v8, s[8:11], s47 offen nt lds
  s_add_u32 s47, s96, 3932160
  s_add_u32 m0, s46, 41984
  s_nop 0
  buffer_load_dwordx4 v8, s[8:11], s47 offen nt lds
  s_add_u32 s47, s96, 4980736
  s_add_u32 m0, s46, 49152
  s_nop 0
  buffer_load_dwordx4 v8, s[8:11], s47 offen nt lds
  s_add_u32 s47, s96, 5111808
  s_add_u32 m0, s46, 50176
  s_nop 0
  buffer_load_dwordx4 v8, s[8:11], s47 offen nt lds
  s_mov_b32 s8, s58
  s_and_b32 s9, s59, 0xffff
  s_mov_b32 s10, 5242880
  s_mov_b32 s11, 0x20000
  s_add_u32 s47, s96, 131072
  s_add_u32 m0, s46, 57344
  s_nop 0
  buffer_load_dwordx4 v8, s[8:11], s47 offen nt lds
  s_add_u32 s47, s96, 1179648
  s_add_u32 m0, s46, 58368
  s_nop 0
  buffer_load_dwordx4 v8, s[8:11], s47 offen nt lds
  s_waitcnt vmcnt(32)
  s_barrier
  v_add_u32 v11, 65536, v10
  ds_read_b64_tr_b16 a[0:1], v11 offset:0
  ds_read_b64_tr_b16 a[2:3], v11 offset:512
  ds_read_b64_tr_b16 a[4:5], v11 offset:4096
  ds_read_b64_tr_b16 a[6:7], v11 offset:4608
  s_waitcnt lgkmcnt(0)
  s_mov_b32 s80, s64
  s_and_b32 s81, s65, 0xffff
  s_mov_b32 s82, 10240
  s_mov_b32 s83, 0x20000
  v_lshrrev_b32 v53, 4, v0
  s_lshl_b32 s47, s13, 6
  v_add_u32 v53, s47, v53
  s_mov_b32 s48, 13108
  v_add_u32 v28, 0, v53
  v_lshrrev_b32 v44, 4, v28
  v_lshrrev_b32 v45, 2, v44
  v_and_b32 v46, 3, v44
  v_mul_u32_u24 v47, s48, v45
  v_lshrrev_b32 v47, 16, v47
  v_mul_u32_u24 v48, 5, v47
  v_sub_u32 v48, v45, v48
  v_and_b32 v49, 1, v28
  v_lshrrev_b32 v50, 1, v48
  v_lshlrev_b32 v50, 8, v50
  v_and_b32 v51, 1, v48
  v_lshl_add_u32 v50, v51, 4, v50
  v_lshlrev_b32 v51, 7, v49
  v_lshlrev_b32 v52, 4, v49
  v_cmp_eq_u32 vcc, 4, v48
  s_nop 1
  v_cndmask_b32 v51, v51, v52, vcc
  v_add_u32 v50, v50, v51
  v_lshl_add_u32 v50, v47, 5, v50
  v_lshl_add_u32 v50, v46, 2, v50
  v_bfe_u32 v51, v28, 1, 3
  s_movk_i32 s49, 1280
  v_mul_lo_u32 v51, v51, s49
  v_lshl_add_u32 v51, v50, 1, v51
  buffer_load_dwordx2 v[34:35], v51, s[80:83], 0 offen
  v_lshlrev_b32 v28, 3, v28
  v_add_u32 v29, 256, v53
  v_lshrrev_b32 v44, 4, v29
  v_lshrrev_b32 v45, 2, v44
  v_and_b32 v46, 3, v44
  v_mul_u32_u24 v47, s48, v45
  v_lshrrev_b32 v47, 16, v47
  v_mul_u32_u24 v48, 5, v47
  v_sub_u32 v48, v45, v48
  v_and_b32 v49, 1, v29
  v_lshrrev_b32 v50, 1, v48
  v_lshlrev_b32 v50, 8, v50
  v_and_b32 v51, 1, v48
  v_lshl_add_u32 v50, v51, 4, v50
  v_lshlrev_b32 v51, 7, v49
  v_lshlrev_b32 v52, 4, v49
  v_cmp_eq_u32 vcc, 4, v48
  s_nop 1
  v_cndmask_b32 v51, v51, v52, vcc
  v_add_u32 v50, v50, v51
  v_lshl_add_u32 v50, v47, 5, v50
  v_lshl_add_u32 v50, v46, 2, v50
  v_bfe_u32 v51, v29, 1, 3
  s_movk_i32 s49, 1280
  v_mul_lo_u32 v51, v51, s49
  v_lshl_add_u32 v51, v50, 1, v51
  buffer_load_dwordx2 v[36:37], v51, s[80:83], 0 offen
  v_lshlrev_b32 v29, 3, v29
  v_add_u32 v30, 512, v53
  v_lshrrev_b32 v44, 4, v30
  v_lshrrev_b32 v45, 2, v44
  v_and_b32 v46, 3, v44
  v_mul_u32_u24 v47, s48, v45
  v_lshrrev_b32 v47, 16, v47
  v_mul_u32_u24 v48, 5, v47
  v_sub_u32 v48, v45, v48
  v_and_b32 v49, 1, v30
  v_lshrrev_b32 v50, 1, v48
  v_lshlrev_b32 v50, 8, v50
  v_and_b32 v51, 1, v48
  v_lshl_add_u32 v50, v51, 4, v50
  v_lshlrev_b32 v51, 7, v49
  v_lshlrev_b32 v52, 4, v49
  v_cmp_eq_u32 vcc, 4, v48
  s_nop 1
  v_cndmask_b32 v51, v51, v52, vcc
  v_add_u32 v50, v50, v51
  v_lshl_add_u32 v50, v47, 5, v50
  v_lshl_add_u32 v50, v46, 2, v50
  v_bfe_u32 v51, v30, 1, 3
  s_movk_i32 s49, 1280
  v_mul_lo_u32 v51, v51, s49
  v_lshl_add_u32 v51, v50, 1, v51
  buffer_load_dwordx2 v[38:39], v51, s[80:83], 0 offen
  v_lshlrev_b32 v30, 3, v30
  v_add_u32 v31, 768, v53
  v_lshrrev_b32 v44, 4, v31
  v_lshrrev_b32 v45, 2, v44
  v_and_b32 v46, 3, v44
  v_mul_u32_u24 v47, s48, v45
  v_lshrrev_b32 v47, 16, v47
  v_mul_u32_u24 v48, 5, v47
  v_sub_u32 v48, v45, v48
  v_and_b32 v49, 1, v31
  v_lshrrev_b32 v50, 1, v48
  v_lshlrev_b32 v50, 8, v50
  v_and_b32 v51, 1, v48
  v_lshl_add_u32 v50, v51, 4, v50
  v_lshlrev_b32 v51, 7, v49
  v_lshlrev_b32 v52, 4, v49
  v_cmp_eq_u32 vcc, 4, v48
  s_nop 1
  v_cndmask_b32 v51, v51, v52, vcc
  v_add_u32 v50, v50, v51
  v_lshl_add_u32 v50, v47, 5, v50
  v_lshl_add_u32 v50, v46, 2, v50
  v_bfe_u32 v51, v31, 1, 3
  s_movk_i32 s49, 1280
  v_mul_lo_u32 v51, v51, s49
  v_lshl_add_u32 v51, v50, 1, v51
  buffer_load_dwordx2 v[40:41], v51, s[80:83], 0 offen
  v_lshlrev_b32 v31, 3, v31
  v_add_u32 v32, 1024, v53
  v_lshrrev_b32 v44, 4, v32
  v_lshrrev_b32 v45, 2, v44
  v_and_b32 v46, 3, v44
  v_mul_u32_u24 v47, s48, v45
  v_lshrrev_b32 v47, 16, v47
  v_mul_u32_u24 v48, 5, v47
  v_sub_u32 v48, v45, v48
  v_and_b32 v49, 1, v32
  v_lshrrev_b32 v50, 1, v48
  v_lshlrev_b32 v50, 8, v50
  v_and_b32 v51, 1, v48
  v_lshl_add_u32 v50, v51, 4, v50
  v_lshlrev_b32 v51, 7, v49
  v_lshlrev_b32 v52, 4, v49
  v_cmp_eq_u32 vcc, 4, v48
  s_nop 1
  v_cndmask_b32 v51, v51, v52, vcc
  v_add_u32 v50, v50, v51
  v_lshl_add_u32 v50, v47, 5, v50
  v_lshl_add_u32 v50, v46, 2, v50
  v_bfe_u32 v51, v32, 1, 3
  s_movk_i32 s49, 1280
  v_mul_lo_u32 v51, v51, s49
  v_lshl_add_u32 v51, v50, 1, v51
  buffer_load_dwordx2 v[42:43], v51, s[80:83], 0 offen
  v_lshlrev_b32 v32, 3, v32
  s_waitcnt vmcnt(35)
  s_barrier
  s_add_u32 s47, s96, 2228224
  s_add_u32 m0, s46, 65536
  s_nop 0
  buffer_load_dwordx4 v8, s[8:11], s47 offen nt lds
  s_add_u32 s47, s96, 3276800
  s_add_u32 m0, s46, 66560
  s_nop 0
  buffer_load_dwordx4 v8, s[8:11], s47 offen nt lds
  v_add_u32 v11, 73728, v10
  ds_read_b64_tr_b16 a[8:9], v11 offset:0
  ds_read_b64_tr_b16 a[10:11], v11 offset:512
  ds_read_b64_tr_b16 a[12:13], v11 offset:4096
  ds_read_b64_tr_b16 a[14:15], v11 offset:4608
  s_waitcnt lgkmcnt(0)
  s_waitcnt vmcnt(35)
  s_barrier
  s_add_u32 s47, s96, 262144
  s_add_u32 m0, s46, 73728
  s_nop 0
  buffer_load_dwordx4 v8, s[8:11], s47 offen nt lds
  s_add_u32 s47, s96, 1310720
  s_add_u32 m0, s46, 74752
  s_nop 0
  buffer_load_dwordx4 v8, s[8:11], s47 offen nt lds
  v_add_u32 v11, 81920, v10
  ds_read_b64_tr_b16 a[16:17], v11 offset:0
  ds_read_b64_tr_b16 a[18:19], v11 offset:512
  ds_read_b64_tr_b16 a[20:21], v11 offset:4096
  ds_read_b64_tr_b16 a[22:23], v11 offset:4608
  s_waitcnt lgkmcnt(0)
  s_waitcnt vmcnt(35)
  s_barrier
  s_add_u32 s47, s96, 4456448
  s_add_u32 m0, s46, 81920
  s_nop 0
  buffer_load_dwordx4 v8, s[8:11], s47 offen nt lds
  s_add_u32 s47, s96, 4587520
  s_add_u32 m0, s46, 82944
  s_nop 0
  buffer_load_dwordx4 v8, s[8:11], s47 offen nt lds
  v_add_u32 v11, 90112, v10
  ds_read_b64_tr_b16 a[24:25], v11 offset:0
  ds_read_b64_tr_b16 a[26:27], v11 offset:512
  ds_read_b64_tr_b16 a[28:29], v11 offset:4096
  ds_read_b64_tr_b16 a[30:31], v11 offset:4608
  s_waitcnt lgkmcnt(0)
  s_waitcnt vmcnt(35)
  s_barrier
  s_add_u32 s47, s96, 655360
  s_add_u32 m0, s46, 90112
  s_nop 0
  buffer_load_dwordx4 v8, s[8:11], s47 offen nt lds
  s_add_u32 s47, s96, 1703936
  s_add_u32 m0, s46, 91136
  s_nop 0
  buffer_load_dwordx4 v8, s[8:11], s47 offen nt lds
  v_add_u32 v11, 98304, v10
  ds_read_b64_tr_b16 a[32:33], v11 offset:0
  ds_read_b64_tr_b16 a[34:35], v11 offset:512
  ds_read_b64_tr_b16 a[36:37], v11 offset:4096
  ds_read_b64_tr_b16 a[38:39], v11 offset:4608
  s_waitcnt lgkmcnt(0)
  s_waitcnt vmcnt(35)
  s_barrier
  s_add_u32 s47, s96, 2752512
  s_add_u32 m0, s46, 98304
  s_nop 0
  buffer_load_dwordx4 v8, s[8:11], s47 offen nt lds
  s_add_u32 s47, s96, 3801088
  s_add_u32 m0, s46, 99328
  s_nop 0
  buffer_load_dwordx4 v8, s[8:11], s47 offen nt lds
  v_add_u32 v11, 106496, v10
  ds_read_b64_tr_b16 a[40:41], v11 offset:0
  ds_read_b64_tr_b16 a[42:43], v11 offset:512
  ds_read_b64_tr_b16 a[44:45], v11 offset:4096
  ds_read_b64_tr_b16 a[46:47], v11 offset:4608
  s_waitcnt lgkmcnt(0)
  s_waitcnt vmcnt(35)
  s_barrier
  s_add_u32 s47, s96, 2883584
  s_add_u32 m0, s46, 106496
  s_nop 0
  buffer_load_dwordx4 v8, s[8:11], s47 offen nt lds
  s_add_u32 s47, s96, 3932160
  s_add_u32 m0, s46, 107520
  s_nop 0
  buffer_load_dwordx4 v8, s[8:11], s47 offen nt lds
  v_add_u32 v11, 114688, v10
  ds_read_b64_tr_b16 a[48:49], v11 offset:0
  ds_read_b64_tr_b16 a[50:51], v11 offset:512
  ds_read_b64_tr_b16 a[52:53], v11 offset:4096
  ds_read_b64_tr_b16 a[54:55], v11 offset:4608
  s_waitcnt lgkmcnt(0)
  s_waitcnt vmcnt(35)
  s_barrier
  s_add_u32 s47, s96, 3014656
  s_add_u32 m0, s46, 114688
  s_nop 0
  buffer_load_dwordx4 v8, s[8:11], s47 offen nt lds
  s_add_u32 s47, s96, 4063232
  s_add_u32 m0, s46, 115712
  s_nop 0
  buffer_load_dwordx4 v8, s[8:11], s47 offen nt lds
  v_add_u32 v11, 122880, v10
  ds_read_b64_tr_b16 a[56:57], v11 offset:0
  ds_read_b64_tr_b16 a[58:59], v11 offset:512
  ds_read_b64_tr_b16 a[60:61], v11 offset:4096
  ds_read_b64_tr_b16 a[62:63], v11 offset:4608
  s_waitcnt lgkmcnt(0)
  s_waitcnt vmcnt(35)
  s_barrier
  s_mov_b32 s8, s60
  s_and_b32 s9, s61, 0xffff
  s_mov_b32 s10, 5242880
  s_mov_b32 s11, 0x20000
  s_add_u32 s47, s96, 0
  s_add_u32 m0, s46, 122880
  s_nop 0
  buffer_load_dwordx4 v8, s[8:11], s47 offen nt lds
  s_add_u32 s47, s96, 1048576
  s_add_u32 m0, s46, 123904
  s_nop 0
  buffer_load_dwordx4 v8, s[8:11], s47 offen nt lds
  v_add_u32 v11, 131072, v10
  ds_read_b64_tr_b16 a[64:65], v11 offset:0
  ds_read_b64_tr_b16 a[66:67], v11 offset:512
  ds_read_b64_tr_b16 a[68:69], v11 offset:4096
  ds_read_b64_tr_b16 a[70:71], v11 offset:4608
  s_waitcnt lgkmcnt(0)
  s_waitcnt vmcnt(35)
  s_barrier
  s_add_u32 s47, s96, 131072
  s_add_u32 m0, s46, 131072
  s_nop 0
  buffer_load_dwordx4 v8, s[8:11], s47 offen nt lds
  s_add_u32 s47, s96, 1179648
  s_add_u32 m0, s46, 132096
  s_nop 0
  buffer_load_dwordx4 v8, s[8:11], s47 offen nt lds
  v_add_u32 v11, 139264, v10
  ds_read_b64_tr_b16 a[72:73], v11 offset:0
  ds_read_b64_tr_b16 a[74:75], v11 offset:512
  ds_read_b64_tr_b16 a[76:77], v11 offset:4096
  ds_read_b64_tr_b16 a[78:79], v11 offset:4608
  s_waitcnt lgkmcnt(0)
  s_waitcnt vmcnt(35)
  s_barrier
  s_add_u32 s47, s96, 2097152
  s_add_u32 m0, s46, 139264
  s_nop 0
  buffer_load_dwordx4 v8, s[8:11], s47 offen nt lds
  s_add_u32 s47, s96, 3145728
  s_add_u32 m0, s46, 140288
  s_nop 0
  buffer_load_dwordx4 v8, s[8:11], s47 offen nt lds
  v_add_u32 v11, 147456, v10
  ds_read_b64_tr_b16 a[80:81], v11 offset:0
  ds_read_b64_tr_b16 a[82:83], v11 offset:512
  ds_read_b64_tr_b16 a[84:85], v11 offset:4096
  ds_read_b64_tr_b16 a[86:87], v11 offset:4608
  s_waitcnt lgkmcnt(0)
  s_waitcnt vmcnt(35)
  s_barrier
  s_add_u32 s47, s96, 2228224
  s_add_u32 m0, s46, 147456
  s_nop 0
  buffer_load_dwordx4 v8, s[8:11], s47 offen nt lds
  s_add_u32 s47, s96, 3276800
  s_add_u32 m0, s46, 148480
  s_nop 0
  buffer_load_dwordx4 v8, s[8:11], s47 offen nt lds
  v_add_u32 v11, 155648, v10
  ds_read_b64_tr_b16 a[88:89], v11 offset:0
  ds_read_b64_tr_b16 a[90:91], v11 offset:512
  ds_read_b64_tr_b16 a[92:93], v11 offset:4096
  ds_read_b64_tr_b16 a[94:95], v11 offset:4608
  s_waitcnt lgkmcnt(0)
  s_waitcnt vmcnt(26)
  ds_write_b64 v28, v[34:35] offset:0
  s_waitcnt vmcnt(25)
  ds_write_b64 v29, v[36:37] offset:0
  s_waitcnt vmcnt(24)
  ds_write_b64 v30, v[38:39] offset:0
  s_waitcnt vmcnt(23)
  ds_write_b64 v31, v[40:41] offset:0
  s_waitcnt vmcnt(22)
  ds_write_b64 v32, v[42:43] offset:0
  s_barrier
  s_add_u32 s47, s96, 4194304
  s_add_u32 m0, s46, 155648
  s_nop 0
  buffer_load_dwordx4 v8, s[8:11], s47 offen nt lds
  s_add_u32 s47, s96, 4325376
  s_add_u32 m0, s46, 156672
  s_nop 0
  buffer_load_dwordx4 v8, s[8:11], s47 offen nt lds
  v_add_u32 v11, 24576, v10
  ds_read_b64_tr_b16 a[96:97], v11 offset:0
  ds_read_b64_tr_b16 a[98:99], v11 offset:512
  ds_read_b64_tr_b16 a[100:101], v11 offset:4096
  ds_read_b64_tr_b16 a[102:103], v11 offset:4608
  s_waitcnt lgkmcnt(0)
  s_barrier
  s_add_u32 s47, s96, 262144
  s_add_u32 m0, s46, 24576
  s_nop 0
  buffer_load_dwordx4 v8, s[8:11], s47 offen nt lds
  s_add_u32 s47, s96, 1310720
  s_add_u32 m0, s46, 25600
  s_nop 0
  buffer_load_dwordx4 v8, s[8:11], s47 offen nt lds
  v_add_u32 v11, 32768, v10
  ds_read_b64_tr_b16 a[104:105], v11 offset:0
  ds_read_b64_tr_b16 a[106:107], v11 offset:512
  ds_read_b64_tr_b16 a[108:109], v11 offset:4096
  ds_read_b64_tr_b16 a[110:111], v11 offset:4608
  s_waitcnt lgkmcnt(0)
  s_barrier
  s_add_u32 s47, s96, 393216
  s_add_u32 m0, s46, 32768
  s_nop 0
  buffer_load_dwordx4 v8, s[8:11], s47 offen nt lds
  s_add_u32 s47, s96, 1441792
  s_add_u32 m0, s46, 33792
  s_nop 0
  buffer_load_dwordx4 v8, s[8:11], s47 offen nt lds
  v_add_u32 v11, 40960, v10
  ds_read_b64_tr_b16 a[112:113], v11 offset:0
  ds_read_b64_tr_b16 a[114:115], v11 offset:512
  ds_read_b64_tr_b16 a[116:117], v11 offset:4096
  ds_read_b64_tr_b16 a[118:119], v11 offset:4608
  s_waitcnt lgkmcnt(0)
  s_barrier
  s_add_u32 s47, s96, 2359296
  s_add_u32 m0, s46, 40960
  s_nop 0
  buffer_load_dwordx4 v8, s[8:11], s47 offen nt lds
  s_add_u32 s47, s96, 3407872
  s_add_u32 m0, s46, 41984
  s_nop 0
  buffer_load_dwordx4 v8, s[8:11], s47 offen nt lds
  v_add_u32 v11, 49152, v10
  ds_read_b64_tr_b16 a[120:121], v11 offset:0
  ds_read_b64_tr_b16 a[122:123], v11 offset:512
  ds_read_b64_tr_b16 a[124:125], v11 offset:4096
  ds_read_b64_tr_b16 a[126:127], v11 offset:4608
  s_waitcnt lgkmcnt(0)
  s_barrier
  s_add_u32 s47, s96, 2490368
  s_add_u32 m0, s46, 49152
  s_nop 0
  buffer_load_dwordx4 v8, s[8:11], s47 offen nt lds
  s_add_u32 s47, s96, 3538944
  s_add_u32 m0, s46, 50176
  s_nop 0
  buffer_load_dwordx4 v8, s[8:11], s47 offen nt lds
  v_add_u32 v11, 57344, v10
  ds_read_b64_tr_b16 a[128:129], v11 offset:0
  ds_read_b64_tr_b16 a[130:131], v11 offset:512
  ds_read_b64_tr_b16 a[132:133], v11 offset:4096
  ds_read_b64_tr_b16 a[134:135], v11 offset:4608
  s_waitcnt lgkmcnt(0)
  s_waitcnt vmcnt(30)
  s_barrier
  s_add_u32 s47, s96, 4456448
  s_add_u32 m0, s46, 57344
  s_nop 0
  buffer_load_dwordx4 v8, s[8:11], s47 offen nt lds
  s_add_u32 s47, s96, 4587520
  s_add_u32 m0, s46, 58368
  s_nop 0
  buffer_load_dwordx4 v8, s[8:11], s47 offen nt lds
  v_add_u32 v11, 65536, v10
  ds_read_b64_tr_b16 a[136:137], v11 offset:0
  ds_read_b64_tr_b16 a[138:139], v11 offset:512
  ds_read_b64_tr_b16 a[140:141], v11 offset:4096
  ds_read_b64_tr_b16 a[142:143], v11 offset:4608
  s_waitcnt lgkmcnt(0)
  s_waitcnt vmcnt(30)
  s_barrier
  s_add_u32 s47, s96, 524288
  s_add_u32 m0, s46, 65536
  s_nop 0
  buffer_load_dwordx4 v8, s[8:11], s47 offen nt lds
  s_add_u32 s47, s96, 1572864
  s_add_u32 m0, s46, 66560
  s_nop 0
  buffer_load_dwordx4 v8, s[8:11], s47 offen nt lds
  v_add_u32 v11, 73728, v10
  ds_read_b64_tr_b16 a[144:145], v11 offset:0
  ds_read_b64_tr_b16 a[146:147], v11 offset:512
  ds_read_b64_tr_b16 a[148:149], v11 offset:4096
  ds_read_b64_tr_b16 a[150:151], v11 offset:4608
  s_waitcnt lgkmcnt(0)
  s_waitcnt vmcnt(30)
  s_barrier
  s_add_u32 s47, s96, 655360
  s_add_u32 m0, s46, 73728
  s_nop 0
  buffer_load_dwordx4 v8, s[8:11], s47 offen nt lds
  s_add_u32 s47, s96, 1703936
  s_add_u32 m0, s46, 74752
  s_nop 0
  buffer_load_dwordx4 v8, s[8:11], s47 offen nt lds
  v_add_u32 v11, 81920, v10
  ds_read_b64_tr_b16 a[152:153], v11 offset:0
  ds_read_b64_tr_b16 a[154:155], v11 offset:512
  ds_read_b64_tr_b16 a[156:157], v11 offset:4096
  ds_read_b64_tr_b16 a[158:159], v11 offset:4608
  s_waitcnt lgkmcnt(0)
  s_waitcnt vmcnt(30)
  s_barrier
  s_add_u32 s47, s96, 2621440
  s_add_u32 m0, s46, 81920
  s_nop 0
  buffer_load_dwordx4 v8, s[8:11], s47 offen nt lds
  s_add_u32 s47, s96, 3670016
  s_add_u32 m0, s46, 82944
  s_nop 0
  buffer_load_dwordx4 v8, s[8:11], s47 offen nt lds
  v_add_u32 v11, 90112, v10
  ds_read_b64_tr_b16 a[160:161], v11 offset:0
  ds_read_b64_tr_b16 a[162:163], v11 offset:512
  ds_read_b64_tr_b16 a[164:165], v11 offset:4096
  ds_read_b64_tr_b16 a[166:167], v11 offset:4608
  s_waitcnt lgkmcnt(0)
  s_waitcnt vmcnt(30)
  s_barrier
  s_add_u32 s47, s96, 2752512
  s_add_u32 m0, s46, 90112
  s_nop 0
  buffer_load_dwordx4 v8, s[8:11], s47 offen nt lds
  s_add_u32 s47, s96, 3801088
  s_add_u32 m0, s46, 91136
  s_nop 0
  buffer_load_dwordx4 v8, s[8:11], s47 offen nt lds
  v_add_u32 v11, 98304, v10
  ds_read_b64_tr_b16 a[168:169], v11 offset:0
  ds_read_b64_tr_b16 a[170:171], v11 offset:512
  ds_read_b64_tr_b16 a[172:173], v11 offset:4096
  ds_read_b64_tr_b16 a[174:175], v11 offset:4608
  s_waitcnt lgkmcnt(0)
  v_mov_b32 v54, 1
  v_mov_b32 v55, 1
  v_mov_b32 v56, 1
  v_mov_b32 v57, 1
  buffer_store_dwordx4 v[54:57], v5, s[4:7], s19 offen sc1
  buffer_store_dwordx4 v[54:57], v5, s[4:7], s20 offen sc1
  v_bfe_u32 v59, v5, 14, 1
  v_and_b32 v58, 0x20f0, v5
  v_lshl_or_b32 v58, v59, 3, v58
  buffer_store_dwordx2 v[54:55], v58, s[4:7], s21 offen sc1
  s_cmp_eq_u32 s24, 0
  s_cbranch_scc1 IX_23
  v_lshrrev_b32 v58, 8, v0
  v_lshlrev_b32 v58, 7, v58
  v_and_b32 v59, 0x30, v0
  v_add_u32 v58, v58, v59
  v_bfe_u32 v59, v0, 6, 1
  v_lshl_add_u32 v58, v59, 3, v58
  v_mov_b32 v60, -1
  v_mov_b32 v61, -1
  s_add_u32 s47, s23, 458752
  buffer_store_dwordx2 v[60:61], v58, s[4:7], s47 offen sc1
  s_add_u32 s47, s23, 468992
  buffer_store_dwordx2 v[60:61], v58, s[4:7], s47 offen sc1
  s_add_u32 s47, s23, 479232
  buffer_store_dwordx2 v[60:61], v58, s[4:7], s47 offen sc1
  s_add_u32 s47, s23, 489472
  buffer_store_dwordx2 v[60:61], v58, s[4:7], s47 offen sc1
IX_23:
  s_waitcnt vmcnt(33)
  s_barrier
  s_add_u32 s47, s96, 4718592
  s_add_u32 m0, s46, 98304
  s_nop 0
  buffer_load_dwordx4 v8, s[8:11], s47 offen nt lds
  s_add_u32 s47, s96, 4849664
  s_add_u32 m0, s46, 99328
  s_nop 0
  buffer_load_dwordx4 v8, s[8:11], s47 offen nt lds
  v_add_u32 v11, 106496, v10
  ds_read_b64_tr_b16 a[176:177], v11 offset:0
  ds_read_b64_tr_b16 a[178:179], v11 offset:512
  ds_read_b64_tr_b16 a[180:181], v11 offset:4096
  ds_read_b64_tr_b16 a[182:183], v11 offset:4608
  s_waitcnt lgkmcnt(0)
  s_waitcnt vmcnt(33)
  s_barrier
  s_add_u32 s47, s96, 786432
  s_add_u32 m0, s46, 106496
  s_nop 0
  buffer_load_dwordx4 v8, s[8:11], s47 offen nt lds
  s_add_u32 s47, s96, 1835008
  s_add_u32 m0, s46, 107520
  s_nop 0
  buffer_load_dwordx4 v8, s[8:11], s47 offen nt lds
  v_add_u32 v11, 114688, v10
  ds_read_b64_tr_b16 a[184:185], v11 offset:0
  ds_read_b64_tr_b16 a[186:187], v11 offset:512
  ds_read_b64_tr_b16 a[188:189], v11 offset:4096
  ds_read_b64_tr_b16 a[190:191], v11 offset:4608
  s_waitcnt lgkmcnt(0)
  s_waitcnt vmcnt(33)
  s_barrier
  s_add_u32 s47, s96, 917504
  s_add_u32 m0, s46, 114688
  s_nop 0
  buffer_load_dwordx4 v8, s[8:11], s47 offen nt lds
  s_add_u32 s47, s96, 1966080
  s_add_u32 m0, s46, 115712
  s_nop 0
  buffer_load_dwordx4 v8, s[8:11], s47 offen nt lds
  v_add_u32 v11, 122880, v10
  ds_read_b64_tr_b16 a[192:193], v11 offset:0
  ds_read_b64_tr_b16 a[194:195], v11 offset:512
  ds_read_b64_tr_b16 a[196:197], v11 offset:4096
  ds_read_b64_tr_b16 a[198:199], v11 offset:4608
  s_waitcnt lgkmcnt(0)
  s_waitcnt vmcnt(33)
  s_barrier
  s_add_u32 s47, s96, 2883584
  s_add_u32 m0, s46, 122880
  s_nop 0
  buffer_load_dwordx4 v8, s[8:11], s47 offen nt lds
  s_add_u32 s47, s96, 3932160
  s_add_u32 m0, s46, 123904
  s_nop 0
  buffer_load_dwordx4 v8, s[8:11], s47 offen nt lds
  v_add_u32 v11, 131072, v10
  ds_read_b64_tr_b16 a[200:201], v11 offset:0
  ds_read_b64_tr_b16 a[202:203], v11 offset:512
  ds_read_b64_tr_b16 a[204:205], v11 offset:4096
  ds_read_b64_tr_b16 a[206:207], v11 offset:4608
  s_waitcnt lgkmcnt(0)
  s_waitcnt vmcnt(33)
  s_barrier
  s_add_u32 s47, s96, 3014656
  s_add_u32 m0, s46, 131072
  s_nop 0
  buffer_load_dwordx4 v8, s[8:11], s47 offen nt lds
  s_add_u32 s47, s96, 4063232
  s_add_u32 m0, s46, 132096
  s_nop 0
  buffer_load_dwordx4 v8, s[8:11], s47 offen nt lds
  v_add_u32 v11, 139264, v10
  ds_read_b64_tr_b16 a[208:209], v11 offset:0
  ds_read_b64_tr_b16 a[210:211], v11 offset:512
  ds_read_b64_tr_b16 a[212:213], v11 offset:4096
  ds_read_b64_tr_b16 a[214:215], v11 offset:4608
  s_waitcnt lgkmcnt(0)
  s_waitcnt vmcnt(33)
  s_barrier
  s_add_u32 s47, s96, 4980736
  s_add_u32 m0, s46, 139264
  s_nop 0
  buffer_load_dwordx4 v8, s[8:11], s47 offen nt lds
  s_add_u32 s47, s96, 5111808
  s_add_u32 m0, s46, 140288
  s_nop 0
  buffer_load_dwordx4 v8, s[8:11], s47 offen nt lds
  v_add_u32 v11, 147456, v10
  ds_read_b64_tr_b16 a[216:217], v11 offset:0
  ds_read_b64_tr_b16 a[218:219], v11 offset:512
  ds_read_b64_tr_b16 a[220:221], v11 offset:4096
  ds_read_b64_tr_b16 a[222:223], v11 offset:4608
  s_waitcnt lgkmcnt(0)
  s_waitcnt vmcnt(33)
  s_barrier
  s_mov_b32 s8, s62
  s_and_b32 s9, s63, 0xffff
  s_mov_b32 s10, 5242880
  s_mov_b32 s11, 0x20000
  s_add_u32 s47, s97, 0
  s_add_u32 m0, s46, 147456
  s_nop 0
  buffer_load_dwordx4 v9, s[8:11], s47 offen nt lds
  s_add_u32 s47, s97, 20480
  s_add_u32 m0, s46, 148480
  s_nop 0
  buffer_load_dwordx4 v9, s[8:11], s47 offen nt lds
  v_add_u32 v11, 155648, v10
  ds_read_b64_tr_b16 a[224:225], v11 offset:0
  ds_read_b64_tr_b16 a[226:227], v11 offset:512
  ds_read_b64_tr_b16 a[228:229], v11 offset:4096
  ds_read_b64_tr_b16 a[230:231], v11 offset:4608
  s_waitcnt lgkmcnt(0)
  s_waitcnt vmcnt(33)
  s_barrier
  s_add_u32 s47, s97, 81920
  s_add_u32 m0, s46, 155648
  s_nop 0
  buffer_load_dwordx4 v9, s[8:11], s47 offen nt lds
  s_add_u32 s47, s97, 102400
  s_add_u32 m0, s46, 156672
  s_nop 0
  buffer_load_dwordx4 v9, s[8:11], s47 offen nt lds
  v_add_u32 v11, 24576, v10
  ds_read_b64_tr_b16 a[232:233], v11 offset:0
  ds_read_b64_tr_b16 a[234:235], v11 offset:512
  ds_read_b64_tr_b16 a[236:237], v11 offset:4096
  ds_read_b64_tr_b16 a[238:239], v11 offset:4608
  s_waitcnt lgkmcnt(0)
  s_waitcnt vmcnt(33)
  s_barrier
  s_add_u32 s47, s97, 256
  s_add_u32 m0, s46, 24576
  s_nop 0
  buffer_load_dwordx4 v9, s[8:11], s47 offen nt lds
  s_add_u32 s47, s97, 20736
  s_add_u32 m0, s46, 25600
  s_nop 0
  buffer_load_dwordx4 v9, s[8:11], s47 offen nt lds
  v_add_u32 v11, 32768, v10
  ds_read_b64_tr_b16 a[240:241], v11 offset:0
  ds_read_b64_tr_b16 a[242:243], v11 offset:512
  ds_read_b64_tr_b16 a[244:245], v11 offset:4096
  ds_read_b64_tr_b16 a[246:247], v11 offset:4608
  s_waitcnt lgkmcnt(0)
  s_waitcnt vmcnt(33)
  s_barrier
  s_add_u32 s47, s97, 82176
  s_add_u32 m0, s46, 32768
  s_nop 0
  buffer_load_dwordx4 v9, s[8:11], s47 offen nt lds
  s_add_u32 s47, s97, 102656
  s_add_u32 m0, s46, 33792
  s_nop 0
  buffer_load_dwordx4 v9, s[8:11], s47 offen nt lds
  v_add_u32 v11, 40960, v10
  ds_read_b64_tr_b16 a[248:249], v11 offset:0
  ds_read_b64_tr_b16 a[250:251], v11 offset:512
  ds_read_b64_tr_b16 a[252:253], v11 offset:4096
  ds_read_b64_tr_b16 a[254:255], v11 offset:4608
  s_waitcnt lgkmcnt(0)
  s_waitcnt vmcnt(33)
  s_barrier
  s_add_u32 s47, s97, 512
  s_add_u32 m0, s46, 40960
  s_nop 0
  buffer_load_dwordx4 v9, s[8:11], s47 offen nt lds
  s_add_u32 s47, s97, 20992
  s_add_u32 m0, s46, 41984
  s_nop 0
  buffer_load_dwordx4 v9, s[8:11], s47 offen nt lds
  v_add_u32 v11, 49152, v10
  ds_read_b64_tr_b16 v[72:73], v11 offset:0
  ds_read_b64_tr_b16 v[74:75], v11 offset:512
  ds_read_b64_tr_b16 v[76:77], v11 offset:4096
  ds_read_b64_tr_b16 v[78:79], v11 offset:4608
  s_waitcnt lgkmcnt(0)
  s_waitcnt vmcnt(33)
  s_barrier
  s_add_u32 s47, s97, 82432
  s_add_u32 m0, s46, 49152
  s_nop 0
  buffer_load_dwordx4 v9, s[8:11], s47 offen nt lds
  s_add_u32 s47, s97, 102912
  s_add_u32 m0, s46, 50176
  s_nop 0
  buffer_load_dwordx4 v9, s[8:11], s47 offen nt lds
  v_add_u32 v11, 57344, v10
  ds_read_b64_tr_b16 v[80:81], v11 offset:0
  ds_read_b64_tr_b16 v[82:83], v11 offset:512
  ds_read_b64_tr_b16 v[84:85], v11 offset:4096
  ds_read_b64_tr_b16 v[86:87], v11 offset:4608
  s_waitcnt lgkmcnt(0)
  s_waitcnt vmcnt(33)
  s_barrier
  s_add_u32 s47, s97, 768
  s_add_u32 m0, s46, 57344
  s_nop 0
  buffer_load_dwordx4 v9, s[8:11], s47 offen nt lds
  s_add_u32 s47, s97, 21248
  s_add_u32 m0, s46, 58368
  s_nop 0
  buffer_load_dwordx4 v9, s[8:11], s47 offen nt lds
  v_add_u32 v11, 65536, v10
  ds_read_b64_tr_b16 v[88:89], v11 offset:0
  ds_read_b64_tr_b16 v[90:91], v11 offset:512
  ds_read_b64_tr_b16 v[92:93], v11 offset:4096
  ds_read_b64_tr_b16 v[94:95], v11 offset:4608
  s_waitcnt lgkmcnt(0)
  s_waitcnt vmcnt(33)
  s_barrier
  s_add_u32 s47, s97, 82688
  s_add_u32 m0, s46, 65536
  s_nop 0
  buffer_load_dwordx4 v9, s[8:11], s47 offen nt lds
  s_add_u32 s47, s97, 103168
  s_add_u32 m0, s46, 66560
  s_nop 0
  buffer_load_dwordx4 v9, s[8:11], s47 offen nt lds
  v_add_u32 v11, 73728, v10
  ds_read_b64_tr_b16 v[96:97], v11 offset:0
  ds_read_b64_tr_b16 v[98:99], v11 offset:512
  ds_read_b64_tr_b16 v[100:101], v11 offset:4096
  ds_read_b64_tr_b16 v[102:103], v11 offset:4608
  s_waitcnt lgkmcnt(0)
  s_waitcnt vmcnt(33)
  s_barrier
  s_add_u32 s47, s97, 1024
  s_add_u32 m0, s46, 73728
  s_nop 0
  buffer_load_dwordx4 v9, s[8:11], s47 offen nt lds
  s_add_u32 s47, s97, 21504
  s_add_u32 m0, s46, 74752
  s_nop 0
  buffer_load_dwordx4 v9, s[8:11], s47 offen nt lds
  v_add_u32 v11, 81920, v10
  ds_read_b64_tr_b16 v[104:105], v11 offset:0
  ds_read_b64_tr_b16 v[106:107], v11 offset:512
  ds_read_b64_tr_b16 v[108:109], v11 offset:4096
  ds_read_b64_tr_b16 v[110:111], v11 offset:4608
  s_waitcnt lgkmcnt(0)
  s_waitcnt vmcnt(33)
  s_barrier
  s_add_u32 s47, s97, 82944
  s_add_u32 m0, s46, 81920
  s_nop 0
  buffer_load_dwordx4 v9, s[8:11], s47 offen nt lds
  s_add_u32 s47, s97, 103424
  s_add_u32 m0, s46, 82944
  s_nop 0
  buffer_load_dwordx4 v9, s[8:11], s47 offen nt lds
  v_add_u32 v11, 90112, v10
  ds_read_b64_tr_b16 v[112:113], v11 offset:0
  ds_read_b64_tr_b16 v[114:115], v11 offset:512
  ds_read_b64_tr_b16 v[116:117], v11 offset:4096
  ds_read_b64_tr_b16 v[118:119], v11 offset:4608
  s_waitcnt lgkmcnt(0)
  s_waitcnt vmcnt(30)
  s_barrier
  s_add_u32 s47, s97, 123904
  s_add_u32 m0, s46, 90112
  s_nop 0
  buffer_load_dwordx4 v9, s[8:11], s47 offen nt lds
  s_add_u32 s47, s97, 144384
  s_add_u32 m0, s46, 91136
  s_nop 0
  buffer_load_dwordx4 v9, s[8:11], s47 offen nt lds
  v_add_u32 v11, 98304, v10
  ds_read_b64_tr_b16 v[120:121], v11 offset:0
  ds_read_b64_tr_b16 v[122:123], v11 offset:512
  ds_read_b64_tr_b16 v[124:125], v11 offset:4096
  ds_read_b64_tr_b16 v[126:127], v11 offset:4608
  s_waitcnt lgkmcnt(0)
  s_waitcnt vmcnt(30)
  s_barrier
  s_mov_b32 s8, s56
  s_and_b32 s9, s57, 0xffff
  s_mov_b32 s10, 5242880
  s_mov_b32 s11, 0x20000
  s_add_u32 s47, s96, 0
  s_add_u32 m0, s46, 98304
  s_nop 0
  buffer_load_dwordx4 v8, s[8:11], s47 offen nt lds
  s_add_u32 s47, s96, 1048576
  s_add_u32 m0, s46, 99328
  s_nop 0
  buffer_load_dwordx4 v8, s[8:11], s47 offen nt lds
  v_add_u32 v11, 106496, v10
  ds_read_b64_tr_b16 v[128:129], v11 offset:0
  ds_read_b64_tr_b16 v[130:131], v11 offset:512
  ds_read_b64_tr_b16 v[132:133], v11 offset:4096
  ds_read_b64_tr_b16 v[134:135], v11 offset:4608
  s_waitcnt lgkmcnt(0)
  s_waitcnt vmcnt(30)
  s_barrier
  s_mov_b32 s8, s58
  s_and_b32 s9, s59, 0xffff
  s_mov_b32 s10, 5242880
  s_mov_b32 s11, 0x20000
  s_add_u32 s47, s96, 0
  s_add_u32 m0, s46, 106496
  s_nop 0
  buffer_load_dwordx4 v8, s[8:11], s47 offen nt lds
  s_add_u32 s47, s96, 1048576
  s_add_u32 m0, s46, 107520
  s_nop 0
  buffer_load_dwordx4 v8, s[8:11], s47 offen nt lds
  v_add_u32 v11, 114688, v10
  ds_read_b64_tr_b16 v[136:137], v11 offset:0
  ds_read_b64_tr_b16 v[138:139], v11 offset:512
  ds_read_b64_tr_b16 v[140:141], v11 offset:4096
  ds_read_b64_tr_b16 v[142:143], v11 offset:4608
  s_waitcnt lgkmcnt(0)
  s_cmp_lg_u32 s13, 0
  s_cbranch_scc1 TBs_24
  s_lshl_b32 s47, s12, 2
  v_mov_b32 v36, s47
  v_mov_b32 v37, 1
  buffer_store_dword v37, v36, s[4:7], 0 offen offset:1024 sc1
TBs_24:
  s_waitcnt vmcnt(30)
  s_barrier
  s_mov_b32 s8, s56
  s_and_b32 s9, s57, 0xffff
  s_mov_b32 s10, 5242880
  s_mov_b32 s11, 0x20000
  s_add_u32 s47, s96, 393216
  s_add_u32 m0, s46, 114688
  s_nop 0
  buffer_load_dwordx4 v8, s[8:11], s47 offen nt lds
  s_add_u32 s47, s96, 1441792
  s_add_u32 m0, s46, 115712
  s_nop 0
  buffer_load_dwordx4 v8, s[8:11], s47 offen nt lds
  v_add_u32 v11, 122880, v10
  ds_read_b64_tr_b16 v[144:145], v11 offset:0
  ds_read_b64_tr_b16 v[146:147], v11 offset:512
  ds_read_b64_tr_b16 v[148:149], v11 offset:4096
  ds_read_b64_tr_b16 v[150:151], v11 offset:4608
  s_waitcnt lgkmcnt(0)
  s_waitcnt vmcnt(30)
  s_barrier
  s_mov_b32 s8, s58
  s_and_b32 s9, s59, 0xffff
  s_mov_b32 s10, 5242880
  s_mov_b32 s11, 0x20000
  s_add_u32 s47, s96, 2359296
  s_add_u32 m0, s46, 122880
  s_nop 0
  buffer_load_dwordx4 v8, s[8:11], s47 offen nt lds
  s_add_u32 s47, s96, 3407872
  s_add_u32 m0, s46, 123904
  s_nop 0
  buffer_load_dwordx4 v8, s[8:11], s47 offen nt lds
  v_add_u32 v11, 131072, v10
  ds_read_b64_tr_b16 v[152:153], v11 offset:0
  ds_read_b64_tr_b16 v[154:155], v11 offset:512
  ds_read_b64_tr_b16 v[156:157], v11 offset:4096
  ds_read_b64_tr_b16 v[158:159], v11 offset:4608
  s_waitcnt lgkmcnt(0)
  s_waitcnt vmcnt(30)
  s_barrier
  s_mov_b32 s8, s56
  s_and_b32 s9, s57, 0xffff
  s_mov_b32 s10, 5242880
  s_mov_b32 s11, 0x20000
  s_add_u32 s47, s96, 2752512
  s_add_u32 m0, s46, 131072
  s_nop 0
  buffer_load_dwordx4 v8, s[8:11], s47 offen nt lds
  s_add_u32 s47, s96, 3801088
  s_add_u32 m0, s46, 132096
  s_nop 0
  buffer_load_dwordx4 v8, s[8:11], s47 offen nt lds
  v_add_u32 v11, 139264, v10
  ds_read_b64_tr_b16 v[160:161], v11 offset:0
  ds_read_b64_tr_b16 v[162:163], v11 offset:512
  ds_read_b64_tr_b16 v[164:165], v11 offset:4096
  ds_read_b64_tr_b16 v[166:167], v11 offset:4608
  s_waitcnt lgkmcnt(0)
  s_waitcnt vmcnt(30)
  s_barrier
  s_mov_b32 s8, s58
  s_and_b32 s9, s59, 0xffff
  s_mov_b32 s10, 5242880
  s_mov_b32 s11, 0x20000
  s_add_u32 s47, s96, 786432
  s_add_u32 m0, s46, 139264
  s_nop 0
  buffer_load_dwordx4 v8, s[8:11], s47 offen nt lds
  s_add_u32 s47, s96, 1835008
  s_add_u32 m0, s46, 140288
  s_nop 0
  buffer_load_dwordx4 v8, s[8:11], s47 offen nt lds
  v_add_u32 v11, 147456, v10
  ds_read_b64_tr_b16 v[168:169], v11 offset:0
  ds_read_b64_tr_b16 v[170:171], v11 offset:512
  ds_read_b64_tr_b16 v[172:173], v11 offset:4096
  ds_read_b64_tr_b16 v[174:175], v11 offset:4608
  s_waitcnt lgkmcnt(0)
  s_waitcnt vmcnt(30)
  s_barrier
  s_mov_b32 s8, s56
  s_and_b32 s9, s57, 0xffff
  s_mov_b32 s10, 5242880
  s_mov_b32 s11, 0x20000
  s_add_u32 s47, s96, 3014656
  s_add_u32 m0, s46, 147456
  s_nop 0
  buffer_load_dwordx4 v8, s[8:11], s47 offen nt lds
  s_add_u32 s47, s96, 4063232
  s_add_u32 m0, s46, 148480
  s_nop 0
  buffer_load_dwordx4 v8, s[8:11], s47 offen nt lds
  v_add_u32 v11, 155648, v10
  ds_read_b64_tr_b16 v[176:177], v11 offset:0
  ds_read_b64_tr_b16 v[178:179], v11 offset:512
  ds_read_b64_tr_b16 v[180:181], v11 offset:4096
  ds_read_b64_tr_b16 v[182:183], v11 offset:4608
  s_waitcnt lgkmcnt(0)
  s_waitcnt vmcnt(30)
  s_barrier
  s_mov_b32 s8, s58
  s_and_b32 s9, s59, 0xffff
  s_mov_b32 s10, 5242880
  s_mov_b32 s11, 0x20000
  s_add_u32 s47, s96, 4980736
  s_add_u32 m0, s46, 155648
  s_nop 0
  buffer_load_dwordx4 v8, s[8:11], s47 offen nt lds
  s_add_u32 s47, s96, 5111808
  s_add_u32 m0, s46, 156672
  s_nop 0
  buffer_load_dwordx4 v8, s[8:11], s47 offen nt lds
  v_add_u32 v11, 24576, v10
  ds_read_b64_tr_b16 v[184:185], v11 offset:0
  ds_read_b64_tr_b16 v[186:187], v11 offset:512
  ds_read_b64_tr_b16 v[188:189], v11 offset:4096
  ds_read_b64_tr_b16 v[190:191], v11 offset:4608
  s_waitcnt lgkmcnt(0)
  s_waitcnt vmcnt(30)
  s_barrier
  s_add_u32 s47, s96, 2097152
  s_add_u32 m0, s46, 24576
  s_nop 0
  buffer_load_dwordx4 v8, s[8:11], s47 offen nt lds
  s_add_u32 s47, s96, 3145728
  s_add_u32 m0, s46, 25600
  s_nop 0
  buffer_load_dwordx4 v8, s[8:11], s47 offen nt lds
  v_add_u32 v11, 32768, v10
  ds_read_b64_tr_b16 v[192:193], v11 offset:0
  ds_read_b64_tr_b16 v[194:195], v11 offset:512
  ds_read_b64_tr_b16 v[196:197], v11 offset:4096
  ds_read_b64_tr_b16 v[198:199], v11 offset:4608
  s_waitcnt lgkmcnt(0)
  s_waitcnt vmcnt(30)
  s_barrier
  s_add_u32 s47, s96, 4194304
  s_add_u32 m0, s46, 32768
  s_nop 0
  buffer_load_dwordx4 v8, s[8:11], s47 offen nt lds
  s_add_u32 s47, s96, 4325376
  s_add_u32 m0, s46, 33792
  s_nop 0
  buffer_load_dwordx4 v8, s[8:11], s47 offen nt lds
  v_add_u32 v11, 40960, v10
  ds_read_b64_tr_b16 v[200:201], v11 offset:0
  ds_read_b64_tr_b16 v[202:203], v11 offset:512
  ds_read_b64_tr_b16 v[204:205], v11 offset:4096
  ds_read_b64_tr_b16 v[206:207], v11 offset:4608
  s_waitcnt lgkmcnt(0)
  s_waitcnt vmcnt(30)
  s_barrier
  s_add_u32 s47, s96, 393216
  s_add_u32 m0, s46, 40960
  s_nop 0
  buffer_load_dwordx4 v8, s[8:11], s47 offen nt lds
  s_add_u32 s47, s96, 1441792
  s_add_u32 m0, s46, 41984
  s_nop 0
  buffer_load_dwordx4 v8, s[8:11], s47 offen nt lds
  v_add_u32 v11, 49152, v10
  ds_read_b64_tr_b16 v[208:209], v11 offset:0
  ds_read_b64_tr_b16 v[210:211], v11 offset:512
  ds_read_b64_tr_b16 v[212:213], v11 offset:4096
  ds_read_b64_tr_b16 v[214:215], v11 offset:4608
  s_waitcnt lgkmcnt(0)
  s_waitcnt vmcnt(30)
  s_barrier
  s_add_u32 s47, s96, 2490368
  s_add_u32 m0, s46, 49152
  s_nop 0
  buffer_load_dwordx4 v8, s[8:11], s47 offen nt lds
  s_add_u32 s47, s96, 3538944
  s_add_u32 m0, s46, 50176
  s_nop 0
  buffer_load_dwordx4 v8, s[8:11], s47 offen nt lds
  v_add_u32 v11, 57344, v10
  ds_read_b64_tr_b16 v[216:217], v11 offset:0
  ds_read_b64_tr_b16 v[218:219], v11 offset:512
  ds_read_b64_tr_b16 v[220:221], v11 offset:4096
  ds_read_b64_tr_b16 v[222:223], v11 offset:4608
  s_waitcnt lgkmcnt(0)
  s_waitcnt vmcnt(30)
  s_barrier
  s_add_u32 s47, s96, 524288
  s_add_u32 m0, s46, 57344
  s_nop 0
  buffer_load_dwordx4 v8, s[8:11], s47 offen nt lds
  s_add_u32 s47, s96, 1572864
  s_add_u32 m0, s46, 58368
  s_nop 0
  buffer_load_dwordx4 v8, s[8:11], s47 offen nt lds
  v_add_u32 v11, 65536, v10
  ds_read_b64_tr_b16 v[224:225], v11 offset:0
  ds_read_b64_tr_b16 v[226:227], v11 offset:512
  ds_read_b64_tr_b16 v[228:229], v11 offset:4096
  ds_read_b64_tr_b16 v[230:231], v11 offset:4608
  s_waitcnt lgkmcnt(0)
  s_waitcnt vmcnt(30)
  s_barrier
  s_add_u32 s47, s96, 2621440
  s_add_u32 m0, s46, 65536
  s_nop 0
  buffer_load_dwordx4 v8, s[8:11], s47 offen nt lds
  s_add_u32 s47, s96, 3670016
  s_add_u32 m0, s46, 66560
  s_nop 0
  buffer_load_dwordx4 v8, s[8:11], s47 offen nt lds
  v_add_u32 v11, 73728, v10
  ds_read_b64_tr_b16 v[232:233], v11 offset:0
  ds_read_b64_tr_b16 v[234:235], v11 offset:512
  ds_read_b64_tr_b16 v[236:237], v11 offset:4096
  ds_read_b64_tr_b16 v[238:239], v11 offset:4608
  s_waitcnt lgkmcnt(0)
  s_waitcnt vmcnt(30)
  s_barrier
  s_add_u32 s47, s96, 4718592
  s_add_u32 m0, s46, 73728
  s_nop 0
  buffer_load_dwordx4 v8, s[8:11], s47 offen nt lds
  s_add_u32 s47, s96, 4849664
  s_add_u32 m0, s46, 74752
  s_nop 0
  buffer_load_dwordx4 v8, s[8:11], s47 offen nt lds
  v_add_u32 v11, 81920, v10
  ds_read_b64_tr_b16 v[240:241], v11 offset:0
  ds_read_b64_tr_b16 v[242:243], v11 offset:512
  ds_read_b64_tr_b16 v[244:245], v11 offset:4096
  ds_read_b64_tr_b16 v[246:247], v11 offset:4608
  s_waitcnt lgkmcnt(0)
  s_waitcnt vmcnt(30)
  s_barrier
  s_add_u32 s47, s96, 917504
  s_add_u32 m0, s46, 81920
  s_nop 0
  buffer_load_dwordx4 v8, s[8:11], s47 offen nt lds
  s_add_u32 s47, s96, 1966080
  s_add_u32 m0, s46, 82944
  s_nop 0
  buffer_load_dwordx4 v8, s[8:11], s47 offen nt lds
  v_add_u32 v11, 90112, v10
  ds_read_b64_tr_b16 v[248:249], v11 offset:0
  ds_read_b64_tr_b16 v[250:251], v11 offset:512
  ds_read_b64_tr_b16 v[252:253], v11 offset:4096
  ds_read_b64_tr_b16 v[254:255], v11 offset:4608
  s_waitcnt lgkmcnt(0)
  s_waitcnt vmcnt(30)
  s_barrier
  s_mov_b32 s8, s62
  s_and_b32 s9, s63, 0xffff
  s_mov_b32 s10, 5242880
  s_mov_b32 s11, 0x20000
  s_add_u32 s47, s97, 40960
  s_add_u32 m0, s46, 90112
  s_nop 0
  buffer_load_dwordx4 v9, s[8:11], s47 offen nt lds
  s_add_u32 s47, s97, 61440
  s_add_u32 m0, s46, 91136
  s_nop 0
  buffer_load_dwordx4 v9, s[8:11], s47 offen nt lds
  v_add_u32 v11, 98304, v10
  ds_read_b64_tr_b16 v[40:41], v11 offset:0
  ds_read_b64_tr_b16 v[42:43], v11 offset:512
  ds_read_b64_tr_b16 v[44:45], v11 offset:4096
  ds_read_b64_tr_b16 v[46:47], v11 offset:4608
  s_waitcnt lgkmcnt(0)
  s_add_u32 s48, s45, 0
  buffer_store_dwordx4 v[40:43], v0, s[4:7], s48 offen
  buffer_store_dwordx4 v[44:47], v0, s[4:7], s48 offen offset:1024
  s_waitcnt vmcnt(32)
  s_barrier
  s_add_u32 s47, s97, 122880
  s_add_u32 m0, s46, 98304
  s_nop 0
  buffer_load_dwordx4 v9, s[8:11], s47 offen nt lds
  s_add_u32 s47, s97, 143360
  s_add_u32 m0, s46, 99328
  s_nop 0
  buffer_load_dwordx4 v9, s[8:11], s47 offen nt lds
  v_add_u32 v11, 106496, v10
  ds_read_b64_tr_b16 v[48:49], v11 offset:0
  ds_read_b64_tr_b16 v[50:51], v11 offset:512
  ds_read_b64_tr_b16 v[52:53], v11 offset:4096
  ds_read_b64_tr_b16 v[54:55], v11 offset:4608
  s_waitcnt lgkmcnt(0)
  s_add_u32 s48, s45, 2048
  buffer_store_dwordx4 v[48:51], v0, s[4:7], s48 offen
  buffer_store_dwordx4 v[52:55], v0, s[4:7], s48 offen offset:1024
  s_waitcnt vmcnt(34)
  s_barrier
  s_add_u32 s47, s97, 41216
  s_add_u32 m0, s46, 106496
  s_nop 0
  buffer_load_dwordx4 v9, s[8:11], s47 offen nt lds
  s_add_u32 s47, s97, 61696
  s_add_u32 m0, s46, 107520
  s_nop 0
  buffer_load_dwordx4 v9, s[8:11], s47 offen nt lds
  v_add_u32 v11, 114688, v10
  ds_read_b64_tr_b16 v[56:57], v11 offset:0
  ds_read_b64_tr_b16 v[58:59], v11 offset:512
  ds_read_b64_tr_b16 v[60:61], v11 offset:4096
  ds_read_b64_tr_b16 v[62:63], v11 offset:4608
  s_waitcnt lgkmcnt(0)
  s_add_u32 s48, s45, 4096
  buffer_store_dwordx4 v[56:59], v0, s[4:7], s48 offen
  buffer_store_dwordx4 v[60:63], v0, s[4:7], s48 offen offset:1024
  s_waitcnt vmcnt(36)
  s_barrier
  s_add_u32 s47, s97, 123136
  s_add_u32 m0, s46, 114688
  s_nop 0
  buffer_load_dwordx4 v9, s[8:11], s47 offen nt lds
  s_add_u32 s47, s97, 143616
  s_add_u32 m0, s46, 115712
  s_nop 0
  buffer_load_dwordx4 v9, s[8:11], s47 offen nt lds
  v_add_u32 v11, 122880, v10
  ds_read_b64_tr_b16 v[12:13], v11 offset:0
  ds_read_b64_tr_b16 v[14:15], v11 offset:512
  ds_read_b64_tr_b16 v[16:17], v11 offset:4096
  ds_read_b64_tr_b16 v[18:19], v11 offset:4608
  s_waitcnt lgkmcnt(0)
  s_add_u32 s48, s45, 6144
  buffer_store_dwordx4 v[12:15], v0, s[4:7], s48 offen
  buffer_store_dwordx4 v[16:19], v0, s[4:7], s48 offen offset:1024
  s_waitcnt vmcnt(38)
  s_barrier
  s_add_u32 s47, s97, 41472
  s_add_u32 m0, s46, 122880
  s_nop 0
  buffer_load_dwordx4 v9, s[8:11], s47 offen nt lds
  s_add_u32 s47, s97, 61952
  s_add_u32 m0, s46, 123904
  s_nop 0
  buffer_load_dwordx4 v9, s[8:11], s47 offen nt lds
  v_add_u32 v11, 131072, v10
  ds_read_b64_tr_b16 v[20:21], v11 offset:0
  ds_read_b64_tr_b16 v[22:23], v11 offset:512
  ds_read_b64_tr_b16 v[24:25], v11 offset:4096
  ds_read_b64_tr_b16 v[26:27], v11 offset:4608
  s_waitcnt lgkmcnt(0)
  s_add_u32 s48, s45, 8192
  buffer_store_dwordx4 v[20:23], v0, s[4:7], s48 offen
  buffer_store_dwordx4 v[24:27], v0, s[4:7], s48 offen offset:1024
  s_waitcnt vmcnt(40)
  s_barrier
  s_add_u32 s47, s97, 123392
  s_add_u32 m0, s46, 131072
  s_nop 0
  buffer_load_dwordx4 v9, s[8:11], s47 offen nt lds
  s_add_u32 s47, s97, 143872
  s_add_u32 m0, s46, 132096
  s_nop 0
  buffer_load_dwordx4 v9, s[8:11], s47 offen nt lds
  v_add_u32 v11, 139264, v10
  ds_read_b64_tr_b16 v[12:13], v11 offset:0
  ds_read_b64_tr_b16 v[14:15], v11 offset:512
  ds_read_b64_tr_b16 v[16:17], v11 offset:4096
  ds_read_b64_tr_b16 v[18:19], v11 offset:4608
  s_waitcnt lgkmcnt(0)
  s_add_u32 s48, s45, 10240
  buffer_store_dwordx4 v[12:15], v0, s[4:7], s48 offen
  buffer_store_dwordx4 v[16:19], v0, s[4:7], s48 offen offset:1024
  s_waitcnt vmcnt(42)
  s_barrier
  s_add_u32 s47, s97, 41728
  s_add_u32 m0, s46, 139264
  s_nop 0
  buffer_load_dwordx4 v9, s[8:11], s47 offen nt lds
  s_add_u32 s47, s97, 62208
  s_add_u32 m0, s46, 140288
  s_nop 0
  buffer_load_dwordx4 v9, s[8:11], s47 offen nt lds
  v_add_u32 v11, 147456, v10
  ds_read_b64_tr_b16 v[20:21], v11 offset:0
  ds_read_b64_tr_b16 v[22:23], v11 offset:512
  ds_read_b64_tr_b16 v[24:25], v11 offset:4096
  ds_read_b64_tr_b16 v[26:27], v11 offset:4608
  s_waitcnt lgkmcnt(0)
  s_add_u32 s48, s45, 12288
  buffer_store_dwordx4 v[20:23], v0, s[4:7], s48 offen
  buffer_store_dwordx4 v[24:27], v0, s[4:7], s48 offen offset:1024
  s_waitcnt vmcnt(44)
  s_barrier
  s_add_u32 s47, s97, 123648
  s_add_u32 m0, s46, 147456
  s_nop 0
  buffer_load_dwordx4 v9, s[8:11], s47 offen nt lds
  s_add_u32 s47, s97, 144128
  s_add_u32 m0, s46, 148480
  s_nop 0
  buffer_load_dwordx4 v9, s[8:11], s47 offen nt lds
  v_add_u32 v11, 155648, v10
  ds_read_b64_tr_b16 v[12:13], v11 offset:0
  ds_read_b64_tr_b16 v[14:15], v11 offset:512
  ds_read_b64_tr_b16 v[16:17], v11 offset:4096
  ds_read_b64_tr_b16 v[18:19], v11 offset:4608
  s_waitcnt lgkmcnt(0)
  s_add_u32 s48, s45, 14336
  buffer_store_dwordx4 v[12:15], v0, s[4:7], s48 offen
  buffer_store_dwordx4 v[16:19], v0, s[4:7], s48 offen offset:1024
  s_waitcnt vmcnt(46)
  s_barrier
  s_add_u32 s47, s97, 41984
  s_add_u32 m0, s46, 155648
  s_nop 0
  buffer_load_dwordx4 v9, s[8:11], s47 offen nt lds
  s_add_u32 s47, s97, 62464
  s_add_u32 m0, s46, 156672
  s_nop 0
  buffer_load_dwordx4 v9, s[8:11], s47 offen nt lds
  v_add_u32 v11, 24576, v10
  ds_read_b64_tr_b16 v[20:21], v11 offset:0
  ds_read_b64_tr_b16 v[22:23], v11 offset:512
  ds_read_b64_tr_b16 v[24:25], v11 offset:4096
  ds_read_b64_tr_b16 v[26:27], v11 offset:4608
  s_waitcnt lgkmcnt(0)
  v_lshlrev_b32 v28, 3, v0
  s_add_u32 s47, s45, 6144
  buffer_load_dword v31, v28, s[4:7], s47 offen
  s_add_u32 s47, s45, 14336
  s_mov_b64 exec, 0xffff
  buffer_load_dword v32, v28, s[4:7], s47 offen
  s_mov_b64 exec, -1
  s_lshl_b32 s47, s12, 12
  s_add_u32 s47, s47, 67108864
  buffer_load_dword v33, v0, s[4:7], s47 offen sc1
  s_getpc_b64 s[48:49]
PC_25:
  s_add_u32 s48, s48, CS_TOP-PC_25
  s_addc_u32 s49, s49, 0
  global_load_dword v34, v28, s[48:49]
  s_waitcnt vmcnt(50)
  s_barrier
  v_add_u32 v11, s44, v0
  v_add_u32 v11, 0, v11
  ds_write_b128 v11, v[20:23]
  ds_write_b128 v11, v[24:27] offset:1024
  v_add_u32 v11, 32768, v10
  ds_read_b64_tr_b16 v[12:13], v11 offset:0
  ds_read_b64_tr_b16 v[14:15], v11 offset:512
  ds_read_b64_tr_b16 v[16:17], v11 offset:4096
  ds_read_b64_tr_b16 v[18:19], v11 offset:4608
  s_waitcnt lgkmcnt(0)
  s_waitcnt vmcnt(48)
  s_barrier
  v_add_u32 v11, s44, v0
  v_add_u32 v11, 8192, v11
  ds_write_b128 v11, v[12:15]
  ds_write_b128 v11, v[16:19] offset:1024
  v_add_u32 v11, 40960, v10
  ds_read_b64_tr_b16 v[20:21], v11 offset:0
  ds_read_b64_tr_b16 v[22:23], v11 offset:512
  ds_read_b64_tr_b16 v[24:25], v11 offset:4096
  ds_read_b64_tr_b16 v[26:27], v11 offset:4608
  s_waitcnt lgkmcnt(0)
  s_waitcnt vmcnt(46)
  s_barrier
  v_add_u32 v11, s44, v0
  v_add_u32 v11, 16384, v11
  ds_write_b128 v11, v[20:23]
  ds_write_b128 v11, v[24:27] offset:1024
  v_add_u32 v11, 49152, v10
  ds_read_b64_tr_b16 v[12:13], v11 offset:0
  ds_read_b64_tr_b16 v[14:15], v11 offset:512
  ds_read_b64_tr_b16 v[16:17], v11 offset:4096
  ds_read_b64_tr_b16 v[18:19], v11 offset:4608
  s_waitcnt lgkmcnt(0)
  s_waitcnt vmcnt(44)
  s_barrier
  v_add_u32 v11, s44, v0
  v_add_u32 v11, 24576, v11
  ds_write_b128 v11, v[12:15]
  ds_write_b128 v11, v[16:19] offset:1024
  v_add_u32 v11, 57344, v10
  ds_read_b64_tr_b16 v[20:21], v11 offset:0
  ds_read_b64_tr_b16 v[22:23], v11 offset:512
  ds_read_b64_tr_b16 v[24:25], v11 offset:4096
  ds_read_b64_tr_b16 v[26:27], v11 offset:4608
  s_waitcnt lgkmcnt(0)
  s_waitcnt vmcnt(42)
  s_barrier
  v_add_u32 v11, s44, v0
  v_add_u32 v11, 32768, v11
  ds_write_b128 v11, v[20:23]
  ds_write_b128 v11, v[24:27] offset:1024
  v_add_u32 v11, 65536, v10
  ds_read_b64_tr_b16 v[12:13], v11 offset:0
  ds_read_b64_tr_b16 v[14:15], v11 offset:512
  ds_read_b64_tr_b16 v[16:17], v11 offset:4096
  ds_read_b64_tr_b16 v[18:19], v11 offset:4608
  s_waitcnt lgkmcnt(0)
  s_waitcnt vmcnt(40)
  s_barrier
  v_add_u32 v11, s44, v0
  v_add_u32 v11, 40960, v11
  ds_write_b128 v11, v[12:15]
  ds_write_b128 v11, v[16:19] offset:1024
  v_add_u32 v11, 73728, v10
  ds_read_b64_tr_b16 v[20:21], v11 offset:0
  ds_read_b64_tr_b16 v[22:23], v11 offset:512
  ds_read_b64_tr_b16 v[24:25], v11 offset:4096
  ds_read_b64_tr_b16 v[26:27], v11 offset:4608
  s_waitcnt lgkmcnt(0)
  s_waitcnt vmcnt(38)
  s_barrier
  v_add_u32 v11, s44, v0
  v_add_u32 v11, 49152, v11
  ds_write_b128 v11, v[20:23]
  ds_write_b128 v11, v[24:27] offset:1024
  v_add_u32 v11, 81920, v10
  ds_read_b64_tr_b16 v[12:13], v11 offset:0
  ds_read_b64_tr_b16 v[14:15], v11 offset:512
  ds_read_b64_tr_b16 v[16:17], v11 offset:4096
  ds_read_b64_tr_b16 v[18:19], v11 offset:4608
  s_waitcnt lgkmcnt(0)
  s_waitcnt vmcnt(36)
  s_barrier
  v_add_u32 v11, s44, v0
  v_add_u32 v11, 57344, v11
  ds_write_b128 v11, v[12:15]
  ds_write_b128 v11, v[16:19] offset:1024
  v_add_u32 v11, 90112, v10
  ds_read_b64_tr_b16 v[20:21], v11 offset:0
  ds_read_b64_tr_b16 v[22:23], v11 offset:512
  ds_read_b64_tr_b16 v[24:25], v11 offset:4096
  ds_read_b64_tr_b16 v[26:27], v11 offset:4608
  s_waitcnt lgkmcnt(0)
  s_waitcnt vmcnt(32)
  s_barrier
  v_add_u32 v11, s44, v0
  v_add_u32 v11, 65536, v11
  ds_write_b128 v11, v[20:23]
  ds_write_b128 v11, v[24:27] offset:1024
  v_add_u32 v11, 98304, v10
  ds_read_b64_tr_b16 v[12:13], v11 offset:0
  ds_read_b64_tr_b16 v[14:15], v11 offset:512
  ds_read_b64_tr_b16 v[16:17], v11 offset:4096
  ds_read_b64_tr_b16 v[18:19], v11 offset:4608
  s_waitcnt lgkmcnt(0)
  s_lshr_b32 s48, s12, 1
  s_lshl_b32 s48, s48, 2
  s_add_u32 s51, s48, 0
  v_bfe_u32 v35, v0, 8, 1
  v_lshlrev_b32 v35, 8, v35
  v_add_u32 v35, s51, v35
  buffer_load_dword v7, v35, s[4:7], 0 offen sc1
  v_lshlrev_b32 v28, 3, v0
  s_lshl_b32 s47, s12, 13
  s_lshl_b32 s48, s13, 11
  s_add_u32 s47, s47, s48
  s_add_u32 s48, s47, 16777216
  s_add_u32 s47, s47, 33554432
  s_mov_b64 exec, 0xffff
  buffer_load_dword v29, v28, s[4:7], s48 offen sc1
  buffer_load_dword v30, v28, s[4:7], s47 offen sc1
  s_mov_b64 exec, -1
  v_lshrrev_b32 v36, 2, v0
  v_and_b32 v36, 0x7c, v36
  buffer_load_dword v37, v36, s[4:7], 0 offen offset:1024 sc1
  s_waitcnt vmcnt(32)
  s_barrier
  v_add_u32 v11, s44, v0
  v_add_u32 v11, 73728, v11
  ds_write_b128 v11, v[12:15]
  ds_write_b128 v11, v[16:19] offset:1024
  v_add_u32 v11, 106496, v10
  ds_read_b64_tr_b16 v[20:21], v11 offset:0
  ds_read_b64_tr_b16 v[22:23], v11 offset:512
  ds_read_b64_tr_b16 v[24:25], v11 offset:4096
  ds_read_b64_tr_b16 v[26:27], v11 offset:4608
  s_waitcnt lgkmcnt(0)
  s_waitcnt vmcnt(28)
  s_barrier
  v_add_u32 v11, s44, v0
  v_add_u32 v11, 81920, v11
  ds_write_b128 v11, v[20:23]
  ds_write_b128 v11, v[24:27] offset:1024
  v_add_u32 v11, 114688, v10
  ds_read_b64_tr_b16 v[12:13], v11 offset:0
  ds_read_b64_tr_b16 v[14:15], v11 offset:512
  ds_read_b64_tr_b16 v[16:17], v11 offset:4096
  ds_read_b64_tr_b16 v[18:19], v11 offset:4608
  s_waitcnt lgkmcnt(0)
  s_waitcnt vmcnt(24)
  s_barrier
  v_add_u32 v11, s44, v0
  v_add_u32 v11, 90112, v11
  ds_write_b128 v11, v[12:15]
  ds_write_b128 v11, v[16:19] offset:1024
  v_add_u32 v11, 122880, v10
  ds_read_b64_tr_b16 v[20:21], v11 offset:0
  ds_read_b64_tr_b16 v[22:23], v11 offset:512
  ds_read_b64_tr_b16 v[24:25], v11 offset:4096
  ds_read_b64_tr_b16 v[26:27], v11 offset:4608
  s_waitcnt lgkmcnt(0)
  s_waitcnt vmcnt(20)
  s_barrier
  v_add_u32 v11, s44, v0
  v_add_u32 v11, 98304, v11
  ds_write_b128 v11, v[20:23]
  ds_write_b128 v11, v[24:27] offset:1024
  v_add_u32 v11, 131072, v10
  ds_read_b64_tr_b16 v[12:13], v11 offset:0
  ds_read_b64_tr_b16 v[14:15], v11 offset:512
  ds_read_b64_tr_b16 v[16:17], v11 offset:4096
  ds_read_b64_tr_b16 v[18:19], v11 offset:4608
  s_waitcnt lgkmcnt(0)
  s_waitcnt vmcnt(16)
  s_barrier
  v_add_u32 v11, s44, v0
  v_add_u32 v11, 106496, v11
  ds_write_b128 v11, v[12:15]
  ds_write_b128 v11, v[16:19] offset:1024
  v_add_u32 v11, 139264, v10
  ds_read_b64_tr_b16 v[20:21], v11 offset:0
  ds_read_b64_tr_b16 v[22:23], v11 offset:512
  ds_read_b64_tr_b16 v[24:25], v11 offset:4096
  ds_read_b64_tr_b16 v[26:27], v11 offset:4608
  s_waitcnt lgkmcnt(0)
  s_waitcnt vmcnt(12)
  s_barrier
  v_add_u32 v11, s44, v0
  v_add_u32 v11, 114688, v11
  ds_write_b128 v11, v[20:23]
  ds_write_b128 v11, v[24:27] offset:1024
  v_add_u32 v11, 147456, v10
  ds_read_b64_tr_b16 v[12:13], v11 offset:0
  ds_read_b64_tr_b16 v[14:15], v11 offset:512
  ds_read_b64_tr_b16 v[16:17], v11 offset:4096
  ds_read_b64_tr_b16 v[18:19], v11 offset:4608
  s_waitcnt lgkmcnt(0)
  s_waitcnt vmcnt(8)
  s_barrier
  v_add_u32 v11, s44, v0
  v_add_u32 v11, 122880, v11
  ds_write_b128 v11, v[12:15]
  ds_write_b128 v11, v[16:19] offset:1024
  v_add_u32 v11, 155648, v10
  ds_read_b64_tr_b16 v[20:21], v11 offset:0
  ds_read_b64_tr_b16 v[22:23], v11 offset:512
  ds_read_b64_tr_b16 v[24:25], v11 offset:4096
  ds_read_b64_tr_b16 v[26:27], v11 offset:4608
  s_waitcnt lgkmcnt(0)
  s_barrier
  v_add_u32 v11, s44, v0
  v_add_u32 v11, 131072, v11
  ds_write_b128 v11, v[20:23]
  ds_write_b128 v11, v[24:27] offset:1024
  s_waitcnt vmcnt(0) lgkmcnt(0)
  s_mov_b32 s14, 0
  s_mov_b32 s15, 0
  v_cmp_eq_u32 vcc, 0, v7
  s_nop 0
  s_cbranch_vccz W0K_27
W0_26:
  buffer_load_dword v7, v35, s[4:7], 0 offen sc1
  s_sub_u32 s74, s74, 1
  s_cbranch_scc1 L_TIMEOUT
  s_waitcnt vmcnt(0)
  v_cmp_eq_u32 vcc, 0, v7
  s_nop 0
  s_cbranch_vccnz W0_26
  v_lshlrev_b32 v28, 3, v0
  s_lshl_b32 s47, s12, 13
  s_lshl_b32 s48, s13, 11
  s_add_u32 s47, s47, s48
  s_add_u32 s48, s47, 16777216
  s_add_u32 s47, s47, 33554432
  s_mov_b64 exec, 0xffff
  buffer_load_dword v29, v28, s[4:7], s48 offen sc1
  buffer_load_dword v30, v28, s[4:7], s47 offen sc1
  s_mov_b64 exec, -1
  s_waitcnt vmcnt(0)
W0K_27:
  s_lshl_b32 s47, s14, 5
  s_add_u32 s47, s47, s12
  s_lshl_b32 s48, s47, 12
  s_lshl_b32 s49, s13, 10
  s_add_u32 s48, s48, s49
  s_add_u32 s75, s48, 67108864
  s_lshl_b32 s48, s47, 13
  s_add_u32 s48, s48, s46
  s_add_u32 s54, s48, 33554432
  s_sub_u32 s55, s54, 16777216
  s_lshl_b32 s48, s47, 13
  s_add_u32 s72, s48, 17039360
  s_add_u32 s73, s72, 0
  s_add_u32 s49, s72, 16777216
  s_cmp_lt_u32 s13, 2
  s_cselect_b32 s73, s73, s49
  s_and_b32 s49, s13, 1
  s_lshl_b32 s49, s49, 12
  s_add_u32 s73, s73, s49
  s_mov_b32 s96, s51
  s_add_u32 s47, s14, 1
  s_lshr_b32 s47, s47, 4
  s_min_u32 s47, s47, 3
  s_lshl_b32 s47, s47, 6
  s_lshr_b32 s48, s12, 1
  s_lshl_b32 s48, s48, 2
  s_add_u32 s51, s47, s48
  s_add_u32 s51, s51, 0
  s_and_b32 s47, s14, 3
  s_mul_i32 s47, s47, 10240
  s_add_u32 s16, s47, s42
  s_add_u32 s16, s16, 458752
  s_add_u32 s17, s47, s23
  s_add_u32 s17, s17, 458752
  s_add_u32 s47, s14, 2
  s_and_b32 s47, s47, 3
  s_mul_i32 s47, s47, 10240
  s_add_u32 s18, s47, s23
  s_add_u32 s18, s18, 458752
TB_28:
  v_cmp_eq_u32 vcc, 0, v37
  s_nop 0
  s_cbranch_vccz TBk_29
  buffer_load_dword v37, v36, s[4:7], 0 offen offset:1024 sc1
  s_sub_u32 s74, s74, 1
  s_cbranch_scc1 L_TIMEOUT
  s_waitcnt vmcnt(0)
  s_branch TB_28
TBk_29:
  v_and_b32 v32, 0x1f0, v0
  v_add_u32 v33, s42, v0
  v_add_u32 v34, s42, v32
  v_mov_b64 v[8:9], 0
  v_mov_b64 v[10:11], 0
  v_mov_b64 v[12:13], 0
  v_mov_b64 v[14:15], 0
  v_mov_b64 v[16:17], 0
  v_mov_b64 v[18:19], 0
  v_bfe_u32 v36, v0, 8, 1
  v_lshlrev_b32 v36, 8, v36
  v_add_u32 v36, s51, v36
  v_lshlrev_b32 v37, 3, v0
  v_add_u32 v37, s73, v37
  v_cndmask_b32 v7, v36, v37, s[36:37]
  s_waitcnt vmcnt(0) lgkmcnt(0)
  s_branch CS_ENTRY
  .p2align 6
CS_TOP:
  v_and_b32 v32, 0x1f0, v0
  v_add_u32 v33, s42, v0
  v_add_u32 v34, s42, v32
  v_mov_b64 v[8:9], 0
  v_mov_b64 v[10:11], 0
  v_mov_b64 v[12:13], 0
  v_mov_b64 v[14:15], 0
  v_mov_b64 v[16:17], 0
  v_mov_b64 v[18:19], 0
  v_bfe_u32 v36, v0, 8, 1
  v_lshlrev_b32 v36, 8, v36
  v_add_u32 v36, s51, v36
  v_lshlrev_b32 v37, 3, v0
  v_add_u32 v37, s73, v37
  v_cndmask_b32 v7, v36, v37, s[36:37]
  buffer_load_dwordx4 v[20:23], v0, s[4:7], s16 offen sc1
  buffer_load_dwordx4 v[24:27], v0, s[4:7], s16 offen offset:1024 sc1
  buffer_load_dwordx4 v[28:31], v32, s[4:7], s16 offen offset:2048 sc1
  s_barrier
  buffer_load_dwordx4 v[40:43], v0, s[4:7], s90 offen offset:0
  buffer_load_dwordx4 v[44:47], v0, s[4:7], s90 offen offset:1024
  buffer_load_dwordx4 v[48:51], v0, s[4:7], s90 offen offset:2048
  buffer_load_dwordx4 v[52:55], v0, s[4:7], s90 offen offset:3072
  s_waitcnt vmcnt(4)
  v_max3_u32 v35, v21, v23, v25
  v_max3_u32 v35, v35, v27, v29
  v_max_u32 v35, v35, v31
  v_cmp_eq_u32 vcc, -1, v35
  s_nop 0
  s_cbranch_vccnz PMR_30
PMK_31:
  ds_write_b128 v33, v[20:23] offset:0
  ds_write_b128 v33, v[24:27] offset:1024
  ds_write_b128 v34, v[28:31] offset:2048
  buffer_load_dwordx4 v[56:59], v0, s[4:7], s91 offen offset:0
  buffer_load_dwordx4 v[60:63], v0, s[4:7], s91 offen offset:1024
CS_ENTRY:
  s_waitcnt lgkmcnt(0)
  s_barrier
  ds_read_b128 v[20:23], v1 offset:0
  ds_read_b128 v[24:27], v1 offset:512
  ds_read_b128 v[32:35], v6 offset:0
  ds_read_b128 v[36:39], v6 offset:1024
  s_waitcnt vmcnt(2) lgkmcnt(3)
  v_smfmac_f32_16x16x64_bf16 v[8:11], v[20:23], v[40:47], v2
  ds_read_b128 v[28:31], v1 offset:1024
  buffer_load_dwordx4 v[64:67], v0, s[4:7], s91 offen offset:2048
  v_smfmac_f32_16x16x64_bf16 v[12:15], v[20:23], v[48:55], v2
  v_smfmac_f32_16x16x64_bf16 v[16:19], v[20:23], a[192:199], v2
  s_waitcnt lgkmcnt(3)
  v_smfmac_f32_16x16x64_bf16 v[8:11], v[24:27], a[0:7], v2
  ds_read_b128 v[20:23], v1 offset:1536
  buffer_load_dwordx4 v[68:71], v0, s[4:7], s91 offen offset:3072
  v_smfmac_f32_16x16x64_bf16 v[12:15], v[24:27], a[128:135], v2
  v_smfmac_f32_16x16x64_bf16 v[16:19], v[24:27], a[200:207], v2
  s_waitcnt lgkmcnt(1)
  v_smfmac_f32_16x16x64_bf16 v[8:11], v[28:31], a[8:15], v2
  ds_read_b128 v[24:27], v1 offset:2048
  v_smfmac_f32_16x16x64_bf16 v[12:15], v[28:31], v[32:39], v2
  ds_read_b128 v[32:35], v6 offset:8192
  ds_read_b128 v[36:39], v6 offset:9216
  v_smfmac_f32_16x16x64_bf16 v[16:19], v[28:31], a[208:215], v2
  s_waitcnt lgkmcnt(3)
  v_smfmac_f32_16x16x64_bf16 v[8:11], v[20:23], a[16:23], v2
  ds_read_b128 v[28:31], v1 offset:2560
  buffer_load_dwordx4 v[40:43], v0, s[4:7], s92 offen offset:0
  v_smfmac_f32_16x16x64_bf16 v[12:15], v[20:23], a[136:143], v2
  v_smfmac_f32_16x16x64_bf16 v[16:19], v[20:23], a[216:223], v2
  s_waitcnt lgkmcnt(1)
  v_smfmac_f32_16x16x64_bf16 v[8:11], v[24:27], a[24:31], v2
  ds_read_b128 v[20:23], v1 offset:3072
  buffer_load_dwordx4 v[44:47], v0, s[4:7], s92 offen offset:1024
  v_smfmac_f32_16x16x64_bf16 v[12:15], v[24:27], v[32:39], v2
  ds_read_b128 v[32:35], v6 offset:16384
  ds_read_b128 v[36:39], v6 offset:17408
  v_smfmac_f32_16x16x64_bf16 v[16:19], v[24:27], a[224:231], v2
  s_waitcnt lgkmcnt(3)
  v_smfmac_f32_16x16x64_bf16 v[8:11], v[28:31], a[32:39], v2
  ds_read_b128 v[24:27], v1 offset:3584
  buffer_load_dwordx4 v[48:51], v0, s[4:7], s92 offen offset:2048
  v_smfmac_f32_16x16x64_bf16 v[12:15], v[28:31], a[144:151], v2
  v_smfmac_f32_16x16x64_bf16 v[16:19], v[28:31], a[232:239], v2
  s_waitcnt vmcnt(5) lgkmcnt(1)
  v_smfmac_f32_16x16x64_bf16 v[8:11], v[20:23], v[56:63], v2
  ds_read_b128 v[28:31], v1 offset:4096
  v_smfmac_f32_16x16x64_bf16 v[12:15], v[20:23], v[32:39], v2
  ds_read_b128 v[32:35], v6 offset:24576
  ds_read_b128 v[36:39], v6 offset:25600
  v_smfmac_f32_16x16x64_bf16 v[16:19], v[20:23], a[240:247], v2
  s_waitcnt vmcnt(3) lgkmcnt(3)
  v_smfmac_f32_16x16x64_bf16 v[8:11], v[24:27], a[40:47], v2
  ds_read_b128 v[20:23], v1 offset:4608
  buffer_load_dwordx4 v[52:55], v0, s[4:7], s92 offen offset:3072
  v_smfmac_f32_16x16x64_bf16 v[12:15], v[24:27], v[64:71], v2
  v_smfmac_f32_16x16x64_bf16 v[16:19], v[24:27], a[248:255], v2
  s_waitcnt lgkmcnt(1)
  v_smfmac_f32_16x16x64_bf16 v[8:11], v[28:31], a[48:55], v2
  ds_read_b128 v[24:27], v1 offset:5120
  buffer_load_dwordx4 v[56:59], v0, s[4:7], s93 offen offset:0
  v_smfmac_f32_16x16x64_bf16 v[12:15], v[28:31], v[32:39], v2
  ds_read_b128 v[32:35], v6 offset:32768
  ds_read_b128 v[36:39], v6 offset:33792
  v_smfmac_f32_16x16x64_bf16 v[16:19], v[28:31], v[72:79], v2
  s_waitcnt lgkmcnt(3)
  v_smfmac_f32_16x16x64_bf16 v[8:11], v[20:23], a[56:63], v2
  ds_read_b128 v[28:31], v1 offset:5632
  buffer_load_dwordx4 v[60:63], v0, s[4:7], s93 offen offset:1024
  v_smfmac_f32_16x16x64_bf16 v[12:15], v[20:23], a[152:159], v2
  v_smfmac_f32_16x16x64_bf16 v[16:19], v[20:23], v[80:87], v2
  s_waitcnt lgkmcnt(1)
  v_smfmac_f32_16x16x64_bf16 v[8:11], v[24:27], a[64:71], v2
  ds_read_b128 v[20:23], v1 offset:6144
  v_smfmac_f32_16x16x64_bf16 v[12:15], v[24:27], v[32:39], v2
  ds_read_b128 v[32:35], v6 offset:40960
  ds_read_b128 v[36:39], v6 offset:41984
  v_smfmac_f32_16x16x64_bf16 v[16:19], v[24:27], v[88:95], v2
  s_waitcnt lgkmcnt(3)
  v_smfmac_f32_16x16x64_bf16 v[8:11], v[28:31], a[72:79], v2
  ds_read_b128 v[24:27], v1 offset:6656
  buffer_load_dwordx4 v[64:67], v0, s[4:7], s93 offen offset:2048
  v_smfmac_f32_16x16x64_bf16 v[12:15], v[28:31], a[160:167], v2
  v_smfmac_f32_16x16x64_bf16 v[16:19], v[28:31], v[96:103], v2
  s_waitcnt lgkmcnt(1)
  v_smfmac_f32_16x16x64_bf16 v[8:11], v[20:23], a[80:87], v2
  ds_read_b128 v[28:31], v1 offset:7168
  buffer_load_dwordx4 v[68:71], v0, s[4:7], s93 offen offset:3072
  v_smfmac_f32_16x16x64_bf16 v[12:15], v[20:23], v[32:39], v2
  ds_read_b128 v[32:35], v6 offset:49152
  ds_read_b128 v[36:39], v6 offset:50176
  v_smfmac_f32_16x16x64_bf16 v[16:19], v[20:23], v[104:111], v2
  s_waitcnt vmcnt(6) lgkmcnt(3)
  v_smfmac_f32_16x16x64_bf16 v[8:11], v[24:27], v[40:47], v2
  ds_read_b128 v[20:23], v1 offset:7680
  v_smfmac_f32_16x16x64_bf16 v[12:15], v[24:27], a[168:175], v2
  v_smfmac_f32_16x16x64_bf16 v[16:19], v[24:27], v[112:119], v2
  s_waitcnt lgkmcnt(1)
  v_smfmac_f32_16x16x64_bf16 v[8:11], v[28:31], a[88:95], v2
  ds_read_b128 v[24:27], v1 offset:8192
  s_add_u32 m0, s46, 16384
  s_nop 0
  buffer_load_dwordx4 v0, s[4:7], s55 offen offset:0 sc1 nt lds
  v_smfmac_f32_16x16x64_bf16 v[12:15], v[28:31], v[32:39], v2
  ds_read_b128 v[32:35], v6 offset:57344
  ds_read_b128 v[36:39], v6 offset:58368
  v_smfmac_f32_16x16x64_bf16 v[16:19], v[28:31], v[120:127], v2
  s_waitcnt vmcnt(5) lgkmcnt(3)
  v_smfmac_f32_16x16x64_bf16 v[8:11], v[20:23], a[96:103], v2
  ds_read_b128 v[28:31], v1 offset:8704
  buffer_load_dwordx4 v0, s[4:7], s55 offen offset:1024 sc1 nt lds
  v_smfmac_f32_16x16x64_bf16 v[12:15], v[20:23], v[48:55], v2
  v_smfmac_f32_16x16x64_bf16 v[16:19], v[20:23], v[128:135], v2
  s_waitcnt lgkmcnt(1)
  v_smfmac_f32_16x16x64_bf16 v[8:11], v[24:27], a[104:111], v2
  ds_read_b128 v[20:23], v1 offset:9216
  v_smfmac_f32_16x16x64_bf16 v[12:15], v[24:27], v[32:39], v2
  v_smfmac_f32_16x16x64_bf16 v[16:19], v[24:27], v[136:143], v2
  s_waitcnt lgkmcnt(1)
  v_smfmac_f32_16x16x64_bf16 v[8:11], v[28:31], a[112:119], v2
  ds_read_b128 v[24:27], v1 offset:9728
  v_smfmac_f32_16x16x64_bf16 v[12:15], v[28:31], a[176:183], v2
  v_smfmac_f32_16x16x64_bf16 v[16:19], v[28:31], v[144:151], v2
  s_waitcnt vmcnt(4) lgkmcnt(1)
  v_smfmac_f32_16x16x64_bf16 v[8:11], v[20:23], v[56:63], v2
  v_smfmac_f32_16x16x64_bf16 v[12:15], v[20:23], a[184:191], v2
  s_waitcnt vmcnt(2) lgkmcnt(0)
  v_smfmac_f32_16x16x64_bf16 v[8:11], v[24:27], a[120:127], v2
  v_smfmac_f32_16x16x64_bf16 v[12:15], v[24:27], v[64:71], v2
  v_smfmac_f32_16x16x64_bf16 v[16:19], v[20:23], v[152:159], v2
  v_smfmac_f32_16x16x64_bf16 v[16:19], v[24:27], v[160:167], v2
  v_mov_b32 v38, s14
  v_mov_b32 v39, 0
  s_nop 2
  v_cvt_pk_bf16_f32 v34, v8, v9
  v_cvt_pk_bf16_f32 v35, v10, v11
  ds_write_b64 v4, v[34:35] offset:10240
  v_cvt_pk_bf16_f32 v32, v12, v13
  v_cvt_pk_bf16_f32 v33, v14, v15
  ds_write_b64 v4, v[32:33] offset:12288
  buffer_load_dwordx4 v[8:11], v0, s[4:7], s54 offen sc1 nt
  buffer_load_dwordx4 v[12:15], v0, s[4:7], s54 offen offset:1024 sc1 nt
  v_cvt_pk_bf16_f32 v34, v16, v17
  v_cvt_pk_bf16_f32 v35, v18, v19
  s_cmp_eq_u32 s14, 63
  s_cbranch_scc1 CS_EXIT
  v_cndmask_b32 v16, 0, v34, s[36:37]
  v_cndmask_b32 v17, 0, v35, s[36:37]
  v_cndmask_b32 v18, 0, v34, s[52:53]
  v_cndmask_b32 v19, 0, v35, s[52:53]
  s_waitcnt vmcnt(2) lgkmcnt(0)
  s_barrier
  ds_read_b64_tr_b16 v[40:41], v3 offset:10240
  ds_read_b64_tr_b16 v[42:43], v3 offset:10304
  ds_read_b128 v[48:51], v0 offset:16384
  ds_read_b128 v[52:55], v0 offset:20480
  ds_read_b64_tr_b16 v[44:45], v3 offset:12288
  ds_read_b64_tr_b16 v[46:47], v3 offset:12352
  ds_read_b64_tr_b16 v[56:57], v3 offset:10752
  ds_read_b64_tr_b16 v[58:59], v3 offset:10816
  ds_read_b128 v[64:67], v0 offset:17408
  ds_read_b128 v[68:71], v0 offset:21504
  ds_read_b64_tr_b16 v[60:61], v3 offset:12800
  ds_read_b64_tr_b16 v[62:63], v3 offset:12864
  buffer_store_dwordx4 v[32:35], v0, s[4:7], s75 offen sc1
  buffer_store_dword v38, v39, s[4:7], s26 offen sc1
  s_waitcnt lgkmcnt(9)
  v_mfma_f32_16x16x32_bf16 v[20:23], v[48:51], v[40:43], 0
  ds_read_b128 v[48:51], v0 offset:18432
  s_waitcnt lgkmcnt(9)
  v_mfma_f32_16x16x32_bf16 v[24:27], v[52:55], v[40:43], 0
  ds_read_b128 v[52:55], v0 offset:22528
  s_waitcnt lgkmcnt(8)
  v_mfma_f32_16x16x32_bf16 v[28:31], v[44:47], v[40:43], 0
  ds_read_b64_tr_b16 v[40:41], v3 offset:11264
  ds_read_b64_tr_b16 v[42:43], v3 offset:11328
  s_waitcnt lgkmcnt(7)
  v_mfma_f32_16x16x32_bf16 v[20:23], v[64:67], v[56:59], v[20:23]
  ds_read_b128 v[64:67], v0 offset:19456
  ds_read_b64_tr_b16 v[44:45], v3 offset:13312
  ds_read_b64_tr_b16 v[46:47], v3 offset:13376
  s_waitcnt lgkmcnt(9)
  v_mfma_f32_16x16x32_bf16 v[24:27], v[68:71], v[56:59], v[24:27]
  ds_read_b128 v[68:71], v0 offset:23552
  s_waitcnt lgkmcnt(8)
  v_mfma_f32_16x16x32_bf16 v[28:31], v[60:63], v[56:59], v[28:31]
  ds_read_b64_tr_b16 v[56:57], v3 offset:11776
  ds_read_b64_tr_b16 v[58:59], v3 offset:11840
  s_waitcnt lgkmcnt(6)
  v_mfma_f32_16x16x32_bf16 v[20:23], v[48:51], v[40:43], v[20:23]
  ds_read_b64_tr_b16 v[60:61], v3 offset:13824
  ds_read_b64_tr_b16 v[62:63], v3 offset:13888
  v_mfma_f32_16x16x32_bf16 v[24:27], v[52:55], v[40:43], v[24:27]
  s_waitcnt lgkmcnt(5)
  v_mfma_f32_16x16x32_bf16 v[28:31], v[44:47], v[40:43], v[28:31]
  s_waitcnt lgkmcnt(2)
  v_mfma_f32_16x16x32_bf16 v[20:23], v[64:67], v[56:59], v[20:23]
  v_mfma_f32_16x16x32_bf16 v[24:27], v[68:71], v[56:59], v[24:27]
  s_waitcnt lgkmcnt(0)
  v_mfma_f32_16x16x32_bf16 v[28:31], v[60:63], v[56:59], v[28:31]
  buffer_load_dword v7, v7, s[4:7], 0 offen sc1
  v_add_u32 v38, 0x10000, v6
  ds_read_b128 v[48:51], v38 offset:0
  ds_read_b128 v[52:55], v38 offset:1024
  ds_read_b128 v[56:59], v38 offset:8192
  ds_read_b128 v[60:63], v38 offset:9216
  ds_read_b128 v[64:67], v38 offset:16384
  ds_read_b128 v[68:71], v38 offset:17408
  v_max3_f32 v36, v20, v21, v22
  v_max3_f32 v37, v23, v24, v25
  v_max3_f32 v36, v36, v26, v27
  v_max3_f32 v37, v37, v28, v29
  v_max3_f32 v36, v36, v30, v31
  v_max_f32 v36, v36, v37
  v_mov_b32 v37, v36
  s_nop 1
  v_permlane32_swap_b32 v36, v37
  v_max_f32 v36, v36, v37
  v_mov_b32 v37, v36
  s_nop 1
  v_permlane16_swap_b32 v36, v37
  v_max_f32 v36, v36, v37
  v_mul_f32 v36, s38, v36
  v_pk_fma_f32 v[20:21], v[20:21], s[38:39], v[36:37] op_sel_hi:[1,0,0] neg_lo:[0,0,1] neg_hi:[0,0,1]
  v_pk_fma_f32 v[22:23], v[22:23], s[38:39], v[36:37] op_sel_hi:[1,0,0] neg_lo:[0,0,1] neg_hi:[0,0,1]
  v_pk_fma_f32 v[24:25], v[24:25], s[38:39], v[36:37] op_sel_hi:[1,0,0] neg_lo:[0,0,1] neg_hi:[0,0,1]
  v_pk_fma_f32 v[26:27], v[26:27], s[38:39], v[36:37] op_sel_hi:[1,0,0] neg_lo:[0,0,1] neg_hi:[0,0,1]
  v_pk_fma_f32 v[28:29], v[28:29], s[38:39], v[36:37] op_sel_hi:[1,0,0] neg_lo:[0,0,1] neg_hi:[0,0,1]
  v_pk_fma_f32 v[30:31], v[30:31], s[38:39], v[36:37] op_sel_hi:[1,0,0] neg_lo:[0,0,1] neg_hi:[0,0,1]
  v_exp_f32 v20, v20
  v_exp_f32 v21, v21
  v_exp_f32 v22, v22
  v_exp_f32 v23, v23
  v_exp_f32 v24, v24
  v_exp_f32 v25, v25
  v_exp_f32 v26, v26
  v_exp_f32 v27, v27
  v_exp_f32 v28, v28
  v_exp_f32 v29, v29
  v_exp_f32 v30, v30
  v_exp_f32 v31, v31
  v_cvt_pk_bf16_f32 v20, v20, v21
  v_cvt_pk_bf16_f32 v21, v22, v23
  v_cvt_pk_bf16_f32 v22, v24, v25
  v_cvt_pk_bf16_f32 v23, v26, v27
  v_cvt_pk_bf16_f32 v28, v28, v29
  v_cvt_pk_bf16_f32 v29, v30, v31
  s_waitcnt vmcnt(3)
  v_mfma_f32_16x16x32_bf16 v[24:27], v[8:11], v[20:23], 0
  v_dot2_f32_bf16 v36, v28, s40, 0
  v_dot2_f32_bf16 v37, v20, s39, 0
  v_mfma_f32_16x16x32_bf16 v[32:35], v[12:15], v[20:23], 0
  v_dot2_f32_bf16 v36, v29, s40, v36
  v_dot2_f32_bf16 v37, v21, s39, v37
  v_mfma_f32_16x16x16_bf16 v[24:27], v[16:17], v[28:29], v[24:27]
  v_dot2_f32_bf16 v36, v22, s39, v36
  v_dot2_f32_bf16 v37, v23, s39, v37
  v_mfma_f32_16x16x16_bf16 v[32:35], v[18:19], v[28:29], v[32:35]
  v_add_u32 v39, s43, v1
  v_add_u32 v44, 73728, v6
  v_add_f32 v36, v36, v37
  v_mov_b32 v37, v36
  s_nop 1
  v_permlane32_swap_b32 v36, v37
  v_add_f32 v36, v36, v37
  v_mov_b32 v37, v36
  s_nop 1
  v_permlane16_swap_b32 v36, v37
  v_add_f32 v36, v36, v37
  v_rcp_f32 v36, v36
  v_bfe_u32 v46, v5, 14, 1
  v_and_b32 v45, 0x20f0, v5
  v_lshl_or_b32 v45, v46, 3, v45
  v_pk_mul_f32 v[24:25], v[24:25], v[36:37] op_sel_hi:[1,0]
  v_pk_mul_f32 v[26:27], v[26:27], v[36:37] op_sel_hi:[1,0]
  v_pk_mul_f32 v[32:33], v[32:33], v[36:37] op_sel_hi:[1,0]
  v_pk_mul_f32 v[34:35], v[34:35], v[36:37] op_sel_hi:[1,0]
  v_cvt_pk_bf16_f32 v24, v24, v25
  v_cvt_pk_bf16_f32 v25, v26, v27
  v_cvt_pk_bf16_f32 v26, v32, v33
  v_cvt_pk_bf16_f32 v27, v34, v35
  ds_write_b128 v39, v[24:27] offset:14336
  v_mov_b64 v[8:9], 0
  v_mov_b64 v[10:11], 0
  v_mov_b64 v[12:13], 0
  v_mov_b64 v[14:15], 0
  v_mov_b64 v[16:17], 0
  v_mov_b64 v[18:19], 0
  v_mov_b64 v[20:21], 0
  v_mov_b64 v[22:23], 0
  s_waitcnt lgkmcnt(0)
  s_barrier
  ds_read_b128 v[28:31], v1 offset:14336
  ds_read_b128 v[32:35], v1 offset:14848
  ds_read_b128 v[36:39], v1 offset:15360
  ds_read_b128 v[40:43], v1 offset:15872
  v_mov_b64 v[24:25], 0
  v_mov_b64 v[26:27], 0
  s_waitcnt lgkmcnt(3)
  v_smfmac_f32_16x16x64_bf16 v[8:11], v[28:31], v[168:175], v2
  s_waitcnt lgkmcnt(2)
  v_smfmac_f32_16x16x64_bf16 v[8:11], v[32:35], v[48:55], v2
  ds_read_b128 v[48:51], v44 offset:16384
  ds_read_b128 v[52:55], v44 offset:17408
  s_waitcnt lgkmcnt(3)
  v_smfmac_f32_16x16x64_bf16 v[8:11], v[36:39], v[176:183], v2
  s_waitcnt lgkmcnt(2)
  v_smfmac_f32_16x16x64_bf16 v[8:11], v[40:43], v[56:63], v2
  ds_read_b128 v[56:59], v44 offset:24576
  ds_read_b128 v[60:63], v44 offset:25600
  v_smfmac_f32_16x16x64_bf16 v[12:15], v[28:31], v[184:191], v2
  v_smfmac_f32_16x16x64_bf16 v[12:15], v[32:35], v[64:71], v2
  ds_read_b128 v[64:67], v44 offset:32768
  ds_read_b128 v[68:71], v44 offset:33792
  v_smfmac_f32_16x16x64_bf16 v[12:15], v[36:39], v[192:199], v2
  s_waitcnt lgkmcnt(4)
  v_smfmac_f32_16x16x64_bf16 v[12:15], v[40:43], v[48:55], v2
  ds_read_b128 v[48:51], v44 offset:40960
  ds_read_b128 v[52:55], v44 offset:41984
  v_smfmac_f32_16x16x64_bf16 v[16:19], v[28:31], v[200:207], v2
  s_waitcnt lgkmcnt(4)
  v_smfmac_f32_16x16x64_bf16 v[16:19], v[32:35], v[56:63], v2
  ds_read_b128 v[56:59], v44 offset:49152
  ds_read_b128 v[60:63], v44 offset:50176
  v_smfmac_f32_16x16x64_bf16 v[16:19], v[36:39], v[208:215], v2
  v_cvt_pk_bf16_f32 v8, v8, v9
  v_cvt_pk_bf16_f32 v9, v10, v11
  s_waitcnt lgkmcnt(4)
  v_smfmac_f32_16x16x64_bf16 v[16:19], v[40:43], v[64:71], v2
  ds_read_b128 v[64:67], v44 offset:57344
  ds_read_b128 v[68:71], v44 offset:58368
  v_smfmac_f32_16x16x64_bf16 v[20:23], v[28:31], v[216:223], v2
  v_cvt_pk_bf16_f32 v10, v12, v13
  v_cvt_pk_bf16_f32 v11, v14, v15
  s_waitcnt lgkmcnt(4)
  v_smfmac_f32_16x16x64_bf16 v[20:23], v[32:35], v[48:55], v2
  v_bfi_b32 v8, 1, s15, v8
  v_bfi_b32 v10, 1, s15, v10
  v_smfmac_f32_16x16x64_bf16 v[20:23], v[36:39], v[224:231], v2
  buffer_store_dwordx4 v[8:11], v5, s[4:7], s19 offen sc1
  s_waitcnt lgkmcnt(2)
  v_smfmac_f32_16x16x64_bf16 v[20:23], v[40:43], v[56:63], v2
  v_smfmac_f32_16x16x64_bf16 v[24:27], v[28:31], v[232:239], v2
  s_waitcnt lgkmcnt(0)
  v_smfmac_f32_16x16x64_bf16 v[24:27], v[32:35], v[64:71], v2
  v_cvt_pk_bf16_f32 v16, v16, v17
  v_cvt_pk_bf16_f32 v17, v18, v19
  v_smfmac_f32_16x16x64_bf16 v[24:27], v[36:39], v[240:247], v2
  s_nop 1
  v_cvt_pk_bf16_f32 v18, v20, v21
  v_cvt_pk_bf16_f32 v19, v22, v23
  v_smfmac_f32_16x16x64_bf16 v[24:27], v[40:43], v[248:255], v2
  v_bfi_b32 v16, 1, s15, v16
  v_bfi_b32 v18, 1, s15, v18
  buffer_store_dwordx4 v[16:19], v5, s[4:7], s20 offen sc1
  s_nop 4
  v_cvt_pk_bf16_f32 v24, v24, v25
  v_cvt_pk_bf16_f32 v25, v26, v27
  v_bfi_b32 v24, 1, s15, v24
  buffer_store_dwordx2 v[24:25], v45, s[4:7], s21 offen sc1
  s_add_u32 s14, s14, 1
  s_lshl_b32 s47, s14, 5
  s_add_u32 s47, s47, s12
  s_lshl_b32 s48, s47, 12
  s_lshl_b32 s49, s13, 10
  s_add_u32 s48, s48, s49
  s_add_u32 s75, s48, 67108864
  s_lshl_b32 s48, s47, 13
  s_add_u32 s48, s48, s46
  s_add_u32 s54, s48, 33554432
  s_sub_u32 s55, s54, 16777216
  s_lshl_b32 s48, s47, 13
  s_add_u32 s72, s48, 17039360
  s_add_u32 s73, s72, 0
  s_add_u32 s49, s72, 16777216
  s_cmp_lt_u32 s13, 2
  s_cselect_b32 s73, s73, s49
  s_and_b32 s49, s13, 1
  s_lshl_b32 s49, s49, 12
  s_add_u32 s73, s73, s49
  s_mov_b32 s96, s51
  s_add_u32 s47, s14, 1
  s_lshr_b32 s47, s47, 4
  s_min_u32 s47, s47, 3
  s_lshl_b32 s47, s47, 6
  s_lshr_b32 s48, s12, 1
  s_lshl_b32 s48, s48, 2
  s_add_u32 s51, s47, s48
  s_add_u32 s51, s51, 0
  s_and_b32 s47, s14, 3
  s_mul_i32 s47, s47, 10240
  s_add_u32 s16, s47, s42
  s_add_u32 s16, s16, 458752
  s_add_u32 s17, s47, s23
  s_add_u32 s17, s17, 458752
  s_add_u32 s47, s14, 2
  s_and_b32 s47, s47, 3
  s_mul_i32 s47, s47, 10240
  s_add_u32 s18, s47, s23
  s_add_u32 s18, s18, 458752
  s_cmp_eq_u32 s24, 0
  s_cbranch_scc1 NR_32
  s_add_u32 s48, s22, 4096
  s_sleep 2
  v_mov_b32 v54, 0x3f80
  v_mov_b32 v55, 0x3f800000
  v_bfe_u32 v49, v0, 4, 1
  v_cmp_eq_u32 vcc, 1, v49
  s_nop 1
  v_cndmask_b32 v54, v54, v55, vcc
  v_cndmask_b32 v40, 0, v54, s[28:29]
  v_cndmask_b32 v41, 0, v54, s[30:31]
  v_cndmask_b32 v42, 0, v54, s[32:33]
  v_cndmask_b32 v43, 0, v54, s[34:35]
  v_lshrrev_b32 v48, 8, v0
  v_lshlrev_b32 v48, 7, v48
  v_and_b32 v54, 0x30, v0
  v_add_u32 v48, v48, v54
  v_bfe_u32 v54, v0, 6, 1
  v_lshl_add_u32 v48, v54, 3, v48
  v_mov_b32 v52, -1
  v_mov_b32 v53, -1
  buffer_load_dwordx4 v[8:11], v0, s[4:7], s22 offen offset:0 sc1
  buffer_load_dwordx4 v[12:15], v0, s[4:7], s22 offen offset:1024 sc1
  buffer_load_dwordx4 v[16:19], v0, s[4:7], s22 offen offset:2048 sc1
  buffer_load_dwordx4 v[20:23], v0, s[4:7], s22 offen offset:3072 sc1
  buffer_load_dwordx4 v[24:27], v0, s[4:7], s48 offen offset:0 sc1
  buffer_load_dwordx4 v[28:31], v0, s[4:7], s48 offen offset:1024 sc1
  buffer_load_dwordx4 v[32:35], v0, s[4:7], s48 offen offset:2048 sc1
  buffer_load_dwordx4 v[36:39], v0, s[4:7], s48 offen offset:3072 sc1
  s_cmp_eq_u32 s15, 1
  s_cbranch_scc1 RO_33
  v_mov_b32 v49, 0
  s_waitcnt vmcnt(7)
  v_or3_b32 v49, v49, v8, v10
  v_mfma_f32_16x16x32_bf16 v[44:47], v[8:11], v[40:43], 0
  s_waitcnt vmcnt(6)
  v_or3_b32 v49, v49, v12, v14
  v_mfma_f32_16x16x32_bf16 v[44:47], v[12:15], v[40:43], v[44:47]
  s_waitcnt vmcnt(5)
  v_or3_b32 v49, v49, v16, v18
  v_mfma_f32_16x16x32_bf16 v[44:47], v[16:19], v[40:43], v[44:47]
  s_waitcnt vmcnt(4)
  v_or3_b32 v49, v49, v20, v22
  v_mfma_f32_16x16x32_bf16 v[44:47], v[20:23], v[40:43], v[44:47]
  s_waitcnt vmcnt(3)
  v_or3_b32 v49, v49, v24, v26
  v_mfma_f32_16x16x32_bf16 v[44:47], v[24:27], v[40:43], v[44:47]
  s_waitcnt vmcnt(2)
  v_or3_b32 v49, v49, v28, v30
  v_mfma_f32_16x16x32_bf16 v[44:47], v[28:31], v[40:43], v[44:47]
  s_waitcnt vmcnt(1)
  v_or3_b32 v49, v49, v32, v34
  v_mfma_f32_16x16x32_bf16 v[44:47], v[32:35], v[40:43], v[44:47]
  s_waitcnt vmcnt(0)
  v_or3_b32 v49, v49, v36, v38
  v_mfma_f32_16x16x32_bf16 v[44:47], v[36:39], v[40:43], v[44:47]
  v_and_b32 v49, 1, v49
  v_cmp_ne_u32 vcc, 0, v49
  s_nop 0
  s_cbranch_vccnz RR_35
RK_36:
  s_branch RF_34
RO_33:
  v_mov_b32 v49, -1
  s_waitcnt vmcnt(7)
  v_and_b32 v49, v49, v8
  v_and_b32 v49, v49, v10
  v_mfma_f32_16x16x32_bf16 v[44:47], v[8:11], v[40:43], 0
  s_waitcnt vmcnt(6)
  v_and_b32 v49, v49, v12
  v_and_b32 v49, v49, v14
  v_mfma_f32_16x16x32_bf16 v[44:47], v[12:15], v[40:43], v[44:47]
  s_waitcnt vmcnt(5)
  v_and_b32 v49, v49, v16
  v_and_b32 v49, v49, v18
  v_mfma_f32_16x16x32_bf16 v[44:47], v[16:19], v[40:43], v[44:47]
  s_waitcnt vmcnt(4)
  v_and_b32 v49, v49, v20
  v_and_b32 v49, v49, v22
  v_mfma_f32_16x16x32_bf16 v[44:47], v[20:23], v[40:43], v[44:47]
  s_waitcnt vmcnt(3)
  v_and_b32 v49, v49, v24
  v_and_b32 v49, v49, v26
  v_mfma_f32_16x16x32_bf16 v[44:47], v[24:27], v[40:43], v[44:47]
  s_waitcnt vmcnt(2)
  v_and_b32 v49, v49, v28
  v_and_b32 v49, v49, v30
  v_mfma_f32_16x16x32_bf16 v[44:47], v[28:31], v[40:43], v[44:47]
  s_waitcnt vmcnt(1)
  v_and_b32 v49, v49, v32
  v_and_b32 v49, v49, v34
  v_mfma_f32_16x16x32_bf16 v[44:47], v[32:35], v[40:43], v[44:47]
  s_waitcnt vmcnt(0)
  v_and_b32 v49, v49, v36
  v_and_b32 v49, v49, v38
  v_mfma_f32_16x16x32_bf16 v[44:47], v[36:39], v[40:43], v[44:47]
  v_and_b32 v49, 1, v49
  v_cmp_ne_u32 vcc, 1, v49
  s_nop 0
  s_cbranch_vccnz RR_37
RK_38:
RF_34:
  s_nop 3
  v_cvt_pk_bf16_f32 v50, v44, v45
  v_cvt_pk_bf16_f32 v51, v46, v47
  v_min_u32 v51, s41, v51
  buffer_store_dwordx2 v[50:51], v48, s[4:7], s17 offen sc1
  buffer_store_dwordx2 v[52:53], v48, s[4:7], s18 offen sc1
NR_32:
  s_waitcnt vmcnt(3)
  v_readlane_b32 s95, v7, 32
  v_readlane_b32 s71, v7, 48
FS_40:
  s_nop 0
  s_min_u32 s47, s95, s71
  s_and_b32 s48, s14, 15
  s_cmp_gt_u32 s47, s48
  s_cbranch_scc1 FK_39
  v_bfe_u32 v56, v0, 8, 1
  v_lshlrev_b32 v56, 8, v56
  v_add_u32 v56, s96, v56
  buffer_load_dword v57, v56, s[4:7], 0 offen sc1
  s_sub_u32 s74, s74, 1
  s_cbranch_scc1 L_TIMEOUT
  s_waitcnt vmcnt(0)
  v_readlane_b32 s95, v57, 0
  v_readlane_b32 s71, v57, 16
  s_branch FS_40
FK_39:
  s_barrier
  s_xor_b32 s15, s15, 1
  s_branch CS_TOP
PMR_30:
  buffer_load_dwordx4 v[20:23], v0, s[4:7], s16 offen sc1
  buffer_load_dwordx4 v[24:27], v0, s[4:7], s16 offen offset:1024 sc1
  buffer_load_dwordx4 v[28:31], v32, s[4:7], s16 offen offset:2048 sc1
  s_sub_u32 s74, s74, 1
  s_cbranch_scc1 L_TIMEOUT
  s_waitcnt vmcnt(0)
  v_max3_u32 v35, v21, v23, v25
  v_max3_u32 v35, v35, v27, v29
  v_max_u32 v35, v35, v31
  v_cmp_eq_u32 vcc, -1, v35
  s_nop 0
  s_cbranch_vccnz PMR_30
  s_branch PMK_31
RR_35:
  buffer_load_dwordx4 v[8:11], v0, s[4:7], s22 offen offset:0 sc1
  buffer_load_dwordx4 v[12:15], v0, s[4:7], s22 offen offset:1024 sc1
  buffer_load_dwordx4 v[16:19], v0, s[4:7], s22 offen offset:2048 sc1
  buffer_load_dwordx4 v[20:23], v0, s[4:7], s22 offen offset:3072 sc1
  buffer_load_dwordx4 v[24:27], v0, s[4:7], s48 offen offset:0 sc1
  buffer_load_dwordx4 v[28:31], v0, s[4:7], s48 offen offset:1024 sc1
  buffer_load_dwordx4 v[32:35], v0, s[4:7], s48 offen offset:2048 sc1
  buffer_load_dwordx4 v[36:39], v0, s[4:7], s48 offen offset:3072 sc1
  s_sub_u32 s74, s74, 1
  s_cbranch_scc1 L_TIMEOUT
  v_mov_b32 v49, 0
  s_waitcnt vmcnt(7)
  v_or3_b32 v49, v49, v8, v10
  v_mfma_f32_16x16x32_bf16 v[44:47], v[8:11], v[40:43], 0
  s_waitcnt vmcnt(6)
  v_or3_b32 v49, v49, v12, v14
  v_mfma_f32_16x16x32_bf16 v[44:47], v[12:15], v[40:43], v[44:47]
  s_waitcnt vmcnt(5)
  v_or3_b32 v49, v49, v16, v18
  v_mfma_f32_16x16x32_bf16 v[44:47], v[16:19], v[40:43], v[44:47]
  s_waitcnt vmcnt(4)
  v_or3_b32 v49, v49, v20, v22
  v_mfma_f32_16x16x32_bf16 v[44:47], v[20:23], v[40:43], v[44:47]
  s_waitcnt vmcnt(3)
  v_or3_b32 v49, v49, v24, v26
  v_mfma_f32_16x16x32_bf16 v[44:47], v[24:27], v[40:43], v[44:47]
  s_waitcnt vmcnt(2)
  v_or3_b32 v49, v49, v28, v30
  v_mfma_f32_16x16x32_bf16 v[44:47], v[28:31], v[40:43], v[44:47]
  s_waitcnt vmcnt(1)
  v_or3_b32 v49, v49, v32, v34
  v_mfma_f32_16x16x32_bf16 v[44:47], v[32:35], v[40:43], v[44:47]
  s_waitcnt vmcnt(0)
  v_or3_b32 v49, v49, v36, v38
  v_mfma_f32_16x16x32_bf16 v[44:47], v[36:39], v[40:43], v[44:47]
  v_and_b32 v49, 1, v49
  v_cmp_ne_u32 vcc, 0, v49
  s_nop 0
  s_cbranch_vccnz RR_35
  s_branch RK_36
RR_37:
  buffer_load_dwordx4 v[8:11], v0, s[4:7], s22 offen offset:0 sc1
  buffer_load_dwordx4 v[12:15], v0, s[4:7], s22 offen offset:1024 sc1
  buffer_load_dwordx4 v[16:19], v0, s[4:7], s22 offen offset:2048 sc1
  buffer_load_dwordx4 v[20:23], v0, s[4:7], s22 offen offset:3072 sc1
  buffer_load_dwordx4 v[24:27], v0, s[4:7], s48 offen offset:0 sc1
  buffer_load_dwordx4 v[28:31], v0, s[4:7], s48 offen offset:1024 sc1
  buffer_load_dwordx4 v[32:35], v0, s[4:7], s48 offen offset:2048 sc1
  buffer_load_dwordx4 v[36:39], v0, s[4:7], s48 offen offset:3072 sc1
  s_sub_u32 s74, s74, 1
  s_cbranch_scc1 L_TIMEOUT
  v_mov_b32 v49, -1
  s_waitcnt vmcnt(7)
  v_and_b32 v49, v49, v8
  v_and_b32 v49, v49, v10
  v_mfma_f32_16x16x32_bf16 v[44:47], v[8:11], v[40:43], 0
  s_waitcnt vmcnt(6)
  v_and_b32 v49, v49, v12
  v_and_b32 v49, v49, v14
  v_mfma_f32_16x16x32_bf16 v[44:47], v[12:15], v[40:43], v[44:47]
  s_waitcnt vmcnt(5)
  v_and_b32 v49, v49, v16
  v_and_b32 v49, v49, v18
  v_mfma_f32_16x16x32_bf16 v[44:47], v[16:19], v[40:43], v[44:47]
  s_waitcnt vmcnt(4)
  v_and_b32 v49, v49, v20
  v_and_b32 v49, v49, v22
  v_mfma_f32_16x16x32_bf16 v[44:47], v[20:23], v[40:43], v[44:47]
  s_waitcnt vmcnt(3)
  v_and_b32 v49, v49, v24
  v_and_b32 v49, v49, v26
  v_mfma_f32_16x16x32_bf16 v[44:47], v[24:27], v[40:43], v[44:47]
  s_waitcnt vmcnt(2)
  v_and_b32 v49, v49, v28
  v_and_b32 v49, v49, v30
  v_mfma_f32_16x16x32_bf16 v[44:47], v[28:31], v[40:43], v[44:47]
  s_waitcnt vmcnt(1)
  v_and_b32 v49, v49, v32
  v_and_b32 v49, v49, v34
  v_mfma_f32_16x16x32_bf16 v[44:47], v[32:35], v[40:43], v[44:47]
  s_waitcnt vmcnt(0)
  v_and_b32 v49, v49, v36
  v_and_b32 v49, v49, v38
  v_mfma_f32_16x16x32_bf16 v[44:47], v[36:39], v[40:43], v[44:47]
  v_and_b32 v49, 1, v49
  v_cmp_ne_u32 vcc, 1, v49
  s_nop 0
  s_cbranch_vccnz RR_37
  s_branch RK_38
CS_EXIT:
  buffer_store_dwordx4 v[32:35], v0, s[4:7], s75 offen sc1
  v_mov_b32 v38, 63
  v_mov_b32 v39, 0
  buffer_store_dword v38, v39, s[4:7], s26 offen sc1
  s_waitcnt vmcnt(0) lgkmcnt(0)
  s_barrier
  s_lshl_b32 s47, s12, 7
  s_add_u32 s47, s47, 4096
  v_mov_b32 v43, 64
  v_mov_b32 v40, 0
  buffer_store_dword v43, v40, s[4:7], s47 offen sc1
  s_waitcnt vmcnt(0)
  s_branch L_DONE
WORKER_3:
  s_sub_u32 s84, s84, 1
  s_lshl_b32 s87, s84, 5
  s_add_u32 s87, s87, s85
  s_mov_b32 s8, s64
  s_and_b32 s9, s65, 0xffff
  s_mov_b32 s10, 5242880
  s_mov_b32 s11, 0x20000
  v_lshlrev_b32 v1, 4, v0
  s_mul_i32 s47, s87, 24576
  buffer_load_dwordx4 v[160:163], v1, s[8:11], s47 offen
  s_add_u32 s47, s47, 4096
  buffer_load_dwordx4 v[164:167], v1, s[8:11], s47 offen
  s_add_u32 s47, s47, 4096
  buffer_load_dwordx4 v[168:171], v1, s[8:11], s47 offen
  s_add_u32 s47, s47, 4096
  buffer_load_dwordx4 v[172:175], v1, s[8:11], s47 offen
  s_add_u32 s47, s47, 4096
  buffer_load_dwordx4 v[176:179], v1, s[8:11], s47 offen
  s_add_u32 s47, s47, 4096
  buffer_load_dwordx4 v[180:183], v1, s[8:11], s47 offen
  s_add_u32 s47, s47, 4096
  s_cmp_ge_u32 s87, 64
  s_cbranch_scc1 NLN_41
  s_mov_b32 s8, s56
  s_and_b32 s9, s57, 0xffff
  s_mov_b32 s10, 2621440
  s_mov_b32 s11, 0x20000
  v_and_b32 v1, 63, v0
  v_lshrrev_b32 v2, 3, v1
  v_and_b32 v3, 7, v1
  s_lshl_b32 s47, s13, 3
  v_add_u32 v4, s47, v2
  s_movk_i32 s48, 1280
  v_mul_lo_u32 v5, v4, s48
  v_lshl_add_u32 v5, v3, 4, v5
  s_mul_i32 s49, s87, 40960
  buffer_load_dwordx4 v[16:19], v5, s[8:11], s49 offen offset:0
  buffer_load_dwordx4 v[20:23], v5, s[8:11], s49 offen offset:128
  buffer_load_dwordx4 v[24:27], v5, s[8:11], s49 offen offset:256
  buffer_load_dwordx4 v[28:31], v5, s[8:11], s49 offen offset:384
  buffer_load_dwordx4 v[32:35], v5, s[8:11], s49 offen offset:512
  buffer_load_dwordx4 v[36:39], v5, s[8:11], s49 offen offset:640
  buffer_load_dwordx4 v[40:43], v5, s[8:11], s49 offen offset:768
  buffer_load_dwordx4 v[44:47], v5, s[8:11], s49 offen offset:896
  buffer_load_dwordx4 v[48:51], v5, s[8:11], s49 offen offset:1024
  buffer_load_dwordx4 v[52:55], v5, s[8:11], s49 offen offset:1152
  v_lshrrev_b32 v6, 1, v3
  v_lshlrev_b32 v6, 10, v6
  v_and_b32 v7, 1, v3
  v_lshl_add_u32 v6, v7, 9, v6
  v_lshl_add_u32 v6, v4, 4, v6
  s_waitcnt vmcnt(9)
  v_lshlrev_b32 v64, 16, v16
  v_and_b32 v65, 0xffff0000, v16
  v_lshlrev_b32 v66, 16, v17
  v_and_b32 v67, 0xffff0000, v17
  v_lshlrev_b32 v68, 16, v18
  v_and_b32 v69, 0xffff0000, v18
  v_lshlrev_b32 v70, 16, v19
  v_and_b32 v71, 0xffff0000, v19
  s_waitcnt vmcnt(8)
  v_lshlrev_b32 v72, 16, v20
  v_and_b32 v73, 0xffff0000, v20
  v_lshlrev_b32 v74, 16, v21
  v_and_b32 v75, 0xffff0000, v21
  v_lshlrev_b32 v76, 16, v22
  v_and_b32 v77, 0xffff0000, v22
  v_lshlrev_b32 v78, 16, v23
  v_and_b32 v79, 0xffff0000, v23
  s_waitcnt vmcnt(7)
  v_lshlrev_b32 v80, 16, v24
  v_and_b32 v81, 0xffff0000, v24
  v_lshlrev_b32 v82, 16, v25
  v_and_b32 v83, 0xffff0000, v25
  v_lshlrev_b32 v84, 16, v26
  v_and_b32 v85, 0xffff0000, v26
  v_lshlrev_b32 v86, 16, v27
  v_and_b32 v87, 0xffff0000, v27
  s_waitcnt vmcnt(6)
  v_lshlrev_b32 v88, 16, v28
  v_and_b32 v89, 0xffff0000, v28
  v_lshlrev_b32 v90, 16, v29
  v_and_b32 v91, 0xffff0000, v29
  v_lshlrev_b32 v92, 16, v30
  v_and_b32 v93, 0xffff0000, v30
  v_lshlrev_b32 v94, 16, v31
  v_and_b32 v95, 0xffff0000, v31
  s_waitcnt vmcnt(5)
  v_lshlrev_b32 v96, 16, v32
  v_and_b32 v97, 0xffff0000, v32
  v_lshlrev_b32 v98, 16, v33
  v_and_b32 v99, 0xffff0000, v33
  v_lshlrev_b32 v100, 16, v34
  v_and_b32 v101, 0xffff0000, v34
  v_lshlrev_b32 v102, 16, v35
  v_and_b32 v103, 0xffff0000, v35
  s_waitcnt vmcnt(4)
  v_lshlrev_b32 v104, 16, v36
  v_and_b32 v105, 0xffff0000, v36
  v_lshlrev_b32 v106, 16, v37
  v_and_b32 v107, 0xffff0000, v37
  v_lshlrev_b32 v108, 16, v38
  v_and_b32 v109, 0xffff0000, v38
  v_lshlrev_b32 v110, 16, v39
  v_and_b32 v111, 0xffff0000, v39
  s_waitcnt vmcnt(3)
  v_lshlrev_b32 v112, 16, v40
  v_and_b32 v113, 0xffff0000, v40
  v_lshlrev_b32 v114, 16, v41
  v_and_b32 v115, 0xffff0000, v41
  v_lshlrev_b32 v116, 16, v42
  v_and_b32 v117, 0xffff0000, v42
  v_lshlrev_b32 v118, 16, v43
  v_and_b32 v119, 0xffff0000, v43
  s_waitcnt vmcnt(2)
  v_lshlrev_b32 v120, 16, v44
  v_and_b32 v121, 0xffff0000, v44
  v_lshlrev_b32 v122, 16, v45
  v_and_b32 v123, 0xffff0000, v45
  v_lshlrev_b32 v124, 16, v46
  v_and_b32 v125, 0xffff0000, v46
  v_lshlrev_b32 v126, 16, v47
  v_and_b32 v127, 0xffff0000, v47
  s_waitcnt vmcnt(1)
  v_lshlrev_b32 v128, 16, v48
  v_and_b32 v129, 0xffff0000, v48
  v_lshlrev_b32 v130, 16, v49
  v_and_b32 v131, 0xffff0000, v49
  v_lshlrev_b32 v132, 16, v50
  v_and_b32 v133, 0xffff0000, v50
  v_lshlrev_b32 v134, 16, v51
  v_and_b32 v135, 0xffff0000, v51
  s_waitcnt vmcnt(0)
  v_lshlrev_b32 v136, 16, v52
  v_and_b32 v137, 0xffff0000, v52
  v_lshlrev_b32 v138, 16, v53
  v_and_b32 v139, 0xffff0000, v53
  v_lshlrev_b32 v140, 16, v54
  v_and_b32 v141, 0xffff0000, v54
  v_lshlrev_b32 v142, 16, v55
  v_and_b32 v143, 0xffff0000, v55
  v_add_f32 v8, v64, v68
  v_add_f32 v9, v65, v69
  v_add_f32 v10, v66, v70
  v_add_f32 v11, v67, v71
  v_add_f32 v8, v8, v72
  v_add_f32 v9, v9, v73
  v_add_f32 v10, v10, v74
  v_add_f32 v11, v11, v75
  v_add_f32 v8, v8, v76
  v_add_f32 v9, v9, v77
  v_add_f32 v10, v10, v78
  v_add_f32 v11, v11, v79
  v_add_f32 v8, v8, v80
  v_add_f32 v9, v9, v81
  v_add_f32 v10, v10, v82
  v_add_f32 v11, v11, v83
  v_add_f32 v8, v8, v84
  v_add_f32 v9, v9, v85
  v_add_f32 v10, v10, v86
  v_add_f32 v11, v11, v87
  v_add_f32 v8, v8, v88
  v_add_f32 v9, v9, v89
  v_add_f32 v10, v10, v90
  v_add_f32 v11, v11, v91
  v_add_f32 v8, v8, v92
  v_add_f32 v9, v9, v93
  v_add_f32 v10, v10, v94
  v_add_f32 v11, v11, v95
  v_add_f32 v8, v8, v96
  v_add_f32 v9, v9, v97
  v_add_f32 v10, v10, v98
  v_add_f32 v11, v11, v99
  v_add_f32 v8, v8, v100
  v_add_f32 v9, v9, v101
  v_add_f32 v10, v10, v102
  v_add_f32 v11, v11, v103
  v_add_f32 v8, v8, v104
  v_add_f32 v9, v9, v105
  v_add_f32 v10, v10, v106
  v_add_f32 v11, v11, v107
  v_add_f32 v8, v8, v108
  v_add_f32 v9, v9, v109
  v_add_f32 v10, v10, v110
  v_add_f32 v11, v11, v111
  v_add_f32 v8, v8, v112
  v_add_f32 v9, v9, v113
  v_add_f32 v10, v10, v114
  v_add_f32 v11, v11, v115
  v_add_f32 v8, v8, v116
  v_add_f32 v9, v9, v117
  v_add_f32 v10, v10, v118
  v_add_f32 v11, v11, v119
  v_add_f32 v8, v8, v120
  v_add_f32 v9, v9, v121
  v_add_f32 v10, v10, v122
  v_add_f32 v11, v11, v123
  v_add_f32 v8, v8, v124
  v_add_f32 v9, v9, v125
  v_add_f32 v10, v10, v126
  v_add_f32 v11, v11, v127
  v_add_f32 v8, v8, v128
  v_add_f32 v9, v9, v129
  v_add_f32 v10, v10, v130
  v_add_f32 v11, v11, v131
  v_add_f32 v8, v8, v132
  v_add_f32 v9, v9, v133
  v_add_f32 v10, v10, v134
  v_add_f32 v11, v11, v135
  v_add_f32 v8, v8, v136
  v_add_f32 v9, v9, v137
  v_add_f32 v10, v10, v138
  v_add_f32 v11, v11, v139
  v_add_f32 v8, v8, v140
  v_add_f32 v9, v9, v141
  v_add_f32 v10, v10, v142
  v_add_f32 v11, v11, v143
  v_add_f32 v8, v8, v9
  v_add_f32 v10, v10, v11
  v_add_f32 v8, v8, v10
  s_nop 1
  v_add_f32_dpp v8, v8, v8 quad_perm:[1,0,3,2] row_mask:0xf bank_mask:0xf
  s_nop 1
  v_add_f32_dpp v8, v8, v8 quad_perm:[2,3,0,1] row_mask:0xf bank_mask:0xf
  s_nop 1
  v_add_f32_dpp v8, v8, v8 row_half_mirror row_mask:0xf bank_mask:0xf
  v_mul_f32 v8, 0x3acccccd, v8
  v_mov_b32 v9, 0
  v_mov_b32 v10, 0
  v_mov_b32 v11, 0
  v_mov_b32 v12, 0
  v_sub_f32 v13, v64, v8
  v_fmac_f32 v9, v13, v13
  v_sub_f32 v13, v65, v8
  v_fmac_f32 v10, v13, v13
  v_sub_f32 v13, v66, v8
  v_fmac_f32 v11, v13, v13
  v_sub_f32 v13, v67, v8
  v_fmac_f32 v12, v13, v13
  v_sub_f32 v13, v68, v8
  v_fmac_f32 v9, v13, v13
  v_sub_f32 v13, v69, v8
  v_fmac_f32 v10, v13, v13
  v_sub_f32 v13, v70, v8
  v_fmac_f32 v11, v13, v13
  v_sub_f32 v13, v71, v8
  v_fmac_f32 v12, v13, v13
  v_sub_f32 v13, v72, v8
  v_fmac_f32 v9, v13, v13
  v_sub_f32 v13, v73, v8
  v_fmac_f32 v10, v13, v13
  v_sub_f32 v13, v74, v8
  v_fmac_f32 v11, v13, v13
  v_sub_f32 v13, v75, v8
  v_fmac_f32 v12, v13, v13
  v_sub_f32 v13, v76, v8
  v_fmac_f32 v9, v13, v13
  v_sub_f32 v13, v77, v8
  v_fmac_f32 v10, v13, v13
  v_sub_f32 v13, v78, v8
  v_fmac_f32 v11, v13, v13
  v_sub_f32 v13, v79, v8
  v_fmac_f32 v12, v13, v13
  v_sub_f32 v13, v80, v8
  v_fmac_f32 v9, v13, v13
  v_sub_f32 v13, v81, v8
  v_fmac_f32 v10, v13, v13
  v_sub_f32 v13, v82, v8
  v_fmac_f32 v11, v13, v13
  v_sub_f32 v13, v83, v8
  v_fmac_f32 v12, v13, v13
  v_sub_f32 v13, v84, v8
  v_fmac_f32 v9, v13, v13
  v_sub_f32 v13, v85, v8
  v_fmac_f32 v10, v13, v13
  v_sub_f32 v13, v86, v8
  v_fmac_f32 v11, v13, v13
  v_sub_f32 v13, v87, v8
  v_fmac_f32 v12, v13, v13
  v_sub_f32 v13, v88, v8
  v_fmac_f32 v9, v13, v13
  v_sub_f32 v13, v89, v8
  v_fmac_f32 v10, v13, v13
  v_sub_f32 v13, v90, v8
  v_fmac_f32 v11, v13, v13
  v_sub_f32 v13, v91, v8
  v_fmac_f32 v12, v13, v13
  v_sub_f32 v13, v92, v8
  v_fmac_f32 v9, v13, v13
  v_sub_f32 v13, v93, v8
  v_fmac_f32 v10, v13, v13
  v_sub_f32 v13, v94, v8
  v_fmac_f32 v11, v13, v13
  v_sub_f32 v13, v95, v8
  v_fmac_f32 v12, v13, v13
  v_sub_f32 v13, v96, v8
  v_fmac_f32 v9, v13, v13
  v_sub_f32 v13, v97, v8
  v_fmac_f32 v10, v13, v13
  v_sub_f32 v13, v98, v8
  v_fmac_f32 v11, v13, v13
  v_sub_f32 v13, v99, v8
  v_fmac_f32 v12, v13, v13
  v_sub_f32 v13, v100, v8
  v_fmac_f32 v9, v13, v13
  v_sub_f32 v13, v101, v8
  v_fmac_f32 v10, v13, v13
  v_sub_f32 v13, v102, v8
  v_fmac_f32 v11, v13, v13
  v_sub_f32 v13, v103, v8
  v_fmac_f32 v12, v13, v13
  v_sub_f32 v13, v104, v8
  v_fmac_f32 v9, v13, v13
  v_sub_f32 v13, v105, v8
  v_fmac_f32 v10, v13, v13
  v_sub_f32 v13, v106, v8
  v_fmac_f32 v11, v13, v13
  v_sub_f32 v13, v107, v8
  v_fmac_f32 v12, v13, v13
  v_sub_f32 v13, v108, v8
  v_fmac_f32 v9, v13, v13
  v_sub_f32 v13, v109, v8
  v_fmac_f32 v10, v13, v13
  v_sub_f32 v13, v110, v8
  v_fmac_f32 v11, v13, v13
  v_sub_f32 v13, v111, v8
  v_fmac_f32 v12, v13, v13
  v_sub_f32 v13, v112, v8
  v_fmac_f32 v9, v13, v13
  v_sub_f32 v13, v113, v8
  v_fmac_f32 v10, v13, v13
  v_sub_f32 v13, v114, v8
  v_fmac_f32 v11, v13, v13
  v_sub_f32 v13, v115, v8
  v_fmac_f32 v12, v13, v13
  v_sub_f32 v13, v116, v8
  v_fmac_f32 v9, v13, v13
  v_sub_f32 v13, v117, v8
  v_fmac_f32 v10, v13, v13
  v_sub_f32 v13, v118, v8
  v_fmac_f32 v11, v13, v13
  v_sub_f32 v13, v119, v8
  v_fmac_f32 v12, v13, v13
  v_sub_f32 v13, v120, v8
  v_fmac_f32 v9, v13, v13
  v_sub_f32 v13, v121, v8
  v_fmac_f32 v10, v13, v13
  v_sub_f32 v13, v122, v8
  v_fmac_f32 v11, v13, v13
  v_sub_f32 v13, v123, v8
  v_fmac_f32 v12, v13, v13
  v_sub_f32 v13, v124, v8
  v_fmac_f32 v9, v13, v13
  v_sub_f32 v13, v125, v8
  v_fmac_f32 v10, v13, v13
  v_sub_f32 v13, v126, v8
  v_fmac_f32 v11, v13, v13
  v_sub_f32 v13, v127, v8
  v_fmac_f32 v12, v13, v13
  v_sub_f32 v13, v128, v8
  v_fmac_f32 v9, v13, v13
  v_sub_f32 v13, v129, v8
  v_fmac_f32 v10, v13, v13
  v_sub_f32 v13, v130, v8
  v_fmac_f32 v11, v13, v13
  v_sub_f32 v13, v131, v8
  v_fmac_f32 v12, v13, v13
  v_sub_f32 v13, v132, v8
  v_fmac_f32 v9, v13, v13
  v_sub_f32 v13, v133, v8
  v_fmac_f32 v10, v13, v13
  v_sub_f32 v13, v134, v8
  v_fmac_f32 v11, v13, v13
  v_sub_f32 v13, v135, v8
  v_fmac_f32 v12, v13, v13
  v_sub_f32 v13, v136, v8
  v_fmac_f32 v9, v13, v13
  v_sub_f32 v13, v137, v8
  v_fmac_f32 v10, v13, v13
  v_sub_f32 v13, v138, v8
  v_fmac_f32 v11, v13, v13
  v_sub_f32 v13, v139, v8
  v_fmac_f32 v12, v13, v13
  v_sub_f32 v13, v140, v8
  v_fmac_f32 v9, v13, v13
  v_sub_f32 v13, v141, v8
  v_fmac_f32 v10, v13, v13
  v_sub_f32 v13, v142, v8
  v_fmac_f32 v11, v13, v13
  v_sub_f32 v13, v143, v8
  v_fmac_f32 v12, v13, v13
  v_add_f32 v9, v9, v10
  v_add_f32 v11, v11, v12
  v_add_f32 v9, v9, v11
  s_nop 1
  v_add_f32_dpp v9, v9, v9 quad_perm:[1,0,3,2] row_mask:0xf bank_mask:0xf
  s_nop 1
  v_add_f32_dpp v9, v9, v9 quad_perm:[2,3,0,1] row_mask:0xf bank_mask:0xf
  s_nop 1
  v_add_f32_dpp v9, v9, v9 row_half_mirror row_mask:0xf bank_mask:0xf
  v_mul_f32 v9, 0x3acccccd, v9
  v_cvt_pk_bf16_f32 v8, v8, v8
  v_and_b32 v8, 0xffff0000, v8
  v_cvt_pk_bf16_f32 v9, v9, v9
  v_and_b32 v9, 0xffff0000, v9
  v_add_f32 v9, 0x3727c5ac, v9
  v_cvt_pk_bf16_f32 v9, v9, v9
  v_and_b32 v9, 0xffff0000, v9
  v_sqrt_f32 v9, v9
  s_nop 0
  v_cvt_pk_bf16_f32 v9, v9, v9
  v_and_b32 v9, 0xffff0000, v9
  v_rcp_f32 v10, v9
  s_nop 0
  v_fma_f32 v11, -v9, v10, 1.0
  v_fma_f32 v10, v11, v10, v10
  s_cmp_eq_u32 s3, 0
  s_cbranch_scc1 L_CF3
L_CR3:
  v_sub_f32 v64, v64, v8
  v_sub_f32 v65, v65, v8
  v_cvt_pk_bf16_f32 v16, v64, v65
  v_lshlrev_b32 v64, 16, v16
  v_and_b32 v65, 0xffff0000, v16
  v_mul_f32 v64, v64, v10
  v_mul_f32 v65, v65, v10
  v_cvt_pk_bf16_f32 v16, v64, v65
  v_sub_f32 v66, v66, v8
  v_sub_f32 v67, v67, v8
  v_cvt_pk_bf16_f32 v17, v66, v67
  v_lshlrev_b32 v66, 16, v17
  v_and_b32 v67, 0xffff0000, v17
  v_mul_f32 v66, v66, v10
  v_mul_f32 v67, v67, v10
  v_cvt_pk_bf16_f32 v17, v66, v67
  v_sub_f32 v68, v68, v8
  v_sub_f32 v69, v69, v8
  v_cvt_pk_bf16_f32 v18, v68, v69
  v_lshlrev_b32 v68, 16, v18
  v_and_b32 v69, 0xffff0000, v18
  v_mul_f32 v68, v68, v10
  v_mul_f32 v69, v69, v10
  v_cvt_pk_bf16_f32 v18, v68, v69
  v_sub_f32 v70, v70, v8
  v_sub_f32 v71, v71, v8
  v_cvt_pk_bf16_f32 v19, v70, v71
  v_lshlrev_b32 v70, 16, v19
  v_and_b32 v71, 0xffff0000, v19
  v_mul_f32 v70, v70, v10
  v_mul_f32 v71, v71, v10
  v_cvt_pk_bf16_f32 v19, v70, v71
  s_add_u32 s50, s49, 3145728
  buffer_store_dwordx4 v[16:19], v6, s[4:7], s50 offen sc1
  v_sub_f32 v72, v72, v8
  v_sub_f32 v73, v73, v8
  v_cvt_pk_bf16_f32 v20, v72, v73
  v_lshlrev_b32 v72, 16, v20
  v_and_b32 v73, 0xffff0000, v20
  v_mul_f32 v72, v72, v10
  v_mul_f32 v73, v73, v10
  v_cvt_pk_bf16_f32 v20, v72, v73
  v_sub_f32 v74, v74, v8
  v_sub_f32 v75, v75, v8
  v_cvt_pk_bf16_f32 v21, v74, v75
  v_lshlrev_b32 v74, 16, v21
  v_and_b32 v75, 0xffff0000, v21
  v_mul_f32 v74, v74, v10
  v_mul_f32 v75, v75, v10
  v_cvt_pk_bf16_f32 v21, v74, v75
  v_sub_f32 v76, v76, v8
  v_sub_f32 v77, v77, v8
  v_cvt_pk_bf16_f32 v22, v76, v77
  v_lshlrev_b32 v76, 16, v22
  v_and_b32 v77, 0xffff0000, v22
  v_mul_f32 v76, v76, v10
  v_mul_f32 v77, v77, v10
  v_cvt_pk_bf16_f32 v22, v76, v77
  v_sub_f32 v78, v78, v8
  v_sub_f32 v79, v79, v8
  v_cvt_pk_bf16_f32 v23, v78, v79
  v_lshlrev_b32 v78, 16, v23
  v_and_b32 v79, 0xffff0000, v23
  v_mul_f32 v78, v78, v10
  v_mul_f32 v79, v79, v10
  v_cvt_pk_bf16_f32 v23, v78, v79
  s_add_u32 s50, s49, 3149824
  buffer_store_dwordx4 v[20:23], v6, s[4:7], s50 offen sc1
  v_sub_f32 v80, v80, v8
  v_sub_f32 v81, v81, v8
  v_cvt_pk_bf16_f32 v24, v80, v81
  v_lshlrev_b32 v80, 16, v24
  v_and_b32 v81, 0xffff0000, v24
  v_mul_f32 v80, v80, v10
  v_mul_f32 v81, v81, v10
  v_cvt_pk_bf16_f32 v24, v80, v81
  v_sub_f32 v82, v82, v8
  v_sub_f32 v83, v83, v8
  v_cvt_pk_bf16_f32 v25, v82, v83
  v_lshlrev_b32 v82, 16, v25
  v_and_b32 v83, 0xffff0000, v25
  v_mul_f32 v82, v82, v10
  v_mul_f32 v83, v83, v10
  v_cvt_pk_bf16_f32 v25, v82, v83
  v_sub_f32 v84, v84, v8
  v_sub_f32 v85, v85, v8
  v_cvt_pk_bf16_f32 v26, v84, v85
  v_lshlrev_b32 v84, 16, v26
  v_and_b32 v85, 0xffff0000, v26
  v_mul_f32 v84, v84, v10
  v_mul_f32 v85, v85, v10
  v_cvt_pk_bf16_f32 v26, v84, v85
  v_sub_f32 v86, v86, v8
  v_sub_f32 v87, v87, v8
  v_cvt_pk_bf16_f32 v27, v86, v87
  v_lshlrev_b32 v86, 16, v27
  v_and_b32 v87, 0xffff0000, v27
  v_mul_f32 v86, v86, v10
  v_mul_f32 v87, v87, v10
  v_cvt_pk_bf16_f32 v27, v86, v87
  s_add_u32 s50, s49, 3153920
  buffer_store_dwordx4 v[24:27], v6, s[4:7], s50 offen sc1
  v_sub_f32 v88, v88, v8
  v_sub_f32 v89, v89, v8
  v_cvt_pk_bf16_f32 v28, v88, v89
  v_lshlrev_b32 v88, 16, v28
  v_and_b32 v89, 0xffff0000, v28
  v_mul_f32 v88, v88, v10
  v_mul_f32 v89, v89, v10
  v_cvt_pk_bf16_f32 v28, v88, v89
  v_sub_f32 v90, v90, v8
  v_sub_f32 v91, v91, v8
  v_cvt_pk_bf16_f32 v29, v90, v91
  v_lshlrev_b32 v90, 16, v29
  v_and_b32 v91, 0xffff0000, v29
  v_mul_f32 v90, v90, v10
  v_mul_f32 v91, v91, v10
  v_cvt_pk_bf16_f32 v29, v90, v91
  v_sub_f32 v92, v92, v8
  v_sub_f32 v93, v93, v8
  v_cvt_pk_bf16_f32 v30, v92, v93
  v_lshlrev_b32 v92, 16, v30
  v_and_b32 v93, 0xffff0000, v30
  v_mul_f32 v92, v92, v10
  v_mul_f32 v93, v93, v10
  v_cvt_pk_bf16_f32 v30, v92, v93
  v_sub_f32 v94, v94, v8
  v_sub_f32 v95, v95, v8
  v_cvt_pk_bf16_f32 v31, v94, v95
  v_lshlrev_b32 v94, 16, v31
  v_and_b32 v95, 0xffff0000, v31
  v_mul_f32 v94, v94, v10
  v_mul_f32 v95, v95, v10
  v_cvt_pk_bf16_f32 v31, v94, v95
  s_add_u32 s50, s49, 3158016
  buffer_store_dwordx4 v[28:31], v6, s[4:7], s50 offen sc1
  v_sub_f32 v96, v96, v8
  v_sub_f32 v97, v97, v8
  v_cvt_pk_bf16_f32 v32, v96, v97
  v_lshlrev_b32 v96, 16, v32
  v_and_b32 v97, 0xffff0000, v32
  v_mul_f32 v96, v96, v10
  v_mul_f32 v97, v97, v10
  v_cvt_pk_bf16_f32 v32, v96, v97
  v_sub_f32 v98, v98, v8
  v_sub_f32 v99, v99, v8
  v_cvt_pk_bf16_f32 v33, v98, v99
  v_lshlrev_b32 v98, 16, v33
  v_and_b32 v99, 0xffff0000, v33
  v_mul_f32 v98, v98, v10
  v_mul_f32 v99, v99, v10
  v_cvt_pk_bf16_f32 v33, v98, v99
  v_sub_f32 v100, v100, v8
  v_sub_f32 v101, v101, v8
  v_cvt_pk_bf16_f32 v34, v100, v101
  v_lshlrev_b32 v100, 16, v34
  v_and_b32 v101, 0xffff0000, v34
  v_mul_f32 v100, v100, v10
  v_mul_f32 v101, v101, v10
  v_cvt_pk_bf16_f32 v34, v100, v101
  v_sub_f32 v102, v102, v8
  v_sub_f32 v103, v103, v8
  v_cvt_pk_bf16_f32 v35, v102, v103
  v_lshlrev_b32 v102, 16, v35
  v_and_b32 v103, 0xffff0000, v35
  v_mul_f32 v102, v102, v10
  v_mul_f32 v103, v103, v10
  v_cvt_pk_bf16_f32 v35, v102, v103
  s_add_u32 s50, s49, 3162112
  buffer_store_dwordx4 v[32:35], v6, s[4:7], s50 offen sc1
  v_sub_f32 v104, v104, v8
  v_sub_f32 v105, v105, v8
  v_cvt_pk_bf16_f32 v36, v104, v105
  v_lshlrev_b32 v104, 16, v36
  v_and_b32 v105, 0xffff0000, v36
  v_mul_f32 v104, v104, v10
  v_mul_f32 v105, v105, v10
  v_cvt_pk_bf16_f32 v36, v104, v105
  v_sub_f32 v106, v106, v8
  v_sub_f32 v107, v107, v8
  v_cvt_pk_bf16_f32 v37, v106, v107
  v_lshlrev_b32 v106, 16, v37
  v_and_b32 v107, 0xffff0000, v37
  v_mul_f32 v106, v106, v10
  v_mul_f32 v107, v107, v10
  v_cvt_pk_bf16_f32 v37, v106, v107
  v_sub_f32 v108, v108, v8
  v_sub_f32 v109, v109, v8
  v_cvt_pk_bf16_f32 v38, v108, v109
  v_lshlrev_b32 v108, 16, v38
  v_and_b32 v109, 0xffff0000, v38
  v_mul_f32 v108, v108, v10
  v_mul_f32 v109, v109, v10
  v_cvt_pk_bf16_f32 v38, v108, v109
  v_sub_f32 v110, v110, v8
  v_sub_f32 v111, v111, v8
  v_cvt_pk_bf16_f32 v39, v110, v111
  v_lshlrev_b32 v110, 16, v39
  v_and_b32 v111, 0xffff0000, v39
  v_mul_f32 v110, v110, v10
  v_mul_f32 v111, v111, v10
  v_cvt_pk_bf16_f32 v39, v110, v111
  s_add_u32 s50, s49, 3166208
  buffer_store_dwordx4 v[36:39], v6, s[4:7], s50 offen sc1
  v_sub_f32 v112, v112, v8
  v_sub_f32 v113, v113, v8
  v_cvt_pk_bf16_f32 v40, v112, v113
  v_lshlrev_b32 v112, 16, v40
  v_and_b32 v113, 0xffff0000, v40
  v_mul_f32 v112, v112, v10
  v_mul_f32 v113, v113, v10
  v_cvt_pk_bf16_f32 v40, v112, v113
  v_sub_f32 v114, v114, v8
  v_sub_f32 v115, v115, v8
  v_cvt_pk_bf16_f32 v41, v114, v115
  v_lshlrev_b32 v114, 16, v41
  v_and_b32 v115, 0xffff0000, v41
  v_mul_f32 v114, v114, v10
  v_mul_f32 v115, v115, v10
  v_cvt_pk_bf16_f32 v41, v114, v115
  v_sub_f32 v116, v116, v8
  v_sub_f32 v117, v117, v8
  v_cvt_pk_bf16_f32 v42, v116, v117
  v_lshlrev_b32 v116, 16, v42
  v_and_b32 v117, 0xffff0000, v42
  v_mul_f32 v116, v116, v10
  v_mul_f32 v117, v117, v10
  v_cvt_pk_bf16_f32 v42, v116, v117
  v_sub_f32 v118, v118, v8
  v_sub_f32 v119, v119, v8
  v_cvt_pk_bf16_f32 v43, v118, v119
  v_lshlrev_b32 v118, 16, v43
  v_and_b32 v119, 0xffff0000, v43
  v_mul_f32 v118, v118, v10
  v_mul_f32 v119, v119, v10
  v_cvt_pk_bf16_f32 v43, v118, v119
  s_add_u32 s50, s49, 3170304
  buffer_store_dwordx4 v[40:43], v6, s[4:7], s50 offen sc1
  v_sub_f32 v120, v120, v8
  v_sub_f32 v121, v121, v8
  v_cvt_pk_bf16_f32 v44, v120, v121
  v_lshlrev_b32 v120, 16, v44
  v_and_b32 v121, 0xffff0000, v44
  v_mul_f32 v120, v120, v10
  v_mul_f32 v121, v121, v10
  v_cvt_pk_bf16_f32 v44, v120, v121
  v_sub_f32 v122, v122, v8
  v_sub_f32 v123, v123, v8
  v_cvt_pk_bf16_f32 v45, v122, v123
  v_lshlrev_b32 v122, 16, v45
  v_and_b32 v123, 0xffff0000, v45
  v_mul_f32 v122, v122, v10
  v_mul_f32 v123, v123, v10
  v_cvt_pk_bf16_f32 v45, v122, v123
  v_sub_f32 v124, v124, v8
  v_sub_f32 v125, v125, v8
  v_cvt_pk_bf16_f32 v46, v124, v125
  v_lshlrev_b32 v124, 16, v46
  v_and_b32 v125, 0xffff0000, v46
  v_mul_f32 v124, v124, v10
  v_mul_f32 v125, v125, v10
  v_cvt_pk_bf16_f32 v46, v124, v125
  v_sub_f32 v126, v126, v8
  v_sub_f32 v127, v127, v8
  v_cvt_pk_bf16_f32 v47, v126, v127
  v_lshlrev_b32 v126, 16, v47
  v_and_b32 v127, 0xffff0000, v47
  v_mul_f32 v126, v126, v10
  v_mul_f32 v127, v127, v10
  v_cvt_pk_bf16_f32 v47, v126, v127
  s_add_u32 s50, s49, 3174400
  buffer_store_dwordx4 v[44:47], v6, s[4:7], s50 offen sc1
  v_sub_f32 v128, v128, v8
  v_sub_f32 v129, v129, v8
  v_cvt_pk_bf16_f32 v48, v128, v129
  v_lshlrev_b32 v128, 16, v48
  v_and_b32 v129, 0xffff0000, v48
  v_mul_f32 v128, v128, v10
  v_mul_f32 v129, v129, v10
  v_cvt_pk_bf16_f32 v48, v128, v129
  v_sub_f32 v130, v130, v8
  v_sub_f32 v131, v131, v8
  v_cvt_pk_bf16_f32 v49, v130, v131
  v_lshlrev_b32 v130, 16, v49
  v_and_b32 v131, 0xffff0000, v49
  v_mul_f32 v130, v130, v10
  v_mul_f32 v131, v131, v10
  v_cvt_pk_bf16_f32 v49, v130, v131
  v_sub_f32 v132, v132, v8
  v_sub_f32 v133, v133, v8
  v_cvt_pk_bf16_f32 v50, v132, v133
  v_lshlrev_b32 v132, 16, v50
  v_and_b32 v133, 0xffff0000, v50
  v_mul_f32 v132, v132, v10
  v_mul_f32 v133, v133, v10
  v_cvt_pk_bf16_f32 v50, v132, v133
  v_sub_f32 v134, v134, v8
  v_sub_f32 v135, v135, v8
  v_cvt_pk_bf16_f32 v51, v134, v135
  v_lshlrev_b32 v134, 16, v51
  v_and_b32 v135, 0xffff0000, v51
  v_mul_f32 v134, v134, v10
  v_mul_f32 v135, v135, v10
  v_cvt_pk_bf16_f32 v51, v134, v135
  s_add_u32 s50, s49, 3178496
  buffer_store_dwordx4 v[48:51], v6, s[4:7], s50 offen sc1
  v_sub_f32 v136, v136, v8
  v_sub_f32 v137, v137, v8
  v_cvt_pk_bf16_f32 v52, v136, v137
  v_lshlrev_b32 v136, 16, v52
  v_and_b32 v137, 0xffff0000, v52
  v_mul_f32 v136, v136, v10
  v_mul_f32 v137, v137, v10
  v_cvt_pk_bf16_f32 v52, v136, v137
  v_sub_f32 v138, v138, v8
  v_sub_f32 v139, v139, v8
  v_cvt_pk_bf16_f32 v53, v138, v139
  v_lshlrev_b32 v138, 16, v53
  v_and_b32 v139, 0xffff0000, v53
  v_mul_f32 v138, v138, v10
  v_mul_f32 v139, v139, v10
  v_cvt_pk_bf16_f32 v53, v138, v139
  v_sub_f32 v140, v140, v8
  v_sub_f32 v141, v141, v8
  v_cvt_pk_bf16_f32 v54, v140, v141
  v_lshlrev_b32 v140, 16, v54
  v_and_b32 v141, 0xffff0000, v54
  v_mul_f32 v140, v140, v10
  v_mul_f32 v141, v141, v10
  v_cvt_pk_bf16_f32 v54, v140, v141
  v_sub_f32 v142, v142, v8
  v_sub_f32 v143, v143, v8
  v_cvt_pk_bf16_f32 v55, v142, v143
  v_lshlrev_b32 v142, 16, v55
  v_and_b32 v143, 0xffff0000, v55
  v_mul_f32 v142, v142, v10
  v_mul_f32 v143, v143, v10
  v_cvt_pk_bf16_f32 v55, v142, v143
  s_add_u32 s50, s49, 3182592
  buffer_store_dwordx4 v[52:55], v6, s[4:7], s50 offen sc1
  s_waitcnt vmcnt(0)
  s_barrier
  s_cmp_lg_u32 s13, 0
  s_cbranch_scc1 LNS_42
  v_mov_b32 v8, 1152
  v_mov_b32 v9, 1
  s_mov_b64 exec, 1
  buffer_atomic_add v9, v8, s[4:7], 0 offen
  s_mov_b64 exec, -1
LNS_42:
NLN_41:
  s_lshl_b32 s20, s84, 3
  s_lshr_b32 s47, s85, 2
  s_add_u32 s20, s20, s47
  s_and_b32 s21, s85, 3
  s_cmp_ge_u32 s20, 55
  s_cbranch_scc1 NW1_43
  s_lshl_b32 s24, s21, 4
  s_and_b32 s49, s20, 15
  s_lshl_b32 s22, s49, 9
  s_movk_i32 s23, 8192
  s_lshl_b32 s47, s49, 1
  s_lshr_b32 s48, s13, 1
  s_add_u32 s47, s47, s48
  s_lshl_b32 s47, s47, 13
  s_and_b32 s48, s13, 1
  s_lshl_b32 s26, s21, 4
  s_add_u32 s26, s26, s49
  s_lshl_b32 s26, s26, 2
  s_cmp_lt_u32 s20, 16
  s_cbranch_scc1 W1K_45
  s_cmp_lt_u32 s20, 32
  s_cbranch_scc1 W1V_46
  s_cmp_lt_u32 s20, 48
  s_cbranch_scc1 W1Q_47
W1F_48:
  s_sub_u32 s49, s20, 48
  s_lshl_b32 s22, s49, 9
  s_movk_i32 s23, 3456
  s_lshl_b32 s47, s49, 3
  s_lshl_b32 s48, s13, 1
  s_add_u32 s47, s47, s48
  s_lshl_b32 s47, s47, 10
  s_add_u32 s31, s47, 83886080
  s_lshl_b32 s26, s21, 3
  s_add_u32 s26, s26, s49
  s_lshl_b32 s26, s26, 2
  s_add_u32 s26, s26, 768
  s_mov_b32 s8, s66
  s_and_b32 s9, s67, 0xffff
  s_mov_b32 s10, 2211840
  s_mov_b32 s11, 0x20000
  s_mov_b32 s51, 1
  v_and_b32 v2, 63, v0
  v_lshlrev_b32 v1, 4, v2
  v_lshrrev_b32 v3, 5, v2
  v_mul_lo_u32 v4, v3, s23
  v_and_b32 v3, 31, v2
  v_lshl_add_u32 v4, v3, 4, v4
  v_lshrrev_b32 v5, 4, v2
  v_and_b32 v6, 1, v5
  v_lshrrev_b32 v5, 1, v5
  v_bfe_u32 v7, v2, 2, 2
  v_lshl_add_u32 v7, v5, 3, v7
  v_lshlrev_b32 v7, 9, v7
  v_and_b32 v8, 3, v2
  v_lshl_add_u32 v8, v6, 2, v8
  v_lshlrev_b32 v9, 2, v8
  v_lshrrev_b32 v10, 2, v8
  v_lshlrev_b32 v10, 4, v10
  v_and_b32 v11, 1, v8
  v_lshl_add_u32 v10, v11, 3, v10
  v_bfe_u32 v11, v8, 1, 1
  v_lshl_add_u32 v10, v11, 2, v10
  s_cmp_lg_u32 s51, 0
  s_cselect_b64 vcc, -1, 0
  v_cndmask_b32 v9, v9, v10, vcc
  v_lshl_add_u32 v7, v9, 1, v7
  s_lshl_b32 s47, s13, 7
  v_add_u32 v7, s47, v7
  s_lshl_b32 s28, s13, 11
  s_mul_i32 s27, s23, s13
  s_lshl_b32 s27, s27, 2
  s_add_u32 s27, s27, s22
  s_lshl_b32 s49, s23, 1
  s_lshl_b32 s50, s23, 4
  s_mov_b32 s47, s27
  s_add_u32 m0, s28, 0
  s_nop 0
  buffer_load_dwordx4 v4, s[8:11], s47 offen lds
  s_add_u32 s47, s27, s49
  s_add_u32 m0, s28, 1024
  s_nop 0
  buffer_load_dwordx4 v4, s[8:11], s47 offen lds
  s_add_u32 s27, s27, s50
  s_mov_b32 s47, s27
  s_add_u32 m0, s28, 8192
  s_nop 0
  buffer_load_dwordx4 v4, s[8:11], s47 offen lds
  s_add_u32 s47, s27, s49
  s_add_u32 m0, s28, 9216
  s_nop 0
  buffer_load_dwordx4 v4, s[8:11], s47 offen lds
  s_add_u32 s27, s27, s50
  s_mov_b32 s47, s27
  s_add_u32 m0, s28, 16384
  s_nop 0
  buffer_load_dwordx4 v4, s[8:11], s47 offen lds
  s_add_u32 s47, s27, s49
  s_add_u32 m0, s28, 17408
  s_nop 0
  buffer_load_dwordx4 v4, s[8:11], s47 offen lds
  s_add_u32 s27, s27, s50
  s_mov_b32 s47, s27
  s_add_u32 m0, s28, 24576
  s_nop 0
  buffer_load_dwordx4 v4, s[8:11], s47 offen lds
  s_add_u32 s47, s27, s49
  s_add_u32 m0, s28, 25600
  s_nop 0
  buffer_load_dwordx4 v4, s[8:11], s47 offen lds
  s_add_u32 s27, s27, s50
  s_mov_b32 s47, s27
  s_add_u32 m0, s28, 32768
  s_nop 0
  buffer_load_dwordx4 v4, s[8:11], s47 offen lds
  s_add_u32 s47, s27, s49
  s_add_u32 m0, s28, 33792
  s_nop 0
  buffer_load_dwordx4 v4, s[8:11], s47 offen lds
  s_add_u32 s27, s27, s50
  s_mov_b32 s47, s27
  s_add_u32 m0, s28, 40960
  s_nop 0
  buffer_load_dwordx4 v4, s[8:11], s47 offen lds
  s_add_u32 s47, s27, s49
  s_add_u32 m0, s28, 41984
  s_nop 0
  buffer_load_dwordx4 v4, s[8:11], s47 offen lds
  s_add_u32 s27, s27, s50
  s_mov_b32 s47, s27
  s_add_u32 m0, s28, 49152
  s_nop 0
  buffer_load_dwordx4 v4, s[8:11], s47 offen lds
  s_add_u32 s47, s27, s49
  s_add_u32 m0, s28, 50176
  s_nop 0
  buffer_load_dwordx4 v4, s[8:11], s47 offen lds
  s_add_u32 s27, s27, s50
  s_mov_b32 s47, s27
  s_add_u32 m0, s28, 57344
  s_nop 0
  buffer_load_dwordx4 v4, s[8:11], s47 offen lds
  s_add_u32 s47, s27, s49
  s_add_u32 m0, s28, 58368
  s_nop 0
  buffer_load_dwordx4 v4, s[8:11], s47 offen lds
  s_add_u32 s27, s27, s50
  s_mov_b32 s47, s27
  s_add_u32 m0, s28, 65536
  s_nop 0
  buffer_load_dwordx4 v4, s[8:11], s47 offen lds
  s_add_u32 s47, s27, s49
  s_add_u32 m0, s28, 66560
  s_nop 0
  buffer_load_dwordx4 v4, s[8:11], s47 offen lds
  s_add_u32 s27, s27, s50
  s_mov_b32 s47, s27
  s_add_u32 m0, s28, 73728
  s_nop 0
  buffer_load_dwordx4 v4, s[8:11], s47 offen lds
  s_add_u32 s47, s27, s49
  s_add_u32 m0, s28, 74752
  s_nop 0
  buffer_load_dwordx4 v4, s[8:11], s47 offen lds
  s_add_u32 s27, s27, s50
  s_mov_b32 s47, s27
  s_add_u32 m0, s28, 81920
  s_nop 0
  buffer_load_dwordx4 v4, s[8:11], s47 offen lds
  s_add_u32 s47, s27, s49
  s_add_u32 m0, s28, 82944
  s_nop 0
  buffer_load_dwordx4 v4, s[8:11], s47 offen lds
  s_add_u32 s27, s27, s50
  s_mov_b32 s47, s27
  s_add_u32 m0, s28, 90112
  s_nop 0
  buffer_load_dwordx4 v4, s[8:11], s47 offen lds
  s_add_u32 s47, s27, s49
  s_add_u32 m0, s28, 91136
  s_nop 0
  buffer_load_dwordx4 v4, s[8:11], s47 offen lds
  s_add_u32 s27, s27, s50
  s_mov_b32 s47, s27
  s_add_u32 m0, s28, 98304
  s_nop 0
  buffer_load_dwordx4 v4, s[8:11], s47 offen lds
  s_add_u32 s47, s27, s49
  s_add_u32 m0, s28, 99328
  s_nop 0
  buffer_load_dwordx4 v4, s[8:11], s47 offen lds
  s_add_u32 s27, s27, s50
  s_mov_b32 s47, s27
  s_add_u32 m0, s28, 106496
  s_nop 0
  buffer_load_dwordx4 v4, s[8:11], s47 offen lds
  s_add_u32 s47, s27, s49
  s_add_u32 m0, s28, 107520
  s_nop 0
  buffer_load_dwordx4 v4, s[8:11], s47 offen lds
  s_add_u32 s27, s27, s50
  s_mov_b32 s47, s27
  s_add_u32 m0, s28, 114688
  s_nop 0
  buffer_load_dwordx4 v4, s[8:11], s47 offen lds
  s_add_u32 s47, s27, s49
  s_add_u32 m0, s28, 115712
  s_nop 0
  buffer_load_dwordx4 v4, s[8:11], s47 offen lds
  s_add_u32 s27, s27, s50
  s_mov_b32 s47, s27
  s_add_u32 m0, s28, 122880
  s_nop 0
  buffer_load_dwordx4 v4, s[8:11], s47 offen lds
  s_add_u32 s47, s27, s49
  s_add_u32 m0, s28, 123904
  s_nop 0
  buffer_load_dwordx4 v4, s[8:11], s47 offen lds
  s_add_u32 s27, s27, s50
  s_waitcnt vmcnt(30)
  s_barrier
  v_add_u32 v12, 0, v7
  ds_read_b64_tr_b16 a[0:1], v12 offset:0
  ds_read_b64_tr_b16 a[2:3], v12 offset:2048
  ds_read_b64_tr_b16 a[4:5], v12 offset:64
  ds_read_b64_tr_b16 a[6:7], v12 offset:2112
  s_waitcnt lgkmcnt(0)
  s_waitcnt vmcnt(28)
  s_barrier
  s_mov_b32 s47, s27
  s_add_u32 m0, s28, 0
  s_nop 0
  buffer_load_dwordx4 v4, s[8:11], s47 offen lds
  s_add_u32 s47, s27, s49
  s_add_u32 m0, s28, 1024
  s_nop 0
  buffer_load_dwordx4 v4, s[8:11], s47 offen lds
  s_add_u32 s27, s27, s50
  v_add_u32 v12, 8192, v7
  ds_read_b64_tr_b16 a[8:9], v12 offset:0
  ds_read_b64_tr_b16 a[10:11], v12 offset:2048
  ds_read_b64_tr_b16 a[12:13], v12 offset:64
  ds_read_b64_tr_b16 a[14:15], v12 offset:2112
  s_waitcnt lgkmcnt(0)
  s_waitcnt vmcnt(28)
  s_barrier
  s_mov_b32 s47, s27
  s_add_u32 m0, s28, 8192
  s_nop 0
  buffer_load_dwordx4 v4, s[8:11], s47 offen lds
  s_add_u32 s47, s27, s49
  s_add_u32 m0, s28, 9216
  s_nop 0
  buffer_load_dwordx4 v4, s[8:11], s47 offen lds
  s_add_u32 s27, s27, s50
  v_add_u32 v12, 16384, v7
  ds_read_b64_tr_b16 a[16:17], v12 offset:0
  ds_read_b64_tr_b16 a[18:19], v12 offset:2048
  ds_read_b64_tr_b16 a[20:21], v12 offset:64
  ds_read_b64_tr_b16 a[22:23], v12 offset:2112
  s_waitcnt lgkmcnt(0)
  s_waitcnt vmcnt(28)
  s_barrier
  s_mov_b32 s47, s27
  s_add_u32 m0, s28, 16384
  s_nop 0
  buffer_load_dwordx4 v4, s[8:11], s47 offen lds
  s_add_u32 s47, s27, s49
  s_add_u32 m0, s28, 17408
  s_nop 0
  buffer_load_dwordx4 v4, s[8:11], s47 offen lds
  s_add_u32 s27, s27, s50
  v_add_u32 v12, 24576, v7
  ds_read_b64_tr_b16 a[24:25], v12 offset:0
  ds_read_b64_tr_b16 a[26:27], v12 offset:2048
  ds_read_b64_tr_b16 a[28:29], v12 offset:64
  ds_read_b64_tr_b16 a[30:31], v12 offset:2112
  s_waitcnt lgkmcnt(0)
  s_waitcnt vmcnt(28)
  s_barrier
  s_mov_b32 s47, s27
  s_add_u32 m0, s28, 24576
  s_nop 0
  buffer_load_dwordx4 v4, s[8:11], s47 offen lds
  s_add_u32 s47, s27, s49
  s_add_u32 m0, s28, 25600
  s_nop 0
  buffer_load_dwordx4 v4, s[8:11], s47 offen lds
  s_add_u32 s27, s27, s50
  v_add_u32 v12, 32768, v7
  ds_read_b64_tr_b16 a[32:33], v12 offset:0
  ds_read_b64_tr_b16 a[34:35], v12 offset:2048
  ds_read_b64_tr_b16 a[36:37], v12 offset:64
  ds_read_b64_tr_b16 a[38:39], v12 offset:2112
  s_waitcnt lgkmcnt(0)
  s_waitcnt vmcnt(28)
  s_barrier
  s_mov_b32 s47, s27
  s_add_u32 m0, s28, 32768
  s_nop 0
  buffer_load_dwordx4 v4, s[8:11], s47 offen lds
  s_add_u32 s47, s27, s49
  s_add_u32 m0, s28, 33792
  s_nop 0
  buffer_load_dwordx4 v4, s[8:11], s47 offen lds
  s_add_u32 s27, s27, s50
  v_add_u32 v12, 40960, v7
  ds_read_b64_tr_b16 a[40:41], v12 offset:0
  ds_read_b64_tr_b16 a[42:43], v12 offset:2048
  ds_read_b64_tr_b16 a[44:45], v12 offset:64
  ds_read_b64_tr_b16 a[46:47], v12 offset:2112
  s_waitcnt lgkmcnt(0)
  s_waitcnt vmcnt(28)
  s_barrier
  s_mov_b32 s47, s27
  s_add_u32 m0, s28, 40960
  s_nop 0
  buffer_load_dwordx4 v4, s[8:11], s47 offen lds
  s_add_u32 s47, s27, s49
  s_add_u32 m0, s28, 41984
  s_nop 0
  buffer_load_dwordx4 v4, s[8:11], s47 offen lds
  s_add_u32 s27, s27, s50
  v_add_u32 v12, 49152, v7
  ds_read_b64_tr_b16 a[48:49], v12 offset:0
  ds_read_b64_tr_b16 a[50:51], v12 offset:2048
  ds_read_b64_tr_b16 a[52:53], v12 offset:64
  ds_read_b64_tr_b16 a[54:55], v12 offset:2112
  s_waitcnt lgkmcnt(0)
  s_waitcnt vmcnt(28)
  s_barrier
  s_mov_b32 s47, s27
  s_add_u32 m0, s28, 49152
  s_nop 0
  buffer_load_dwordx4 v4, s[8:11], s47 offen lds
  s_add_u32 s47, s27, s49
  s_add_u32 m0, s28, 50176
  s_nop 0
  buffer_load_dwordx4 v4, s[8:11], s47 offen lds
  s_add_u32 s27, s27, s50
  v_add_u32 v12, 57344, v7
  ds_read_b64_tr_b16 a[56:57], v12 offset:0
  ds_read_b64_tr_b16 a[58:59], v12 offset:2048
  ds_read_b64_tr_b16 a[60:61], v12 offset:64
  ds_read_b64_tr_b16 a[62:63], v12 offset:2112
  s_waitcnt lgkmcnt(0)
  s_waitcnt vmcnt(28)
  s_barrier
  s_mov_b32 s47, s27
  s_add_u32 m0, s28, 57344
  s_nop 0
  buffer_load_dwordx4 v4, s[8:11], s47 offen lds
  s_add_u32 s47, s27, s49
  s_add_u32 m0, s28, 58368
  s_nop 0
  buffer_load_dwordx4 v4, s[8:11], s47 offen lds
  s_add_u32 s27, s27, s50
  v_add_u32 v12, 65536, v7
  ds_read_b64_tr_b16 a[64:65], v12 offset:0
  ds_read_b64_tr_b16 a[66:67], v12 offset:2048
  ds_read_b64_tr_b16 a[68:69], v12 offset:64
  ds_read_b64_tr_b16 a[70:71], v12 offset:2112
  s_waitcnt lgkmcnt(0)
  s_waitcnt vmcnt(28)
  s_barrier
  s_mov_b32 s47, s27
  s_add_u32 m0, s28, 65536
  s_nop 0
  buffer_load_dwordx4 v4, s[8:11], s47 offen lds
  s_add_u32 s47, s27, s49
  s_add_u32 m0, s28, 66560
  s_nop 0
  buffer_load_dwordx4 v4, s[8:11], s47 offen lds
  s_add_u32 s27, s27, s50
  v_add_u32 v12, 73728, v7
  ds_read_b64_tr_b16 a[72:73], v12 offset:0
  ds_read_b64_tr_b16 a[74:75], v12 offset:2048
  ds_read_b64_tr_b16 a[76:77], v12 offset:64
  ds_read_b64_tr_b16 a[78:79], v12 offset:2112
  s_waitcnt lgkmcnt(0)
  s_waitcnt vmcnt(28)
  s_barrier
  s_mov_b32 s47, s27
  s_add_u32 m0, s28, 73728
  s_nop 0
  buffer_load_dwordx4 v4, s[8:11], s47 offen lds
  s_add_u32 s47, s27, s49
  s_add_u32 m0, s28, 74752
  s_nop 0
  buffer_load_dwordx4 v4, s[8:11], s47 offen lds
  s_add_u32 s27, s27, s50
  v_add_u32 v12, 81920, v7
  ds_read_b64_tr_b16 a[80:81], v12 offset:0
  ds_read_b64_tr_b16 a[82:83], v12 offset:2048
  ds_read_b64_tr_b16 a[84:85], v12 offset:64
  ds_read_b64_tr_b16 a[86:87], v12 offset:2112
  s_waitcnt lgkmcnt(0)
  s_waitcnt vmcnt(28)
  s_barrier
  s_mov_b32 s47, s27
  s_add_u32 m0, s28, 81920
  s_nop 0
  buffer_load_dwordx4 v4, s[8:11], s47 offen lds
  s_add_u32 s47, s27, s49
  s_add_u32 m0, s28, 82944
  s_nop 0
  buffer_load_dwordx4 v4, s[8:11], s47 offen lds
  s_add_u32 s27, s27, s50
  v_add_u32 v12, 90112, v7
  ds_read_b64_tr_b16 a[88:89], v12 offset:0
  ds_read_b64_tr_b16 a[90:91], v12 offset:2048
  ds_read_b64_tr_b16 a[92:93], v12 offset:64
  ds_read_b64_tr_b16 a[94:95], v12 offset:2112
  s_waitcnt lgkmcnt(0)
  s_waitcnt vmcnt(28)
  s_barrier
  s_mov_b32 s47, s27
  s_add_u32 m0, s28, 90112
  s_nop 0
  buffer_load_dwordx4 v4, s[8:11], s47 offen lds
  s_add_u32 s47, s27, s49
  s_add_u32 m0, s28, 91136
  s_nop 0
  buffer_load_dwordx4 v4, s[8:11], s47 offen lds
  s_add_u32 s27, s27, s50
  v_add_u32 v12, 98304, v7
  ds_read_b64_tr_b16 a[96:97], v12 offset:0
  ds_read_b64_tr_b16 a[98:99], v12 offset:2048
  ds_read_b64_tr_b16 a[100:101], v12 offset:64
  ds_read_b64_tr_b16 a[102:103], v12 offset:2112
  s_waitcnt lgkmcnt(0)
  s_waitcnt vmcnt(28)
  s_barrier
  s_mov_b32 s47, s27
  s_add_u32 m0, s28, 98304
  s_nop 0
  buffer_load_dwordx4 v4, s[8:11], s47 offen lds
  s_add_u32 s47, s27, s49
  s_add_u32 m0, s28, 99328
  s_nop 0
  buffer_load_dwordx4 v4, s[8:11], s47 offen lds
  s_add_u32 s27, s27, s50
  v_add_u32 v12, 106496, v7
  ds_read_b64_tr_b16 a[104:105], v12 offset:0
  ds_read_b64_tr_b16 a[106:107], v12 offset:2048
  ds_read_b64_tr_b16 a[108:109], v12 offset:64
  ds_read_b64_tr_b16 a[110:111], v12 offset:2112
  s_waitcnt lgkmcnt(0)
  s_waitcnt vmcnt(28)
  s_barrier
  s_mov_b32 s47, s27
  s_add_u32 m0, s28, 106496
  s_nop 0
  buffer_load_dwordx4 v4, s[8:11], s47 offen lds
  s_add_u32 s47, s27, s49
  s_add_u32 m0, s28, 107520
  s_nop 0
  buffer_load_dwordx4 v4, s[8:11], s47 offen lds
  s_add_u32 s27, s27, s50
  v_add_u32 v12, 114688, v7
  ds_read_b64_tr_b16 a[112:113], v12 offset:0
  ds_read_b64_tr_b16 a[114:115], v12 offset:2048
  ds_read_b64_tr_b16 a[116:117], v12 offset:64
  ds_read_b64_tr_b16 a[118:119], v12 offset:2112
  s_waitcnt lgkmcnt(0)
  s_waitcnt vmcnt(28)
  s_barrier
  s_mov_b32 s47, s27
  s_add_u32 m0, s28, 114688
  s_nop 0
  buffer_load_dwordx4 v4, s[8:11], s47 offen lds
  s_add_u32 s47, s27, s49
  s_add_u32 m0, s28, 115712
  s_nop 0
  buffer_load_dwordx4 v4, s[8:11], s47 offen lds
  s_add_u32 s27, s27, s50
  v_add_u32 v12, 122880, v7
  ds_read_b64_tr_b16 a[120:121], v12 offset:0
  ds_read_b64_tr_b16 a[122:123], v12 offset:2048
  ds_read_b64_tr_b16 a[124:125], v12 offset:64
  ds_read_b64_tr_b16 a[126:127], v12 offset:2112
  s_waitcnt lgkmcnt(0)
  s_waitcnt vmcnt(28)
  s_barrier
  s_mov_b32 s47, s27
  s_add_u32 m0, s28, 122880
  s_nop 0
  buffer_load_dwordx4 v4, s[8:11], s47 offen lds
  s_add_u32 s47, s27, s49
  s_add_u32 m0, s28, 123904
  s_nop 0
  buffer_load_dwordx4 v4, s[8:11], s47 offen lds
  s_add_u32 s27, s27, s50
  v_add_u32 v12, 0, v7
  ds_read_b64_tr_b16 a[128:129], v12 offset:0
  ds_read_b64_tr_b16 a[130:131], v12 offset:2048
  ds_read_b64_tr_b16 a[132:133], v12 offset:64
  ds_read_b64_tr_b16 a[134:135], v12 offset:2112
  s_waitcnt lgkmcnt(0)
  s_waitcnt vmcnt(28)
  s_barrier
  s_mov_b32 s47, s27
  s_add_u32 m0, s28, 0
  s_nop 0
  buffer_load_dwordx4 v4, s[8:11], s47 offen lds
  s_add_u32 s47, s27, s49
  s_add_u32 m0, s28, 1024
  s_nop 0
  buffer_load_dwordx4 v4, s[8:11], s47 offen lds
  s_add_u32 s27, s27, s50
  v_add_u32 v12, 8192, v7
  ds_read_b64_tr_b16 a[136:137], v12 offset:0
  ds_read_b64_tr_b16 a[138:139], v12 offset:2048
  ds_read_b64_tr_b16 a[140:141], v12 offset:64
  ds_read_b64_tr_b16 a[142:143], v12 offset:2112
  s_waitcnt lgkmcnt(0)
  s_waitcnt vmcnt(28)
  s_barrier
  s_mov_b32 s47, s27
  s_add_u32 m0, s28, 8192
  s_nop 0
  buffer_load_dwordx4 v4, s[8:11], s47 offen lds
  s_add_u32 s47, s27, s49
  s_add_u32 m0, s28, 9216
  s_nop 0
  buffer_load_dwordx4 v4, s[8:11], s47 offen lds
  s_add_u32 s27, s27, s50
  v_add_u32 v12, 16384, v7
  ds_read_b64_tr_b16 a[144:145], v12 offset:0
  ds_read_b64_tr_b16 a[146:147], v12 offset:2048
  ds_read_b64_tr_b16 a[148:149], v12 offset:64
  ds_read_b64_tr_b16 a[150:151], v12 offset:2112
  s_waitcnt lgkmcnt(0)
  s_waitcnt vmcnt(28)
  s_barrier
  s_mov_b32 s47, s27
  s_add_u32 m0, s28, 16384
  s_nop 0
  buffer_load_dwordx4 v4, s[8:11], s47 offen lds
  s_add_u32 s47, s27, s49
  s_add_u32 m0, s28, 17408
  s_nop 0
  buffer_load_dwordx4 v4, s[8:11], s47 offen lds
  s_add_u32 s27, s27, s50
  v_add_u32 v12, 24576, v7
  ds_read_b64_tr_b16 a[152:153], v12 offset:0
  ds_read_b64_tr_b16 a[154:155], v12 offset:2048
  ds_read_b64_tr_b16 a[156:157], v12 offset:64
  ds_read_b64_tr_b16 a[158:159], v12 offset:2112
  s_waitcnt lgkmcnt(0)
  s_waitcnt vmcnt(28)
  s_barrier
  s_mov_b32 s47, s27
  s_add_u32 m0, s28, 24576
  s_nop 0
  buffer_load_dwordx4 v4, s[8:11], s47 offen lds
  s_add_u32 s47, s27, s49
  s_add_u32 m0, s28, 25600
  s_nop 0
  buffer_load_dwordx4 v4, s[8:11], s47 offen lds
  s_add_u32 s27, s27, s50
  v_add_u32 v12, 32768, v7
  ds_read_b64_tr_b16 a[160:161], v12 offset:0
  ds_read_b64_tr_b16 a[162:163], v12 offset:2048
  ds_read_b64_tr_b16 a[164:165], v12 offset:64
  ds_read_b64_tr_b16 a[166:167], v12 offset:2112
  s_waitcnt lgkmcnt(0)
  s_waitcnt vmcnt(28)
  s_barrier
  s_mov_b32 s47, s27
  s_add_u32 m0, s28, 32768
  s_nop 0
  buffer_load_dwordx4 v4, s[8:11], s47 offen lds
  s_add_u32 s47, s27, s49
  s_add_u32 m0, s28, 33792
  s_nop 0
  buffer_load_dwordx4 v4, s[8:11], s47 offen lds
  s_add_u32 s27, s27, s50
  v_add_u32 v12, 40960, v7
  ds_read_b64_tr_b16 a[168:169], v12 offset:0
  ds_read_b64_tr_b16 a[170:171], v12 offset:2048
  ds_read_b64_tr_b16 a[172:173], v12 offset:64
  ds_read_b64_tr_b16 a[174:175], v12 offset:2112
  s_waitcnt lgkmcnt(0)
  s_waitcnt vmcnt(28)
  s_barrier
  s_mov_b32 s47, s27
  s_add_u32 m0, s28, 40960
  s_nop 0
  buffer_load_dwordx4 v4, s[8:11], s47 offen lds
  s_add_u32 s47, s27, s49
  s_add_u32 m0, s28, 41984
  s_nop 0
  buffer_load_dwordx4 v4, s[8:11], s47 offen lds
  s_add_u32 s27, s27, s50
  v_add_u32 v12, 49152, v7
  ds_read_b64_tr_b16 a[176:177], v12 offset:0
  ds_read_b64_tr_b16 a[178:179], v12 offset:2048
  ds_read_b64_tr_b16 a[180:181], v12 offset:64
  ds_read_b64_tr_b16 a[182:183], v12 offset:2112
  s_waitcnt lgkmcnt(0)
  s_waitcnt vmcnt(28)
  s_barrier
  s_mov_b32 s47, s27
  s_add_u32 m0, s28, 49152
  s_nop 0
  buffer_load_dwordx4 v4, s[8:11], s47 offen lds
  s_add_u32 s47, s27, s49
  s_add_u32 m0, s28, 50176
  s_nop 0
  buffer_load_dwordx4 v4, s[8:11], s47 offen lds
  s_add_u32 s27, s27, s50
  v_add_u32 v12, 57344, v7
  ds_read_b64_tr_b16 a[184:185], v12 offset:0
  ds_read_b64_tr_b16 a[186:187], v12 offset:2048
  ds_read_b64_tr_b16 a[188:189], v12 offset:64
  ds_read_b64_tr_b16 a[190:191], v12 offset:2112
  s_waitcnt lgkmcnt(0)
  s_waitcnt vmcnt(28)
  s_barrier
  s_mov_b32 s47, s27
  s_add_u32 m0, s28, 57344
  s_nop 0
  buffer_load_dwordx4 v4, s[8:11], s47 offen lds
  s_add_u32 s47, s27, s49
  s_add_u32 m0, s28, 58368
  s_nop 0
  buffer_load_dwordx4 v4, s[8:11], s47 offen lds
  s_add_u32 s27, s27, s50
  v_add_u32 v12, 65536, v7
  ds_read_b64_tr_b16 a[192:193], v12 offset:0
  ds_read_b64_tr_b16 a[194:195], v12 offset:2048
  ds_read_b64_tr_b16 a[196:197], v12 offset:64
  ds_read_b64_tr_b16 a[198:199], v12 offset:2112
  s_waitcnt lgkmcnt(0)
  s_waitcnt vmcnt(28)
  s_barrier
  v_add_u32 v12, 73728, v7
  ds_read_b64_tr_b16 a[200:201], v12 offset:0
  ds_read_b64_tr_b16 a[202:203], v12 offset:2048
  ds_read_b64_tr_b16 a[204:205], v12 offset:64
  ds_read_b64_tr_b16 a[206:207], v12 offset:2112
  s_waitcnt lgkmcnt(0)
  s_waitcnt vmcnt(26)
  s_barrier
  v_add_u32 v12, 81920, v7
  ds_read_b64_tr_b16 a[208:209], v12 offset:0
  ds_read_b64_tr_b16 a[210:211], v12 offset:2048
  ds_read_b64_tr_b16 a[212:213], v12 offset:64
  ds_read_b64_tr_b16 a[214:215], v12 offset:2112
  s_waitcnt lgkmcnt(0)
  s_waitcnt vmcnt(24)
  s_barrier
  v_add_u32 v12, 90112, v7
  ds_read_b64_tr_b16 a[216:217], v12 offset:0
  ds_read_b64_tr_b16 a[218:219], v12 offset:2048
  ds_read_b64_tr_b16 a[220:221], v12 offset:64
  ds_read_b64_tr_b16 a[222:223], v12 offset:2112
  s_waitcnt lgkmcnt(0)
  s_waitcnt vmcnt(22)
  s_barrier
  v_add_u32 v12, 98304, v7
  ds_read_b64_tr_b16 a[224:225], v12 offset:0
  ds_read_b64_tr_b16 a[226:227], v12 offset:2048
  ds_read_b64_tr_b16 a[228:229], v12 offset:64
  ds_read_b64_tr_b16 a[230:231], v12 offset:2112
  s_waitcnt lgkmcnt(0)
  s_waitcnt vmcnt(20)
  s_barrier
  v_add_u32 v12, 106496, v7
  ds_read_b64_tr_b16 a[232:233], v12 offset:0
  ds_read_b64_tr_b16 a[234:235], v12 offset:2048
  ds_read_b64_tr_b16 a[236:237], v12 offset:64
  ds_read_b64_tr_b16 a[238:239], v12 offset:2112
  s_waitcnt lgkmcnt(0)
  s_waitcnt vmcnt(18)
  s_barrier
  v_add_u32 v12, 114688, v7
  ds_read_b64_tr_b16 a[240:241], v12 offset:0
  ds_read_b64_tr_b16 a[242:243], v12 offset:2048
  ds_read_b64_tr_b16 a[244:245], v12 offset:64
  ds_read_b64_tr_b16 a[246:247], v12 offset:2112
  s_waitcnt lgkmcnt(0)
  s_waitcnt vmcnt(16)
  s_barrier
  v_add_u32 v12, 122880, v7
  ds_read_b64_tr_b16 a[248:249], v12 offset:0
  ds_read_b64_tr_b16 a[250:251], v12 offset:2048
  ds_read_b64_tr_b16 a[252:253], v12 offset:64
  ds_read_b64_tr_b16 a[254:255], v12 offset:2112
  s_waitcnt lgkmcnt(0)
  s_waitcnt vmcnt(14)
  s_barrier
  v_add_u32 v12, 0, v7
  ds_read_b64_tr_b16 v[192:193], v12 offset:0
  ds_read_b64_tr_b16 v[194:195], v12 offset:2048
  ds_read_b64_tr_b16 v[196:197], v12 offset:64
  ds_read_b64_tr_b16 v[198:199], v12 offset:2112
  s_waitcnt lgkmcnt(0)
  s_waitcnt vmcnt(12)
  s_barrier
  v_add_u32 v12, 8192, v7
  ds_read_b64_tr_b16 v[200:201], v12 offset:0
  ds_read_b64_tr_b16 v[202:203], v12 offset:2048
  ds_read_b64_tr_b16 v[204:205], v12 offset:64
  ds_read_b64_tr_b16 v[206:207], v12 offset:2112
  s_waitcnt lgkmcnt(0)
  s_waitcnt vmcnt(10)
  s_barrier
  v_add_u32 v12, 16384, v7
  ds_read_b64_tr_b16 v[208:209], v12 offset:0
  ds_read_b64_tr_b16 v[210:211], v12 offset:2048
  ds_read_b64_tr_b16 v[212:213], v12 offset:64
  ds_read_b64_tr_b16 v[214:215], v12 offset:2112
  s_waitcnt lgkmcnt(0)
  s_waitcnt vmcnt(8)
  s_barrier
  v_add_u32 v12, 24576, v7
  ds_read_b64_tr_b16 v[216:217], v12 offset:0
  ds_read_b64_tr_b16 v[218:219], v12 offset:2048
  ds_read_b64_tr_b16 v[220:221], v12 offset:64
  ds_read_b64_tr_b16 v[222:223], v12 offset:2112
  s_waitcnt lgkmcnt(0)
  s_waitcnt vmcnt(6)
  s_barrier
  v_add_u32 v12, 32768, v7
  ds_read_b64_tr_b16 v[224:225], v12 offset:0
  ds_read_b64_tr_b16 v[226:227], v12 offset:2048
  ds_read_b64_tr_b16 v[228:229], v12 offset:64
  ds_read_b64_tr_b16 v[230:231], v12 offset:2112
  s_waitcnt lgkmcnt(0)
  s_waitcnt vmcnt(4)
  s_barrier
  v_add_u32 v12, 40960, v7
  ds_read_b64_tr_b16 v[232:233], v12 offset:0
  ds_read_b64_tr_b16 v[234:235], v12 offset:2048
  ds_read_b64_tr_b16 v[236:237], v12 offset:64
  ds_read_b64_tr_b16 v[238:239], v12 offset:2112
  s_waitcnt lgkmcnt(0)
  s_waitcnt vmcnt(2)
  s_barrier
  v_add_u32 v12, 49152, v7
  ds_read_b64_tr_b16 v[240:241], v12 offset:0
  ds_read_b64_tr_b16 v[242:243], v12 offset:2048
  ds_read_b64_tr_b16 v[244:245], v12 offset:64
  ds_read_b64_tr_b16 v[246:247], v12 offset:2112
  s_waitcnt lgkmcnt(0)
  s_waitcnt vmcnt(0)
  s_barrier
  v_add_u32 v12, 57344, v7
  ds_read_b64_tr_b16 v[248:249], v12 offset:0
  ds_read_b64_tr_b16 v[250:251], v12 offset:2048
  ds_read_b64_tr_b16 v[252:253], v12 offset:64
  ds_read_b64_tr_b16 v[254:255], v12 offset:2112
  s_waitcnt lgkmcnt(0)
  s_barrier
  v_and_b32 v2, 63, v0
  v_and_b32 v3, 15, v2
  v_bfe_u32 v4, v2, 4, 1
  v_lshrrev_b32 v5, 5, v2
  s_mov_b32 s47, 57344
  v_mul_lo_u32 v6, v4, s47
  v_lshl_add_u32 v6, v5, 8, v6
  v_lshl_add_u32 v6, v3, 4, v6
  s_lshl_b32 s47, s13, 7
  s_add_u32 s47, s47, s22
  s_cmp_ge_u32 s47, 3456
  s_cselect_b32 s48, 0x7fffffff, 0
  v_or_b32 v6, s48, v6
  s_mov_b32 s16, s68
  s_and_b32 s17, s69, 0xffff
  s_mov_b32 s18, 3456
  s_mov_b32 s19, 0x20000
  v_lshlrev_b32 v7, 4, v5
  buffer_load_dwordx4 v[32:35], v7, s[16:19], s47 offen offset:0
  buffer_load_dwordx4 v[36:39], v7, s[16:19], s47 offen offset:32
  buffer_load_dwordx4 v[40:43], v7, s[16:19], s47 offen offset:64
  buffer_load_dwordx4 v[44:47], v7, s[16:19], s47 offen offset:96
  s_waitcnt vmcnt(0)
  v_lshlrev_b32 v160, 16, v32
  v_and_b32 v161, 0xffff0000, v32
  v_lshlrev_b32 v162, 16, v33
  v_and_b32 v163, 0xffff0000, v33
  v_lshlrev_b32 v164, 16, v34
  v_and_b32 v165, 0xffff0000, v34
  v_lshlrev_b32 v166, 16, v35
  v_and_b32 v167, 0xffff0000, v35
  v_lshlrev_b32 v168, 16, v36
  v_and_b32 v169, 0xffff0000, v36
  v_lshlrev_b32 v170, 16, v37
  v_and_b32 v171, 0xffff0000, v37
  v_lshlrev_b32 v172, 16, v38
  v_and_b32 v173, 0xffff0000, v38
  v_lshlrev_b32 v174, 16, v39
  v_and_b32 v175, 0xffff0000, v39
  v_lshlrev_b32 v176, 16, v40
  v_and_b32 v177, 0xffff0000, v40
  v_lshlrev_b32 v178, 16, v41
  v_and_b32 v179, 0xffff0000, v41
  v_lshlrev_b32 v180, 16, v42
  v_and_b32 v181, 0xffff0000, v42
  v_lshlrev_b32 v182, 16, v43
  v_and_b32 v183, 0xffff0000, v43
  v_lshlrev_b32 v184, 16, v44
  v_and_b32 v185, 0xffff0000, v44
  v_lshlrev_b32 v186, 16, v45
  v_and_b32 v187, 0xffff0000, v45
  v_lshlrev_b32 v188, 16, v46
  v_and_b32 v189, 0xffff0000, v46
  v_lshlrev_b32 v190, 16, v47
  v_and_b32 v191, 0xffff0000, v47
  s_cmp_eq_u32 s3, 0
  s_cbranch_scc1 L_CF4
L_CR4:
  s_cmp_lg_u32 s13, 0
  s_cbranch_scc1 LNW_50
  v_mov_b32 v8, 1152
LNP_51:
  buffer_load_dword v9, v8, s[4:7], 0 offen sc1
  s_sub_u32 s74, s74, 1
  s_cbranch_scc1 L_TIMEOUT
  s_waitcnt vmcnt(0)
  v_cmp_gt_u32 vcc, 64, v9
  s_nop 0
  s_cbranch_vccz LNK_52
  s_sleep 12
  s_branch LNP_51
LNK_52:
LNW_50:
  s_barrier
  s_mul_i32 s30, s13, 10240
  s_mul_i32 s47, s24, 40960
  s_add_u32 s47, s47, s30
  s_add_u32 s27, s47, 3145728
  s_add_u32 s34, s27, 614400
  s_mov_b32 s29, 0
  s_mov_b32 s32, 0
  s_mov_b32 s33, 0
  s_barrier
  s_add_u32 s52, s33, s30
  s_add_u32 s53, s27, 0
  s_add_u32 m0, s52, 0
  s_nop 0
  buffer_load_dwordx4 v1, s[4:7], s53 offen offset:0 sc1 lds
  buffer_load_dwordx4 v1, s[4:7], s53 offen offset:1024 sc1 lds
  buffer_load_dwordx4 v1, s[4:7], s53 offen offset:2048 sc1 lds
  buffer_load_dwordx4 v1, s[4:7], s53 offen offset:3072 sc1 lds
  s_add_u32 s53, s27, 4096
  s_add_u32 m0, s52, 4096
  s_nop 0
  buffer_load_dwordx4 v1, s[4:7], s53 offen offset:0 sc1 lds
  buffer_load_dwordx4 v1, s[4:7], s53 offen offset:1024 sc1 lds
  buffer_load_dwordx4 v1, s[4:7], s53 offen offset:2048 sc1 lds
  buffer_load_dwordx4 v1, s[4:7], s53 offen offset:3072 sc1 lds
  s_add_u32 s53, s27, 8192
  s_add_u32 m0, s52, 8192
  s_nop 0
  buffer_load_dwordx4 v1, s[4:7], s53 offen offset:0 sc1 lds
  buffer_load_dwordx4 v1, s[4:7], s53 offen offset:1024 sc1 lds
  s_add_u32 s27, s27, 40960
  s_min_u32 s27, s27, s34
  s_add_u32 s33, s33, 40960
  s_cmp_eq_u32 s33, 122880
  s_cselect_b32 s33, 0, s33
  s_add_u32 s52, s33, s30
  s_add_u32 s53, s27, 0
  s_add_u32 m0, s52, 0
  s_nop 0
  buffer_load_dwordx4 v1, s[4:7], s53 offen offset:0 sc1 lds
  buffer_load_dwordx4 v1, s[4:7], s53 offen offset:1024 sc1 lds
  buffer_load_dwordx4 v1, s[4:7], s53 offen offset:2048 sc1 lds
  buffer_load_dwordx4 v1, s[4:7], s53 offen offset:3072 sc1 lds
  s_add_u32 s53, s27, 4096
  s_add_u32 m0, s52, 4096
  s_nop 0
  buffer_load_dwordx4 v1, s[4:7], s53 offen offset:0 sc1 lds
  buffer_load_dwordx4 v1, s[4:7], s53 offen offset:1024 sc1 lds
  buffer_load_dwordx4 v1, s[4:7], s53 offen offset:2048 sc1 lds
  buffer_load_dwordx4 v1, s[4:7], s53 offen offset:3072 sc1 lds
  s_add_u32 s53, s27, 8192
  s_add_u32 m0, s52, 8192
  s_nop 0
  buffer_load_dwordx4 v1, s[4:7], s53 offen offset:0 sc1 lds
  buffer_load_dwordx4 v1, s[4:7], s53 offen offset:1024 sc1 lds
  s_add_u32 s27, s27, 40960
  s_min_u32 s27, s27, s34
  s_add_u32 s33, s33, 40960
  s_cmp_eq_u32 s33, 122880
  s_cselect_b32 s33, 0, s33
  s_waitcnt vmcnt(10)
  s_barrier
  v_add_u32 v12, s32, v1
  ds_read_b128 v[16:19], v12 offset:0
  ds_read_b128 v[20:23], v12 offset:1024
  ds_read_b128 v[24:27], v12 offset:2048
  s_waitcnt lgkmcnt(2)
  v_mfma_f32_32x32x16_bf16 v[96:111], a[0:3], v[16:19], 0
  ds_read_b128 v[28:31], v12 offset:3072
  v_mfma_f32_32x32x16_bf16 v[112:127], a[4:7], v[16:19], 0
  s_add_u32 s52, s33, s30
  s_add_u32 s53, s27, 0
  s_add_u32 m0, s52, 0
  s_nop 0
  buffer_load_dwordx4 v1, s[4:7], s53 offen offset:0 sc1 lds
  s_waitcnt lgkmcnt(2)
  v_mfma_f32_32x32x16_bf16 v[96:111], a[8:11], v[20:23], v[96:111]
  ds_read_b128 v[16:19], v12 offset:4096
  v_mfma_f32_32x32x16_bf16 v[112:127], a[12:15], v[20:23], v[112:127]
  s_waitcnt lgkmcnt(2)
  v_mfma_f32_32x32x16_bf16 v[96:111], a[16:19], v[24:27], v[96:111]
  ds_read_b128 v[20:23], v12 offset:5120
  v_mfma_f32_32x32x16_bf16 v[112:127], a[20:23], v[24:27], v[112:127]
  s_waitcnt lgkmcnt(2)
  v_mfma_f32_32x32x16_bf16 v[96:111], a[24:27], v[28:31], v[96:111]
  ds_read_b128 v[24:27], v12 offset:6144
  v_mfma_f32_32x32x16_bf16 v[112:127], a[28:31], v[28:31], v[112:127]
  buffer_load_dwordx4 v1, s[4:7], s53 offen offset:1024 sc1 lds
  s_waitcnt lgkmcnt(2)
  v_mfma_f32_32x32x16_bf16 v[96:111], a[32:35], v[16:19], v[96:111]
  ds_read_b128 v[28:31], v12 offset:7168
  v_mfma_f32_32x32x16_bf16 v[112:127], a[36:39], v[16:19], v[112:127]
  s_waitcnt lgkmcnt(2)
  v_mfma_f32_32x32x16_bf16 v[96:111], a[40:43], v[20:23], v[96:111]
  ds_read_b128 v[16:19], v12 offset:8192
  v_mfma_f32_32x32x16_bf16 v[112:127], a[44:47], v[20:23], v[112:127]
  s_waitcnt lgkmcnt(2)
  v_mfma_f32_32x32x16_bf16 v[96:111], a[48:51], v[24:27], v[96:111]
  ds_read_b128 v[20:23], v12 offset:9216
  v_mfma_f32_32x32x16_bf16 v[112:127], a[52:55], v[24:27], v[112:127]
  buffer_load_dwordx4 v1, s[4:7], s53 offen offset:2048 sc1 lds
  s_waitcnt lgkmcnt(2)
  v_mfma_f32_32x32x16_bf16 v[96:111], a[56:59], v[28:31], v[96:111]
  ds_read_b128 v[24:27], v12 offset:10240
  v_mfma_f32_32x32x16_bf16 v[112:127], a[60:63], v[28:31], v[112:127]
  s_waitcnt lgkmcnt(2)
  v_mfma_f32_32x32x16_bf16 v[96:111], a[64:67], v[16:19], v[96:111]
  ds_read_b128 v[28:31], v12 offset:11264
  v_mfma_f32_32x32x16_bf16 v[112:127], a[68:71], v[16:19], v[112:127]
  s_waitcnt lgkmcnt(2)
  v_mfma_f32_32x32x16_bf16 v[96:111], a[72:75], v[20:23], v[96:111]
  ds_read_b128 v[16:19], v12 offset:12288
  v_mfma_f32_32x32x16_bf16 v[112:127], a[76:79], v[20:23], v[112:127]
  buffer_load_dwordx4 v1, s[4:7], s53 offen offset:3072 sc1 lds
  s_waitcnt lgkmcnt(2)
  v_mfma_f32_32x32x16_bf16 v[96:111], a[80:83], v[24:27], v[96:111]
  ds_read_b128 v[20:23], v12 offset:13312
  v_mfma_f32_32x32x16_bf16 v[112:127], a[84:87], v[24:27], v[112:127]
  s_waitcnt lgkmcnt(2)
  v_mfma_f32_32x32x16_bf16 v[96:111], a[88:91], v[28:31], v[96:111]
  ds_read_b128 v[24:27], v12 offset:14336
  v_mfma_f32_32x32x16_bf16 v[112:127], a[92:95], v[28:31], v[112:127]
  s_waitcnt lgkmcnt(2)
  v_mfma_f32_32x32x16_bf16 v[96:111], a[96:99], v[16:19], v[96:111]
  ds_read_b128 v[28:31], v12 offset:15360
  v_mfma_f32_32x32x16_bf16 v[112:127], a[100:103], v[16:19], v[112:127]
  s_add_u32 s53, s27, 4096
  s_add_u32 m0, s52, 4096
  s_nop 0
  buffer_load_dwordx4 v1, s[4:7], s53 offen offset:0 sc1 lds
  s_waitcnt lgkmcnt(2)
  v_mfma_f32_32x32x16_bf16 v[96:111], a[104:107], v[20:23], v[96:111]
  ds_read_b128 v[16:19], v12 offset:16384
  v_mfma_f32_32x32x16_bf16 v[112:127], a[108:111], v[20:23], v[112:127]
  s_waitcnt lgkmcnt(2)
  v_mfma_f32_32x32x16_bf16 v[96:111], a[112:115], v[24:27], v[96:111]
  ds_read_b128 v[20:23], v12 offset:17408
  v_mfma_f32_32x32x16_bf16 v[112:127], a[116:119], v[24:27], v[112:127]
  s_waitcnt lgkmcnt(2)
  v_mfma_f32_32x32x16_bf16 v[96:111], a[120:123], v[28:31], v[96:111]
  ds_read_b128 v[24:27], v12 offset:18432
  v_mfma_f32_32x32x16_bf16 v[112:127], a[124:127], v[28:31], v[112:127]
  buffer_load_dwordx4 v1, s[4:7], s53 offen offset:1024 sc1 lds
  s_waitcnt lgkmcnt(2)
  v_mfma_f32_32x32x16_bf16 v[96:111], a[128:131], v[16:19], v[96:111]
  ds_read_b128 v[28:31], v12 offset:19456
  v_mfma_f32_32x32x16_bf16 v[112:127], a[132:135], v[16:19], v[112:127]
  s_waitcnt lgkmcnt(2)
  v_mfma_f32_32x32x16_bf16 v[96:111], a[136:139], v[20:23], v[96:111]
  ds_read_b128 v[16:19], v12 offset:20480
  v_mfma_f32_32x32x16_bf16 v[112:127], a[140:143], v[20:23], v[112:127]
  s_waitcnt lgkmcnt(2)
  v_mfma_f32_32x32x16_bf16 v[96:111], a[144:147], v[24:27], v[96:111]
  ds_read_b128 v[20:23], v12 offset:21504
  v_mfma_f32_32x32x16_bf16 v[112:127], a[148:151], v[24:27], v[112:127]
  buffer_load_dwordx4 v1, s[4:7], s53 offen offset:2048 sc1 lds
  s_waitcnt lgkmcnt(2)
  v_mfma_f32_32x32x16_bf16 v[96:111], a[152:155], v[28:31], v[96:111]
  ds_read_b128 v[24:27], v12 offset:22528
  v_mfma_f32_32x32x16_bf16 v[112:127], a[156:159], v[28:31], v[112:127]
  s_waitcnt lgkmcnt(2)
  v_mfma_f32_32x32x16_bf16 v[96:111], a[160:163], v[16:19], v[96:111]
  ds_read_b128 v[28:31], v12 offset:23552
  v_mfma_f32_32x32x16_bf16 v[112:127], a[164:167], v[16:19], v[112:127]
  s_waitcnt lgkmcnt(2)
  v_mfma_f32_32x32x16_bf16 v[96:111], a[168:171], v[20:23], v[96:111]
  ds_read_b128 v[16:19], v12 offset:24576
  v_mfma_f32_32x32x16_bf16 v[112:127], a[172:175], v[20:23], v[112:127]
  buffer_load_dwordx4 v1, s[4:7], s53 offen offset:3072 sc1 lds
  s_waitcnt lgkmcnt(2)
  v_mfma_f32_32x32x16_bf16 v[96:111], a[176:179], v[24:27], v[96:111]
  ds_read_b128 v[20:23], v12 offset:25600
  v_mfma_f32_32x32x16_bf16 v[112:127], a[180:183], v[24:27], v[112:127]
  s_waitcnt lgkmcnt(2)
  v_mfma_f32_32x32x16_bf16 v[96:111], a[184:187], v[28:31], v[96:111]
  ds_read_b128 v[24:27], v12 offset:26624
  v_mfma_f32_32x32x16_bf16 v[112:127], a[188:191], v[28:31], v[112:127]
  s_waitcnt lgkmcnt(2)
  v_mfma_f32_32x32x16_bf16 v[96:111], a[192:195], v[16:19], v[96:111]
  ds_read_b128 v[28:31], v12 offset:27648
  v_mfma_f32_32x32x16_bf16 v[112:127], a[196:199], v[16:19], v[112:127]
  s_add_u32 s53, s27, 8192
  s_add_u32 m0, s52, 8192
  s_nop 0
  buffer_load_dwordx4 v1, s[4:7], s53 offen offset:0 sc1 lds
  s_waitcnt lgkmcnt(2)
  v_mfma_f32_32x32x16_bf16 v[96:111], a[200:203], v[20:23], v[96:111]
  ds_read_b128 v[16:19], v12 offset:28672
  v_mfma_f32_32x32x16_bf16 v[112:127], a[204:207], v[20:23], v[112:127]
  s_waitcnt lgkmcnt(2)
  v_mfma_f32_32x32x16_bf16 v[96:111], a[208:211], v[24:27], v[96:111]
  ds_read_b128 v[20:23], v12 offset:29696
  v_mfma_f32_32x32x16_bf16 v[112:127], a[212:215], v[24:27], v[112:127]
  s_waitcnt lgkmcnt(2)
  v_mfma_f32_32x32x16_bf16 v[96:111], a[216:219], v[28:31], v[96:111]
  ds_read_b128 v[24:27], v12 offset:30720
  v_mfma_f32_32x32x16_bf16 v[112:127], a[220:223], v[28:31], v[112:127]
  buffer_load_dwordx4 v1, s[4:7], s53 offen offset:1024 sc1 lds
  s_add_u32 s27, s27, 40960
  s_min_u32 s27, s27, s34
  s_add_u32 s33, s33, 40960
  s_cmp_eq_u32 s33, 122880
  s_cselect_b32 s33, 0, s33
  s_waitcnt lgkmcnt(2)
  v_mfma_f32_32x32x16_bf16 v[96:111], a[224:227], v[16:19], v[96:111]
  ds_read_b128 v[28:31], v12 offset:31744
  v_mfma_f32_32x32x16_bf16 v[112:127], a[228:231], v[16:19], v[112:127]
  s_waitcnt lgkmcnt(2)
  v_mfma_f32_32x32x16_bf16 v[96:111], a[232:235], v[20:23], v[96:111]
  ds_read_b128 v[16:19], v12 offset:32768
  v_mfma_f32_32x32x16_bf16 v[112:127], a[236:239], v[20:23], v[112:127]
  s_waitcnt lgkmcnt(2)
  v_mfma_f32_32x32x16_bf16 v[96:111], a[240:243], v[24:27], v[96:111]
  ds_read_b128 v[20:23], v12 offset:33792
  v_mfma_f32_32x32x16_bf16 v[112:127], a[244:247], v[24:27], v[112:127]
  s_waitcnt lgkmcnt(2)
  v_mfma_f32_32x32x16_bf16 v[96:111], a[248:251], v[28:31], v[96:111]
  ds_read_b128 v[24:27], v12 offset:34816
  v_mfma_f32_32x32x16_bf16 v[112:127], a[252:255], v[28:31], v[112:127]
  s_waitcnt lgkmcnt(2)
  v_mfma_f32_32x32x16_bf16 v[96:111], v[192:195], v[16:19], v[96:111]
  ds_read_b128 v[28:31], v12 offset:35840
  v_mfma_f32_32x32x16_bf16 v[112:127], v[196:199], v[16:19], v[112:127]
  s_waitcnt lgkmcnt(2)
  v_mfma_f32_32x32x16_bf16 v[96:111], v[200:203], v[20:23], v[96:111]
  ds_read_b128 v[16:19], v12 offset:36864
  v_mfma_f32_32x32x16_bf16 v[112:127], v[204:207], v[20:23], v[112:127]
  s_waitcnt lgkmcnt(2)
  v_mfma_f32_32x32x16_bf16 v[96:111], v[208:211], v[24:27], v[96:111]
  ds_read_b128 v[20:23], v12 offset:37888
  v_mfma_f32_32x32x16_bf16 v[112:127], v[212:215], v[24:27], v[112:127]
  s_waitcnt lgkmcnt(2)
  v_mfma_f32_32x32x16_bf16 v[96:111], v[216:219], v[28:31], v[96:111]
  ds_read_b128 v[24:27], v12 offset:38912
  v_mfma_f32_32x32x16_bf16 v[112:127], v[220:223], v[28:31], v[112:127]
  s_waitcnt lgkmcnt(2)
  v_mfma_f32_32x32x16_bf16 v[96:111], v[224:227], v[16:19], v[96:111]
  ds_read_b128 v[28:31], v12 offset:39936
  v_mfma_f32_32x32x16_bf16 v[112:127], v[228:231], v[16:19], v[112:127]
  s_waitcnt lgkmcnt(2)
  v_mfma_f32_32x32x16_bf16 v[96:111], v[232:235], v[20:23], v[96:111]
  v_mfma_f32_32x32x16_bf16 v[112:127], v[236:239], v[20:23], v[112:127]
  s_waitcnt lgkmcnt(1)
  v_mfma_f32_32x32x16_bf16 v[96:111], v[240:243], v[24:27], v[96:111]
  v_mfma_f32_32x32x16_bf16 v[112:127], v[244:247], v[24:27], v[112:127]
  s_waitcnt lgkmcnt(0)
  v_mfma_f32_32x32x16_bf16 v[96:111], v[248:251], v[28:31], v[96:111]
  v_mfma_f32_32x32x16_bf16 v[112:127], v[252:255], v[28:31], v[112:127]
  s_add_u32 s32, s32, 40960
  s_cmp_eq_u32 s32, 122880
  s_cselect_b32 s32, 0, s32
  s_add_u32 s29, s29, 1
  s_waitcnt vmcnt(10)
  s_barrier
  s_sub_u32 s49, s29, 2
  s_max_i32 s49, s49, 0
  s_cmp_lg_u32 s13, 0
  s_cbranch_scc1 PB_56
  v_mov_b32 v8, s49
  v_mov_b32 v9, s26
  buffer_store_dword v8, v9, s[4:7], 0 offen sc1
PB_56:
  s_add_u32 s47, s24, s29
  s_sub_u32 s47, s47, 1
  s_mul_i32 s25, s47, 114688
  s_add_u32 s25, s25, s31
  v_add_u32 v12, s32, v1
  ds_read_b128 v[16:19], v12 offset:0
  ds_read_b128 v[20:23], v12 offset:1024
  ds_read_b128 v[24:27], v12 offset:2048
  s_waitcnt lgkmcnt(2)
  v_mfma_f32_32x32x16_bf16 v[128:143], a[0:3], v[16:19], 0
  ds_read_b128 v[28:31], v12 offset:3072
  v_mfma_f32_32x32x16_bf16 v[144:159], a[4:7], v[16:19], 0
  s_add_u32 s52, s33, s30
  s_add_u32 s53, s27, 0
  s_add_u32 m0, s52, 0
  s_nop 0
  buffer_load_dwordx4 v1, s[4:7], s53 offen offset:0 sc1 lds
  s_waitcnt lgkmcnt(2)
  v_mfma_f32_32x32x16_bf16 v[128:143], a[8:11], v[20:23], v[128:143]
  ds_read_b128 v[16:19], v12 offset:4096
  v_mfma_f32_32x32x16_bf16 v[144:159], a[12:15], v[20:23], v[144:159]
  s_waitcnt lgkmcnt(2)
  v_mfma_f32_32x32x16_bf16 v[128:143], a[16:19], v[24:27], v[128:143]
  ds_read_b128 v[20:23], v12 offset:5120
  v_mfma_f32_32x32x16_bf16 v[144:159], a[20:23], v[24:27], v[144:159]
  s_waitcnt lgkmcnt(2)
  v_mfma_f32_32x32x16_bf16 v[128:143], a[24:27], v[28:31], v[128:143]
  ds_read_b128 v[24:27], v12 offset:6144
  v_add_f32 v96, v96, v160
  v_add_f32 v97, v97, v161
  v_add_f32 v98, v98, v162
  v_add_f32 v99, v99, v163
  v_mul_f32 v48, 0x3fb8aa3b, v96
  v_mfma_f32_32x32x16_bf16 v[144:159], a[28:31], v[28:31], v[144:159]
  buffer_load_dwordx4 v1, s[4:7], s53 offen offset:1024 sc1 lds
  v_mul_f32 v50, 0x3fb8aa3b, v97
  v_mul_f32 v52, 0x3fb8aa3b, v98
  v_mul_f32 v54, 0x3fb8aa3b, v99
  v_min_f32 v48, 0x41f00000, v48
  v_min_f32 v50, 0x41f00000, v50
  s_waitcnt lgkmcnt(2)
  v_mfma_f32_32x32x16_bf16 v[128:143], a[32:35], v[16:19], v[128:143]
  ds_read_b128 v[28:31], v12 offset:7168
  v_min_f32 v52, 0x41f00000, v52
  v_min_f32 v54, 0x41f00000, v54
  v_exp_f32 v48, v48
  v_exp_f32 v50, v50
  v_exp_f32 v52, v52
  v_mfma_f32_32x32x16_bf16 v[144:159], a[36:39], v[16:19], v[144:159]
  v_exp_f32 v54, v54
  v_add_f32 v49, 2.0, v48
  v_add_f32 v51, 2.0, v50
  v_add_f32 v53, 2.0, v52
  v_add_f32 v55, 2.0, v54
  s_waitcnt lgkmcnt(2)
  v_mfma_f32_32x32x16_bf16 v[128:143], a[40:43], v[20:23], v[128:143]
  ds_read_b128 v[16:19], v12 offset:8192
  v_mul_f32 v48, v48, v49
  v_mul_f32 v50, v50, v51
  v_mul_f32 v52, v52, v53
  v_mul_f32 v54, v54, v55
  v_add_f32 v49, 2.0, v48
  v_mfma_f32_32x32x16_bf16 v[144:159], a[44:47], v[20:23], v[144:159]
  v_add_f32 v51, 2.0, v50
  v_add_f32 v53, 2.0, v52
  v_add_f32 v55, 2.0, v54
  v_rcp_f32 v49, v49
  v_rcp_f32 v51, v51
  s_waitcnt lgkmcnt(2)
  v_mfma_f32_32x32x16_bf16 v[128:143], a[48:51], v[24:27], v[128:143]
  ds_read_b128 v[20:23], v12 offset:9216
  v_rcp_f32 v53, v53
  v_rcp_f32 v55, v55
  v_mul_f32 v96, v96, v48
  v_mul_f32 v97, v97, v50
  v_mul_f32 v98, v98, v52
  v_mfma_f32_32x32x16_bf16 v[144:159], a[52:55], v[24:27], v[144:159]
  buffer_load_dwordx4 v1, s[4:7], s53 offen offset:2048 sc1 lds
  v_mul_f32 v99, v99, v54
  v_mul_f32 v96, v96, v49
  v_mul_f32 v97, v97, v51
  v_mul_f32 v98, v98, v53
  v_mul_f32 v99, v99, v55
  s_waitcnt lgkmcnt(2)
  v_mfma_f32_32x32x16_bf16 v[128:143], a[56:59], v[28:31], v[128:143]
  ds_read_b128 v[24:27], v12 offset:10240
  v_add_f32 v100, v100, v164
  v_add_f32 v101, v101, v165
  v_add_f32 v102, v102, v166
  v_add_f32 v103, v103, v167
  v_mul_f32 v48, 0x3fb8aa3b, v100
  v_mfma_f32_32x32x16_bf16 v[144:159], a[60:63], v[28:31], v[144:159]
  v_mul_f32 v50, 0x3fb8aa3b, v101
  v_mul_f32 v52, 0x3fb8aa3b, v102
  v_mul_f32 v54, 0x3fb8aa3b, v103
  v_min_f32 v48, 0x41f00000, v48
  v_min_f32 v50, 0x41f00000, v50
  s_waitcnt lgkmcnt(2)
  v_mfma_f32_32x32x16_bf16 v[128:143], a[64:67], v[16:19], v[128:143]
  ds_read_b128 v[28:31], v12 offset:11264
  v_min_f32 v52, 0x41f00000, v52
  v_min_f32 v54, 0x41f00000, v54
  v_exp_f32 v48, v48
  v_exp_f32 v50, v50
  v_exp_f32 v52, v52
  v_mfma_f32_32x32x16_bf16 v[144:159], a[68:71], v[16:19], v[144:159]
  v_exp_f32 v54, v54
  v_add_f32 v49, 2.0, v48
  v_add_f32 v51, 2.0, v50
  v_add_f32 v53, 2.0, v52
  v_add_f32 v55, 2.0, v54
  s_waitcnt lgkmcnt(2)
  v_mfma_f32_32x32x16_bf16 v[128:143], a[72:75], v[20:23], v[128:143]
  ds_read_b128 v[16:19], v12 offset:12288
  v_mul_f32 v48, v48, v49
  v_mul_f32 v50, v50, v51
  v_mul_f32 v52, v52, v53
  v_mul_f32 v54, v54, v55
  v_add_f32 v49, 2.0, v48
  v_mfma_f32_32x32x16_bf16 v[144:159], a[76:79], v[20:23], v[144:159]
  buffer_load_dwordx4 v1, s[4:7], s53 offen offset:3072 sc1 lds
  v_add_f32 v51, 2.0, v50
  v_add_f32 v53, 2.0, v52
  v_add_f32 v55, 2.0, v54
  v_rcp_f32 v49, v49
  v_rcp_f32 v51, v51
  s_waitcnt lgkmcnt(2)
  v_mfma_f32_32x32x16_bf16 v[128:143], a[80:83], v[24:27], v[128:143]
  ds_read_b128 v[20:23], v12 offset:13312
  v_rcp_f32 v53, v53
  v_rcp_f32 v55, v55
  v_mul_f32 v100, v100, v48
  v_mul_f32 v101, v101, v50
  v_mul_f32 v102, v102, v52
  v_mfma_f32_32x32x16_bf16 v[144:159], a[84:87], v[24:27], v[144:159]
  v_mul_f32 v103, v103, v54
  v_mul_f32 v100, v100, v49
  v_mul_f32 v101, v101, v51
  v_mul_f32 v102, v102, v53
  v_mul_f32 v103, v103, v55
  s_waitcnt lgkmcnt(2)
  v_mfma_f32_32x32x16_bf16 v[128:143], a[88:91], v[28:31], v[128:143]
  ds_read_b128 v[24:27], v12 offset:14336
  v_cvt_pk_bf16_f32 v40, v96, v97
  v_cvt_pk_bf16_f32 v41, v98, v99
  v_cvt_pk_bf16_f32 v42, v100, v101
  v_cvt_pk_bf16_f32 v43, v102, v103
  buffer_store_dwordx4 v[40:43], v6, s[4:7], s25 offen offset:0 sc1
  v_mfma_f32_32x32x16_bf16 v[144:159], a[92:95], v[28:31], v[144:159]
  v_add_f32 v104, v104, v168
  v_add_f32 v105, v105, v169
  v_add_f32 v106, v106, v170
  v_add_f32 v107, v107, v171
  v_mul_f32 v48, 0x3fb8aa3b, v104
  s_waitcnt lgkmcnt(2)
  v_mfma_f32_32x32x16_bf16 v[128:143], a[96:99], v[16:19], v[128:143]
  ds_read_b128 v[28:31], v12 offset:15360
  v_mul_f32 v50, 0x3fb8aa3b, v105
  v_mul_f32 v52, 0x3fb8aa3b, v106
  v_mul_f32 v54, 0x3fb8aa3b, v107
  v_min_f32 v48, 0x41f00000, v48
  v_min_f32 v50, 0x41f00000, v50
  v_mfma_f32_32x32x16_bf16 v[144:159], a[100:103], v[16:19], v[144:159]
  s_add_u32 s53, s27, 4096
  s_add_u32 m0, s52, 4096
  s_nop 0
  buffer_load_dwordx4 v1, s[4:7], s53 offen offset:0 sc1 lds
  v_min_f32 v52, 0x41f00000, v52
  v_min_f32 v54, 0x41f00000, v54
  v_exp_f32 v48, v48
  v_exp_f32 v50, v50
  v_exp_f32 v52, v52
  s_waitcnt lgkmcnt(2)
  v_mfma_f32_32x32x16_bf16 v[128:143], a[104:107], v[20:23], v[128:143]
  ds_read_b128 v[16:19], v12 offset:16384
  v_exp_f32 v54, v54
  v_add_f32 v49, 2.0, v48
  v_add_f32 v51, 2.0, v50
  v_add_f32 v53, 2.0, v52
  v_add_f32 v55, 2.0, v54
  v_mfma_f32_32x32x16_bf16 v[144:159], a[108:111], v[20:23], v[144:159]
  v_mul_f32 v48, v48, v49
  v_mul_f32 v50, v50, v51
  v_mul_f32 v52, v52, v53
  v_mul_f32 v54, v54, v55
  v_add_f32 v49, 2.0, v48
  s_waitcnt lgkmcnt(2)
  v_mfma_f32_32x32x16_bf16 v[128:143], a[112:115], v[24:27], v[128:143]
  ds_read_b128 v[20:23], v12 offset:17408
  v_add_f32 v51, 2.0, v50
  v_add_f32 v53, 2.0, v52
  v_add_f32 v55, 2.0, v54
  v_rcp_f32 v49, v49
  v_rcp_f32 v51, v51
  v_mfma_f32_32x32x16_bf16 v[144:159], a[116:119], v[24:27], v[144:159]
  v_rcp_f32 v53, v53
  v_rcp_f32 v55, v55
  v_mul_f32 v104, v104, v48
  v_mul_f32 v105, v105, v50
  v_mul_f32 v106, v106, v52
  s_waitcnt lgkmcnt(2)
  v_mfma_f32_32x32x16_bf16 v[128:143], a[120:123], v[28:31], v[128:143]
  ds_read_b128 v[24:27], v12 offset:18432
  v_mul_f32 v107, v107, v54
  v_mul_f32 v104, v104, v49
  v_mul_f32 v105, v105, v51
  v_mul_f32 v106, v106, v53
  v_mul_f32 v107, v107, v55
  v_mfma_f32_32x32x16_bf16 v[144:159], a[124:127], v[28:31], v[144:159]
  buffer_load_dwordx4 v1, s[4:7], s53 offen offset:1024 sc1 lds
  v_add_f32 v108, v108, v172
  v_add_f32 v109, v109, v173
  v_add_f32 v110, v110, v174
  v_add_f32 v111, v111, v175
  v_mul_f32 v48, 0x3fb8aa3b, v108
  s_waitcnt lgkmcnt(2)
  v_mfma_f32_32x32x16_bf16 v[128:143], a[128:131], v[16:19], v[128:143]
  ds_read_b128 v[28:31], v12 offset:19456
  v_mul_f32 v50, 0x3fb8aa3b, v109
  v_mul_f32 v52, 0x3fb8aa3b, v110
  v_mul_f32 v54, 0x3fb8aa3b, v111
  v_min_f32 v48, 0x41f00000, v48
  v_min_f32 v50, 0x41f00000, v50
  v_mfma_f32_32x32x16_bf16 v[144:159], a[132:135], v[16:19], v[144:159]
  v_min_f32 v52, 0x41f00000, v52
  v_min_f32 v54, 0x41f00000, v54
  v_exp_f32 v48, v48
  v_exp_f32 v50, v50
  v_exp_f32 v52, v52
  s_waitcnt lgkmcnt(2)
  v_mfma_f32_32x32x16_bf16 v[128:143], a[136:139], v[20:23], v[128:143]
  ds_read_b128 v[16:19], v12 offset:20480
  v_exp_f32 v54, v54
  v_add_f32 v49, 2.0, v48
  v_add_f32 v51, 2.0, v50
  v_add_f32 v53, 2.0, v52
  v_add_f32 v55, 2.0, v54
  v_mfma_f32_32x32x16_bf16 v[144:159], a[140:143], v[20:23], v[144:159]
  v_mul_f32 v48, v48, v49
  v_mul_f32 v50, v50, v51
  v_mul_f32 v52, v52, v53
  v_mul_f32 v54, v54, v55
  v_add_f32 v49, 2.0, v48
  s_waitcnt lgkmcnt(2)
  v_mfma_f32_32x32x16_bf16 v[128:143], a[144:147], v[24:27], v[128:143]
  ds_read_b128 v[20:23], v12 offset:21504
  v_add_f32 v51, 2.0, v50
  v_add_f32 v53, 2.0, v52
  v_add_f32 v55, 2.0, v54
  v_rcp_f32 v49, v49
  v_rcp_f32 v51, v51
  v_mfma_f32_32x32x16_bf16 v[144:159], a[148:151], v[24:27], v[144:159]
  buffer_load_dwordx4 v1, s[4:7], s53 offen offset:2048 sc1 lds
  v_rcp_f32 v53, v53
  v_rcp_f32 v55, v55
  v_mul_f32 v108, v108, v48
  v_mul_f32 v109, v109, v50
  v_mul_f32 v110, v110, v52
  s_waitcnt lgkmcnt(2)
  v_mfma_f32_32x32x16_bf16 v[128:143], a[152:155], v[28:31], v[128:143]
  ds_read_b128 v[24:27], v12 offset:22528
  v_mul_f32 v111, v111, v54
  v_mul_f32 v108, v108, v49
  v_mul_f32 v109, v109, v51
  v_mul_f32 v110, v110, v53
  v_mul_f32 v111, v111, v55
  v_mfma_f32_32x32x16_bf16 v[144:159], a[156:159], v[28:31], v[144:159]
  v_cvt_pk_bf16_f32 v44, v104, v105
  v_cvt_pk_bf16_f32 v45, v106, v107
  v_cvt_pk_bf16_f32 v46, v108, v109
  v_cvt_pk_bf16_f32 v47, v110, v111
  buffer_store_dwordx4 v[44:47], v6, s[4:7], s25 offen offset:512 sc1
  s_waitcnt lgkmcnt(2)
  v_mfma_f32_32x32x16_bf16 v[128:143], a[160:163], v[16:19], v[128:143]
  ds_read_b128 v[28:31], v12 offset:23552
  v_add_f32 v112, v112, v176
  v_add_f32 v113, v113, v177
  v_add_f32 v114, v114, v178
  v_add_f32 v115, v115, v179
  v_mul_f32 v48, 0x3fb8aa3b, v112
  v_mfma_f32_32x32x16_bf16 v[144:159], a[164:167], v[16:19], v[144:159]
  v_mul_f32 v50, 0x3fb8aa3b, v113
  v_mul_f32 v52, 0x3fb8aa3b, v114
  v_mul_f32 v54, 0x3fb8aa3b, v115
  v_min_f32 v48, 0x41f00000, v48
  v_min_f32 v50, 0x41f00000, v50
  s_waitcnt lgkmcnt(2)
  v_mfma_f32_32x32x16_bf16 v[128:143], a[168:171], v[20:23], v[128:143]
  ds_read_b128 v[16:19], v12 offset:24576
  v_min_f32 v52, 0x41f00000, v52
  v_min_f32 v54, 0x41f00000, v54
  v_exp_f32 v48, v48
  v_exp_f32 v50, v50
  v_exp_f32 v52, v52
  v_mfma_f32_32x32x16_bf16 v[144:159], a[172:175], v[20:23], v[144:159]
  buffer_load_dwordx4 v1, s[4:7], s53 offen offset:3072 sc1 lds
  v_exp_f32 v54, v54
  v_add_f32 v49, 2.0, v48
  v_add_f32 v51, 2.0, v50
  v_add_f32 v53, 2.0, v52
  v_add_f32 v55, 2.0, v54
  s_waitcnt lgkmcnt(2)
  v_mfma_f32_32x32x16_bf16 v[128:143], a[176:179], v[24:27], v[128:143]
  ds_read_b128 v[20:23], v12 offset:25600
  v_mul_f32 v48, v48, v49
  v_mul_f32 v50, v50, v51
  v_mul_f32 v52, v52, v53
  v_mul_f32 v54, v54, v55
  v_add_f32 v49, 2.0, v48
  v_mfma_f32_32x32x16_bf16 v[144:159], a[180:183], v[24:27], v[144:159]
  v_add_f32 v51, 2.0, v50
  v_add_f32 v53, 2.0, v52
  v_add_f32 v55, 2.0, v54
  v_rcp_f32 v49, v49
  v_rcp_f32 v51, v51
  s_waitcnt lgkmcnt(2)
  v_mfma_f32_32x32x16_bf16 v[128:143], a[184:187], v[28:31], v[128:143]
  ds_read_b128 v[24:27], v12 offset:26624
  v_rcp_f32 v53, v53
  v_rcp_f32 v55, v55
  v_mul_f32 v112, v112, v48
  v_mul_f32 v113, v113, v50
  v_mul_f32 v114, v114, v52
  v_mfma_f32_32x32x16_bf16 v[144:159], a[188:191], v[28:31], v[144:159]
  v_mul_f32 v115, v115, v54
  v_mul_f32 v112, v112, v49
  v_mul_f32 v113, v113, v51
  v_mul_f32 v114, v114, v53
  v_mul_f32 v115, v115, v55
  s_waitcnt lgkmcnt(2)
  v_mfma_f32_32x32x16_bf16 v[128:143], a[192:195], v[16:19], v[128:143]
  ds_read_b128 v[28:31], v12 offset:27648
  v_add_f32 v116, v116, v180
  v_add_f32 v117, v117, v181
  v_add_f32 v118, v118, v182
  v_add_f32 v119, v119, v183
  v_mul_f32 v48, 0x3fb8aa3b, v116
  v_mfma_f32_32x32x16_bf16 v[144:159], a[196:199], v[16:19], v[144:159]
  s_add_u32 s53, s27, 8192
  s_add_u32 m0, s52, 8192
  s_nop 0
  buffer_load_dwordx4 v1, s[4:7], s53 offen offset:0 sc1 lds
  v_mul_f32 v50, 0x3fb8aa3b, v117
  v_mul_f32 v52, 0x3fb8aa3b, v118
  v_mul_f32 v54, 0x3fb8aa3b, v119
  v_min_f32 v48, 0x41f00000, v48
  v_min_f32 v50, 0x41f00000, v50
  s_waitcnt lgkmcnt(2)
  v_mfma_f32_32x32x16_bf16 v[128:143], a[200:203], v[20:23], v[128:143]
  ds_read_b128 v[16:19], v12 offset:28672
  v_min_f32 v52, 0x41f00000, v52
  v_min_f32 v54, 0x41f00000, v54
  v_exp_f32 v48, v48
  v_exp_f32 v50, v50
  v_exp_f32 v52, v52
  v_mfma_f32_32x32x16_bf16 v[144:159], a[204:207], v[20:23], v[144:159]
  v_exp_f32 v54, v54
  v_add_f32 v49, 2.0, v48
  v_add_f32 v51, 2.0, v50
  v_add_f32 v53, 2.0, v52
  v_add_f32 v55, 2.0, v54
  s_waitcnt lgkmcnt(2)
  v_mfma_f32_32x32x16_bf16 v[128:143], a[208:211], v[24:27], v[128:143]
  ds_read_b128 v[20:23], v12 offset:29696
  v_mul_f32 v48, v48, v49
  v_mul_f32 v50, v50, v51
  v_mul_f32 v52, v52, v53
  v_mul_f32 v54, v54, v55
  v_add_f32 v49, 2.0, v48
  v_mfma_f32_32x32x16_bf16 v[144:159], a[212:215], v[24:27], v[144:159]
  v_add_f32 v51, 2.0, v50
  v_add_f32 v53, 2.0, v52
  v_add_f32 v55, 2.0, v54
  v_rcp_f32 v49, v49
  v_rcp_f32 v51, v51
  s_waitcnt lgkmcnt(2)
  v_mfma_f32_32x32x16_bf16 v[128:143], a[216:219], v[28:31], v[128:143]
  ds_read_b128 v[24:27], v12 offset:30720
  v_rcp_f32 v53, v53
  v_rcp_f32 v55, v55
  v_mul_f32 v116, v116, v48
  v_mul_f32 v117, v117, v50
  v_mul_f32 v118, v118, v52
  v_mfma_f32_32x32x16_bf16 v[144:159], a[220:223], v[28:31], v[144:159]
  buffer_load_dwordx4 v1, s[4:7], s53 offen offset:1024 sc1 lds
  s_add_u32 s27, s27, 40960
  s_min_u32 s27, s27, s34
  s_add_u32 s33, s33, 40960
  s_cmp_eq_u32 s33, 122880
  s_cselect_b32 s33, 0, s33
  v_mul_f32 v119, v119, v54
  v_mul_f32 v116, v116, v49
  v_mul_f32 v117, v117, v51
  v_mul_f32 v118, v118, v53
  v_mul_f32 v119, v119, v55
  s_waitcnt lgkmcnt(2)
  v_mfma_f32_32x32x16_bf16 v[128:143], a[224:227], v[16:19], v[128:143]
  ds_read_b128 v[28:31], v12 offset:31744
  v_cvt_pk_bf16_f32 v40, v112, v113
  v_cvt_pk_bf16_f32 v41, v114, v115
  v_cvt_pk_bf16_f32 v42, v116, v117
  v_cvt_pk_bf16_f32 v43, v118, v119
  buffer_store_dwordx4 v[40:43], v6, s[4:7], s25 offen offset:1024 sc1
  v_mfma_f32_32x32x16_bf16 v[144:159], a[228:231], v[16:19], v[144:159]
  v_add_f32 v120, v120, v184
  v_add_f32 v121, v121, v185
  v_add_f32 v122, v122, v186
  v_add_f32 v123, v123, v187
  v_mul_f32 v48, 0x3fb8aa3b, v120
  s_waitcnt lgkmcnt(2)
  v_mfma_f32_32x32x16_bf16 v[128:143], a[232:235], v[20:23], v[128:143]
  ds_read_b128 v[16:19], v12 offset:32768
  v_mul_f32 v50, 0x3fb8aa3b, v121
  v_mul_f32 v52, 0x3fb8aa3b, v122
  v_mul_f32 v54, 0x3fb8aa3b, v123
  v_min_f32 v48, 0x41f00000, v48
  v_min_f32 v50, 0x41f00000, v50
  v_mfma_f32_32x32x16_bf16 v[144:159], a[236:239], v[20:23], v[144:159]
  v_min_f32 v52, 0x41f00000, v52
  v_min_f32 v54, 0x41f00000, v54
  v_exp_f32 v48, v48
  v_exp_f32 v50, v50
  v_exp_f32 v52, v52
  s_waitcnt lgkmcnt(2)
  v_mfma_f32_32x32x16_bf16 v[128:143], a[240:243], v[24:27], v[128:143]
  ds_read_b128 v[20:23], v12 offset:33792
  v_exp_f32 v54, v54
  v_add_f32 v49, 2.0, v48
  v_add_f32 v51, 2.0, v50
  v_add_f32 v53, 2.0, v52
  v_add_f32 v55, 2.0, v54
  v_mfma_f32_32x32x16_bf16 v[144:159], a[244:247], v[24:27], v[144:159]
  v_mul_f32 v48, v48, v49
  v_mul_f32 v50, v50, v51
  v_mul_f32 v52, v52, v53
  v_mul_f32 v54, v54, v55
  v_add_f32 v49, 2.0, v48
  s_waitcnt lgkmcnt(2)
  v_mfma_f32_32x32x16_bf16 v[128:143], a[248:251], v[28:31], v[128:143]
  ds_read_b128 v[24:27], v12 offset:34816
  v_add_f32 v51, 2.0, v50
  v_add_f32 v53, 2.0, v52
  v_add_f32 v55, 2.0, v54
  v_rcp_f32 v49, v49
  v_rcp_f32 v51, v51
  v_mfma_f32_32x32x16_bf16 v[144:159], a[252:255], v[28:31], v[144:159]
  v_rcp_f32 v53, v53
  v_rcp_f32 v55, v55
  v_mul_f32 v120, v120, v48
  v_mul_f32 v121, v121, v50
  v_mul_f32 v122, v122, v52
  s_waitcnt lgkmcnt(2)
  v_mfma_f32_32x32x16_bf16 v[128:143], v[192:195], v[16:19], v[128:143]
  ds_read_b128 v[28:31], v12 offset:35840
  v_mul_f32 v123, v123, v54
  v_mul_f32 v120, v120, v49
  v_mul_f32 v121, v121, v51
  v_mul_f32 v122, v122, v53
  v_mul_f32 v123, v123, v55
  v_mfma_f32_32x32x16_bf16 v[144:159], v[196:199], v[16:19], v[144:159]
  v_add_f32 v124, v124, v188
  v_add_f32 v125, v125, v189
  v_add_f32 v126, v126, v190
  v_add_f32 v127, v127, v191
  v_mul_f32 v48, 0x3fb8aa3b, v124
  s_waitcnt lgkmcnt(2)
  v_mfma_f32_32x32x16_bf16 v[128:143], v[200:203], v[20:23], v[128:143]
  ds_read_b128 v[16:19], v12 offset:36864
  v_mul_f32 v50, 0x3fb8aa3b, v125
  v_mul_f32 v52, 0x3fb8aa3b, v126
  v_mul_f32 v54, 0x3fb8aa3b, v127
  v_min_f32 v48, 0x41f00000, v48
  v_min_f32 v50, 0x41f00000, v50
  v_mfma_f32_32x32x16_bf16 v[144:159], v[204:207], v[20:23], v[144:159]
  v_min_f32 v52, 0x41f00000, v52
  v_min_f32 v54, 0x41f00000, v54
  v_exp_f32 v48, v48
  v_exp_f32 v50, v50
  v_exp_f32 v52, v52
  s_waitcnt lgkmcnt(2)
  v_mfma_f32_32x32x16_bf16 v[128:143], v[208:211], v[24:27], v[128:143]
  ds_read_b128 v[20:23], v12 offset:37888
  v_exp_f32 v54, v54
  v_add_f32 v49, 2.0, v48
  v_add_f32 v51, 2.0, v50
  v_add_f32 v53, 2.0, v52
  v_add_f32 v55, 2.0, v54
  v_mfma_f32_32x32x16_bf16 v[144:159], v[212:215], v[24:27], v[144:159]
  v_mul_f32 v48, v48, v49
  v_mul_f32 v50, v50, v51
  v_mul_f32 v52, v52, v53
  v_mul_f32 v54, v54, v55
  v_add_f32 v49, 2.0, v48
  s_waitcnt lgkmcnt(2)
  v_mfma_f32_32x32x16_bf16 v[128:143], v[216:219], v[28:31], v[128:143]
  ds_read_b128 v[24:27], v12 offset:38912
  v_add_f32 v51, 2.0, v50
  v_add_f32 v53, 2.0, v52
  v_add_f32 v55, 2.0, v54
  v_rcp_f32 v49, v49
  v_rcp_f32 v51, v51
  v_mfma_f32_32x32x16_bf16 v[144:159], v[220:223], v[28:31], v[144:159]
  v_rcp_f32 v53, v53
  v_rcp_f32 v55, v55
  v_mul_f32 v124, v124, v48
  v_mul_f32 v125, v125, v50
  v_mul_f32 v126, v126, v52
  s_waitcnt lgkmcnt(2)
  v_mfma_f32_32x32x16_bf16 v[128:143], v[224:227], v[16:19], v[128:143]
  ds_read_b128 v[28:31], v12 offset:39936
  v_mul_f32 v127, v127, v54
  v_mul_f32 v124, v124, v49
  v_mul_f32 v125, v125, v51
  v_mul_f32 v126, v126, v53
  v_mul_f32 v127, v127, v55
  v_mfma_f32_32x32x16_bf16 v[144:159], v[228:231], v[16:19], v[144:159]
  v_cvt_pk_bf16_f32 v44, v120, v121
  v_cvt_pk_bf16_f32 v45, v122, v123
  v_cvt_pk_bf16_f32 v46, v124, v125
  v_cvt_pk_bf16_f32 v47, v126, v127
  buffer_store_dwordx4 v[44:47], v6, s[4:7], s25 offen offset:1536 sc1
  s_waitcnt lgkmcnt(2)
  v_mfma_f32_32x32x16_bf16 v[128:143], v[232:235], v[20:23], v[128:143]
  v_mfma_f32_32x32x16_bf16 v[144:159], v[236:239], v[20:23], v[144:159]
  s_waitcnt lgkmcnt(1)
  v_mfma_f32_32x32x16_bf16 v[128:143], v[240:243], v[24:27], v[128:143]
  v_mfma_f32_32x32x16_bf16 v[144:159], v[244:247], v[24:27], v[144:159]
  s_waitcnt lgkmcnt(0)
  v_mfma_f32_32x32x16_bf16 v[128:143], v[248:251], v[28:31], v[128:143]
  v_mfma_f32_32x32x16_bf16 v[144:159], v[252:255], v[28:31], v[144:159]
  s_add_u32 s32, s32, 40960
  s_cmp_eq_u32 s32, 122880
  s_cselect_b32 s32, 0, s32
  s_add_u32 s29, s29, 1
W1T_53:
  s_waitcnt vmcnt(14)
  s_barrier
  s_sub_u32 s49, s29, 2
  s_max_i32 s49, s49, 0
  s_cmp_lg_u32 s13, 0
  s_cbranch_scc1 PB_57
  v_mov_b32 v8, s49
  v_mov_b32 v9, s26
  buffer_store_dword v8, v9, s[4:7], 0 offen sc1
PB_57:
  s_add_u32 s47, s24, s29
  s_sub_u32 s47, s47, 1
  s_mul_i32 s25, s47, 114688
  s_add_u32 s25, s25, s31
  v_add_u32 v12, s32, v1
  ds_read_b128 v[16:19], v12 offset:0
  ds_read_b128 v[20:23], v12 offset:1024
  ds_read_b128 v[24:27], v12 offset:2048
  s_waitcnt lgkmcnt(2)
  v_mfma_f32_32x32x16_bf16 v[96:111], a[0:3], v[16:19], 0
  ds_read_b128 v[28:31], v12 offset:3072
  v_mfma_f32_32x32x16_bf16 v[112:127], a[4:7], v[16:19], 0
  s_add_u32 s52, s33, s30
  s_add_u32 s53, s27, 0
  s_add_u32 m0, s52, 0
  s_nop 0
  buffer_load_dwordx4 v1, s[4:7], s53 offen offset:0 sc1 lds
  s_waitcnt lgkmcnt(2)
  v_mfma_f32_32x32x16_bf16 v[96:111], a[8:11], v[20:23], v[96:111]
  ds_read_b128 v[16:19], v12 offset:4096
  v_mfma_f32_32x32x16_bf16 v[112:127], a[12:15], v[20:23], v[112:127]
  s_waitcnt lgkmcnt(2)
  v_mfma_f32_32x32x16_bf16 v[96:111], a[16:19], v[24:27], v[96:111]
  ds_read_b128 v[20:23], v12 offset:5120
  v_mfma_f32_32x32x16_bf16 v[112:127], a[20:23], v[24:27], v[112:127]
  s_waitcnt lgkmcnt(2)
  v_mfma_f32_32x32x16_bf16 v[96:111], a[24:27], v[28:31], v[96:111]
  ds_read_b128 v[24:27], v12 offset:6144
  v_add_f32 v128, v128, v160
  v_add_f32 v129, v129, v161
  v_add_f32 v130, v130, v162
  v_add_f32 v131, v131, v163
  v_mul_f32 v48, 0x3fb8aa3b, v128
  v_mfma_f32_32x32x16_bf16 v[112:127], a[28:31], v[28:31], v[112:127]
  buffer_load_dwordx4 v1, s[4:7], s53 offen offset:1024 sc1 lds
  v_mul_f32 v50, 0x3fb8aa3b, v129
  v_mul_f32 v52, 0x3fb8aa3b, v130
  v_mul_f32 v54, 0x3fb8aa3b, v131
  v_min_f32 v48, 0x41f00000, v48
  v_min_f32 v50, 0x41f00000, v50
  s_waitcnt lgkmcnt(2)
  v_mfma_f32_32x32x16_bf16 v[96:111], a[32:35], v[16:19], v[96:111]
  ds_read_b128 v[28:31], v12 offset:7168
  v_min_f32 v52, 0x41f00000, v52
  v_min_f32 v54, 0x41f00000, v54
  v_exp_f32 v48, v48
  v_exp_f32 v50, v50
  v_exp_f32 v52, v52
  v_mfma_f32_32x32x16_bf16 v[112:127], a[36:39], v[16:19], v[112:127]
  v_exp_f32 v54, v54
  v_add_f32 v49, 2.0, v48
  v_add_f32 v51, 2.0, v50
  v_add_f32 v53, 2.0, v52
  v_add_f32 v55, 2.0, v54
  s_waitcnt lgkmcnt(2)
  v_mfma_f32_32x32x16_bf16 v[96:111], a[40:43], v[20:23], v[96:111]
  ds_read_b128 v[16:19], v12 offset:8192
  v_mul_f32 v48, v48, v49
  v_mul_f32 v50, v50, v51
  v_mul_f32 v52, v52, v53
  v_mul_f32 v54, v54, v55
  v_add_f32 v49, 2.0, v48
  v_mfma_f32_32x32x16_bf16 v[112:127], a[44:47], v[20:23], v[112:127]
  v_add_f32 v51, 2.0, v50
  v_add_f32 v53, 2.0, v52
  v_add_f32 v55, 2.0, v54
  v_rcp_f32 v49, v49
  v_rcp_f32 v51, v51
  s_waitcnt lgkmcnt(2)
  v_mfma_f32_32x32x16_bf16 v[96:111], a[48:51], v[24:27], v[96:111]
  ds_read_b128 v[20:23], v12 offset:9216
  v_rcp_f32 v53, v53
  v_rcp_f32 v55, v55
  v_mul_f32 v128, v128, v48
  v_mul_f32 v129, v129, v50
  v_mul_f32 v130, v130, v52
  v_mfma_f32_32x32x16_bf16 v[112:127], a[52:55], v[24:27], v[112:127]
  buffer_load_dwordx4 v1, s[4:7], s53 offen offset:2048 sc1 lds
  v_mul_f32 v131, v131, v54
  v_mul_f32 v128, v128, v49
  v_mul_f32 v129, v129, v51
  v_mul_f32 v130, v130, v53
  v_mul_f32 v131, v131, v55
  s_waitcnt lgkmcnt(2)
  v_mfma_f32_32x32x16_bf16 v[96:111], a[56:59], v[28:31], v[96:111]
  ds_read_b128 v[24:27], v12 offset:10240
  v_add_f32 v132, v132, v164
  v_add_f32 v133, v133, v165
  v_add_f32 v134, v134, v166
  v_add_f32 v135, v135, v167
  v_mul_f32 v48, 0x3fb8aa3b, v132
  v_mfma_f32_32x32x16_bf16 v[112:127], a[60:63], v[28:31], v[112:127]
  v_mul_f32 v50, 0x3fb8aa3b, v133
  v_mul_f32 v52, 0x3fb8aa3b, v134
  v_mul_f32 v54, 0x3fb8aa3b, v135
  v_min_f32 v48, 0x41f00000, v48
  v_min_f32 v50, 0x41f00000, v50
  s_waitcnt lgkmcnt(2)
  v_mfma_f32_32x32x16_bf16 v[96:111], a[64:67], v[16:19], v[96:111]
  ds_read_b128 v[28:31], v12 offset:11264
  v_min_f32 v52, 0x41f00000, v52
  v_min_f32 v54, 0x41f00000, v54
  v_exp_f32 v48, v48
  v_exp_f32 v50, v50
  v_exp_f32 v52, v52
  v_mfma_f32_32x32x16_bf16 v[112:127], a[68:71], v[16:19], v[112:127]
  v_exp_f32 v54, v54
  v_add_f32 v49, 2.0, v48
  v_add_f32 v51, 2.0, v50
  v_add_f32 v53, 2.0, v52
  v_add_f32 v55, 2.0, v54
  s_waitcnt lgkmcnt(2)
  v_mfma_f32_32x32x16_bf16 v[96:111], a[72:75], v[20:23], v[96:111]
  ds_read_b128 v[16:19], v12 offset:12288
  v_mul_f32 v48, v48, v49
  v_mul_f32 v50, v50, v51
  v_mul_f32 v52, v52, v53
  v_mul_f32 v54, v54, v55
  v_add_f32 v49, 2.0, v48
  v_mfma_f32_32x32x16_bf16 v[112:127], a[76:79], v[20:23], v[112:127]
  buffer_load_dwordx4 v1, s[4:7], s53 offen offset:3072 sc1 lds
  v_add_f32 v51, 2.0, v50
  v_add_f32 v53, 2.0, v52
  v_add_f32 v55, 2.0, v54
  v_rcp_f32 v49, v49
  v_rcp_f32 v51, v51
  s_waitcnt lgkmcnt(2)
  v_mfma_f32_32x32x16_bf16 v[96:111], a[80:83], v[24:27], v[96:111]
  ds_read_b128 v[20:23], v12 offset:13312
  v_rcp_f32 v53, v53
  v_rcp_f32 v55, v55
  v_mul_f32 v132, v132, v48
  v_mul_f32 v133, v133, v50
  v_mul_f32 v134, v134, v52
  v_mfma_f32_32x32x16_bf16 v[112:127], a[84:87], v[24:27], v[112:127]
  v_mul_f32 v135, v135, v54
  v_mul_f32 v132, v132, v49
  v_mul_f32 v133, v133, v51
  v_mul_f32 v134, v134, v53
  v_mul_f32 v135, v135, v55
  s_waitcnt lgkmcnt(2)
  v_mfma_f32_32x32x16_bf16 v[96:111], a[88:91], v[28:31], v[96:111]
  ds_read_b128 v[24:27], v12 offset:14336
  v_cvt_pk_bf16_f32 v40, v128, v129
  v_cvt_pk_bf16_f32 v41, v130, v131
  v_cvt_pk_bf16_f32 v42, v132, v133
  v_cvt_pk_bf16_f32 v43, v134, v135
  buffer_store_dwordx4 v[40:43], v6, s[4:7], s25 offen offset:0 sc1
  v_mfma_f32_32x32x16_bf16 v[112:127], a[92:95], v[28:31], v[112:127]
  v_add_f32 v136, v136, v168
  v_add_f32 v137, v137, v169
  v_add_f32 v138, v138, v170
  v_add_f32 v139, v139, v171
  v_mul_f32 v48, 0x3fb8aa3b, v136
  s_waitcnt lgkmcnt(2)
  v_mfma_f32_32x32x16_bf16 v[96:111], a[96:99], v[16:19], v[96:111]
  ds_read_b128 v[28:31], v12 offset:15360
  v_mul_f32 v50, 0x3fb8aa3b, v137
  v_mul_f32 v52, 0x3fb8aa3b, v138
  v_mul_f32 v54, 0x3fb8aa3b, v139
  v_min_f32 v48, 0x41f00000, v48
  v_min_f32 v50, 0x41f00000, v50
  v_mfma_f32_32x32x16_bf16 v[112:127], a[100:103], v[16:19], v[112:127]
  s_add_u32 s53, s27, 4096
  s_add_u32 m0, s52, 4096
  s_nop 0
  buffer_load_dwordx4 v1, s[4:7], s53 offen offset:0 sc1 lds
  v_min_f32 v52, 0x41f00000, v52
  v_min_f32 v54, 0x41f00000, v54
  v_exp_f32 v48, v48
  v_exp_f32 v50, v50
  v_exp_f32 v52, v52
  s_waitcnt lgkmcnt(2)
  v_mfma_f32_32x32x16_bf16 v[96:111], a[104:107], v[20:23], v[96:111]
  ds_read_b128 v[16:19], v12 offset:16384
  v_exp_f32 v54, v54
  v_add_f32 v49, 2.0, v48
  v_add_f32 v51, 2.0, v50
  v_add_f32 v53, 2.0, v52
  v_add_f32 v55, 2.0, v54
  v_mfma_f32_32x32x16_bf16 v[112:127], a[108:111], v[20:23], v[112:127]
  v_mul_f32 v48, v48, v49
  v_mul_f32 v50, v50, v51
  v_mul_f32 v52, v52, v53
  v_mul_f32 v54, v54, v55
  v_add_f32 v49, 2.0, v48
  s_waitcnt lgkmcnt(2)
  v_mfma_f32_32x32x16_bf16 v[96:111], a[112:115], v[24:27], v[96:111]
  ds_read_b128 v[20:23], v12 offset:17408
  v_add_f32 v51, 2.0, v50
  v_add_f32 v53, 2.0, v52
  v_add_f32 v55, 2.0, v54
  v_rcp_f32 v49, v49
  v_rcp_f32 v51, v51
  v_mfma_f32_32x32x16_bf16 v[112:127], a[116:119], v[24:27], v[112:127]
  v_rcp_f32 v53, v53
  v_rcp_f32 v55, v55
  v_mul_f32 v136, v136, v48
  v_mul_f32 v137, v137, v50
  v_mul_f32 v138, v138, v52
  s_waitcnt lgkmcnt(2)
  v_mfma_f32_32x32x16_bf16 v[96:111], a[120:123], v[28:31], v[96:111]
  ds_read_b128 v[24:27], v12 offset:18432
  v_mul_f32 v139, v139, v54
  v_mul_f32 v136, v136, v49
  v_mul_f32 v137, v137, v51
  v_mul_f32 v138, v138, v53
  v_mul_f32 v139, v139, v55
  v_mfma_f32_32x32x16_bf16 v[112:127], a[124:127], v[28:31], v[112:127]
  buffer_load_dwordx4 v1, s[4:7], s53 offen offset:1024 sc1 lds
  v_add_f32 v140, v140, v172
  v_add_f32 v141, v141, v173
  v_add_f32 v142, v142, v174
  v_add_f32 v143, v143, v175
  v_mul_f32 v48, 0x3fb8aa3b, v140
  s_waitcnt lgkmcnt(2)
  v_mfma_f32_32x32x16_bf16 v[96:111], a[128:131], v[16:19], v[96:111]
  ds_read_b128 v[28:31], v12 offset:19456
  v_mul_f32 v50, 0x3fb8aa3b, v141
  v_mul_f32 v52, 0x3fb8aa3b, v142
  v_mul_f32 v54, 0x3fb8aa3b, v143
  v_min_f32 v48, 0x41f00000, v48
  v_min_f32 v50, 0x41f00000, v50
  v_mfma_f32_32x32x16_bf16 v[112:127], a[132:135], v[16:19], v[112:127]
  v_min_f32 v52, 0x41f00000, v52
  v_min_f32 v54, 0x41f00000, v54
  v_exp_f32 v48, v48
  v_exp_f32 v50, v50
  v_exp_f32 v52, v52
  s_waitcnt lgkmcnt(2)
  v_mfma_f32_32x32x16_bf16 v[96:111], a[136:139], v[20:23], v[96:111]
  ds_read_b128 v[16:19], v12 offset:20480
  v_exp_f32 v54, v54
  v_add_f32 v49, 2.0, v48
  v_add_f32 v51, 2.0, v50
  v_add_f32 v53, 2.0, v52
  v_add_f32 v55, 2.0, v54
  v_mfma_f32_32x32x16_bf16 v[112:127], a[140:143], v[20:23], v[112:127]
  v_mul_f32 v48, v48, v49
  v_mul_f32 v50, v50, v51
  v_mul_f32 v52, v52, v53
  v_mul_f32 v54, v54, v55
  v_add_f32 v49, 2.0, v48
  s_waitcnt lgkmcnt(2)
  v_mfma_f32_32x32x16_bf16 v[96:111], a[144:147], v[24:27], v[96:111]
  ds_read_b128 v[20:23], v12 offset:21504
  v_add_f32 v51, 2.0, v50
  v_add_f32 v53, 2.0, v52
  v_add_f32 v55, 2.0, v54
  v_rcp_f32 v49, v49
  v_rcp_f32 v51, v51
  v_mfma_f32_32x32x16_bf16 v[112:127], a[148:151], v[24:27], v[112:127]
  buffer_load_dwordx4 v1, s[4:7], s53 offen offset:2048 sc1 lds
  v_rcp_f32 v53, v53
  v_rcp_f32 v55, v55
  v_mul_f32 v140, v140, v48
  v_mul_f32 v141, v141, v50
  v_mul_f32 v142, v142, v52
  s_waitcnt lgkmcnt(2)
  v_mfma_f32_32x32x16_bf16 v[96:111], a[152:155], v[28:31], v[96:111]
  ds_read_b128 v[24:27], v12 offset:22528
  v_mul_f32 v143, v143, v54
  v_mul_f32 v140, v140, v49
  v_mul_f32 v141, v141, v51
  v_mul_f32 v142, v142, v53
  v_mul_f32 v143, v143, v55
  v_mfma_f32_32x32x16_bf16 v[112:127], a[156:159], v[28:31], v[112:127]
  v_cvt_pk_bf16_f32 v44, v136, v137
  v_cvt_pk_bf16_f32 v45, v138, v139
  v_cvt_pk_bf16_f32 v46, v140, v141
  v_cvt_pk_bf16_f32 v47, v142, v143
  buffer_store_dwordx4 v[44:47], v6, s[4:7], s25 offen offset:512 sc1
  s_waitcnt lgkmcnt(2)
  v_mfma_f32_32x32x16_bf16 v[96:111], a[160:163], v[16:19], v[96:111]
  ds_read_b128 v[28:31], v12 offset:23552
  v_add_f32 v144, v144, v176
  v_add_f32 v145, v145, v177
  v_add_f32 v146, v146, v178
  v_add_f32 v147, v147, v179
  v_mul_f32 v48, 0x3fb8aa3b, v144
  v_mfma_f32_32x32x16_bf16 v[112:127], a[164:167], v[16:19], v[112:127]
  v_mul_f32 v50, 0x3fb8aa3b, v145
  v_mul_f32 v52, 0x3fb8aa3b, v146
  v_mul_f32 v54, 0x3fb8aa3b, v147
  v_min_f32 v48, 0x41f00000, v48
  v_min_f32 v50, 0x41f00000, v50
  s_waitcnt lgkmcnt(2)
  v_mfma_f32_32x32x16_bf16 v[96:111], a[168:171], v[20:23], v[96:111]
  ds_read_b128 v[16:19], v12 offset:24576
  v_min_f32 v52, 0x41f00000, v52
  v_min_f32 v54, 0x41f00000, v54
  v_exp_f32 v48, v48
  v_exp_f32 v50, v50
  v_exp_f32 v52, v52
  v_mfma_f32_32x32x16_bf16 v[112:127], a[172:175], v[20:23], v[112:127]
  buffer_load_dwordx4 v1, s[4:7], s53 offen offset:3072 sc1 lds
  v_exp_f32 v54, v54
  v_add_f32 v49, 2.0, v48
  v_add_f32 v51, 2.0, v50
  v_add_f32 v53, 2.0, v52
  v_add_f32 v55, 2.0, v54
  s_waitcnt lgkmcnt(2)
  v_mfma_f32_32x32x16_bf16 v[96:111], a[176:179], v[24:27], v[96:111]
  ds_read_b128 v[20:23], v12 offset:25600
  v_mul_f32 v48, v48, v49
  v_mul_f32 v50, v50, v51
  v_mul_f32 v52, v52, v53
  v_mul_f32 v54, v54, v55
  v_add_f32 v49, 2.0, v48
  v_mfma_f32_32x32x16_bf16 v[112:127], a[180:183], v[24:27], v[112:127]
  v_add_f32 v51, 2.0, v50
  v_add_f32 v53, 2.0, v52
  v_add_f32 v55, 2.0, v54
  v_rcp_f32 v49, v49
  v_rcp_f32 v51, v51
  s_waitcnt lgkmcnt(2)
  v_mfma_f32_32x32x16_bf16 v[96:111], a[184:187], v[28:31], v[96:111]
  ds_read_b128 v[24:27], v12 offset:26624
  v_rcp_f32 v53, v53
  v_rcp_f32 v55, v55
  v_mul_f32 v144, v144, v48
  v_mul_f32 v145, v145, v50
  v_mul_f32 v146, v146, v52
  v_mfma_f32_32x32x16_bf16 v[112:127], a[188:191], v[28:31], v[112:127]
  v_mul_f32 v147, v147, v54
  v_mul_f32 v144, v144, v49
  v_mul_f32 v145, v145, v51
  v_mul_f32 v146, v146, v53
  v_mul_f32 v147, v147, v55
  s_waitcnt lgkmcnt(2)
  v_mfma_f32_32x32x16_bf16 v[96:111], a[192:195], v[16:19], v[96:111]
  ds_read_b128 v[28:31], v12 offset:27648
  v_add_f32 v148, v148, v180
  v_add_f32 v149, v149, v181
  v_add_f32 v150, v150, v182
  v_add_f32 v151, v151, v183
  v_mul_f32 v48, 0x3fb8aa3b, v148
  v_mfma_f32_32x32x16_bf16 v[112:127], a[196:199], v[16:19], v[112:127]
  s_add_u32 s53, s27, 8192
  s_add_u32 m0, s52, 8192
  s_nop 0
  buffer_load_dwordx4 v1, s[4:7], s53 offen offset:0 sc1 lds
  v_mul_f32 v50, 0x3fb8aa3b, v149
  v_mul_f32 v52, 0x3fb8aa3b, v150
  v_mul_f32 v54, 0x3fb8aa3b, v151
  v_min_f32 v48, 0x41f00000, v48
  v_min_f32 v50, 0x41f00000, v50
  s_waitcnt lgkmcnt(2)
  v_mfma_f32_32x32x16_bf16 v[96:111], a[200:203], v[20:23], v[96:111]
  ds_read_b128 v[16:19], v12 offset:28672
  v_min_f32 v52, 0x41f00000, v52
  v_min_f32 v54, 0x41f00000, v54
  v_exp_f32 v48, v48
  v_exp_f32 v50, v50
  v_exp_f32 v52, v52
  v_mfma_f32_32x32x16_bf16 v[112:127], a[204:207], v[20:23], v[112:127]
  v_exp_f32 v54, v54
  v_add_f32 v49, 2.0, v48
  v_add_f32 v51, 2.0, v50
  v_add_f32 v53, 2.0, v52
  v_add_f32 v55, 2.0, v54
  s_waitcnt lgkmcnt(2)
  v_mfma_f32_32x32x16_bf16 v[96:111], a[208:211], v[24:27], v[96:111]
  ds_read_b128 v[20:23], v12 offset:29696
  v_mul_f32 v48, v48, v49
  v_mul_f32 v50, v50, v51
  v_mul_f32 v52, v52, v53
  v_mul_f32 v54, v54, v55
  v_add_f32 v49, 2.0, v48
  v_mfma_f32_32x32x16_bf16 v[112:127], a[212:215], v[24:27], v[112:127]
  v_add_f32 v51, 2.0, v50
  v_add_f32 v53, 2.0, v52
  v_add_f32 v55, 2.0, v54
  v_rcp_f32 v49, v49
  v_rcp_f32 v51, v51
  s_waitcnt lgkmcnt(2)
  v_mfma_f32_32x32x16_bf16 v[96:111], a[216:219], v[28:31], v[96:111]
  ds_read_b128 v[24:27], v12 offset:30720
  v_rcp_f32 v53, v53
  v_rcp_f32 v55, v55
  v_mul_f32 v148, v148, v48
  v_mul_f32 v149, v149, v50
  v_mul_f32 v150, v150, v52
  v_mfma_f32_32x32x16_bf16 v[112:127], a[220:223], v[28:31], v[112:127]
  buffer_load_dwordx4 v1, s[4:7], s53 offen offset:1024 sc1 lds
  s_add_u32 s27, s27, 40960
  s_min_u32 s27, s27, s34
  s_add_u32 s33, s33, 40960
  s_cmp_eq_u32 s33, 122880
  s_cselect_b32 s33, 0, s33
  v_mul_f32 v151, v151, v54
  v_mul_f32 v148, v148, v49
  v_mul_f32 v149, v149, v51
  v_mul_f32 v150, v150, v53
  v_mul_f32 v151, v151, v55
  s_waitcnt lgkmcnt(2)
  v_mfma_f32_32x32x16_bf16 v[96:111], a[224:227], v[16:19], v[96:111]
  ds_read_b128 v[28:31], v12 offset:31744
  v_cvt_pk_bf16_f32 v40, v144, v145
  v_cvt_pk_bf16_f32 v41, v146, v147
  v_cvt_pk_bf16_f32 v42, v148, v149
  v_cvt_pk_bf16_f32 v43, v150, v151
  buffer_store_dwordx4 v[40:43], v6, s[4:7], s25 offen offset:1024 sc1
  v_mfma_f32_32x32x16_bf16 v[112:127], a[228:231], v[16:19], v[112:127]
  v_add_f32 v152, v152, v184
  v_add_f32 v153, v153, v185
  v_add_f32 v154, v154, v186
  v_add_f32 v155, v155, v187
  v_mul_f32 v48, 0x3fb8aa3b, v152
  s_waitcnt lgkmcnt(2)
  v_mfma_f32_32x32x16_bf16 v[96:111], a[232:235], v[20:23], v[96:111]
  ds_read_b128 v[16:19], v12 offset:32768
  v_mul_f32 v50, 0x3fb8aa3b, v153
  v_mul_f32 v52, 0x3fb8aa3b, v154
  v_mul_f32 v54, 0x3fb8aa3b, v155
  v_min_f32 v48, 0x41f00000, v48
  v_min_f32 v50, 0x41f00000, v50
  v_mfma_f32_32x32x16_bf16 v[112:127], a[236:239], v[20:23], v[112:127]
  v_min_f32 v52, 0x41f00000, v52
  v_min_f32 v54, 0x41f00000, v54
  v_exp_f32 v48, v48
  v_exp_f32 v50, v50
  v_exp_f32 v52, v52
  s_waitcnt lgkmcnt(2)
  v_mfma_f32_32x32x16_bf16 v[96:111], a[240:243], v[24:27], v[96:111]
  ds_read_b128 v[20:23], v12 offset:33792
  v_exp_f32 v54, v54
  v_add_f32 v49, 2.0, v48
  v_add_f32 v51, 2.0, v50
  v_add_f32 v53, 2.0, v52
  v_add_f32 v55, 2.0, v54
  v_mfma_f32_32x32x16_bf16 v[112:127], a[244:247], v[24:27], v[112:127]
  v_mul_f32 v48, v48, v49
  v_mul_f32 v50, v50, v51
  v_mul_f32 v52, v52, v53
  v_mul_f32 v54, v54, v55
  v_add_f32 v49, 2.0, v48
  s_waitcnt lgkmcnt(2)
  v_mfma_f32_32x32x16_bf16 v[96:111], a[248:251], v[28:31], v[96:111]
  ds_read_b128 v[24:27], v12 offset:34816
  v_add_f32 v51, 2.0, v50
  v_add_f32 v53, 2.0, v52
  v_add_f32 v55, 2.0, v54
  v_rcp_f32 v49, v49
  v_rcp_f32 v51, v51
  v_mfma_f32_32x32x16_bf16 v[112:127], a[252:255], v[28:31], v[112:127]
  v_rcp_f32 v53, v53
  v_rcp_f32 v55, v55
  v_mul_f32 v152, v152, v48
  v_mul_f32 v153, v153, v50
  v_mul_f32 v154, v154, v52
  s_waitcnt lgkmcnt(2)
  v_mfma_f32_32x32x16_bf16 v[96:111], v[192:195], v[16:19], v[96:111]
  ds_read_b128 v[28:31], v12 offset:35840
  v_mul_f32 v155, v155, v54
  v_mul_f32 v152, v152, v49
  v_mul_f32 v153, v153, v51
  v_mul_f32 v154, v154, v53
  v_mul_f32 v155, v155, v55
  v_mfma_f32_32x32x16_bf16 v[112:127], v[196:199], v[16:19], v[112:127]
  v_add_f32 v156, v156, v188
  v_add_f32 v157, v157, v189
  v_add_f32 v158, v158, v190
  v_add_f32 v159, v159, v191
  v_mul_f32 v48, 0x3fb8aa3b, v156
  s_waitcnt lgkmcnt(2)
  v_mfma_f32_32x32x16_bf16 v[96:111], v[200:203], v[20:23], v[96:111]
  ds_read_b128 v[16:19], v12 offset:36864
  v_mul_f32 v50, 0x3fb8aa3b, v157
  v_mul_f32 v52, 0x3fb8aa3b, v158
  v_mul_f32 v54, 0x3fb8aa3b, v159
  v_min_f32 v48, 0x41f00000, v48
  v_min_f32 v50, 0x41f00000, v50
  v_mfma_f32_32x32x16_bf16 v[112:127], v[204:207], v[20:23], v[112:127]
  v_min_f32 v52, 0x41f00000, v52
  v_min_f32 v54, 0x41f00000, v54
  v_exp_f32 v48, v48
  v_exp_f32 v50, v50
  v_exp_f32 v52, v52
  s_waitcnt lgkmcnt(2)
  v_mfma_f32_32x32x16_bf16 v[96:111], v[208:211], v[24:27], v[96:111]
  ds_read_b128 v[20:23], v12 offset:37888
  v_exp_f32 v54, v54
  v_add_f32 v49, 2.0, v48
  v_add_f32 v51, 2.0, v50
  v_add_f32 v53, 2.0, v52
  v_add_f32 v55, 2.0, v54
  v_mfma_f32_32x32x16_bf16 v[112:127], v[212:215], v[24:27], v[112:127]
  v_mul_f32 v48, v48, v49
  v_mul_f32 v50, v50, v51
  v_mul_f32 v52, v52, v53
  v_mul_f32 v54, v54, v55
  v_add_f32 v49, 2.0, v48
  s_waitcnt lgkmcnt(2)
  v_mfma_f32_32x32x16_bf16 v[96:111], v[216:219], v[28:31], v[96:111]
  ds_read_b128 v[24:27], v12 offset:38912
  v_add_f32 v51, 2.0, v50
  v_add_f32 v53, 2.0, v52
  v_add_f32 v55, 2.0, v54
  v_rcp_f32 v49, v49
  v_rcp_f32 v51, v51
  v_mfma_f32_32x32x16_bf16 v[112:127], v[220:223], v[28:31], v[112:127]
  v_rcp_f32 v53, v53
  v_rcp_f32 v55, v55
  v_mul_f32 v156, v156, v48
  v_mul_f32 v157, v157, v50
  v_mul_f32 v158, v158, v52
  s_waitcnt lgkmcnt(2)
  v_mfma_f32_32x32x16_bf16 v[96:111], v[224:227], v[16:19], v[96:111]
  ds_read_b128 v[28:31], v12 offset:39936
  v_mul_f32 v159, v159, v54
  v_mul_f32 v156, v156, v49
  v_mul_f32 v157, v157, v51
  v_mul_f32 v158, v158, v53
  v_mul_f32 v159, v159, v55
  v_mfma_f32_32x32x16_bf16 v[112:127], v[228:231], v[16:19], v[112:127]
  v_cvt_pk_bf16_f32 v44, v152, v153
  v_cvt_pk_bf16_f32 v45, v154, v155
  v_cvt_pk_bf16_f32 v46, v156, v157
  v_cvt_pk_bf16_f32 v47, v158, v159
  buffer_store_dwordx4 v[44:47], v6, s[4:7], s25 offen offset:1536 sc1
  s_waitcnt lgkmcnt(2)
  v_mfma_f32_32x32x16_bf16 v[96:111], v[232:235], v[20:23], v[96:111]
  v_mfma_f32_32x32x16_bf16 v[112:127], v[236:239], v[20:23], v[112:127]
  s_waitcnt lgkmcnt(1)
  v_mfma_f32_32x32x16_bf16 v[96:111], v[240:243], v[24:27], v[96:111]
  v_mfma_f32_32x32x16_bf16 v[112:127], v[244:247], v[24:27], v[112:127]
  s_waitcnt lgkmcnt(0)
  v_mfma_f32_32x32x16_bf16 v[96:111], v[248:251], v[28:31], v[96:111]
  v_mfma_f32_32x32x16_bf16 v[112:127], v[252:255], v[28:31], v[112:127]
  s_add_u32 s32, s32, 40960
  s_cmp_eq_u32 s32, 122880
  s_cselect_b32 s32, 0, s32
  s_add_u32 s29, s29, 1
  s_waitcnt vmcnt(14)
  s_barrier
  s_sub_u32 s49, s29, 2
  s_max_i32 s49, s49, 0
  s_cmp_lg_u32 s13, 0
  s_cbranch_scc1 PB_58
  v_mov_b32 v8, s49
  v_mov_b32 v9, s26
  buffer_store_dword v8, v9, s[4:7], 0 offen sc1
PB_58:
  s_add_u32 s47, s24, s29
  s_sub_u32 s47, s47, 1
  s_mul_i32 s25, s47, 114688
  s_add_u32 s25, s25, s31
  v_add_u32 v12, s32, v1
  ds_read_b128 v[16:19], v12 offset:0
  ds_read_b128 v[20:23], v12 offset:1024
  ds_read_b128 v[24:27], v12 offset:2048
  s_waitcnt lgkmcnt(2)
  v_mfma_f32_32x32x16_bf16 v[128:143], a[0:3], v[16:19], 0
  ds_read_b128 v[28:31], v12 offset:3072
  v_mfma_f32_32x32x16_bf16 v[144:159], a[4:7], v[16:19], 0
  s_add_u32 s52, s33, s30
  s_add_u32 s53, s27, 0
  s_add_u32 m0, s52, 0
  s_nop 0
  buffer_load_dwordx4 v1, s[4:7], s53 offen offset:0 sc1 lds
  s_waitcnt lgkmcnt(2)
  v_mfma_f32_32x32x16_bf16 v[128:143], a[8:11], v[20:23], v[128:143]
  ds_read_b128 v[16:19], v12 offset:4096
  v_mfma_f32_32x32x16_bf16 v[144:159], a[12:15], v[20:23], v[144:159]
  s_waitcnt lgkmcnt(2)
  v_mfma_f32_32x32x16_bf16 v[128:143], a[16:19], v[24:27], v[128:143]
  ds_read_b128 v[20:23], v12 offset:5120
  v_mfma_f32_32x32x16_bf16 v[144:159], a[20:23], v[24:27], v[144:159]
  s_waitcnt lgkmcnt(2)
  v_mfma_f32_32x32x16_bf16 v[128:143], a[24:27], v[28:31], v[128:143]
  ds_read_b128 v[24:27], v12 offset:6144
  v_add_f32 v96, v96, v160
  v_add_f32 v97, v97, v161
  v_add_f32 v98, v98, v162
  v_add_f32 v99, v99, v163
  v_mul_f32 v48, 0x3fb8aa3b, v96
  v_mfma_f32_32x32x16_bf16 v[144:159], a[28:31], v[28:31], v[144:159]
  buffer_load_dwordx4 v1, s[4:7], s53 offen offset:1024 sc1 lds
  v_mul_f32 v50, 0x3fb8aa3b, v97
  v_mul_f32 v52, 0x3fb8aa3b, v98
  v_mul_f32 v54, 0x3fb8aa3b, v99
  v_min_f32 v48, 0x41f00000, v48
  v_min_f32 v50, 0x41f00000, v50
  s_waitcnt lgkmcnt(2)
  v_mfma_f32_32x32x16_bf16 v[128:143], a[32:35], v[16:19], v[128:143]
  ds_read_b128 v[28:31], v12 offset:7168
  v_min_f32 v52, 0x41f00000, v52
  v_min_f32 v54, 0x41f00000, v54
  v_exp_f32 v48, v48
  v_exp_f32 v50, v50
  v_exp_f32 v52, v52
  v_mfma_f32_32x32x16_bf16 v[144:159], a[36:39], v[16:19], v[144:159]
  v_exp_f32 v54, v54
  v_add_f32 v49, 2.0, v48
  v_add_f32 v51, 2.0, v50
  v_add_f32 v53, 2.0, v52
  v_add_f32 v55, 2.0, v54
  s_waitcnt lgkmcnt(2)
  v_mfma_f32_32x32x16_bf16 v[128:143], a[40:43], v[20:23], v[128:143]
  ds_read_b128 v[16:19], v12 offset:8192
  v_mul_f32 v48, v48, v49
  v_mul_f32 v50, v50, v51
  v_mul_f32 v52, v52, v53
  v_mul_f32 v54, v54, v55
  v_add_f32 v49, 2.0, v48
  v_mfma_f32_32x32x16_bf16 v[144:159], a[44:47], v[20:23], v[144:159]
  v_add_f32 v51, 2.0, v50
  v_add_f32 v53, 2.0, v52
  v_add_f32 v55, 2.0, v54
  v_rcp_f32 v49, v49
  v_rcp_f32 v51, v51
  s_waitcnt lgkmcnt(2)
  v_mfma_f32_32x32x16_bf16 v[128:143], a[48:51], v[24:27], v[128:143]
  ds_read_b128 v[20:23], v12 offset:9216
  v_rcp_f32 v53, v53
  v_rcp_f32 v55, v55
  v_mul_f32 v96, v96, v48
  v_mul_f32 v97, v97, v50
  v_mul_f32 v98, v98, v52
  v_mfma_f32_32x32x16_bf16 v[144:159], a[52:55], v[24:27], v[144:159]
  buffer_load_dwordx4 v1, s[4:7], s53 offen offset:2048 sc1 lds
  v_mul_f32 v99, v99, v54
  v_mul_f32 v96, v96, v49
  v_mul_f32 v97, v97, v51
  v_mul_f32 v98, v98, v53
  v_mul_f32 v99, v99, v55
  s_waitcnt lgkmcnt(2)
  v_mfma_f32_32x32x16_bf16 v[128:143], a[56:59], v[28:31], v[128:143]
  ds_read_b128 v[24:27], v12 offset:10240
  v_add_f32 v100, v100, v164
  v_add_f32 v101, v101, v165
  v_add_f32 v102, v102, v166
  v_add_f32 v103, v103, v167
  v_mul_f32 v48, 0x3fb8aa3b, v100
  v_mfma_f32_32x32x16_bf16 v[144:159], a[60:63], v[28:31], v[144:159]
  v_mul_f32 v50, 0x3fb8aa3b, v101
  v_mul_f32 v52, 0x3fb8aa3b, v102
  v_mul_f32 v54, 0x3fb8aa3b, v103
  v_min_f32 v48, 0x41f00000, v48
  v_min_f32 v50, 0x41f00000, v50
  s_waitcnt lgkmcnt(2)
  v_mfma_f32_32x32x16_bf16 v[128:143], a[64:67], v[16:19], v[128:143]
  ds_read_b128 v[28:31], v12 offset:11264
  v_min_f32 v52, 0x41f00000, v52
  v_min_f32 v54, 0x41f00000, v54
  v_exp_f32 v48, v48
  v_exp_f32 v50, v50
  v_exp_f32 v52, v52
  v_mfma_f32_32x32x16_bf16 v[144:159], a[68:71], v[16:19], v[144:159]
  v_exp_f32 v54, v54
  v_add_f32 v49, 2.0, v48
  v_add_f32 v51, 2.0, v50
  v_add_f32 v53, 2.0, v52
  v_add_f32 v55, 2.0, v54
  s_waitcnt lgkmcnt(2)
  v_mfma_f32_32x32x16_bf16 v[128:143], a[72:75], v[20:23], v[128:143]
  ds_read_b128 v[16:19], v12 offset:12288
  v_mul_f32 v48, v48, v49
  v_mul_f32 v50, v50, v51
  v_mul_f32 v52, v52, v53
  v_mul_f32 v54, v54, v55
  v_add_f32 v49, 2.0, v48
  v_mfma_f32_32x32x16_bf16 v[144:159], a[76:79], v[20:23], v[144:159]
  buffer_load_dwordx4 v1, s[4:7], s53 offen offset:3072 sc1 lds
  v_add_f32 v51, 2.0, v50
  v_add_f32 v53, 2.0, v52
  v_add_f32 v55, 2.0, v54
  v_rcp_f32 v49, v49
  v_rcp_f32 v51, v51
  s_waitcnt lgkmcnt(2)
  v_mfma_f32_32x32x16_bf16 v[128:143], a[80:83], v[24:27], v[128:143]
  ds_read_b128 v[20:23], v12 offset:13312
  v_rcp_f32 v53, v53
  v_rcp_f32 v55, v55
  v_mul_f32 v100, v100, v48
  v_mul_f32 v101, v101, v50
  v_mul_f32 v102, v102, v52
  v_mfma_f32_32x32x16_bf16 v[144:159], a[84:87], v[24:27], v[144:159]
  v_mul_f32 v103, v103, v54
  v_mul_f32 v100, v100, v49
  v_mul_f32 v101, v101, v51
  v_mul_f32 v102, v102, v53
  v_mul_f32 v103, v103, v55
  s_waitcnt lgkmcnt(2)
  v_mfma_f32_32x32x16_bf16 v[128:143], a[88:91], v[28:31], v[128:143]
  ds_read_b128 v[24:27], v12 offset:14336
  v_cvt_pk_bf16_f32 v40, v96, v97
  v_cvt_pk_bf16_f32 v41, v98, v99
  v_cvt_pk_bf16_f32 v42, v100, v101
  v_cvt_pk_bf16_f32 v43, v102, v103
  buffer_store_dwordx4 v[40:43], v6, s[4:7], s25 offen offset:0 sc1
  v_mfma_f32_32x32x16_bf16 v[144:159], a[92:95], v[28:31], v[144:159]
  v_add_f32 v104, v104, v168
  v_add_f32 v105, v105, v169
  v_add_f32 v106, v106, v170
  v_add_f32 v107, v107, v171
  v_mul_f32 v48, 0x3fb8aa3b, v104
  s_waitcnt lgkmcnt(2)
  v_mfma_f32_32x32x16_bf16 v[128:143], a[96:99], v[16:19], v[128:143]
  ds_read_b128 v[28:31], v12 offset:15360
  v_mul_f32 v50, 0x3fb8aa3b, v105
  v_mul_f32 v52, 0x3fb8aa3b, v106
  v_mul_f32 v54, 0x3fb8aa3b, v107
  v_min_f32 v48, 0x41f00000, v48
  v_min_f32 v50, 0x41f00000, v50
  v_mfma_f32_32x32x16_bf16 v[144:159], a[100:103], v[16:19], v[144:159]
  s_add_u32 s53, s27, 4096
  s_add_u32 m0, s52, 4096
  s_nop 0
  buffer_load_dwordx4 v1, s[4:7], s53 offen offset:0 sc1 lds
  v_min_f32 v52, 0x41f00000, v52
  v_min_f32 v54, 0x41f00000, v54
  v_exp_f32 v48, v48
  v_exp_f32 v50, v50
  v_exp_f32 v52, v52
  s_waitcnt lgkmcnt(2)
  v_mfma_f32_32x32x16_bf16 v[128:143], a[104:107], v[20:23], v[128:143]
  ds_read_b128 v[16:19], v12 offset:16384
  v_exp_f32 v54, v54
  v_add_f32 v49, 2.0, v48
  v_add_f32 v51, 2.0, v50
  v_add_f32 v53, 2.0, v52
  v_add_f32 v55, 2.0, v54
  v_mfma_f32_32x32x16_bf16 v[144:159], a[108:111], v[20:23], v[144:159]
  v_mul_f32 v48, v48, v49
  v_mul_f32 v50, v50, v51
  v_mul_f32 v52, v52, v53
  v_mul_f32 v54, v54, v55
  v_add_f32 v49, 2.0, v48
  s_waitcnt lgkmcnt(2)
  v_mfma_f32_32x32x16_bf16 v[128:143], a[112:115], v[24:27], v[128:143]
  ds_read_b128 v[20:23], v12 offset:17408
  v_add_f32 v51, 2.0, v50
  v_add_f32 v53, 2.0, v52
  v_add_f32 v55, 2.0, v54
  v_rcp_f32 v49, v49
  v_rcp_f32 v51, v51
  v_mfma_f32_32x32x16_bf16 v[144:159], a[116:119], v[24:27], v[144:159]
  v_rcp_f32 v53, v53
  v_rcp_f32 v55, v55
  v_mul_f32 v104, v104, v48
  v_mul_f32 v105, v105, v50
  v_mul_f32 v106, v106, v52
  s_waitcnt lgkmcnt(2)
  v_mfma_f32_32x32x16_bf16 v[128:143], a[120:123], v[28:31], v[128:143]
  ds_read_b128 v[24:27], v12 offset:18432
  v_mul_f32 v107, v107, v54
  v_mul_f32 v104, v104, v49
  v_mul_f32 v105, v105, v51
  v_mul_f32 v106, v106, v53
  v_mul_f32 v107, v107, v55
  v_mfma_f32_32x32x16_bf16 v[144:159], a[124:127], v[28:31], v[144:159]
  buffer_load_dwordx4 v1, s[4:7], s53 offen offset:1024 sc1 lds
  v_add_f32 v108, v108, v172
  v_add_f32 v109, v109, v173
  v_add_f32 v110, v110, v174
  v_add_f32 v111, v111, v175
  v_mul_f32 v48, 0x3fb8aa3b, v108
  s_waitcnt lgkmcnt(2)
  v_mfma_f32_32x32x16_bf16 v[128:143], a[128:131], v[16:19], v[128:143]
  ds_read_b128 v[28:31], v12 offset:19456
  v_mul_f32 v50, 0x3fb8aa3b, v109
  v_mul_f32 v52, 0x3fb8aa3b, v110
  v_mul_f32 v54, 0x3fb8aa3b, v111
  v_min_f32 v48, 0x41f00000, v48
  v_min_f32 v50, 0x41f00000, v50
  v_mfma_f32_32x32x16_bf16 v[144:159], a[132:135], v[16:19], v[144:159]
  v_min_f32 v52, 0x41f00000, v52
  v_min_f32 v54, 0x41f00000, v54
  v_exp_f32 v48, v48
  v_exp_f32 v50, v50
  v_exp_f32 v52, v52
  s_waitcnt lgkmcnt(2)
  v_mfma_f32_32x32x16_bf16 v[128:143], a[136:139], v[20:23], v[128:143]
  ds_read_b128 v[16:19], v12 offset:20480
  v_exp_f32 v54, v54
  v_add_f32 v49, 2.0, v48
  v_add_f32 v51, 2.0, v50
  v_add_f32 v53, 2.0, v52
  v_add_f32 v55, 2.0, v54
  v_mfma_f32_32x32x16_bf16 v[144:159], a[140:143], v[20:23], v[144:159]
  v_mul_f32 v48, v48, v49
  v_mul_f32 v50, v50, v51
  v_mul_f32 v52, v52, v53
  v_mul_f32 v54, v54, v55
  v_add_f32 v49, 2.0, v48
  s_waitcnt lgkmcnt(2)
  v_mfma_f32_32x32x16_bf16 v[128:143], a[144:147], v[24:27], v[128:143]
  ds_read_b128 v[20:23], v12 offset:21504
  v_add_f32 v51, 2.0, v50
  v_add_f32 v53, 2.0, v52
  v_add_f32 v55, 2.0, v54
  v_rcp_f32 v49, v49
  v_rcp_f32 v51, v51
  v_mfma_f32_32x32x16_bf16 v[144:159], a[148:151], v[24:27], v[144:159]
  buffer_load_dwordx4 v1, s[4:7], s53 offen offset:2048 sc1 lds
  v_rcp_f32 v53, v53
  v_rcp_f32 v55, v55
  v_mul_f32 v108, v108, v48
  v_mul_f32 v109, v109, v50
  v_mul_f32 v110, v110, v52
  s_waitcnt lgkmcnt(2)
  v_mfma_f32_32x32x16_bf16 v[128:143], a[152:155], v[28:31], v[128:143]
  ds_read_b128 v[24:27], v12 offset:22528
  v_mul_f32 v111, v111, v54
  v_mul_f32 v108, v108, v49
  v_mul_f32 v109, v109, v51
  v_mul_f32 v110, v110, v53
  v_mul_f32 v111, v111, v55
  v_mfma_f32_32x32x16_bf16 v[144:159], a[156:159], v[28:31], v[144:159]
  v_cvt_pk_bf16_f32 v44, v104, v105
  v_cvt_pk_bf16_f32 v45, v106, v107
  v_cvt_pk_bf16_f32 v46, v108, v109
  v_cvt_pk_bf16_f32 v47, v110, v111
  buffer_store_dwordx4 v[44:47], v6, s[4:7], s25 offen offset:512 sc1
  s_waitcnt lgkmcnt(2)
  v_mfma_f32_32x32x16_bf16 v[128:143], a[160:163], v[16:19], v[128:143]
  ds_read_b128 v[28:31], v12 offset:23552
  v_add_f32 v112, v112, v176
  v_add_f32 v113, v113, v177
  v_add_f32 v114, v114, v178
  v_add_f32 v115, v115, v179
  v_mul_f32 v48, 0x3fb8aa3b, v112
  v_mfma_f32_32x32x16_bf16 v[144:159], a[164:167], v[16:19], v[144:159]
  v_mul_f32 v50, 0x3fb8aa3b, v113
  v_mul_f32 v52, 0x3fb8aa3b, v114
  v_mul_f32 v54, 0x3fb8aa3b, v115
  v_min_f32 v48, 0x41f00000, v48
  v_min_f32 v50, 0x41f00000, v50
  s_waitcnt lgkmcnt(2)
  v_mfma_f32_32x32x16_bf16 v[128:143], a[168:171], v[20:23], v[128:143]
  ds_read_b128 v[16:19], v12 offset:24576
  v_min_f32 v52, 0x41f00000, v52
  v_min_f32 v54, 0x41f00000, v54
  v_exp_f32 v48, v48
  v_exp_f32 v50, v50
  v_exp_f32 v52, v52
  v_mfma_f32_32x32x16_bf16 v[144:159], a[172:175], v[20:23], v[144:159]
  buffer_load_dwordx4 v1, s[4:7], s53 offen offset:3072 sc1 lds
  v_exp_f32 v54, v54
  v_add_f32 v49, 2.0, v48
  v_add_f32 v51, 2.0, v50
  v_add_f32 v53, 2.0, v52
  v_add_f32 v55, 2.0, v54
  s_waitcnt lgkmcnt(2)
  v_mfma_f32_32x32x16_bf16 v[128:143], a[176:179], v[24:27], v[128:143]
  ds_read_b128 v[20:23], v12 offset:25600
  v_mul_f32 v48, v48, v49
  v_mul_f32 v50, v50, v51
  v_mul_f32 v52, v52, v53
  v_mul_f32 v54, v54, v55
  v_add_f32 v49, 2.0, v48
  v_mfma_f32_32x32x16_bf16 v[144:159], a[180:183], v[24:27], v[144:159]
  v_add_f32 v51, 2.0, v50
  v_add_f32 v53, 2.0, v52
  v_add_f32 v55, 2.0, v54
  v_rcp_f32 v49, v49
  v_rcp_f32 v51, v51
  s_waitcnt lgkmcnt(2)
  v_mfma_f32_32x32x16_bf16 v[128:143], a[184:187], v[28:31], v[128:143]
  ds_read_b128 v[24:27], v12 offset:26624
  v_rcp_f32 v53, v53
  v_rcp_f32 v55, v55
  v_mul_f32 v112, v112, v48
  v_mul_f32 v113, v113, v50
  v_mul_f32 v114, v114, v52
  v_mfma_f32_32x32x16_bf16 v[144:159], a[188:191], v[28:31], v[144:159]
  v_mul_f32 v115, v115, v54
  v_mul_f32 v112, v112, v49
  v_mul_f32 v113, v113, v51
  v_mul_f32 v114, v114, v53
  v_mul_f32 v115, v115, v55
  s_waitcnt lgkmcnt(2)
  v_mfma_f32_32x32x16_bf16 v[128:143], a[192:195], v[16:19], v[128:143]
  ds_read_b128 v[28:31], v12 offset:27648
  v_add_f32 v116, v116, v180
  v_add_f32 v117, v117, v181
  v_add_f32 v118, v118, v182
  v_add_f32 v119, v119, v183
  v_mul_f32 v48, 0x3fb8aa3b, v116
  v_mfma_f32_32x32x16_bf16 v[144:159], a[196:199], v[16:19], v[144:159]
  s_add_u32 s53, s27, 8192
  s_add_u32 m0, s52, 8192
  s_nop 0
  buffer_load_dwordx4 v1, s[4:7], s53 offen offset:0 sc1 lds
  v_mul_f32 v50, 0x3fb8aa3b, v117
  v_mul_f32 v52, 0x3fb8aa3b, v118
  v_mul_f32 v54, 0x3fb8aa3b, v119
  v_min_f32 v48, 0x41f00000, v48
  v_min_f32 v50, 0x41f00000, v50
  s_waitcnt lgkmcnt(2)
  v_mfma_f32_32x32x16_bf16 v[128:143], a[200:203], v[20:23], v[128:143]
  ds_read_b128 v[16:19], v12 offset:28672
  v_min_f32 v52, 0x41f00000, v52
  v_min_f32 v54, 0x41f00000, v54
  v_exp_f32 v48, v48
  v_exp_f32 v50, v50
  v_exp_f32 v52, v52
  v_mfma_f32_32x32x16_bf16 v[144:159], a[204:207], v[20:23], v[144:159]
  v_exp_f32 v54, v54
  v_add_f32 v49, 2.0, v48
  v_add_f32 v51, 2.0, v50
  v_add_f32 v53, 2.0, v52
  v_add_f32 v55, 2.0, v54
  s_waitcnt lgkmcnt(2)
  v_mfma_f32_32x32x16_bf16 v[128:143], a[208:211], v[24:27], v[128:143]
  ds_read_b128 v[20:23], v12 offset:29696
  v_mul_f32 v48, v48, v49
  v_mul_f32 v50, v50, v51
  v_mul_f32 v52, v52, v53
  v_mul_f32 v54, v54, v55
  v_add_f32 v49, 2.0, v48
  v_mfma_f32_32x32x16_bf16 v[144:159], a[212:215], v[24:27], v[144:159]
  v_add_f32 v51, 2.0, v50
  v_add_f32 v53, 2.0, v52
  v_add_f32 v55, 2.0, v54
  v_rcp_f32 v49, v49
  v_rcp_f32 v51, v51
  s_waitcnt lgkmcnt(2)
  v_mfma_f32_32x32x16_bf16 v[128:143], a[216:219], v[28:31], v[128:143]
  ds_read_b128 v[24:27], v12 offset:30720
  v_rcp_f32 v53, v53
  v_rcp_f32 v55, v55
  v_mul_f32 v116, v116, v48
  v_mul_f32 v117, v117, v50
  v_mul_f32 v118, v118, v52
  v_mfma_f32_32x32x16_bf16 v[144:159], a[220:223], v[28:31], v[144:159]
  buffer_load_dwordx4 v1, s[4:7], s53 offen offset:1024 sc1 lds
  s_add_u32 s27, s27, 40960
  s_min_u32 s27, s27, s34
  s_add_u32 s33, s33, 40960
  s_cmp_eq_u32 s33, 122880
  s_cselect_b32 s33, 0, s33
  v_mul_f32 v119, v119, v54
  v_mul_f32 v116, v116, v49
  v_mul_f32 v117, v117, v51
  v_mul_f32 v118, v118, v53
  v_mul_f32 v119, v119, v55
  s_waitcnt lgkmcnt(2)
  v_mfma_f32_32x32x16_bf16 v[128:143], a[224:227], v[16:19], v[128:143]
  ds_read_b128 v[28:31], v12 offset:31744
  v_cvt_pk_bf16_f32 v40, v112, v113
  v_cvt_pk_bf16_f32 v41, v114, v115
  v_cvt_pk_bf16_f32 v42, v116, v117
  v_cvt_pk_bf16_f32 v43, v118, v119
  buffer_store_dwordx4 v[40:43], v6, s[4:7], s25 offen offset:1024 sc1
  v_mfma_f32_32x32x16_bf16 v[144:159], a[228:231], v[16:19], v[144:159]
  v_add_f32 v120, v120, v184
  v_add_f32 v121, v121, v185
  v_add_f32 v122, v122, v186
  v_add_f32 v123, v123, v187
  v_mul_f32 v48, 0x3fb8aa3b, v120
  s_waitcnt lgkmcnt(2)
  v_mfma_f32_32x32x16_bf16 v[128:143], a[232:235], v[20:23], v[128:143]
  ds_read_b128 v[16:19], v12 offset:32768
  v_mul_f32 v50, 0x3fb8aa3b, v121
  v_mul_f32 v52, 0x3fb8aa3b, v122
  v_mul_f32 v54, 0x3fb8aa3b, v123
  v_min_f32 v48, 0x41f00000, v48
  v_min_f32 v50, 0x41f00000, v50
  v_mfma_f32_32x32x16_bf16 v[144:159], a[236:239], v[20:23], v[144:159]
  v_min_f32 v52, 0x41f00000, v52
  v_min_f32 v54, 0x41f00000, v54
  v_exp_f32 v48, v48
  v_exp_f32 v50, v50
  v_exp_f32 v52, v52
  s_waitcnt lgkmcnt(2)
  v_mfma_f32_32x32x16_bf16 v[128:143], a[240:243], v[24:27], v[128:143]
  ds_read_b128 v[20:23], v12 offset:33792
  v_exp_f32 v54, v54
  v_add_f32 v49, 2.0, v48
  v_add_f32 v51, 2.0, v50
  v_add_f32 v53, 2.0, v52
  v_add_f32 v55, 2.0, v54
  v_mfma_f32_32x32x16_bf16 v[144:159], a[244:247], v[24:27], v[144:159]
  v_mul_f32 v48, v48, v49
  v_mul_f32 v50, v50, v51
  v_mul_f32 v52, v52, v53
  v_mul_f32 v54, v54, v55
  v_add_f32 v49, 2.0, v48
  s_waitcnt lgkmcnt(2)
  v_mfma_f32_32x32x16_bf16 v[128:143], a[248:251], v[28:31], v[128:143]
  ds_read_b128 v[24:27], v12 offset:34816
  v_add_f32 v51, 2.0, v50
  v_add_f32 v53, 2.0, v52
  v_add_f32 v55, 2.0, v54
  v_rcp_f32 v49, v49
  v_rcp_f32 v51, v51
  v_mfma_f32_32x32x16_bf16 v[144:159], a[252:255], v[28:31], v[144:159]
  v_rcp_f32 v53, v53
  v_rcp_f32 v55, v55
  v_mul_f32 v120, v120, v48
  v_mul_f32 v121, v121, v50
  v_mul_f32 v122, v122, v52
  s_waitcnt lgkmcnt(2)
  v_mfma_f32_32x32x16_bf16 v[128:143], v[192:195], v[16:19], v[128:143]
  ds_read_b128 v[28:31], v12 offset:35840
  v_mul_f32 v123, v123, v54
  v_mul_f32 v120, v120, v49
  v_mul_f32 v121, v121, v51
  v_mul_f32 v122, v122, v53
  v_mul_f32 v123, v123, v55
  v_mfma_f32_32x32x16_bf16 v[144:159], v[196:199], v[16:19], v[144:159]
  v_add_f32 v124, v124, v188
  v_add_f32 v125, v125, v189
  v_add_f32 v126, v126, v190
  v_add_f32 v127, v127, v191
  v_mul_f32 v48, 0x3fb8aa3b, v124
  s_waitcnt lgkmcnt(2)
  v_mfma_f32_32x32x16_bf16 v[128:143], v[200:203], v[20:23], v[128:143]
  ds_read_b128 v[16:19], v12 offset:36864
  v_mul_f32 v50, 0x3fb8aa3b, v125
  v_mul_f32 v52, 0x3fb8aa3b, v126
  v_mul_f32 v54, 0x3fb8aa3b, v127
  v_min_f32 v48, 0x41f00000, v48
  v_min_f32 v50, 0x41f00000, v50
  v_mfma_f32_32x32x16_bf16 v[144:159], v[204:207], v[20:23], v[144:159]
  v_min_f32 v52, 0x41f00000, v52
  v_min_f32 v54, 0x41f00000, v54
  v_exp_f32 v48, v48
  v_exp_f32 v50, v50
  v_exp_f32 v52, v52
  s_waitcnt lgkmcnt(2)
  v_mfma_f32_32x32x16_bf16 v[128:143], v[208:211], v[24:27], v[128:143]
  ds_read_b128 v[20:23], v12 offset:37888
  v_exp_f32 v54, v54
  v_add_f32 v49, 2.0, v48
  v_add_f32 v51, 2.0, v50
  v_add_f32 v53, 2.0, v52
  v_add_f32 v55, 2.0, v54
  v_mfma_f32_32x32x16_bf16 v[144:159], v[212:215], v[24:27], v[144:159]
  v_mul_f32 v48, v48, v49
  v_mul_f32 v50, v50, v51
  v_mul_f32 v52, v52, v53
  v_mul_f32 v54, v54, v55
  v_add_f32 v49, 2.0, v48
  s_waitcnt lgkmcnt(2)
  v_mfma_f32_32x32x16_bf16 v[128:143], v[216:219], v[28:31], v[128:143]
  ds_read_b128 v[24:27], v12 offset:38912
  v_add_f32 v51, 2.0, v50
  v_add_f32 v53, 2.0, v52
  v_add_f32 v55, 2.0, v54
  v_rcp_f32 v49, v49
  v_rcp_f32 v51, v51
  v_mfma_f32_32x32x16_bf16 v[144:159], v[220:223], v[28:31], v[144:159]
  v_rcp_f32 v53, v53
  v_rcp_f32 v55, v55
  v_mul_f32 v124, v124, v48
  v_mul_f32 v125, v125, v50
  v_mul_f32 v126, v126, v52
  s_waitcnt lgkmcnt(2)
  v_mfma_f32_32x32x16_bf16 v[128:143], v[224:227], v[16:19], v[128:143]
  ds_read_b128 v[28:31], v12 offset:39936
  v_mul_f32 v127, v127, v54
  v_mul_f32 v124, v124, v49
  v_mul_f32 v125, v125, v51
  v_mul_f32 v126, v126, v53
  v_mul_f32 v127, v127, v55
  v_mfma_f32_32x32x16_bf16 v[144:159], v[228:231], v[16:19], v[144:159]
  v_cvt_pk_bf16_f32 v44, v120, v121
  v_cvt_pk_bf16_f32 v45, v122, v123
  v_cvt_pk_bf16_f32 v46, v124, v125
  v_cvt_pk_bf16_f32 v47, v126, v127
  buffer_store_dwordx4 v[44:47], v6, s[4:7], s25 offen offset:1536 sc1
  s_waitcnt lgkmcnt(2)
  v_mfma_f32_32x32x16_bf16 v[128:143], v[232:235], v[20:23], v[128:143]
  v_mfma_f32_32x32x16_bf16 v[144:159], v[236:239], v[20:23], v[144:159]
  s_waitcnt lgkmcnt(1)
  v_mfma_f32_32x32x16_bf16 v[128:143], v[240:243], v[24:27], v[128:143]
  v_mfma_f32_32x32x16_bf16 v[144:159], v[244:247], v[24:27], v[144:159]
  s_waitcnt lgkmcnt(0)
  v_mfma_f32_32x32x16_bf16 v[128:143], v[248:251], v[28:31], v[128:143]
  v_mfma_f32_32x32x16_bf16 v[144:159], v[252:255], v[28:31], v[144:159]
  s_add_u32 s32, s32, 40960
  s_cmp_eq_u32 s32, 122880
  s_cselect_b32 s32, 0, s32
  s_add_u32 s29, s29, 1
  s_cmp_lt_u32 s29, 16
  s_cbranch_scc1 W1T_53
  s_add_u32 s47, s24, s29
  s_sub_u32 s47, s47, 1
  s_mul_i32 s25, s47, 114688
  s_add_u32 s25, s25, s31
  s_nop 0
  v_add_f32 v128, v128, v160
  v_add_f32 v129, v129, v161
  v_add_f32 v130, v130, v162
  v_add_f32 v131, v131, v163
  v_mul_f32 v48, 0x3fb8aa3b, v128
  v_mul_f32 v50, 0x3fb8aa3b, v129
  v_mul_f32 v52, 0x3fb8aa3b, v130
  v_mul_f32 v54, 0x3fb8aa3b, v131
  v_min_f32 v48, 0x41f00000, v48
  v_min_f32 v50, 0x41f00000, v50
  v_min_f32 v52, 0x41f00000, v52
  v_min_f32 v54, 0x41f00000, v54
  v_exp_f32 v48, v48
  v_exp_f32 v50, v50
  v_exp_f32 v52, v52
  v_exp_f32 v54, v54
  v_add_f32 v49, 2.0, v48
  v_add_f32 v51, 2.0, v50
  v_add_f32 v53, 2.0, v52
  v_add_f32 v55, 2.0, v54
  v_mul_f32 v48, v48, v49
  v_mul_f32 v50, v50, v51
  v_mul_f32 v52, v52, v53
  v_mul_f32 v54, v54, v55
  v_add_f32 v49, 2.0, v48
  v_add_f32 v51, 2.0, v50
  v_add_f32 v53, 2.0, v52
  v_add_f32 v55, 2.0, v54
  v_rcp_f32 v49, v49
  v_rcp_f32 v51, v51
  v_rcp_f32 v53, v53
  v_rcp_f32 v55, v55
  v_mul_f32 v128, v128, v48
  v_mul_f32 v129, v129, v50
  v_mul_f32 v130, v130, v52
  v_mul_f32 v131, v131, v54
  v_mul_f32 v128, v128, v49
  v_mul_f32 v129, v129, v51
  v_mul_f32 v130, v130, v53
  v_mul_f32 v131, v131, v55
  v_add_f32 v132, v132, v164
  v_add_f32 v133, v133, v165
  v_add_f32 v134, v134, v166
  v_add_f32 v135, v135, v167
  v_mul_f32 v48, 0x3fb8aa3b, v132
  v_mul_f32 v50, 0x3fb8aa3b, v133
  v_mul_f32 v52, 0x3fb8aa3b, v134
  v_mul_f32 v54, 0x3fb8aa3b, v135
  v_min_f32 v48, 0x41f00000, v48
  v_min_f32 v50, 0x41f00000, v50
  v_min_f32 v52, 0x41f00000, v52
  v_min_f32 v54, 0x41f00000, v54
  v_exp_f32 v48, v48
  v_exp_f32 v50, v50
  v_exp_f32 v52, v52
  v_exp_f32 v54, v54
  v_add_f32 v49, 2.0, v48
  v_add_f32 v51, 2.0, v50
  v_add_f32 v53, 2.0, v52
  v_add_f32 v55, 2.0, v54
  v_mul_f32 v48, v48, v49
  v_mul_f32 v50, v50, v51
  v_mul_f32 v52, v52, v53
  v_mul_f32 v54, v54, v55
  v_add_f32 v49, 2.0, v48
  v_add_f32 v51, 2.0, v50
  v_add_f32 v53, 2.0, v52
  v_add_f32 v55, 2.0, v54
  v_rcp_f32 v49, v49
  v_rcp_f32 v51, v51
  v_rcp_f32 v53, v53
  v_rcp_f32 v55, v55
  v_mul_f32 v132, v132, v48
  v_mul_f32 v133, v133, v50
  v_mul_f32 v134, v134, v52
  v_mul_f32 v135, v135, v54
  v_mul_f32 v132, v132, v49
  v_mul_f32 v133, v133, v51
  v_mul_f32 v134, v134, v53
  v_mul_f32 v135, v135, v55
  v_cvt_pk_bf16_f32 v40, v128, v129
  v_cvt_pk_bf16_f32 v41, v130, v131
  v_cvt_pk_bf16_f32 v42, v132, v133
  v_cvt_pk_bf16_f32 v43, v134, v135
  buffer_store_dwordx4 v[40:43], v6, s[4:7], s25 offen offset:0 sc1
  v_add_f32 v136, v136, v168
  v_add_f32 v137, v137, v169
  v_add_f32 v138, v138, v170
  v_add_f32 v139, v139, v171
  v_mul_f32 v48, 0x3fb8aa3b, v136
  v_mul_f32 v50, 0x3fb8aa3b, v137
  v_mul_f32 v52, 0x3fb8aa3b, v138
  v_mul_f32 v54, 0x3fb8aa3b, v139
  v_min_f32 v48, 0x41f00000, v48
  v_min_f32 v50, 0x41f00000, v50
  v_min_f32 v52, 0x41f00000, v52
  v_min_f32 v54, 0x41f00000, v54
  v_exp_f32 v48, v48
  v_exp_f32 v50, v50
  v_exp_f32 v52, v52
  v_exp_f32 v54, v54
  v_add_f32 v49, 2.0, v48
  v_add_f32 v51, 2.0, v50
  v_add_f32 v53, 2.0, v52
  v_add_f32 v55, 2.0, v54
  v_mul_f32 v48, v48, v49
  v_mul_f32 v50, v50, v51
  v_mul_f32 v52, v52, v53
  v_mul_f32 v54, v54, v55
  v_add_f32 v49, 2.0, v48
  v_add_f32 v51, 2.0, v50
  v_add_f32 v53, 2.0, v52
  v_add_f32 v55, 2.0, v54
  v_rcp_f32 v49, v49
  v_rcp_f32 v51, v51
  v_rcp_f32 v53, v53
  v_rcp_f32 v55, v55
  v_mul_f32 v136, v136, v48
  v_mul_f32 v137, v137, v50
  v_mul_f32 v138, v138, v52
  v_mul_f32 v139, v139, v54
  v_mul_f32 v136, v136, v49
  v_mul_f32 v137, v137, v51
  v_mul_f32 v138, v138, v53
  v_mul_f32 v139, v139, v55
  v_add_f32 v140, v140, v172
  v_add_f32 v141, v141, v173
  v_add_f32 v142, v142, v174
  v_add_f32 v143, v143, v175
  v_mul_f32 v48, 0x3fb8aa3b, v140
  v_mul_f32 v50, 0x3fb8aa3b, v141
  v_mul_f32 v52, 0x3fb8aa3b, v142
  v_mul_f32 v54, 0x3fb8aa3b, v143
  v_min_f32 v48, 0x41f00000, v48
  v_min_f32 v50, 0x41f00000, v50
  v_min_f32 v52, 0x41f00000, v52
  v_min_f32 v54, 0x41f00000, v54
  v_exp_f32 v48, v48
  v_exp_f32 v50, v50
  v_exp_f32 v52, v52
  v_exp_f32 v54, v54
  v_add_f32 v49, 2.0, v48
  v_add_f32 v51, 2.0, v50
  v_add_f32 v53, 2.0, v52
  v_add_f32 v55, 2.0, v54
  v_mul_f32 v48, v48, v49
  v_mul_f32 v50, v50, v51
  v_mul_f32 v52, v52, v53
  v_mul_f32 v54, v54, v55
  v_add_f32 v49, 2.0, v48
  v_add_f32 v51, 2.0, v50
  v_add_f32 v53, 2.0, v52
  v_add_f32 v55, 2.0, v54
  v_rcp_f32 v49, v49
  v_rcp_f32 v51, v51
  v_rcp_f32 v53, v53
  v_rcp_f32 v55, v55
  v_mul_f32 v140, v140, v48
  v_mul_f32 v141, v141, v50
  v_mul_f32 v142, v142, v52
  v_mul_f32 v143, v143, v54
  v_mul_f32 v140, v140, v49
  v_mul_f32 v141, v141, v51
  v_mul_f32 v142, v142, v53
  v_mul_f32 v143, v143, v55
  v_cvt_pk_bf16_f32 v44, v136, v137
  v_cvt_pk_bf16_f32 v45, v138, v139
  v_cvt_pk_bf16_f32 v46, v140, v141
  v_cvt_pk_bf16_f32 v47, v142, v143
  buffer_store_dwordx4 v[44:47], v6, s[4:7], s25 offen offset:512 sc1
  v_add_f32 v144, v144, v176
  v_add_f32 v145, v145, v177
  v_add_f32 v146, v146, v178
  v_add_f32 v147, v147, v179
  v_mul_f32 v48, 0x3fb8aa3b, v144
  v_mul_f32 v50, 0x3fb8aa3b, v145
  v_mul_f32 v52, 0x3fb8aa3b, v146
  v_mul_f32 v54, 0x3fb8aa3b, v147
  v_min_f32 v48, 0x41f00000, v48
  v_min_f32 v50, 0x41f00000, v50
  v_min_f32 v52, 0x41f00000, v52
  v_min_f32 v54, 0x41f00000, v54
  v_exp_f32 v48, v48
  v_exp_f32 v50, v50
  v_exp_f32 v52, v52
  v_exp_f32 v54, v54
  v_add_f32 v49, 2.0, v48
  v_add_f32 v51, 2.0, v50
  v_add_f32 v53, 2.0, v52
  v_add_f32 v55, 2.0, v54
  v_mul_f32 v48, v48, v49
  v_mul_f32 v50, v50, v51
  v_mul_f32 v52, v52, v53
  v_mul_f32 v54, v54, v55
  v_add_f32 v49, 2.0, v48
  v_add_f32 v51, 2.0, v50
  v_add_f32 v53, 2.0, v52
  v_add_f32 v55, 2.0, v54
  v_rcp_f32 v49, v49
  v_rcp_f32 v51, v51
  v_rcp_f32 v53, v53
  v_rcp_f32 v55, v55
  v_mul_f32 v144, v144, v48
  v_mul_f32 v145, v145, v50
  v_mul_f32 v146, v146, v52
  v_mul_f32 v147, v147, v54
  v_mul_f32 v144, v144, v49
  v_mul_f32 v145, v145, v51
  v_mul_f32 v146, v146, v53
  v_mul_f32 v147, v147, v55
  v_add_f32 v148, v148, v180
  v_add_f32 v149, v149, v181
  v_add_f32 v150, v150, v182
  v_add_f32 v151, v151, v183
  v_mul_f32 v48, 0x3fb8aa3b, v148
  v_mul_f32 v50, 0x3fb8aa3b, v149
  v_mul_f32 v52, 0x3fb8aa3b, v150
  v_mul_f32 v54, 0x3fb8aa3b, v151
  v_min_f32 v48, 0x41f00000, v48
  v_min_f32 v50, 0x41f00000, v50
  v_min_f32 v52, 0x41f00000, v52
  v_min_f32 v54, 0x41f00000, v54
  v_exp_f32 v48, v48
  v_exp_f32 v50, v50
  v_exp_f32 v52, v52
  v_exp_f32 v54, v54
  v_add_f32 v49, 2.0, v48
  v_add_f32 v51, 2.0, v50
  v_add_f32 v53, 2.0, v52
  v_add_f32 v55, 2.0, v54
  v_mul_f32 v48, v48, v49
  v_mul_f32 v50, v50, v51
  v_mul_f32 v52, v52, v53
  v_mul_f32 v54, v54, v55
  v_add_f32 v49, 2.0, v48
  v_add_f32 v51, 2.0, v50
  v_add_f32 v53, 2.0, v52
  v_add_f32 v55, 2.0, v54
  v_rcp_f32 v49, v49
  v_rcp_f32 v51, v51
  v_rcp_f32 v53, v53
  v_rcp_f32 v55, v55
  v_mul_f32 v148, v148, v48
  v_mul_f32 v149, v149, v50
  v_mul_f32 v150, v150, v52
  v_mul_f32 v151, v151, v54
  v_mul_f32 v148, v148, v49
  v_mul_f32 v149, v149, v51
  v_mul_f32 v150, v150, v53
  v_mul_f32 v151, v151, v55
  v_cvt_pk_bf16_f32 v40, v144, v145
  v_cvt_pk_bf16_f32 v41, v146, v147
  v_cvt_pk_bf16_f32 v42, v148, v149
  v_cvt_pk_bf16_f32 v43, v150, v151
  buffer_store_dwordx4 v[40:43], v6, s[4:7], s25 offen offset:1024 sc1
  v_add_f32 v152, v152, v184
  v_add_f32 v153, v153, v185
  v_add_f32 v154, v154, v186
  v_add_f32 v155, v155, v187
  v_mul_f32 v48, 0x3fb8aa3b, v152
  v_mul_f32 v50, 0x3fb8aa3b, v153
  v_mul_f32 v52, 0x3fb8aa3b, v154
  v_mul_f32 v54, 0x3fb8aa3b, v155
  v_min_f32 v48, 0x41f00000, v48
  v_min_f32 v50, 0x41f00000, v50
  v_min_f32 v52, 0x41f00000, v52
  v_min_f32 v54, 0x41f00000, v54
  v_exp_f32 v48, v48
  v_exp_f32 v50, v50
  v_exp_f32 v52, v52
  v_exp_f32 v54, v54
  v_add_f32 v49, 2.0, v48
  v_add_f32 v51, 2.0, v50
  v_add_f32 v53, 2.0, v52
  v_add_f32 v55, 2.0, v54
  v_mul_f32 v48, v48, v49
  v_mul_f32 v50, v50, v51
  v_mul_f32 v52, v52, v53
  v_mul_f32 v54, v54, v55
  v_add_f32 v49, 2.0, v48
  v_add_f32 v51, 2.0, v50
  v_add_f32 v53, 2.0, v52
  v_add_f32 v55, 2.0, v54
  v_rcp_f32 v49, v49
  v_rcp_f32 v51, v51
  v_rcp_f32 v53, v53
  v_rcp_f32 v55, v55
  v_mul_f32 v152, v152, v48
  v_mul_f32 v153, v153, v50
  v_mul_f32 v154, v154, v52
  v_mul_f32 v155, v155, v54
  v_mul_f32 v152, v152, v49
  v_mul_f32 v153, v153, v51
  v_mul_f32 v154, v154, v53
  v_mul_f32 v155, v155, v55
  v_add_f32 v156, v156, v188
  v_add_f32 v157, v157, v189
  v_add_f32 v158, v158, v190
  v_add_f32 v159, v159, v191
  v_mul_f32 v48, 0x3fb8aa3b, v156
  v_mul_f32 v50, 0x3fb8aa3b, v157
  v_mul_f32 v52, 0x3fb8aa3b, v158
  v_mul_f32 v54, 0x3fb8aa3b, v159
  v_min_f32 v48, 0x41f00000, v48
  v_min_f32 v50, 0x41f00000, v50
  v_min_f32 v52, 0x41f00000, v52
  v_min_f32 v54, 0x41f00000, v54
  v_exp_f32 v48, v48
  v_exp_f32 v50, v50
  v_exp_f32 v52, v52
  v_exp_f32 v54, v54
  v_add_f32 v49, 2.0, v48
  v_add_f32 v51, 2.0, v50
  v_add_f32 v53, 2.0, v52
  v_add_f32 v55, 2.0, v54
  v_mul_f32 v48, v48, v49
  v_mul_f32 v50, v50, v51
  v_mul_f32 v52, v52, v53
  v_mul_f32 v54, v54, v55
  v_add_f32 v49, 2.0, v48
  v_add_f32 v51, 2.0, v50
  v_add_f32 v53, 2.0, v52
  v_add_f32 v55, 2.0, v54
  v_rcp_f32 v49, v49
  v_rcp_f32 v51, v51
  v_rcp_f32 v53, v53
  v_rcp_f32 v55, v55
  v_mul_f32 v156, v156, v48
  v_mul_f32 v157, v157, v50
  v_mul_f32 v158, v158, v52
  v_mul_f32 v159, v159, v54
  v_mul_f32 v156, v156, v49
  v_mul_f32 v157, v157, v51
  v_mul_f32 v158, v158, v53
  v_mul_f32 v159, v159, v55
  v_cvt_pk_bf16_f32 v44, v152, v153
  v_cvt_pk_bf16_f32 v45, v154, v155
  v_cvt_pk_bf16_f32 v46, v156, v157
  v_cvt_pk_bf16_f32 v47, v158, v159
  buffer_store_dwordx4 v[44:47], v6, s[4:7], s25 offen offset:1536 sc1
  s_waitcnt vmcnt(0)
  s_barrier
  s_cmp_lg_u32 s13, 0
  s_cbranch_scc1 PB_59
  v_mov_b32 v8, 16
  v_mov_b32 v9, s26
  buffer_store_dword v8, v9, s[4:7], 0 offen sc1
PB_59:
  s_branch W1E_60
W1K_45:
  s_lshl_b32 s48, s48, 11
  s_add_u32 s31, s47, s48
  s_add_u32 s31, s31, 16777216
  s_add_u32 s26, s26, 0
  s_mov_b32 s8, s60
  s_and_b32 s9, s61, 0xffff
  s_mov_b32 s10, 5242880
  s_mov_b32 s11, 0x20000
  s_branch W1G_49
W1Q_47:
  s_lshl_b32 s48, s48, 11
  s_add_u32 s31, s47, s48
  s_add_u32 s31, s31, 50331648
  s_add_u32 s26, s26, 512
  s_mov_b32 s8, s58
  s_and_b32 s9, s59, 0xffff
  s_mov_b32 s10, 5242880
  s_mov_b32 s11, 0x20000
W1G_49:
  s_mov_b32 s51, 1
  v_and_b32 v2, 63, v0
  v_lshlrev_b32 v1, 4, v2
  v_lshrrev_b32 v3, 5, v2
  v_mul_lo_u32 v4, v3, s23
  v_and_b32 v3, 31, v2
  v_lshl_add_u32 v4, v3, 4, v4
  v_lshrrev_b32 v5, 4, v2
  v_and_b32 v6, 1, v5
  v_lshrrev_b32 v5, 1, v5
  v_bfe_u32 v7, v2, 2, 2
  v_lshl_add_u32 v7, v5, 3, v7
  v_lshlrev_b32 v7, 9, v7
  v_and_b32 v8, 3, v2
  v_lshl_add_u32 v8, v6, 2, v8
  v_lshlrev_b32 v9, 2, v8
  v_lshrrev_b32 v10, 2, v8
  v_lshlrev_b32 v10, 4, v10
  v_and_b32 v11, 1, v8
  v_lshl_add_u32 v10, v11, 3, v10
  v_bfe_u32 v11, v8, 1, 1
  v_lshl_add_u32 v10, v11, 2, v10
  s_cmp_lg_u32 s51, 0
  s_cselect_b64 vcc, -1, 0
  v_cndmask_b32 v9, v9, v10, vcc
  v_lshl_add_u32 v7, v9, 1, v7
  s_lshl_b32 s47, s13, 7
  v_add_u32 v7, s47, v7
  s_lshl_b32 s28, s13, 11
  s_mul_i32 s27, s23, s13
  s_lshl_b32 s27, s27, 2
  s_add_u32 s27, s27, s22
  s_lshl_b32 s49, s23, 1
  s_lshl_b32 s50, s23, 4
  s_mov_b32 s47, s27
  s_add_u32 m0, s28, 0
  s_nop 0
  buffer_load_dwordx4 v4, s[8:11], s47 offen lds
  s_add_u32 s47, s27, s49
  s_add_u32 m0, s28, 1024
  s_nop 0
  buffer_load_dwordx4 v4, s[8:11], s47 offen lds
  s_add_u32 s27, s27, s50
  s_mov_b32 s47, s27
  s_add_u32 m0, s28, 8192
  s_nop 0
  buffer_load_dwordx4 v4, s[8:11], s47 offen lds
  s_add_u32 s47, s27, s49
  s_add_u32 m0, s28, 9216
  s_nop 0
  buffer_load_dwordx4 v4, s[8:11], s47 offen lds
  s_add_u32 s27, s27, s50
  s_mov_b32 s47, s27
  s_add_u32 m0, s28, 16384
  s_nop 0
  buffer_load_dwordx4 v4, s[8:11], s47 offen lds
  s_add_u32 s47, s27, s49
  s_add_u32 m0, s28, 17408
  s_nop 0
  buffer_load_dwordx4 v4, s[8:11], s47 offen lds
  s_add_u32 s27, s27, s50
  s_mov_b32 s47, s27
  s_add_u32 m0, s28, 24576
  s_nop 0
  buffer_load_dwordx4 v4, s[8:11], s47 offen lds
  s_add_u32 s47, s27, s49
  s_add_u32 m0, s28, 25600
  s_nop 0
  buffer_load_dwordx4 v4, s[8:11], s47 offen lds
  s_add_u32 s27, s27, s50
  s_mov_b32 s47, s27
  s_add_u32 m0, s28, 32768
  s_nop 0
  buffer_load_dwordx4 v4, s[8:11], s47 offen lds
  s_add_u32 s47, s27, s49
  s_add_u32 m0, s28, 33792
  s_nop 0
  buffer_load_dwordx4 v4, s[8:11], s47 offen lds
  s_add_u32 s27, s27, s50
  s_mov_b32 s47, s27
  s_add_u32 m0, s28, 40960
  s_nop 0
  buffer_load_dwordx4 v4, s[8:11], s47 offen lds
  s_add_u32 s47, s27, s49
  s_add_u32 m0, s28, 41984
  s_nop 0
  buffer_load_dwordx4 v4, s[8:11], s47 offen lds
  s_add_u32 s27, s27, s50
  s_mov_b32 s47, s27
  s_add_u32 m0, s28, 49152
  s_nop 0
  buffer_load_dwordx4 v4, s[8:11], s47 offen lds
  s_add_u32 s47, s27, s49
  s_add_u32 m0, s28, 50176
  s_nop 0
  buffer_load_dwordx4 v4, s[8:11], s47 offen lds
  s_add_u32 s27, s27, s50
  s_mov_b32 s47, s27
  s_add_u32 m0, s28, 57344
  s_nop 0
  buffer_load_dwordx4 v4, s[8:11], s47 offen lds
  s_add_u32 s47, s27, s49
  s_add_u32 m0, s28, 58368
  s_nop 0
  buffer_load_dwordx4 v4, s[8:11], s47 offen lds
  s_add_u32 s27, s27, s50
  s_mov_b32 s47, s27
  s_add_u32 m0, s28, 65536
  s_nop 0
  buffer_load_dwordx4 v4, s[8:11], s47 offen lds
  s_add_u32 s47, s27, s49
  s_add_u32 m0, s28, 66560
  s_nop 0
  buffer_load_dwordx4 v4, s[8:11], s47 offen lds
  s_add_u32 s27, s27, s50
  s_mov_b32 s47, s27
  s_add_u32 m0, s28, 73728
  s_nop 0
  buffer_load_dwordx4 v4, s[8:11], s47 offen lds
  s_add_u32 s47, s27, s49
  s_add_u32 m0, s28, 74752
  s_nop 0
  buffer_load_dwordx4 v4, s[8:11], s47 offen lds
  s_add_u32 s27, s27, s50
  s_mov_b32 s47, s27
  s_add_u32 m0, s28, 81920
  s_nop 0
  buffer_load_dwordx4 v4, s[8:11], s47 offen lds
  s_add_u32 s47, s27, s49
  s_add_u32 m0, s28, 82944
  s_nop 0
  buffer_load_dwordx4 v4, s[8:11], s47 offen lds
  s_add_u32 s27, s27, s50
  s_mov_b32 s47, s27
  s_add_u32 m0, s28, 90112
  s_nop 0
  buffer_load_dwordx4 v4, s[8:11], s47 offen lds
  s_add_u32 s47, s27, s49
  s_add_u32 m0, s28, 91136
  s_nop 0
  buffer_load_dwordx4 v4, s[8:11], s47 offen lds
  s_add_u32 s27, s27, s50
  s_mov_b32 s47, s27
  s_add_u32 m0, s28, 98304
  s_nop 0
  buffer_load_dwordx4 v4, s[8:11], s47 offen lds
  s_add_u32 s47, s27, s49
  s_add_u32 m0, s28, 99328
  s_nop 0
  buffer_load_dwordx4 v4, s[8:11], s47 offen lds
  s_add_u32 s27, s27, s50
  s_mov_b32 s47, s27
  s_add_u32 m0, s28, 106496
  s_nop 0
  buffer_load_dwordx4 v4, s[8:11], s47 offen lds
  s_add_u32 s47, s27, s49
  s_add_u32 m0, s28, 107520
  s_nop 0
  buffer_load_dwordx4 v4, s[8:11], s47 offen lds
  s_add_u32 s27, s27, s50
  s_mov_b32 s47, s27
  s_add_u32 m0, s28, 114688
  s_nop 0
  buffer_load_dwordx4 v4, s[8:11], s47 offen lds
  s_add_u32 s47, s27, s49
  s_add_u32 m0, s28, 115712
  s_nop 0
  buffer_load_dwordx4 v4, s[8:11], s47 offen lds
  s_add_u32 s27, s27, s50
  s_mov_b32 s47, s27
  s_add_u32 m0, s28, 122880
  s_nop 0
  buffer_load_dwordx4 v4, s[8:11], s47 offen lds
  s_add_u32 s47, s27, s49
  s_add_u32 m0, s28, 123904
  s_nop 0
  buffer_load_dwordx4 v4, s[8:11], s47 offen lds
  s_add_u32 s27, s27, s50
  s_waitcnt vmcnt(30)
  s_barrier
  v_add_u32 v12, 0, v7
  ds_read_b64_tr_b16 a[0:1], v12 offset:0
  ds_read_b64_tr_b16 a[2:3], v12 offset:2048
  ds_read_b64_tr_b16 a[4:5], v12 offset:64
  ds_read_b64_tr_b16 a[6:7], v12 offset:2112
  s_waitcnt lgkmcnt(0)
  s_waitcnt vmcnt(28)
  s_barrier
  s_mov_b32 s47, s27
  s_add_u32 m0, s28, 0
  s_nop 0
  buffer_load_dwordx4 v4, s[8:11], s47 offen lds
  s_add_u32 s47, s27, s49
  s_add_u32 m0, s28, 1024
  s_nop 0
  buffer_load_dwordx4 v4, s[8:11], s47 offen lds
  s_add_u32 s27, s27, s50
  v_add_u32 v12, 8192, v7
  ds_read_b64_tr_b16 a[8:9], v12 offset:0
  ds_read_b64_tr_b16 a[10:11], v12 offset:2048
  ds_read_b64_tr_b16 a[12:13], v12 offset:64
  ds_read_b64_tr_b16 a[14:15], v12 offset:2112
  s_waitcnt lgkmcnt(0)
  s_waitcnt vmcnt(28)
  s_barrier
  s_mov_b32 s47, s27
  s_add_u32 m0, s28, 8192
  s_nop 0
  buffer_load_dwordx4 v4, s[8:11], s47 offen lds
  s_add_u32 s47, s27, s49
  s_add_u32 m0, s28, 9216
  s_nop 0
  buffer_load_dwordx4 v4, s[8:11], s47 offen lds
  s_add_u32 s27, s27, s50
  v_add_u32 v12, 16384, v7
  ds_read_b64_tr_b16 a[16:17], v12 offset:0
  ds_read_b64_tr_b16 a[18:19], v12 offset:2048
  ds_read_b64_tr_b16 a[20:21], v12 offset:64
  ds_read_b64_tr_b16 a[22:23], v12 offset:2112
  s_waitcnt lgkmcnt(0)
  s_waitcnt vmcnt(28)
  s_barrier
  s_mov_b32 s47, s27
  s_add_u32 m0, s28, 16384
  s_nop 0
  buffer_load_dwordx4 v4, s[8:11], s47 offen lds
  s_add_u32 s47, s27, s49
  s_add_u32 m0, s28, 17408
  s_nop 0
  buffer_load_dwordx4 v4, s[8:11], s47 offen lds
  s_add_u32 s27, s27, s50
  v_add_u32 v12, 24576, v7
  ds_read_b64_tr_b16 a[24:25], v12 offset:0
  ds_read_b64_tr_b16 a[26:27], v12 offset:2048
  ds_read_b64_tr_b16 a[28:29], v12 offset:64
  ds_read_b64_tr_b16 a[30:31], v12 offset:2112
  s_waitcnt lgkmcnt(0)
  s_waitcnt vmcnt(28)
  s_barrier
  s_mov_b32 s47, s27
  s_add_u32 m0, s28, 24576
  s_nop 0
  buffer_load_dwordx4 v4, s[8:11], s47 offen lds
  s_add_u32 s47, s27, s49
  s_add_u32 m0, s28, 25600
  s_nop 0
  buffer_load_dwordx4 v4, s[8:11], s47 offen lds
  s_add_u32 s27, s27, s50
  v_add_u32 v12, 32768, v7
  ds_read_b64_tr_b16 a[32:33], v12 offset:0
  ds_read_b64_tr_b16 a[34:35], v12 offset:2048
  ds_read_b64_tr_b16 a[36:37], v12 offset:64
  ds_read_b64_tr_b16 a[38:39], v12 offset:2112
  s_waitcnt lgkmcnt(0)
  s_waitcnt vmcnt(28)
  s_barrier
  s_mov_b32 s47, s27
  s_add_u32 m0, s28, 32768
  s_nop 0
  buffer_load_dwordx4 v4, s[8:11], s47 offen lds
  s_add_u32 s47, s27, s49
  s_add_u32 m0, s28, 33792
  s_nop 0
  buffer_load_dwordx4 v4, s[8:11], s47 offen lds
  s_add_u32 s27, s27, s50
  v_add_u32 v12, 40960, v7
  ds_read_b64_tr_b16 a[40:41], v12 offset:0
  ds_read_b64_tr_b16 a[42:43], v12 offset:2048
  ds_read_b64_tr_b16 a[44:45], v12 offset:64
  ds_read_b64_tr_b16 a[46:47], v12 offset:2112
  s_waitcnt lgkmcnt(0)
  s_waitcnt vmcnt(28)
  s_barrier
  s_mov_b32 s47, s27
  s_add_u32 m0, s28, 40960
  s_nop 0
  buffer_load_dwordx4 v4, s[8:11], s47 offen lds
  s_add_u32 s47, s27, s49
  s_add_u32 m0, s28, 41984
  s_nop 0
  buffer_load_dwordx4 v4, s[8:11], s47 offen lds
  s_add_u32 s27, s27, s50
  v_add_u32 v12, 49152, v7
  ds_read_b64_tr_b16 a[48:49], v12 offset:0
  ds_read_b64_tr_b16 a[50:51], v12 offset:2048
  ds_read_b64_tr_b16 a[52:53], v12 offset:64
  ds_read_b64_tr_b16 a[54:55], v12 offset:2112
  s_waitcnt lgkmcnt(0)
  s_waitcnt vmcnt(28)
  s_barrier
  s_mov_b32 s47, s27
  s_add_u32 m0, s28, 49152
  s_nop 0
  buffer_load_dwordx4 v4, s[8:11], s47 offen lds
  s_add_u32 s47, s27, s49
  s_add_u32 m0, s28, 50176
  s_nop 0
  buffer_load_dwordx4 v4, s[8:11], s47 offen lds
  s_add_u32 s27, s27, s50
  v_add_u32 v12, 57344, v7
  ds_read_b64_tr_b16 a[56:57], v12 offset:0
  ds_read_b64_tr_b16 a[58:59], v12 offset:2048
  ds_read_b64_tr_b16 a[60:61], v12 offset:64
  ds_read_b64_tr_b16 a[62:63], v12 offset:2112
  s_waitcnt lgkmcnt(0)
  s_waitcnt vmcnt(28)
  s_barrier
  s_mov_b32 s47, s27
  s_add_u32 m0, s28, 57344
  s_nop 0
  buffer_load_dwordx4 v4, s[8:11], s47 offen lds
  s_add_u32 s47, s27, s49
  s_add_u32 m0, s28, 58368
  s_nop 0
  buffer_load_dwordx4 v4, s[8:11], s47 offen lds
  s_add_u32 s27, s27, s50
  v_add_u32 v12, 65536, v7
  ds_read_b64_tr_b16 a[64:65], v12 offset:0
  ds_read_b64_tr_b16 a[66:67], v12 offset:2048
  ds_read_b64_tr_b16 a[68:69], v12 offset:64
  ds_read_b64_tr_b16 a[70:71], v12 offset:2112
  s_waitcnt lgkmcnt(0)
  s_waitcnt vmcnt(28)
  s_barrier
  s_mov_b32 s47, s27
  s_add_u32 m0, s28, 65536
  s_nop 0
  buffer_load_dwordx4 v4, s[8:11], s47 offen lds
  s_add_u32 s47, s27, s49
  s_add_u32 m0, s28, 66560
  s_nop 0
  buffer_load_dwordx4 v4, s[8:11], s47 offen lds
  s_add_u32 s27, s27, s50
  v_add_u32 v12, 73728, v7
  ds_read_b64_tr_b16 a[72:73], v12 offset:0
  ds_read_b64_tr_b16 a[74:75], v12 offset:2048
  ds_read_b64_tr_b16 a[76:77], v12 offset:64
  ds_read_b64_tr_b16 a[78:79], v12 offset:2112
  s_waitcnt lgkmcnt(0)
  s_waitcnt vmcnt(28)
  s_barrier
  s_mov_b32 s47, s27
  s_add_u32 m0, s28, 73728
  s_nop 0
  buffer_load_dwordx4 v4, s[8:11], s47 offen lds
  s_add_u32 s47, s27, s49
  s_add_u32 m0, s28, 74752
  s_nop 0
  buffer_load_dwordx4 v4, s[8:11], s47 offen lds
  s_add_u32 s27, s27, s50
  v_add_u32 v12, 81920, v7
  ds_read_b64_tr_b16 a[80:81], v12 offset:0
  ds_read_b64_tr_b16 a[82:83], v12 offset:2048
  ds_read_b64_tr_b16 a[84:85], v12 offset:64
  ds_read_b64_tr_b16 a[86:87], v12 offset:2112
  s_waitcnt lgkmcnt(0)
  s_waitcnt vmcnt(28)
  s_barrier
  s_mov_b32 s47, s27
  s_add_u32 m0, s28, 81920
  s_nop 0
  buffer_load_dwordx4 v4, s[8:11], s47 offen lds
  s_add_u32 s47, s27, s49
  s_add_u32 m0, s28, 82944
  s_nop 0
  buffer_load_dwordx4 v4, s[8:11], s47 offen lds
  s_add_u32 s27, s27, s50
  v_add_u32 v12, 90112, v7
  ds_read_b64_tr_b16 a[88:89], v12 offset:0
  ds_read_b64_tr_b16 a[90:91], v12 offset:2048
  ds_read_b64_tr_b16 a[92:93], v12 offset:64
  ds_read_b64_tr_b16 a[94:95], v12 offset:2112
  s_waitcnt lgkmcnt(0)
  s_waitcnt vmcnt(28)
  s_barrier
  s_mov_b32 s47, s27
  s_add_u32 m0, s28, 90112
  s_nop 0
  buffer_load_dwordx4 v4, s[8:11], s47 offen lds
  s_add_u32 s47, s27, s49
  s_add_u32 m0, s28, 91136
  s_nop 0
  buffer_load_dwordx4 v4, s[8:11], s47 offen lds
  s_add_u32 s27, s27, s50
  v_add_u32 v12, 98304, v7
  ds_read_b64_tr_b16 a[96:97], v12 offset:0
  ds_read_b64_tr_b16 a[98:99], v12 offset:2048
  ds_read_b64_tr_b16 a[100:101], v12 offset:64
  ds_read_b64_tr_b16 a[102:103], v12 offset:2112
  s_waitcnt lgkmcnt(0)
  s_waitcnt vmcnt(28)
  s_barrier
  s_mov_b32 s47, s27
  s_add_u32 m0, s28, 98304
  s_nop 0
  buffer_load_dwordx4 v4, s[8:11], s47 offen lds
  s_add_u32 s47, s27, s49
  s_add_u32 m0, s28, 99328
  s_nop 0
  buffer_load_dwordx4 v4, s[8:11], s47 offen lds
  s_add_u32 s27, s27, s50
  v_add_u32 v12, 106496, v7
  ds_read_b64_tr_b16 a[104:105], v12 offset:0
  ds_read_b64_tr_b16 a[106:107], v12 offset:2048
  ds_read_b64_tr_b16 a[108:109], v12 offset:64
  ds_read_b64_tr_b16 a[110:111], v12 offset:2112
  s_waitcnt lgkmcnt(0)
  s_waitcnt vmcnt(28)
  s_barrier
  s_mov_b32 s47, s27
  s_add_u32 m0, s28, 106496
  s_nop 0
  buffer_load_dwordx4 v4, s[8:11], s47 offen lds
  s_add_u32 s47, s27, s49
  s_add_u32 m0, s28, 107520
  s_nop 0
  buffer_load_dwordx4 v4, s[8:11], s47 offen lds
  s_add_u32 s27, s27, s50
  v_add_u32 v12, 114688, v7
  ds_read_b64_tr_b16 a[112:113], v12 offset:0
  ds_read_b64_tr_b16 a[114:115], v12 offset:2048
  ds_read_b64_tr_b16 a[116:117], v12 offset:64
  ds_read_b64_tr_b16 a[118:119], v12 offset:2112
  s_waitcnt lgkmcnt(0)
  s_waitcnt vmcnt(28)
  s_barrier
  s_mov_b32 s47, s27
  s_add_u32 m0, s28, 114688
  s_nop 0
  buffer_load_dwordx4 v4, s[8:11], s47 offen lds
  s_add_u32 s47, s27, s49
  s_add_u32 m0, s28, 115712
  s_nop 0
  buffer_load_dwordx4 v4, s[8:11], s47 offen lds
  s_add_u32 s27, s27, s50
  v_add_u32 v12, 122880, v7
  ds_read_b64_tr_b16 a[120:121], v12 offset:0
  ds_read_b64_tr_b16 a[122:123], v12 offset:2048
  ds_read_b64_tr_b16 a[124:125], v12 offset:64
  ds_read_b64_tr_b16 a[126:127], v12 offset:2112
  s_waitcnt lgkmcnt(0)
  s_waitcnt vmcnt(28)
  s_barrier
  s_mov_b32 s47, s27
  s_add_u32 m0, s28, 122880
  s_nop 0
  buffer_load_dwordx4 v4, s[8:11], s47 offen lds
  s_add_u32 s47, s27, s49
  s_add_u32 m0, s28, 123904
  s_nop 0
  buffer_load_dwordx4 v4, s[8:11], s47 offen lds
  s_add_u32 s27, s27, s50
  v_add_u32 v12, 0, v7
  ds_read_b64_tr_b16 a[128:129], v12 offset:0
  ds_read_b64_tr_b16 a[130:131], v12 offset:2048
  ds_read_b64_tr_b16 a[132:133], v12 offset:64
  ds_read_b64_tr_b16 a[134:135], v12 offset:2112
  s_waitcnt lgkmcnt(0)
  s_waitcnt vmcnt(28)
  s_barrier
  s_mov_b32 s47, s27
  s_add_u32 m0, s28, 0
  s_nop 0
  buffer_load_dwordx4 v4, s[8:11], s47 offen lds
  s_add_u32 s47, s27, s49
  s_add_u32 m0, s28, 1024
  s_nop 0
  buffer_load_dwordx4 v4, s[8:11], s47 offen lds
  s_add_u32 s27, s27, s50
  v_add_u32 v12, 8192, v7
  ds_read_b64_tr_b16 a[136:137], v12 offset:0
  ds_read_b64_tr_b16 a[138:139], v12 offset:2048
  ds_read_b64_tr_b16 a[140:141], v12 offset:64
  ds_read_b64_tr_b16 a[142:143], v12 offset:2112
  s_waitcnt lgkmcnt(0)
  s_waitcnt vmcnt(28)
  s_barrier
  s_mov_b32 s47, s27
  s_add_u32 m0, s28, 8192
  s_nop 0
  buffer_load_dwordx4 v4, s[8:11], s47 offen lds
  s_add_u32 s47, s27, s49
  s_add_u32 m0, s28, 9216
  s_nop 0
  buffer_load_dwordx4 v4, s[8:11], s47 offen lds
  s_add_u32 s27, s27, s50
  v_add_u32 v12, 16384, v7
  ds_read_b64_tr_b16 a[144:145], v12 offset:0
  ds_read_b64_tr_b16 a[146:147], v12 offset:2048
  ds_read_b64_tr_b16 a[148:149], v12 offset:64
  ds_read_b64_tr_b16 a[150:151], v12 offset:2112
  s_waitcnt lgkmcnt(0)
  s_waitcnt vmcnt(28)
  s_barrier
  s_mov_b32 s47, s27
  s_add_u32 m0, s28, 16384
  s_nop 0
  buffer_load_dwordx4 v4, s[8:11], s47 offen lds
  s_add_u32 s47, s27, s49
  s_add_u32 m0, s28, 17408
  s_nop 0
  buffer_load_dwordx4 v4, s[8:11], s47 offen lds
  s_add_u32 s27, s27, s50
  v_add_u32 v12, 24576, v7
  ds_read_b64_tr_b16 a[152:153], v12 offset:0
  ds_read_b64_tr_b16 a[154:155], v12 offset:2048
  ds_read_b64_tr_b16 a[156:157], v12 offset:64
  ds_read_b64_tr_b16 a[158:159], v12 offset:2112
  s_waitcnt lgkmcnt(0)
  s_waitcnt vmcnt(28)
  s_barrier
  s_mov_b32 s47, s27
  s_add_u32 m0, s28, 24576
  s_nop 0
  buffer_load_dwordx4 v4, s[8:11], s47 offen lds
  s_add_u32 s47, s27, s49
  s_add_u32 m0, s28, 25600
  s_nop 0
  buffer_load_dwordx4 v4, s[8:11], s47 offen lds
  s_add_u32 s27, s27, s50
  v_add_u32 v12, 32768, v7
  ds_read_b64_tr_b16 a[160:161], v12 offset:0
  ds_read_b64_tr_b16 a[162:163], v12 offset:2048
  ds_read_b64_tr_b16 a[164:165], v12 offset:64
  ds_read_b64_tr_b16 a[166:167], v12 offset:2112
  s_waitcnt lgkmcnt(0)
  s_waitcnt vmcnt(28)
  s_barrier
  s_mov_b32 s47, s27
  s_add_u32 m0, s28, 32768
  s_nop 0
  buffer_load_dwordx4 v4, s[8:11], s47 offen lds
  s_add_u32 s47, s27, s49
  s_add_u32 m0, s28, 33792
  s_nop 0
  buffer_load_dwordx4 v4, s[8:11], s47 offen lds
  s_add_u32 s27, s27, s50
  v_add_u32 v12, 40960, v7
  ds_read_b64_tr_b16 a[168:169], v12 offset:0
  ds_read_b64_tr_b16 a[170:171], v12 offset:2048
  ds_read_b64_tr_b16 a[172:173], v12 offset:64
  ds_read_b64_tr_b16 a[174:175], v12 offset:2112
  s_waitcnt lgkmcnt(0)
  s_waitcnt vmcnt(28)
  s_barrier
  s_mov_b32 s47, s27
  s_add_u32 m0, s28, 40960
  s_nop 0
  buffer_load_dwordx4 v4, s[8:11], s47 offen lds
  s_add_u32 s47, s27, s49
  s_add_u32 m0, s28, 41984
  s_nop 0
  buffer_load_dwordx4 v4, s[8:11], s47 offen lds
  s_add_u32 s27, s27, s50
  v_add_u32 v12, 49152, v7
  ds_read_b64_tr_b16 a[176:177], v12 offset:0
  ds_read_b64_tr_b16 a[178:179], v12 offset:2048
  ds_read_b64_tr_b16 a[180:181], v12 offset:64
  ds_read_b64_tr_b16 a[182:183], v12 offset:2112
  s_waitcnt lgkmcnt(0)
  s_waitcnt vmcnt(28)
  s_barrier
  s_mov_b32 s47, s27
  s_add_u32 m0, s28, 49152
  s_nop 0
  buffer_load_dwordx4 v4, s[8:11], s47 offen lds
  s_add_u32 s47, s27, s49
  s_add_u32 m0, s28, 50176
  s_nop 0
  buffer_load_dwordx4 v4, s[8:11], s47 offen lds
  s_add_u32 s27, s27, s50
  v_add_u32 v12, 57344, v7
  ds_read_b64_tr_b16 a[184:185], v12 offset:0
  ds_read_b64_tr_b16 a[186:187], v12 offset:2048
  ds_read_b64_tr_b16 a[188:189], v12 offset:64
  ds_read_b64_tr_b16 a[190:191], v12 offset:2112
  s_waitcnt lgkmcnt(0)
  s_waitcnt vmcnt(28)
  s_barrier
  s_mov_b32 s47, s27
  s_add_u32 m0, s28, 57344
  s_nop 0
  buffer_load_dwordx4 v4, s[8:11], s47 offen lds
  s_add_u32 s47, s27, s49
  s_add_u32 m0, s28, 58368
  s_nop 0
  buffer_load_dwordx4 v4, s[8:11], s47 offen lds
  s_add_u32 s27, s27, s50
  v_add_u32 v12, 65536, v7
  ds_read_b64_tr_b16 a[192:193], v12 offset:0
  ds_read_b64_tr_b16 a[194:195], v12 offset:2048
  ds_read_b64_tr_b16 a[196:197], v12 offset:64
  ds_read_b64_tr_b16 a[198:199], v12 offset:2112
  s_waitcnt lgkmcnt(0)
  s_waitcnt vmcnt(28)
  s_barrier
  v_add_u32 v12, 73728, v7
  ds_read_b64_tr_b16 a[200:201], v12 offset:0
  ds_read_b64_tr_b16 a[202:203], v12 offset:2048
  ds_read_b64_tr_b16 a[204:205], v12 offset:64
  ds_read_b64_tr_b16 a[206:207], v12 offset:2112
  s_waitcnt lgkmcnt(0)
  s_waitcnt vmcnt(26)
  s_barrier
  v_add_u32 v12, 81920, v7
  ds_read_b64_tr_b16 a[208:209], v12 offset:0
  ds_read_b64_tr_b16 a[210:211], v12 offset:2048
  ds_read_b64_tr_b16 a[212:213], v12 offset:64
  ds_read_b64_tr_b16 a[214:215], v12 offset:2112
  s_waitcnt lgkmcnt(0)
  s_waitcnt vmcnt(24)
  s_barrier
  v_add_u32 v12, 90112, v7
  ds_read_b64_tr_b16 a[216:217], v12 offset:0
  ds_read_b64_tr_b16 a[218:219], v12 offset:2048
  ds_read_b64_tr_b16 a[220:221], v12 offset:64
  ds_read_b64_tr_b16 a[222:223], v12 offset:2112
  s_waitcnt lgkmcnt(0)
  s_waitcnt vmcnt(22)
  s_barrier
  v_add_u32 v12, 98304, v7
  ds_read_b64_tr_b16 a[224:225], v12 offset:0
  ds_read_b64_tr_b16 a[226:227], v12 offset:2048
  ds_read_b64_tr_b16 a[228:229], v12 offset:64
  ds_read_b64_tr_b16 a[230:231], v12 offset:2112
  s_waitcnt lgkmcnt(0)
  s_waitcnt vmcnt(20)
  s_barrier
  v_add_u32 v12, 106496, v7
  ds_read_b64_tr_b16 a[232:233], v12 offset:0
  ds_read_b64_tr_b16 a[234:235], v12 offset:2048
  ds_read_b64_tr_b16 a[236:237], v12 offset:64
  ds_read_b64_tr_b16 a[238:239], v12 offset:2112
  s_waitcnt lgkmcnt(0)
  s_waitcnt vmcnt(18)
  s_barrier
  v_add_u32 v12, 114688, v7
  ds_read_b64_tr_b16 a[240:241], v12 offset:0
  ds_read_b64_tr_b16 a[242:243], v12 offset:2048
  ds_read_b64_tr_b16 a[244:245], v12 offset:64
  ds_read_b64_tr_b16 a[246:247], v12 offset:2112
  s_waitcnt lgkmcnt(0)
  s_waitcnt vmcnt(16)
  s_barrier
  v_add_u32 v12, 122880, v7
  ds_read_b64_tr_b16 a[248:249], v12 offset:0
  ds_read_b64_tr_b16 a[250:251], v12 offset:2048
  ds_read_b64_tr_b16 a[252:253], v12 offset:64
  ds_read_b64_tr_b16 a[254:255], v12 offset:2112
  s_waitcnt lgkmcnt(0)
  s_waitcnt vmcnt(14)
  s_barrier
  v_add_u32 v12, 0, v7
  ds_read_b64_tr_b16 v[192:193], v12 offset:0
  ds_read_b64_tr_b16 v[194:195], v12 offset:2048
  ds_read_b64_tr_b16 v[196:197], v12 offset:64
  ds_read_b64_tr_b16 v[198:199], v12 offset:2112
  s_waitcnt lgkmcnt(0)
  s_waitcnt vmcnt(12)
  s_barrier
  v_add_u32 v12, 8192, v7
  ds_read_b64_tr_b16 v[200:201], v12 offset:0
  ds_read_b64_tr_b16 v[202:203], v12 offset:2048
  ds_read_b64_tr_b16 v[204:205], v12 offset:64
  ds_read_b64_tr_b16 v[206:207], v12 offset:2112
  s_waitcnt lgkmcnt(0)
  s_waitcnt vmcnt(10)
  s_barrier
  v_add_u32 v12, 16384, v7
  ds_read_b64_tr_b16 v[208:209], v12 offset:0
  ds_read_b64_tr_b16 v[210:211], v12 offset:2048
  ds_read_b64_tr_b16 v[212:213], v12 offset:64
  ds_read_b64_tr_b16 v[214:215], v12 offset:2112
  s_waitcnt lgkmcnt(0)
  s_waitcnt vmcnt(8)
  s_barrier
  v_add_u32 v12, 24576, v7
  ds_read_b64_tr_b16 v[216:217], v12 offset:0
  ds_read_b64_tr_b16 v[218:219], v12 offset:2048
  ds_read_b64_tr_b16 v[220:221], v12 offset:64
  ds_read_b64_tr_b16 v[222:223], v12 offset:2112
  s_waitcnt lgkmcnt(0)
  s_waitcnt vmcnt(6)
  s_barrier
  v_add_u32 v12, 32768, v7
  ds_read_b64_tr_b16 v[224:225], v12 offset:0
  ds_read_b64_tr_b16 v[226:227], v12 offset:2048
  ds_read_b64_tr_b16 v[228:229], v12 offset:64
  ds_read_b64_tr_b16 v[230:231], v12 offset:2112
  s_waitcnt lgkmcnt(0)
  s_waitcnt vmcnt(4)
  s_barrier
  v_add_u32 v12, 40960, v7
  ds_read_b64_tr_b16 v[232:233], v12 offset:0
  ds_read_b64_tr_b16 v[234:235], v12 offset:2048
  ds_read_b64_tr_b16 v[236:237], v12 offset:64
  ds_read_b64_tr_b16 v[238:239], v12 offset:2112
  s_waitcnt lgkmcnt(0)
  s_waitcnt vmcnt(2)
  s_barrier
  v_add_u32 v12, 49152, v7
  ds_read_b64_tr_b16 v[240:241], v12 offset:0
  ds_read_b64_tr_b16 v[242:243], v12 offset:2048
  ds_read_b64_tr_b16 v[244:245], v12 offset:64
  ds_read_b64_tr_b16 v[246:247], v12 offset:2112
  s_waitcnt lgkmcnt(0)
  s_waitcnt vmcnt(0)
  s_barrier
  v_add_u32 v12, 57344, v7
  ds_read_b64_tr_b16 v[248:249], v12 offset:0
  ds_read_b64_tr_b16 v[250:251], v12 offset:2048
  ds_read_b64_tr_b16 v[252:253], v12 offset:64
  ds_read_b64_tr_b16 v[254:255], v12 offset:2112
  s_waitcnt lgkmcnt(0)
  s_barrier
  v_and_b32 v2, 63, v0
  v_and_b32 v3, 15, v2
  v_bfe_u32 v4, v2, 4, 1
  v_lshrrev_b32 v5, 5, v2
  v_lshlrev_b32 v6, 12, v4
  v_lshl_add_u32 v6, v5, 8, v6
  v_lshl_add_u32 v6, v3, 4, v6
  s_cmp_eq_u32 s3, 0
  s_cbranch_scc1 L_CF5
L_CR5:
  s_cmp_lg_u32 s13, 0
  s_cbranch_scc1 LNW_61
  v_mov_b32 v8, 1152
LNP_62:
  buffer_load_dword v9, v8, s[4:7], 0 offen sc1
  s_sub_u32 s74, s74, 1
  s_cbranch_scc1 L_TIMEOUT
  s_waitcnt vmcnt(0)
  v_cmp_gt_u32 vcc, 64, v9
  s_nop 0
  s_cbranch_vccz LNK_63
  s_sleep 12
  s_branch LNP_62
LNK_63:
LNW_61:
  s_barrier
  s_mul_i32 s30, s13, 10240
  s_mul_i32 s47, s24, 40960
  s_add_u32 s47, s47, s30
  s_add_u32 s27, s47, 3145728
  s_add_u32 s34, s27, 614400
  s_mov_b32 s29, 0
  s_mov_b32 s32, 0
  s_mov_b32 s33, 0
  s_barrier
  s_add_u32 s52, s33, s30
  s_add_u32 s53, s27, 0
  s_add_u32 m0, s52, 0
  s_nop 0
  buffer_load_dwordx4 v1, s[4:7], s53 offen offset:0 sc1 lds
  buffer_load_dwordx4 v1, s[4:7], s53 offen offset:1024 sc1 lds
  buffer_load_dwordx4 v1, s[4:7], s53 offen offset:2048 sc1 lds
  buffer_load_dwordx4 v1, s[4:7], s53 offen offset:3072 sc1 lds
  s_add_u32 s53, s27, 4096
  s_add_u32 m0, s52, 4096
  s_nop 0
  buffer_load_dwordx4 v1, s[4:7], s53 offen offset:0 sc1 lds
  buffer_load_dwordx4 v1, s[4:7], s53 offen offset:1024 sc1 lds
  buffer_load_dwordx4 v1, s[4:7], s53 offen offset:2048 sc1 lds
  buffer_load_dwordx4 v1, s[4:7], s53 offen offset:3072 sc1 lds
  s_add_u32 s53, s27, 8192
  s_add_u32 m0, s52, 8192
  s_nop 0
  buffer_load_dwordx4 v1, s[4:7], s53 offen offset:0 sc1 lds
  buffer_load_dwordx4 v1, s[4:7], s53 offen offset:1024 sc1 lds
  s_add_u32 s27, s27, 40960
  s_min_u32 s27, s27, s34
  s_add_u32 s33, s33, 40960
  s_cmp_eq_u32 s33, 122880
  s_cselect_b32 s33, 0, s33
  s_add_u32 s52, s33, s30
  s_add_u32 s53, s27, 0
  s_add_u32 m0, s52, 0
  s_nop 0
  buffer_load_dwordx4 v1, s[4:7], s53 offen offset:0 sc1 lds
  buffer_load_dwordx4 v1, s[4:7], s53 offen offset:1024 sc1 lds
  buffer_load_dwordx4 v1, s[4:7], s53 offen offset:2048 sc1 lds
  buffer_load_dwordx4 v1, s[4:7], s53 offen offset:3072 sc1 lds
  s_add_u32 s53, s27, 4096
  s_add_u32 m0, s52, 4096
  s_nop 0
  buffer_load_dwordx4 v1, s[4:7], s53 offen offset:0 sc1 lds
  buffer_load_dwordx4 v1, s[4:7], s53 offen offset:1024 sc1 lds
  buffer_load_dwordx4 v1, s[4:7], s53 offen offset:2048 sc1 lds
  buffer_load_dwordx4 v1, s[4:7], s53 offen offset:3072 sc1 lds
  s_add_u32 s53, s27, 8192
  s_add_u32 m0, s52, 8192
  s_nop 0
  buffer_load_dwordx4 v1, s[4:7], s53 offen offset:0 sc1 lds
  buffer_load_dwordx4 v1, s[4:7], s53 offen offset:1024 sc1 lds
  s_add_u32 s27, s27, 40960
  s_min_u32 s27, s27, s34
  s_add_u32 s33, s33, 40960
  s_cmp_eq_u32 s33, 122880
  s_cselect_b32 s33, 0, s33
  s_waitcnt vmcnt(10)
  s_barrier
  v_add_u32 v12, s32, v1
  ds_read_b128 v[16:19], v12 offset:0
  ds_read_b128 v[20:23], v12 offset:1024
  ds_read_b128 v[24:27], v12 offset:2048
  s_waitcnt lgkmcnt(2)
  v_mfma_f32_32x32x16_bf16 v[96:111], a[0:3], v[16:19], 0
  ds_read_b128 v[28:31], v12 offset:3072
  v_mfma_f32_32x32x16_bf16 v[112:127], a[4:7], v[16:19], 0
  s_add_u32 s52, s33, s30
  s_add_u32 s53, s27, 0
  s_add_u32 m0, s52, 0
  s_nop 0
  buffer_load_dwordx4 v1, s[4:7], s53 offen offset:0 sc1 lds
  s_waitcnt lgkmcnt(2)
  v_mfma_f32_32x32x16_bf16 v[96:111], a[8:11], v[20:23], v[96:111]
  ds_read_b128 v[16:19], v12 offset:4096
  v_mfma_f32_32x32x16_bf16 v[112:127], a[12:15], v[20:23], v[112:127]
  s_waitcnt lgkmcnt(2)
  v_mfma_f32_32x32x16_bf16 v[96:111], a[16:19], v[24:27], v[96:111]
  ds_read_b128 v[20:23], v12 offset:5120
  v_mfma_f32_32x32x16_bf16 v[112:127], a[20:23], v[24:27], v[112:127]
  buffer_load_dwordx4 v1, s[4:7], s53 offen offset:1024 sc1 lds
  s_waitcnt lgkmcnt(2)
  v_mfma_f32_32x32x16_bf16 v[96:111], a[24:27], v[28:31], v[96:111]
  ds_read_b128 v[24:27], v12 offset:6144
  v_mfma_f32_32x32x16_bf16 v[112:127], a[28:31], v[28:31], v[112:127]
  s_waitcnt lgkmcnt(2)
  v_mfma_f32_32x32x16_bf16 v[96:111], a[32:35], v[16:19], v[96:111]
  ds_read_b128 v[28:31], v12 offset:7168
  v_mfma_f32_32x32x16_bf16 v[112:127], a[36:39], v[16:19], v[112:127]
  buffer_load_dwordx4 v1, s[4:7], s53 offen offset:2048 sc1 lds
  s_waitcnt lgkmcnt(2)
  v_mfma_f32_32x32x16_bf16 v[96:111], a[40:43], v[20:23], v[96:111]
  ds_read_b128 v[16:19], v12 offset:8192
  v_mfma_f32_32x32x16_bf16 v[112:127], a[44:47], v[20:23], v[112:127]
  s_waitcnt lgkmcnt(2)
  v_mfma_f32_32x32x16_bf16 v[96:111], a[48:51], v[24:27], v[96:111]
  ds_read_b128 v[20:23], v12 offset:9216
  v_mfma_f32_32x32x16_bf16 v[112:127], a[52:55], v[24:27], v[112:127]
  buffer_load_dwordx4 v1, s[4:7], s53 offen offset:3072 sc1 lds
  s_waitcnt lgkmcnt(2)
  v_mfma_f32_32x32x16_bf16 v[96:111], a[56:59], v[28:31], v[96:111]
  ds_read_b128 v[24:27], v12 offset:10240
  v_mfma_f32_32x32x16_bf16 v[112:127], a[60:63], v[28:31], v[112:127]
  s_waitcnt lgkmcnt(2)
  v_mfma_f32_32x32x16_bf16 v[96:111], a[64:67], v[16:19], v[96:111]
  ds_read_b128 v[28:31], v12 offset:11264
  v_mfma_f32_32x32x16_bf16 v[112:127], a[68:71], v[16:19], v[112:127]
  s_add_u32 s53, s27, 4096
  s_add_u32 m0, s52, 4096
  s_nop 0
  buffer_load_dwordx4 v1, s[4:7], s53 offen offset:0 sc1 lds
  s_waitcnt lgkmcnt(2)
  v_mfma_f32_32x32x16_bf16 v[96:111], a[72:75], v[20:23], v[96:111]
  ds_read_b128 v[16:19], v12 offset:12288
  v_mfma_f32_32x32x16_bf16 v[112:127], a[76:79], v[20:23], v[112:127]
  s_waitcnt lgkmcnt(2)
  v_mfma_f32_32x32x16_bf16 v[96:111], a[80:83], v[24:27], v[96:111]
  ds_read_b128 v[20:23], v12 offset:13312
  v_mfma_f32_32x32x16_bf16 v[112:127], a[84:87], v[24:27], v[112:127]
  buffer_load_dwordx4 v1, s[4:7], s53 offen offset:1024 sc1 lds
  s_waitcnt lgkmcnt(2)
  v_mfma_f32_32x32x16_bf16 v[96:111], a[88:91], v[28:31], v[96:111]
  ds_read_b128 v[24:27], v12 offset:14336
  v_mfma_f32_32x32x16_bf16 v[112:127], a[92:95], v[28:31], v[112:127]
  s_waitcnt lgkmcnt(2)
  v_mfma_f32_32x32x16_bf16 v[96:111], a[96:99], v[16:19], v[96:111]
  ds_read_b128 v[28:31], v12 offset:15360
  v_mfma_f32_32x32x16_bf16 v[112:127], a[100:103], v[16:19], v[112:127]
  buffer_load_dwordx4 v1, s[4:7], s53 offen offset:2048 sc1 lds
  s_waitcnt lgkmcnt(2)
  v_mfma_f32_32x32x16_bf16 v[96:111], a[104:107], v[20:23], v[96:111]
  ds_read_b128 v[16:19], v12 offset:16384
  v_mfma_f32_32x32x16_bf16 v[112:127], a[108:111], v[20:23], v[112:127]
  s_waitcnt lgkmcnt(2)
  v_mfma_f32_32x32x16_bf16 v[96:111], a[112:115], v[24:27], v[96:111]
  ds_read_b128 v[20:23], v12 offset:17408
  v_mfma_f32_32x32x16_bf16 v[112:127], a[116:119], v[24:27], v[112:127]
  buffer_load_dwordx4 v1, s[4:7], s53 offen offset:3072 sc1 lds
  s_waitcnt lgkmcnt(2)
  v_mfma_f32_32x32x16_bf16 v[96:111], a[120:123], v[28:31], v[96:111]
  ds_read_b128 v[24:27], v12 offset:18432
  v_mfma_f32_32x32x16_bf16 v[112:127], a[124:127], v[28:31], v[112:127]
  s_waitcnt lgkmcnt(2)
  v_mfma_f32_32x32x16_bf16 v[96:111], a[128:131], v[16:19], v[96:111]
  ds_read_b128 v[28:31], v12 offset:19456
  v_mfma_f32_32x32x16_bf16 v[112:127], a[132:135], v[16:19], v[112:127]
  s_add_u32 s53, s27, 8192
  s_add_u32 m0, s52, 8192
  s_nop 0
  buffer_load_dwordx4 v1, s[4:7], s53 offen offset:0 sc1 lds
  s_waitcnt lgkmcnt(2)
  v_mfma_f32_32x32x16_bf16 v[96:111], a[136:139], v[20:23], v[96:111]
  ds_read_b128 v[16:19], v12 offset:20480
  v_mfma_f32_32x32x16_bf16 v[112:127], a[140:143], v[20:23], v[112:127]
  s_waitcnt lgkmcnt(2)
  v_mfma_f32_32x32x16_bf16 v[96:111], a[144:147], v[24:27], v[96:111]
  ds_read_b128 v[20:23], v12 offset:21504
  v_mfma_f32_32x32x16_bf16 v[112:127], a[148:151], v[24:27], v[112:127]
  buffer_load_dwordx4 v1, s[4:7], s53 offen offset:1024 sc1 lds
  s_add_u32 s27, s27, 40960
  s_min_u32 s27, s27, s34
  s_add_u32 s33, s33, 40960
  s_cmp_eq_u32 s33, 122880
  s_cselect_b32 s33, 0, s33
  s_waitcnt lgkmcnt(2)
  v_mfma_f32_32x32x16_bf16 v[96:111], a[152:155], v[28:31], v[96:111]
  ds_read_b128 v[24:27], v12 offset:22528
  v_mfma_f32_32x32x16_bf16 v[112:127], a[156:159], v[28:31], v[112:127]
  s_waitcnt lgkmcnt(2)
  v_mfma_f32_32x32x16_bf16 v[96:111], a[160:163], v[16:19], v[96:111]
  ds_read_b128 v[28:31], v12 offset:23552
  v_mfma_f32_32x32x16_bf16 v[112:127], a[164:167], v[16:19], v[112:127]
  s_waitcnt lgkmcnt(2)
  v_mfma_f32_32x32x16_bf16 v[96:111], a[168:171], v[20:23], v[96:111]
  ds_read_b128 v[16:19], v12 offset:24576
  v_mfma_f32_32x32x16_bf16 v[112:127], a[172:175], v[20:23], v[112:127]
  s_waitcnt lgkmcnt(2)
  v_mfma_f32_32x32x16_bf16 v[96:111], a[176:179], v[24:27], v[96:111]
  ds_read_b128 v[20:23], v12 offset:25600
  v_mfma_f32_32x32x16_bf16 v[112:127], a[180:183], v[24:27], v[112:127]
  s_waitcnt lgkmcnt(2)
  v_mfma_f32_32x32x16_bf16 v[96:111], a[184:187], v[28:31], v[96:111]
  ds_read_b128 v[24:27], v12 offset:26624
  v_mfma_f32_32x32x16_bf16 v[112:127], a[188:191], v[28:31], v[112:127]
  s_waitcnt lgkmcnt(2)
  v_mfma_f32_32x32x16_bf16 v[96:111], a[192:195], v[16:19], v[96:111]
  ds_read_b128 v[28:31], v12 offset:27648
  v_mfma_f32_32x32x16_bf16 v[112:127], a[196:199], v[16:19], v[112:127]
  s_waitcnt lgkmcnt(2)
  v_mfma_f32_32x32x16_bf16 v[96:111], a[200:203], v[20:23], v[96:111]
  ds_read_b128 v[16:19], v12 offset:28672
  v_mfma_f32_32x32x16_bf16 v[112:127], a[204:207], v[20:23], v[112:127]
  s_waitcnt lgkmcnt(2)
  v_mfma_f32_32x32x16_bf16 v[96:111], a[208:211], v[24:27], v[96:111]
  ds_read_b128 v[20:23], v12 offset:29696
  v_mfma_f32_32x32x16_bf16 v[112:127], a[212:215], v[24:27], v[112:127]
  s_waitcnt lgkmcnt(2)
  v_mfma_f32_32x32x16_bf16 v[96:111], a[216:219], v[28:31], v[96:111]
  ds_read_b128 v[24:27], v12 offset:30720
  v_mfma_f32_32x32x16_bf16 v[112:127], a[220:223], v[28:31], v[112:127]
  s_waitcnt lgkmcnt(2)
  v_mfma_f32_32x32x16_bf16 v[96:111], a[224:227], v[16:19], v[96:111]
  ds_read_b128 v[28:31], v12 offset:31744
  v_mfma_f32_32x32x16_bf16 v[112:127], a[228:231], v[16:19], v[112:127]
  s_waitcnt lgkmcnt(2)
  v_mfma_f32_32x32x16_bf16 v[96:111], a[232:235], v[20:23], v[96:111]
  ds_read_b128 v[16:19], v12 offset:32768
  v_mfma_f32_32x32x16_bf16 v[112:127], a[236:239], v[20:23], v[112:127]
  s_waitcnt lgkmcnt(2)
  v_mfma_f32_32x32x16_bf16 v[96:111], a[240:243], v[24:27], v[96:111]
  ds_read_b128 v[20:23], v12 offset:33792
  v_mfma_f32_32x32x16_bf16 v[112:127], a[244:247], v[24:27], v[112:127]
  s_waitcnt lgkmcnt(2)
  v_mfma_f32_32x32x16_bf16 v[96:111], a[248:251], v[28:31], v[96:111]
  ds_read_b128 v[24:27], v12 offset:34816
  v_mfma_f32_32x32x16_bf16 v[112:127], a[252:255], v[28:31], v[112:127]
  s_waitcnt lgkmcnt(2)
  v_mfma_f32_32x32x16_bf16 v[96:111], v[192:195], v[16:19], v[96:111]
  ds_read_b128 v[28:31], v12 offset:35840
  v_mfma_f32_32x32x16_bf16 v[112:127], v[196:199], v[16:19], v[112:127]
  s_waitcnt lgkmcnt(2)
  v_mfma_f32_32x32x16_bf16 v[96:111], v[200:203], v[20:23], v[96:111]
  ds_read_b128 v[16:19], v12 offset:36864
  v_mfma_f32_32x32x16_bf16 v[112:127], v[204:207], v[20:23], v[112:127]
  s_waitcnt lgkmcnt(2)
  v_mfma_f32_32x32x16_bf16 v[96:111], v[208:211], v[24:27], v[96:111]
  ds_read_b128 v[20:23], v12 offset:37888
  v_mfma_f32_32x32x16_bf16 v[112:127], v[212:215], v[24:27], v[112:127]
  s_waitcnt lgkmcnt(2)
  v_mfma_f32_32x32x16_bf16 v[96:111], v[216:219], v[28:31], v[96:111]
  ds_read_b128 v[24:27], v12 offset:38912
  v_mfma_f32_32x32x16_bf16 v[112:127], v[220:223], v[28:31], v[112:127]
  s_waitcnt lgkmcnt(2)
  v_mfma_f32_32x32x16_bf16 v[96:111], v[224:227], v[16:19], v[96:111]
  ds_read_b128 v[28:31], v12 offset:39936
  v_mfma_f32_32x32x16_bf16 v[112:127], v[228:231], v[16:19], v[112:127]
  s_waitcnt lgkmcnt(2)
  v_mfma_f32_32x32x16_bf16 v[96:111], v[232:235], v[20:23], v[96:111]
  v_mfma_f32_32x32x16_bf16 v[112:127], v[236:239], v[20:23], v[112:127]
  s_waitcnt lgkmcnt(1)
  v_mfma_f32_32x32x16_bf16 v[96:111], v[240:243], v[24:27], v[96:111]
  v_mfma_f32_32x32x16_bf16 v[112:127], v[244:247], v[24:27], v[112:127]
  s_waitcnt lgkmcnt(0)
  v_mfma_f32_32x32x16_bf16 v[96:111], v[248:251], v[28:31], v[96:111]
  v_mfma_f32_32x32x16_bf16 v[112:127], v[252:255], v[28:31], v[112:127]
  s_add_u32 s32, s32, 40960
  s_cmp_eq_u32 s32, 122880
  s_cselect_b32 s32, 0, s32
  s_add_u32 s29, s29, 1
  s_waitcnt vmcnt(10)
  s_barrier
  s_sub_u32 s49, s29, 2
  s_max_i32 s49, s49, 0
  s_cmp_lg_u32 s13, 0
  s_cbranch_scc1 PB_67
  v_mov_b32 v8, s49
  v_mov_b32 v9, s26
  buffer_store_dword v8, v9, s[4:7], 0 offen sc1
PB_67:
  s_add_u32 s47, s24, s29
  s_sub_u32 s47, s47, 1
  s_lshl_b32 s25, s47, 18
  s_add_u32 s25, s25, s31
  v_add_u32 v12, s32, v1
  ds_read_b128 v[16:19], v12 offset:0
  ds_read_b128 v[20:23], v12 offset:1024
  ds_read_b128 v[24:27], v12 offset:2048
  s_waitcnt lgkmcnt(2)
  v_mfma_f32_32x32x16_bf16 v[128:143], a[0:3], v[16:19], 0
  ds_read_b128 v[28:31], v12 offset:3072
  v_mfma_f32_32x32x16_bf16 v[144:159], a[4:7], v[16:19], 0
  s_add_u32 s52, s33, s30
  s_add_u32 s53, s27, 0
  s_add_u32 m0, s52, 0
  s_nop 0
  buffer_load_dwordx4 v1, s[4:7], s53 offen offset:0 sc1 lds
  s_waitcnt lgkmcnt(2)
  v_mfma_f32_32x32x16_bf16 v[128:143], a[8:11], v[20:23], v[128:143]
  ds_read_b128 v[16:19], v12 offset:4096
  v_mfma_f32_32x32x16_bf16 v[144:159], a[12:15], v[20:23], v[144:159]
  s_waitcnt lgkmcnt(2)
  v_mfma_f32_32x32x16_bf16 v[128:143], a[16:19], v[24:27], v[128:143]
  ds_read_b128 v[20:23], v12 offset:5120
  v_mfma_f32_32x32x16_bf16 v[144:159], a[20:23], v[24:27], v[144:159]
  buffer_load_dwordx4 v1, s[4:7], s53 offen offset:1024 sc1 lds
  s_waitcnt lgkmcnt(2)
  v_mfma_f32_32x32x16_bf16 v[128:143], a[24:27], v[28:31], v[128:143]
  ds_read_b128 v[24:27], v12 offset:6144
  v_mfma_f32_32x32x16_bf16 v[144:159], a[28:31], v[28:31], v[144:159]
  s_waitcnt lgkmcnt(2)
  v_mfma_f32_32x32x16_bf16 v[128:143], a[32:35], v[16:19], v[128:143]
  ds_read_b128 v[28:31], v12 offset:7168
  v_mfma_f32_32x32x16_bf16 v[144:159], a[36:39], v[16:19], v[144:159]
  buffer_load_dwordx4 v1, s[4:7], s53 offen offset:2048 sc1 lds
  s_waitcnt lgkmcnt(2)
  v_mfma_f32_32x32x16_bf16 v[128:143], a[40:43], v[20:23], v[128:143]
  ds_read_b128 v[16:19], v12 offset:8192
  v_mfma_f32_32x32x16_bf16 v[144:159], a[44:47], v[20:23], v[144:159]
  s_waitcnt lgkmcnt(2)
  v_mfma_f32_32x32x16_bf16 v[128:143], a[48:51], v[24:27], v[128:143]
  ds_read_b128 v[20:23], v12 offset:9216
  v_mfma_f32_32x32x16_bf16 v[144:159], a[52:55], v[24:27], v[144:159]
  buffer_load_dwordx4 v1, s[4:7], s53 offen offset:3072 sc1 lds
  s_waitcnt lgkmcnt(2)
  v_mfma_f32_32x32x16_bf16 v[128:143], a[56:59], v[28:31], v[128:143]
  ds_read_b128 v[24:27], v12 offset:10240
  v_mfma_f32_32x32x16_bf16 v[144:159], a[60:63], v[28:31], v[144:159]
  s_waitcnt lgkmcnt(2)
  v_mfma_f32_32x32x16_bf16 v[128:143], a[64:67], v[16:19], v[128:143]
  ds_read_b128 v[28:31], v12 offset:11264
  v_mfma_f32_32x32x16_bf16 v[144:159], a[68:71], v[16:19], v[144:159]
  s_add_u32 s53, s27, 4096
  s_add_u32 m0, s52, 4096
  s_nop 0
  buffer_load_dwordx4 v1, s[4:7], s53 offen offset:0 sc1 lds
  s_waitcnt lgkmcnt(2)
  v_mfma_f32_32x32x16_bf16 v[128:143], a[72:75], v[20:23], v[128:143]
  ds_read_b128 v[16:19], v12 offset:12288
  v_mfma_f32_32x32x16_bf16 v[144:159], a[76:79], v[20:23], v[144:159]
  s_waitcnt lgkmcnt(2)
  v_mfma_f32_32x32x16_bf16 v[128:143], a[80:83], v[24:27], v[128:143]
  ds_read_b128 v[20:23], v12 offset:13312
  v_mfma_f32_32x32x16_bf16 v[144:159], a[84:87], v[24:27], v[144:159]
  buffer_load_dwordx4 v1, s[4:7], s53 offen offset:1024 sc1 lds
  s_waitcnt lgkmcnt(2)
  v_mfma_f32_32x32x16_bf16 v[128:143], a[88:91], v[28:31], v[128:143]
  ds_read_b128 v[24:27], v12 offset:14336
  v_mfma_f32_32x32x16_bf16 v[144:159], a[92:95], v[28:31], v[144:159]
  s_waitcnt lgkmcnt(2)
  v_mfma_f32_32x32x16_bf16 v[128:143], a[96:99], v[16:19], v[128:143]
  ds_read_b128 v[28:31], v12 offset:15360
  v_mfma_f32_32x32x16_bf16 v[144:159], a[100:103], v[16:19], v[144:159]
  buffer_load_dwordx4 v1, s[4:7], s53 offen offset:2048 sc1 lds
  s_waitcnt lgkmcnt(2)
  v_mfma_f32_32x32x16_bf16 v[128:143], a[104:107], v[20:23], v[128:143]
  ds_read_b128 v[16:19], v12 offset:16384
  v_mfma_f32_32x32x16_bf16 v[144:159], a[108:111], v[20:23], v[144:159]
  s_waitcnt lgkmcnt(2)
  v_mfma_f32_32x32x16_bf16 v[128:143], a[112:115], v[24:27], v[128:143]
  ds_read_b128 v[20:23], v12 offset:17408
  v_mfma_f32_32x32x16_bf16 v[144:159], a[116:119], v[24:27], v[144:159]
  buffer_load_dwordx4 v1, s[4:7], s53 offen offset:3072 sc1 lds
  s_waitcnt lgkmcnt(2)
  v_mfma_f32_32x32x16_bf16 v[128:143], a[120:123], v[28:31], v[128:143]
  ds_read_b128 v[24:27], v12 offset:18432
  v_mfma_f32_32x32x16_bf16 v[144:159], a[124:127], v[28:31], v[144:159]
  s_waitcnt lgkmcnt(2)
  v_mfma_f32_32x32x16_bf16 v[128:143], a[128:131], v[16:19], v[128:143]
  ds_read_b128 v[28:31], v12 offset:19456
  v_mfma_f32_32x32x16_bf16 v[144:159], a[132:135], v[16:19], v[144:159]
  s_add_u32 s53, s27, 8192
  s_add_u32 m0, s52, 8192
  s_nop 0
  buffer_load_dwordx4 v1, s[4:7], s53 offen offset:0 sc1 lds
  s_waitcnt lgkmcnt(2)
  v_mfma_f32_32x32x16_bf16 v[128:143], a[136:139], v[20:23], v[128:143]
  ds_read_b128 v[16:19], v12 offset:20480
  v_mfma_f32_32x32x16_bf16 v[144:159], a[140:143], v[20:23], v[144:159]
  s_waitcnt lgkmcnt(2)
  v_mfma_f32_32x32x16_bf16 v[128:143], a[144:147], v[24:27], v[128:143]
  ds_read_b128 v[20:23], v12 offset:21504
  v_mfma_f32_32x32x16_bf16 v[144:159], a[148:151], v[24:27], v[144:159]
  buffer_load_dwordx4 v1, s[4:7], s53 offen offset:1024 sc1 lds
  s_add_u32 s27, s27, 40960
  s_min_u32 s27, s27, s34
  s_add_u32 s33, s33, 40960
  s_cmp_eq_u32 s33, 122880
  s_cselect_b32 s33, 0, s33
  s_waitcnt lgkmcnt(2)
  v_mfma_f32_32x32x16_bf16 v[128:143], a[152:155], v[28:31], v[128:143]
  ds_read_b128 v[24:27], v12 offset:22528
  v_mfma_f32_32x32x16_bf16 v[144:159], a[156:159], v[28:31], v[144:159]
  s_waitcnt lgkmcnt(2)
  v_mfma_f32_32x32x16_bf16 v[128:143], a[160:163], v[16:19], v[128:143]
  ds_read_b128 v[28:31], v12 offset:23552
  v_mfma_f32_32x32x16_bf16 v[144:159], a[164:167], v[16:19], v[144:159]
  s_waitcnt lgkmcnt(2)
  v_mfma_f32_32x32x16_bf16 v[128:143], a[168:171], v[20:23], v[128:143]
  ds_read_b128 v[16:19], v12 offset:24576
  v_mfma_f32_32x32x16_bf16 v[144:159], a[172:175], v[20:23], v[144:159]
  s_waitcnt lgkmcnt(2)
  v_mfma_f32_32x32x16_bf16 v[128:143], a[176:179], v[24:27], v[128:143]
  ds_read_b128 v[20:23], v12 offset:25600
  v_mfma_f32_32x32x16_bf16 v[144:159], a[180:183], v[24:27], v[144:159]
  s_waitcnt lgkmcnt(2)
  v_mfma_f32_32x32x16_bf16 v[128:143], a[184:187], v[28:31], v[128:143]
  ds_read_b128 v[24:27], v12 offset:26624
  v_mfma_f32_32x32x16_bf16 v[144:159], a[188:191], v[28:31], v[144:159]
  s_waitcnt lgkmcnt(2)
  v_mfma_f32_32x32x16_bf16 v[128:143], a[192:195], v[16:19], v[128:143]
  ds_read_b128 v[28:31], v12 offset:27648
  v_mfma_f32_32x32x16_bf16 v[144:159], a[196:199], v[16:19], v[144:159]
  s_waitcnt lgkmcnt(2)
  v_mfma_f32_32x32x16_bf16 v[128:143], a[200:203], v[20:23], v[128:143]
  ds_read_b128 v[16:19], v12 offset:28672
  v_mfma_f32_32x32x16_bf16 v[144:159], a[204:207], v[20:23], v[144:159]
  s_waitcnt lgkmcnt(2)
  v_mfma_f32_32x32x16_bf16 v[128:143], a[208:211], v[24:27], v[128:143]
  ds_read_b128 v[20:23], v12 offset:29696
  v_mfma_f32_32x32x16_bf16 v[144:159], a[212:215], v[24:27], v[144:159]
  s_waitcnt lgkmcnt(2)
  v_mfma_f32_32x32x16_bf16 v[128:143], a[216:219], v[28:31], v[128:143]
  ds_read_b128 v[24:27], v12 offset:30720
  v_mfma_f32_32x32x16_bf16 v[144:159], a[220:223], v[28:31], v[144:159]
  s_waitcnt lgkmcnt(2)
  v_mfma_f32_32x32x16_bf16 v[128:143], a[224:227], v[16:19], v[128:143]
  ds_read_b128 v[28:31], v12 offset:31744
  v_cvt_pk_bf16_f32 v40, v96, v97
  v_mfma_f32_32x32x16_bf16 v[144:159], a[228:231], v[16:19], v[144:159]
  v_cvt_pk_bf16_f32 v41, v98, v99
  s_waitcnt lgkmcnt(2)
  v_mfma_f32_32x32x16_bf16 v[128:143], a[232:235], v[20:23], v[128:143]
  ds_read_b128 v[16:19], v12 offset:32768
  v_cvt_pk_bf16_f32 v42, v100, v101
  v_mfma_f32_32x32x16_bf16 v[144:159], a[236:239], v[20:23], v[144:159]
  v_cvt_pk_bf16_f32 v43, v102, v103
  s_waitcnt lgkmcnt(2)
  v_mfma_f32_32x32x16_bf16 v[128:143], a[240:243], v[24:27], v[128:143]
  ds_read_b128 v[20:23], v12 offset:33792
  buffer_store_dwordx4 v[40:43], v6, s[4:7], s25 offen offset:0 sc1
  v_mfma_f32_32x32x16_bf16 v[144:159], a[244:247], v[24:27], v[144:159]
  v_cvt_pk_bf16_f32 v44, v104, v105
  s_waitcnt lgkmcnt(2)
  v_mfma_f32_32x32x16_bf16 v[128:143], a[248:251], v[28:31], v[128:143]
  ds_read_b128 v[24:27], v12 offset:34816
  v_cvt_pk_bf16_f32 v45, v106, v107
  v_mfma_f32_32x32x16_bf16 v[144:159], a[252:255], v[28:31], v[144:159]
  v_cvt_pk_bf16_f32 v46, v108, v109
  s_waitcnt lgkmcnt(2)
  v_mfma_f32_32x32x16_bf16 v[128:143], v[192:195], v[16:19], v[128:143]
  ds_read_b128 v[28:31], v12 offset:35840
  v_cvt_pk_bf16_f32 v47, v110, v111
  v_mfma_f32_32x32x16_bf16 v[144:159], v[196:199], v[16:19], v[144:159]
  buffer_store_dwordx4 v[44:47], v6, s[4:7], s25 offen offset:512 sc1
  s_waitcnt lgkmcnt(2)
  v_mfma_f32_32x32x16_bf16 v[128:143], v[200:203], v[20:23], v[128:143]
  ds_read_b128 v[16:19], v12 offset:36864
  v_cvt_pk_bf16_f32 v40, v112, v113
  v_mfma_f32_32x32x16_bf16 v[144:159], v[204:207], v[20:23], v[144:159]
  v_cvt_pk_bf16_f32 v41, v114, v115
  s_waitcnt lgkmcnt(2)
  v_mfma_f32_32x32x16_bf16 v[128:143], v[208:211], v[24:27], v[128:143]
  ds_read_b128 v[20:23], v12 offset:37888
  v_cvt_pk_bf16_f32 v42, v116, v117
  v_mfma_f32_32x32x16_bf16 v[144:159], v[212:215], v[24:27], v[144:159]
  v_cvt_pk_bf16_f32 v43, v118, v119
  s_waitcnt lgkmcnt(2)
  v_mfma_f32_32x32x16_bf16 v[128:143], v[216:219], v[28:31], v[128:143]
  ds_read_b128 v[24:27], v12 offset:38912
  buffer_store_dwordx4 v[40:43], v6, s[4:7], s25 offen offset:1024 sc1
  v_mfma_f32_32x32x16_bf16 v[144:159], v[220:223], v[28:31], v[144:159]
  v_cvt_pk_bf16_f32 v44, v120, v121
  s_waitcnt lgkmcnt(2)
  v_mfma_f32_32x32x16_bf16 v[128:143], v[224:227], v[16:19], v[128:143]
  ds_read_b128 v[28:31], v12 offset:39936
  v_cvt_pk_bf16_f32 v45, v122, v123
  v_mfma_f32_32x32x16_bf16 v[144:159], v[228:231], v[16:19], v[144:159]
  v_cvt_pk_bf16_f32 v46, v124, v125
  s_waitcnt lgkmcnt(2)
  v_mfma_f32_32x32x16_bf16 v[128:143], v[232:235], v[20:23], v[128:143]
  v_cvt_pk_bf16_f32 v47, v126, v127
  v_mfma_f32_32x32x16_bf16 v[144:159], v[236:239], v[20:23], v[144:159]
  buffer_store_dwordx4 v[44:47], v6, s[4:7], s25 offen offset:1536 sc1
  s_waitcnt lgkmcnt(1)
  v_mfma_f32_32x32x16_bf16 v[128:143], v[240:243], v[24:27], v[128:143]
  v_mfma_f32_32x32x16_bf16 v[144:159], v[244:247], v[24:27], v[144:159]
  s_waitcnt lgkmcnt(0)
  v_mfma_f32_32x32x16_bf16 v[128:143], v[248:251], v[28:31], v[128:143]
  v_mfma_f32_32x32x16_bf16 v[144:159], v[252:255], v[28:31], v[144:159]
  s_add_u32 s32, s32, 40960
  s_cmp_eq_u32 s32, 122880
  s_cselect_b32 s32, 0, s32
  s_add_u32 s29, s29, 1
W1T_64:
  s_waitcnt vmcnt(14)
  s_barrier
  s_sub_u32 s49, s29, 2
  s_max_i32 s49, s49, 0
  s_cmp_lg_u32 s13, 0
  s_cbranch_scc1 PB_68
  v_mov_b32 v8, s49
  v_mov_b32 v9, s26
  buffer_store_dword v8, v9, s[4:7], 0 offen sc1
PB_68:
  s_add_u32 s47, s24, s29
  s_sub_u32 s47, s47, 1
  s_lshl_b32 s25, s47, 18
  s_add_u32 s25, s25, s31
  v_add_u32 v12, s32, v1
  ds_read_b128 v[16:19], v12 offset:0
  ds_read_b128 v[20:23], v12 offset:1024
  ds_read_b128 v[24:27], v12 offset:2048
  s_waitcnt lgkmcnt(2)
  v_mfma_f32_32x32x16_bf16 v[96:111], a[0:3], v[16:19], 0
  ds_read_b128 v[28:31], v12 offset:3072
  v_mfma_f32_32x32x16_bf16 v[112:127], a[4:7], v[16:19], 0
  s_add_u32 s52, s33, s30
  s_add_u32 s53, s27, 0
  s_add_u32 m0, s52, 0
  s_nop 0
  buffer_load_dwordx4 v1, s[4:7], s53 offen offset:0 sc1 lds
  s_waitcnt lgkmcnt(2)
  v_mfma_f32_32x32x16_bf16 v[96:111], a[8:11], v[20:23], v[96:111]
  ds_read_b128 v[16:19], v12 offset:4096
  v_mfma_f32_32x32x16_bf16 v[112:127], a[12:15], v[20:23], v[112:127]
  s_waitcnt lgkmcnt(2)
  v_mfma_f32_32x32x16_bf16 v[96:111], a[16:19], v[24:27], v[96:111]
  ds_read_b128 v[20:23], v12 offset:5120
  v_mfma_f32_32x32x16_bf16 v[112:127], a[20:23], v[24:27], v[112:127]
  buffer_load_dwordx4 v1, s[4:7], s53 offen offset:1024 sc1 lds
  s_waitcnt lgkmcnt(2)
  v_mfma_f32_32x32x16_bf16 v[96:111], a[24:27], v[28:31], v[96:111]
  ds_read_b128 v[24:27], v12 offset:6144
  v_mfma_f32_32x32x16_bf16 v[112:127], a[28:31], v[28:31], v[112:127]
  s_waitcnt lgkmcnt(2)
  v_mfma_f32_32x32x16_bf16 v[96:111], a[32:35], v[16:19], v[96:111]
  ds_read_b128 v[28:31], v12 offset:7168
  v_mfma_f32_32x32x16_bf16 v[112:127], a[36:39], v[16:19], v[112:127]
  buffer_load_dwordx4 v1, s[4:7], s53 offen offset:2048 sc1 lds
  s_waitcnt lgkmcnt(2)
  v_mfma_f32_32x32x16_bf16 v[96:111], a[40:43], v[20:23], v[96:111]
  ds_read_b128 v[16:19], v12 offset:8192
  v_mfma_f32_32x32x16_bf16 v[112:127], a[44:47], v[20:23], v[112:127]
  s_waitcnt lgkmcnt(2)
  v_mfma_f32_32x32x16_bf16 v[96:111], a[48:51], v[24:27], v[96:111]
  ds_read_b128 v[20:23], v12 offset:9216
  v_mfma_f32_32x32x16_bf16 v[112:127], a[52:55], v[24:27], v[112:127]
  buffer_load_dwordx4 v1, s[4:7], s53 offen offset:3072 sc1 lds
  s_waitcnt lgkmcnt(2)
  v_mfma_f32_32x32x16_bf16 v[96:111], a[56:59], v[28:31], v[96:111]
  ds_read_b128 v[24:27], v12 offset:10240
  v_mfma_f32_32x32x16_bf16 v[112:127], a[60:63], v[28:31], v[112:127]
  s_waitcnt lgkmcnt(2)
  v_mfma_f32_32x32x16_bf16 v[96:111], a[64:67], v[16:19], v[96:111]
  ds_read_b128 v[28:31], v12 offset:11264
  v_mfma_f32_32x32x16_bf16 v[112:127], a[68:71], v[16:19], v[112:127]
  s_add_u32 s53, s27, 4096
  s_add_u32 m0, s52, 4096
  s_nop 0
  buffer_load_dwordx4 v1, s[4:7], s53 offen offset:0 sc1 lds
  s_waitcnt lgkmcnt(2)
  v_mfma_f32_32x32x16_bf16 v[96:111], a[72:75], v[20:23], v[96:111]
  ds_read_b128 v[16:19], v12 offset:12288
  v_mfma_f32_32x32x16_bf16 v[112:127], a[76:79], v[20:23], v[112:127]
  s_waitcnt lgkmcnt(2)
  v_mfma_f32_32x32x16_bf16 v[96:111], a[80:83], v[24:27], v[96:111]
  ds_read_b128 v[20:23], v12 offset:13312
  v_mfma_f32_32x32x16_bf16 v[112:127], a[84:87], v[24:27], v[112:127]
  buffer_load_dwordx4 v1, s[4:7], s53 offen offset:1024 sc1 lds
  s_waitcnt lgkmcnt(2)
  v_mfma_f32_32x32x16_bf16 v[96:111], a[88:91], v[28:31], v[96:111]
  ds_read_b128 v[24:27], v12 offset:14336
  v_mfma_f32_32x32x16_bf16 v[112:127], a[92:95], v[28:31], v[112:127]
  s_waitcnt lgkmcnt(2)
  v_mfma_f32_32x32x16_bf16 v[96:111], a[96:99], v[16:19], v[96:111]
  ds_read_b128 v[28:31], v12 offset:15360
  v_mfma_f32_32x32x16_bf16 v[112:127], a[100:103], v[16:19], v[112:127]
  buffer_load_dwordx4 v1, s[4:7], s53 offen offset:2048 sc1 lds
  s_waitcnt lgkmcnt(2)
  v_mfma_f32_32x32x16_bf16 v[96:111], a[104:107], v[20:23], v[96:111]
  ds_read_b128 v[16:19], v12 offset:16384
  v_mfma_f32_32x32x16_bf16 v[112:127], a[108:111], v[20:23], v[112:127]
  s_waitcnt lgkmcnt(2)
  v_mfma_f32_32x32x16_bf16 v[96:111], a[112:115], v[24:27], v[96:111]
  ds_read_b128 v[20:23], v12 offset:17408
  v_mfma_f32_32x32x16_bf16 v[112:127], a[116:119], v[24:27], v[112:127]
  buffer_load_dwordx4 v1, s[4:7], s53 offen offset:3072 sc1 lds
  s_waitcnt lgkmcnt(2)
  v_mfma_f32_32x32x16_bf16 v[96:111], a[120:123], v[28:31], v[96:111]
  ds_read_b128 v[24:27], v12 offset:18432
  v_mfma_f32_32x32x16_bf16 v[112:127], a[124:127], v[28:31], v[112:127]
  s_waitcnt lgkmcnt(2)
  v_mfma_f32_32x32x16_bf16 v[96:111], a[128:131], v[16:19], v[96:111]
  ds_read_b128 v[28:31], v12 offset:19456
  v_mfma_f32_32x32x16_bf16 v[112:127], a[132:135], v[16:19], v[112:127]
  s_add_u32 s53, s27, 8192
  s_add_u32 m0, s52, 8192
  s_nop 0
  buffer_load_dwordx4 v1, s[4:7], s53 offen offset:0 sc1 lds
  s_waitcnt lgkmcnt(2)
  v_mfma_f32_32x32x16_bf16 v[96:111], a[136:139], v[20:23], v[96:111]
  ds_read_b128 v[16:19], v12 offset:20480
  v_mfma_f32_32x32x16_bf16 v[112:127], a[140:143], v[20:23], v[112:127]
  s_waitcnt lgkmcnt(2)
  v_mfma_f32_32x32x16_bf16 v[96:111], a[144:147], v[24:27], v[96:111]
  ds_read_b128 v[20:23], v12 offset:21504
  v_mfma_f32_32x32x16_bf16 v[112:127], a[148:151], v[24:27], v[112:127]
  buffer_load_dwordx4 v1, s[4:7], s53 offen offset:1024 sc1 lds
  s_add_u32 s27, s27, 40960
  s_min_u32 s27, s27, s34
  s_add_u32 s33, s33, 40960
  s_cmp_eq_u32 s33, 122880
  s_cselect_b32 s33, 0, s33
  s_waitcnt lgkmcnt(2)
  v_mfma_f32_32x32x16_bf16 v[96:111], a[152:155], v[28:31], v[96:111]
  ds_read_b128 v[24:27], v12 offset:22528
  v_mfma_f32_32x32x16_bf16 v[112:127], a[156:159], v[28:31], v[112:127]
  s_waitcnt lgkmcnt(2)
  v_mfma_f32_32x32x16_bf16 v[96:111], a[160:163], v[16:19], v[96:111]
  ds_read_b128 v[28:31], v12 offset:23552
  v_mfma_f32_32x32x16_bf16 v[112:127], a[164:167], v[16:19], v[112:127]
  s_waitcnt lgkmcnt(2)
  v_mfma_f32_32x32x16_bf16 v[96:111], a[168:171], v[20:23], v[96:111]
  ds_read_b128 v[16:19], v12 offset:24576
  v_mfma_f32_32x32x16_bf16 v[112:127], a[172:175], v[20:23], v[112:127]
  s_waitcnt lgkmcnt(2)
  v_mfma_f32_32x32x16_bf16 v[96:111], a[176:179], v[24:27], v[96:111]
  ds_read_b128 v[20:23], v12 offset:25600
  v_mfma_f32_32x32x16_bf16 v[112:127], a[180:183], v[24:27], v[112:127]
  s_waitcnt lgkmcnt(2)
  v_mfma_f32_32x32x16_bf16 v[96:111], a[184:187], v[28:31], v[96:111]
  ds_read_b128 v[24:27], v12 offset:26624
  v_mfma_f32_32x32x16_bf16 v[112:127], a[188:191], v[28:31], v[112:127]
  s_waitcnt lgkmcnt(2)
  v_mfma_f32_32x32x16_bf16 v[96:111], a[192:195], v[16:19], v[96:111]
  ds_read_b128 v[28:31], v12 offset:27648
  v_mfma_f32_32x32x16_bf16 v[112:127], a[196:199], v[16:19], v[112:127]
  s_waitcnt lgkmcnt(2)
  v_mfma_f32_32x32x16_bf16 v[96:111], a[200:203], v[20:23], v[96:111]
  ds_read_b128 v[16:19], v12 offset:28672
  v_mfma_f32_32x32x16_bf16 v[112:127], a[204:207], v[20:23], v[112:127]
  s_waitcnt lgkmcnt(2)
  v_mfma_f32_32x32x16_bf16 v[96:111], a[208:211], v[24:27], v[96:111]
  ds_read_b128 v[20:23], v12 offset:29696
  v_mfma_f32_32x32x16_bf16 v[112:127], a[212:215], v[24:27], v[112:127]
  s_waitcnt lgkmcnt(2)
  v_mfma_f32_32x32x16_bf16 v[96:111], a[216:219], v[28:31], v[96:111]
  ds_read_b128 v[24:27], v12 offset:30720
  v_mfma_f32_32x32x16_bf16 v[112:127], a[220:223], v[28:31], v[112:127]
  s_waitcnt lgkmcnt(2)
  v_mfma_f32_32x32x16_bf16 v[96:111], a[224:227], v[16:19], v[96:111]
  ds_read_b128 v[28:31], v12 offset:31744
  v_cvt_pk_bf16_f32 v40, v128, v129
  v_mfma_f32_32x32x16_bf16 v[112:127], a[228:231], v[16:19], v[112:127]
  v_cvt_pk_bf16_f32 v41, v130, v131
  s_waitcnt lgkmcnt(2)
  v_mfma_f32_32x32x16_bf16 v[96:111], a[232:235], v[20:23], v[96:111]
  ds_read_b128 v[16:19], v12 offset:32768
  v_cvt_pk_bf16_f32 v42, v132, v133
  v_mfma_f32_32x32x16_bf16 v[112:127], a[236:239], v[20:23], v[112:127]
  v_cvt_pk_bf16_f32 v43, v134, v135
  s_waitcnt lgkmcnt(2)
  v_mfma_f32_32x32x16_bf16 v[96:111], a[240:243], v[24:27], v[96:111]
  ds_read_b128 v[20:23], v12 offset:33792
  buffer_store_dwordx4 v[40:43], v6, s[4:7], s25 offen offset:0 sc1
  v_mfma_f32_32x32x16_bf16 v[112:127], a[244:247], v[24:27], v[112:127]
  v_cvt_pk_bf16_f32 v44, v136, v137
  s_waitcnt lgkmcnt(2)
  v_mfma_f32_32x32x16_bf16 v[96:111], a[248:251], v[28:31], v[96:111]
  ds_read_b128 v[24:27], v12 offset:34816
  v_cvt_pk_bf16_f32 v45, v138, v139
  v_mfma_f32_32x32x16_bf16 v[112:127], a[252:255], v[28:31], v[112:127]
  v_cvt_pk_bf16_f32 v46, v140, v141
  s_waitcnt lgkmcnt(2)
  v_mfma_f32_32x32x16_bf16 v[96:111], v[192:195], v[16:19], v[96:111]
  ds_read_b128 v[28:31], v12 offset:35840
  v_cvt_pk_bf16_f32 v47, v142, v143
  v_mfma_f32_32x32x16_bf16 v[112:127], v[196:199], v[16:19], v[112:127]
  buffer_store_dwordx4 v[44:47], v6, s[4:7], s25 offen offset:512 sc1
  s_waitcnt lgkmcnt(2)
  v_mfma_f32_32x32x16_bf16 v[96:111], v[200:203], v[20:23], v[96:111]
  ds_read_b128 v[16:19], v12 offset:36864
  v_cvt_pk_bf16_f32 v40, v144, v145
  v_mfma_f32_32x32x16_bf16 v[112:127], v[204:207], v[20:23], v[112:127]
  v_cvt_pk_bf16_f32 v41, v146, v147
  s_waitcnt lgkmcnt(2)
  v_mfma_f32_32x32x16_bf16 v[96:111], v[208:211], v[24:27], v[96:111]
  ds_read_b128 v[20:23], v12 offset:37888
  v_cvt_pk_bf16_f32 v42, v148, v149
  v_mfma_f32_32x32x16_bf16 v[112:127], v[212:215], v[24:27], v[112:127]
  v_cvt_pk_bf16_f32 v43, v150, v151
  s_waitcnt lgkmcnt(2)
  v_mfma_f32_32x32x16_bf16 v[96:111], v[216:219], v[28:31], v[96:111]
  ds_read_b128 v[24:27], v12 offset:38912
  buffer_store_dwordx4 v[40:43], v6, s[4:7], s25 offen offset:1024 sc1
  v_mfma_f32_32x32x16_bf16 v[112:127], v[220:223], v[28:31], v[112:127]
  v_cvt_pk_bf16_f32 v44, v152, v153
  s_waitcnt lgkmcnt(2)
  v_mfma_f32_32x32x16_bf16 v[96:111], v[224:227], v[16:19], v[96:111]
  ds_read_b128 v[28:31], v12 offset:39936
  v_cvt_pk_bf16_f32 v45, v154, v155
  v_mfma_f32_32x32x16_bf16 v[112:127], v[228:231], v[16:19], v[112:127]
  v_cvt_pk_bf16_f32 v46, v156, v157
  s_waitcnt lgkmcnt(2)
  v_mfma_f32_32x32x16_bf16 v[96:111], v[232:235], v[20:23], v[96:111]
  v_cvt_pk_bf16_f32 v47, v158, v159
  v_mfma_f32_32x32x16_bf16 v[112:127], v[236:239], v[20:23], v[112:127]
  buffer_store_dwordx4 v[44:47], v6, s[4:7], s25 offen offset:1536 sc1
  s_waitcnt lgkmcnt(1)
  v_mfma_f32_32x32x16_bf16 v[96:111], v[240:243], v[24:27], v[96:111]
  v_mfma_f32_32x32x16_bf16 v[112:127], v[244:247], v[24:27], v[112:127]
  s_waitcnt lgkmcnt(0)
  v_mfma_f32_32x32x16_bf16 v[96:111], v[248:251], v[28:31], v[96:111]
  v_mfma_f32_32x32x16_bf16 v[112:127], v[252:255], v[28:31], v[112:127]
  s_add_u32 s32, s32, 40960
  s_cmp_eq_u32 s32, 122880
  s_cselect_b32 s32, 0, s32
  s_add_u32 s29, s29, 1
  s_waitcnt vmcnt(14)
  s_barrier
  s_sub_u32 s49, s29, 2
  s_max_i32 s49, s49, 0
  s_cmp_lg_u32 s13, 0
  s_cbranch_scc1 PB_69
  v_mov_b32 v8, s49
  v_mov_b32 v9, s26
  buffer_store_dword v8, v9, s[4:7], 0 offen sc1
PB_69:
  s_add_u32 s47, s24, s29
  s_sub_u32 s47, s47, 1
  s_lshl_b32 s25, s47, 18
  s_add_u32 s25, s25, s31
  v_add_u32 v12, s32, v1
  ds_read_b128 v[16:19], v12 offset:0
  ds_read_b128 v[20:23], v12 offset:1024
  ds_read_b128 v[24:27], v12 offset:2048
  s_waitcnt lgkmcnt(2)
  v_mfma_f32_32x32x16_bf16 v[128:143], a[0:3], v[16:19], 0
  ds_read_b128 v[28:31], v12 offset:3072
  v_mfma_f32_32x32x16_bf16 v[144:159], a[4:7], v[16:19], 0
  s_add_u32 s52, s33, s30
  s_add_u32 s53, s27, 0
  s_add_u32 m0, s52, 0
  s_nop 0
  buffer_load_dwordx4 v1, s[4:7], s53 offen offset:0 sc1 lds
  s_waitcnt lgkmcnt(2)
  v_mfma_f32_32x32x16_bf16 v[128:143], a[8:11], v[20:23], v[128:143]
  ds_read_b128 v[16:19], v12 offset:4096
  v_mfma_f32_32x32x16_bf16 v[144:159], a[12:15], v[20:23], v[144:159]
  s_waitcnt lgkmcnt(2)
  v_mfma_f32_32x32x16_bf16 v[128:143], a[16:19], v[24:27], v[128:143]
  ds_read_b128 v[20:23], v12 offset:5120
  v_mfma_f32_32x32x16_bf16 v[144:159], a[20:23], v[24:27], v[144:159]
  buffer_load_dwordx4 v1, s[4:7], s53 offen offset:1024 sc1 lds
  s_waitcnt lgkmcnt(2)
  v_mfma_f32_32x32x16_bf16 v[128:143], a[24:27], v[28:31], v[128:143]
  ds_read_b128 v[24:27], v12 offset:6144
  v_mfma_f32_32x32x16_bf16 v[144:159], a[28:31], v[28:31], v[144:159]
  s_waitcnt lgkmcnt(2)
  v_mfma_f32_32x32x16_bf16 v[128:143], a[32:35], v[16:19], v[128:143]
  ds_read_b128 v[28:31], v12 offset:7168
  v_mfma_f32_32x32x16_bf16 v[144:159], a[36:39], v[16:19], v[144:159]
  buffer_load_dwordx4 v1, s[4:7], s53 offen offset:2048 sc1 lds
  s_waitcnt lgkmcnt(2)
  v_mfma_f32_32x32x16_bf16 v[128:143], a[40:43], v[20:23], v[128:143]
  ds_read_b128 v[16:19], v12 offset:8192
  v_mfma_f32_32x32x16_bf16 v[144:159], a[44:47], v[20:23], v[144:159]
  s_waitcnt lgkmcnt(2)
  v_mfma_f32_32x32x16_bf16 v[128:143], a[48:51], v[24:27], v[128:143]
  ds_read_b128 v[20:23], v12 offset:9216
  v_mfma_f32_32x32x16_bf16 v[144:159], a[52:55], v[24:27], v[144:159]
  buffer_load_dwordx4 v1, s[4:7], s53 offen offset:3072 sc1 lds
  s_waitcnt lgkmcnt(2)
  v_mfma_f32_32x32x16_bf16 v[128:143], a[56:59], v[28:31], v[128:143]
  ds_read_b128 v[24:27], v12 offset:10240
  v_mfma_f32_32x32x16_bf16 v[144:159], a[60:63], v[28:31], v[144:159]
  s_waitcnt lgkmcnt(2)
  v_mfma_f32_32x32x16_bf16 v[128:143], a[64:67], v[16:19], v[128:143]
  ds_read_b128 v[28:31], v12 offset:11264
  v_mfma_f32_32x32x16_bf16 v[144:159], a[68:71], v[16:19], v[144:159]
  s_add_u32 s53, s27, 4096
  s_add_u32 m0, s52, 4096
  s_nop 0
  buffer_load_dwordx4 v1, s[4:7], s53 offen offset:0 sc1 lds
  s_waitcnt lgkmcnt(2)
  v_mfma_f32_32x32x16_bf16 v[128:143], a[72:75], v[20:23], v[128:143]
  ds_read_b128 v[16:19], v12 offset:12288
  v_mfma_f32_32x32x16_bf16 v[144:159], a[76:79], v[20:23], v[144:159]
  s_waitcnt lgkmcnt(2)
  v_mfma_f32_32x32x16_bf16 v[128:143], a[80:83], v[24:27], v[128:143]
  ds_read_b128 v[20:23], v12 offset:13312
  v_mfma_f32_32x32x16_bf16 v[144:159], a[84:87], v[24:27], v[144:159]
  buffer_load_dwordx4 v1, s[4:7], s53 offen offset:1024 sc1 lds
  s_waitcnt lgkmcnt(2)
  v_mfma_f32_32x32x16_bf16 v[128:143], a[88:91], v[28:31], v[128:143]
  ds_read_b128 v[24:27], v12 offset:14336
  v_mfma_f32_32x32x16_bf16 v[144:159], a[92:95], v[28:31], v[144:159]
  s_waitcnt lgkmcnt(2)
  v_mfma_f32_32x32x16_bf16 v[128:143], a[96:99], v[16:19], v[128:143]
  ds_read_b128 v[28:31], v12 offset:15360
  v_mfma_f32_32x32x16_bf16 v[144:159], a[100:103], v[16:19], v[144:159]
  buffer_load_dwordx4 v1, s[4:7], s53 offen offset:2048 sc1 lds
  s_waitcnt lgkmcnt(2)
  v_mfma_f32_32x32x16_bf16 v[128:143], a[104:107], v[20:23], v[128:143]
  ds_read_b128 v[16:19], v12 offset:16384
  v_mfma_f32_32x32x16_bf16 v[144:159], a[108:111], v[20:23], v[144:159]
  s_waitcnt lgkmcnt(2)
  v_mfma_f32_32x32x16_bf16 v[128:143], a[112:115], v[24:27], v[128:143]
  ds_read_b128 v[20:23], v12 offset:17408
  v_mfma_f32_32x32x16_bf16 v[144:159], a[116:119], v[24:27], v[144:159]
  buffer_load_dwordx4 v1, s[4:7], s53 offen offset:3072 sc1 lds
  s_waitcnt lgkmcnt(2)
  v_mfma_f32_32x32x16_bf16 v[128:143], a[120:123], v[28:31], v[128:143]
  ds_read_b128 v[24:27], v12 offset:18432
  v_mfma_f32_32x32x16_bf16 v[144:159], a[124:127], v[28:31], v[144:159]
  s_waitcnt lgkmcnt(2)
  v_mfma_f32_32x32x16_bf16 v[128:143], a[128:131], v[16:19], v[128:143]
  ds_read_b128 v[28:31], v12 offset:19456
  v_mfma_f32_32x32x16_bf16 v[144:159], a[132:135], v[16:19], v[144:159]
  s_add_u32 s53, s27, 8192
  s_add_u32 m0, s52, 8192
  s_nop 0
  buffer_load_dwordx4 v1, s[4:7], s53 offen offset:0 sc1 lds
  s_waitcnt lgkmcnt(2)
  v_mfma_f32_32x32x16_bf16 v[128:143], a[136:139], v[20:23], v[128:143]
  ds_read_b128 v[16:19], v12 offset:20480
  v_mfma_f32_32x32x16_bf16 v[144:159], a[140:143], v[20:23], v[144:159]
  s_waitcnt lgkmcnt(2)
  v_mfma_f32_32x32x16_bf16 v[128:143], a[144:147], v[24:27], v[128:143]
  ds_read_b128 v[20:23], v12 offset:21504
  v_mfma_f32_32x32x16_bf16 v[144:159], a[148:151], v[24:27], v[144:159]
  buffer_load_dwordx4 v1, s[4:7], s53 offen offset:1024 sc1 lds
  s_add_u32 s27, s27, 40960
  s_min_u32 s27, s27, s34
  s_add_u32 s33, s33, 40960
  s_cmp_eq_u32 s33, 122880
  s_cselect_b32 s33, 0, s33
  s_waitcnt lgkmcnt(2)
  v_mfma_f32_32x32x16_bf16 v[128:143], a[152:155], v[28:31], v[128:143]
  ds_read_b128 v[24:27], v12 offset:22528
  v_mfma_f32_32x32x16_bf16 v[144:159], a[156:159], v[28:31], v[144:159]
  s_waitcnt lgkmcnt(2)
  v_mfma_f32_32x32x16_bf16 v[128:143], a[160:163], v[16:19], v[128:143]
  ds_read_b128 v[28:31], v12 offset:23552
  v_mfma_f32_32x32x16_bf16 v[144:159], a[164:167], v[16:19], v[144:159]
  s_waitcnt lgkmcnt(2)
  v_mfma_f32_32x32x16_bf16 v[128:143], a[168:171], v[20:23], v[128:143]
  ds_read_b128 v[16:19], v12 offset:24576
  v_mfma_f32_32x32x16_bf16 v[144:159], a[172:175], v[20:23], v[144:159]
  s_waitcnt lgkmcnt(2)
  v_mfma_f32_32x32x16_bf16 v[128:143], a[176:179], v[24:27], v[128:143]
  ds_read_b128 v[20:23], v12 offset:25600
  v_mfma_f32_32x32x16_bf16 v[144:159], a[180:183], v[24:27], v[144:159]
  s_waitcnt lgkmcnt(2)
  v_mfma_f32_32x32x16_bf16 v[128:143], a[184:187], v[28:31], v[128:143]
  ds_read_b128 v[24:27], v12 offset:26624
  v_mfma_f32_32x32x16_bf16 v[144:159], a[188:191], v[28:31], v[144:159]
  s_waitcnt lgkmcnt(2)
  v_mfma_f32_32x32x16_bf16 v[128:143], a[192:195], v[16:19], v[128:143]
  ds_read_b128 v[28:31], v12 offset:27648
  v_mfma_f32_32x32x16_bf16 v[144:159], a[196:199], v[16:19], v[144:159]
  s_waitcnt lgkmcnt(2)
  v_mfma_f32_32x32x16_bf16 v[128:143], a[200:203], v[20:23], v[128:143]
  ds_read_b128 v[16:19], v12 offset:28672
  v_mfma_f32_32x32x16_bf16 v[144:159], a[204:207], v[20:23], v[144:159]
  s_waitcnt lgkmcnt(2)
  v_mfma_f32_32x32x16_bf16 v[128:143], a[208:211], v[24:27], v[128:143]
  ds_read_b128 v[20:23], v12 offset:29696
  v_mfma_f32_32x32x16_bf16 v[144:159], a[212:215], v[24:27], v[144:159]
  s_waitcnt lgkmcnt(2)
  v_mfma_f32_32x32x16_bf16 v[128:143], a[216:219], v[28:31], v[128:143]
  ds_read_b128 v[24:27], v12 offset:30720
  v_mfma_f32_32x32x16_bf16 v[144:159], a[220:223], v[28:31], v[144:159]
  s_waitcnt lgkmcnt(2)
  v_mfma_f32_32x32x16_bf16 v[128:143], a[224:227], v[16:19], v[128:143]
  ds_read_b128 v[28:31], v12 offset:31744
  v_cvt_pk_bf16_f32 v40, v96, v97
  v_mfma_f32_32x32x16_bf16 v[144:159], a[228:231], v[16:19], v[144:159]
  v_cvt_pk_bf16_f32 v41, v98, v99
  s_waitcnt lgkmcnt(2)
  v_mfma_f32_32x32x16_bf16 v[128:143], a[232:235], v[20:23], v[128:143]
  ds_read_b128 v[16:19], v12 offset:32768
  v_cvt_pk_bf16_f32 v42, v100, v101
  v_mfma_f32_32x32x16_bf16 v[144:159], a[236:239], v[20:23], v[144:159]
  v_cvt_pk_bf16_f32 v43, v102, v103
  s_waitcnt lgkmcnt(2)
  v_mfma_f32_32x32x16_bf16 v[128:143], a[240:243], v[24:27], v[128:143]
  ds_read_b128 v[20:23], v12 offset:33792
  buffer_store_dwordx4 v[40:43], v6, s[4:7], s25 offen offset:0 sc1
  v_mfma_f32_32x32x16_bf16 v[144:159], a[244:247], v[24:27], v[144:159]
  v_cvt_pk_bf16_f32 v44, v104, v105
  s_waitcnt lgkmcnt(2)
  v_mfma_f32_32x32x16_bf16 v[128:143], a[248:251], v[28:31], v[128:143]
  ds_read_b128 v[24:27], v12 offset:34816
  v_cvt_pk_bf16_f32 v45, v106, v107
  v_mfma_f32_32x32x16_bf16 v[144:159], a[252:255], v[28:31], v[144:159]
  v_cvt_pk_bf16_f32 v46, v108, v109
  s_waitcnt lgkmcnt(2)
  v_mfma_f32_32x32x16_bf16 v[128:143], v[192:195], v[16:19], v[128:143]
  ds_read_b128 v[28:31], v12 offset:35840
  v_cvt_pk_bf16_f32 v47, v110, v111
  v_mfma_f32_32x32x16_bf16 v[144:159], v[196:199], v[16:19], v[144:159]
  buffer_store_dwordx4 v[44:47], v6, s[4:7], s25 offen offset:512 sc1
  s_waitcnt lgkmcnt(2)
  v_mfma_f32_32x32x16_bf16 v[128:143], v[200:203], v[20:23], v[128:143]
  ds_read_b128 v[16:19], v12 offset:36864
  v_cvt_pk_bf16_f32 v40, v112, v113
  v_mfma_f32_32x32x16_bf16 v[144:159], v[204:207], v[20:23], v[144:159]
  v_cvt_pk_bf16_f32 v41, v114, v115
  s_waitcnt lgkmcnt(2)
  v_mfma_f32_32x32x16_bf16 v[128:143], v[208:211], v[24:27], v[128:143]
  ds_read_b128 v[20:23], v12 offset:37888
  v_cvt_pk_bf16_f32 v42, v116, v117
  v_mfma_f32_32x32x16_bf16 v[144:159], v[212:215], v[24:27], v[144:159]
  v_cvt_pk_bf16_f32 v43, v118, v119
  s_waitcnt lgkmcnt(2)
  v_mfma_f32_32x32x16_bf16 v[128:143], v[216:219], v[28:31], v[128:143]
  ds_read_b128 v[24:27], v12 offset:38912
  buffer_store_dwordx4 v[40:43], v6, s[4:7], s25 offen offset:1024 sc1
  v_mfma_f32_32x32x16_bf16 v[144:159], v[220:223], v[28:31], v[144:159]
  v_cvt_pk_bf16_f32 v44, v120, v121
  s_waitcnt lgkmcnt(2)
  v_mfma_f32_32x32x16_bf16 v[128:143], v[224:227], v[16:19], v[128:143]
  ds_read_b128 v[28:31], v12 offset:39936
  v_cvt_pk_bf16_f32 v45, v122, v123
  v_mfma_f32_32x32x16_bf16 v[144:159], v[228:231], v[16:19], v[144:159]
  v_cvt_pk_bf16_f32 v46, v124, v125
  s_waitcnt lgkmcnt(2)
  v_mfma_f32_32x32x16_bf16 v[128:143], v[232:235], v[20:23], v[128:143]
  v_cvt_pk_bf16_f32 v47, v126, v127
  v_mfma_f32_32x32x16_bf16 v[144:159], v[236:239], v[20:23], v[144:159]
  buffer_store_dwordx4 v[44:47], v6, s[4:7], s25 offen offset:1536 sc1
  s_waitcnt lgkmcnt(1)
  v_mfma_f32_32x32x16_bf16 v[128:143], v[240:243], v[24:27], v[128:143]
  v_mfma_f32_32x32x16_bf16 v[144:159], v[244:247], v[24:27], v[144:159]
  s_waitcnt lgkmcnt(0)
  v_mfma_f32_32x32x16_bf16 v[128:143], v[248:251], v[28:31], v[128:143]
  v_mfma_f32_32x32x16_bf16 v[144:159], v[252:255], v[28:31], v[144:159]
  s_add_u32 s32, s32, 40960
  s_cmp_eq_u32 s32, 122880
  s_cselect_b32 s32, 0, s32
  s_add_u32 s29, s29, 1
  s_cmp_lt_u32 s29, 16
  s_cbranch_scc1 W1T_64
  s_add_u32 s47, s24, s29
  s_sub_u32 s47, s47, 1
  s_lshl_b32 s25, s47, 18
  s_add_u32 s25, s25, s31
  s_nop 0
  v_cvt_pk_bf16_f32 v40, v128, v129
  v_cvt_pk_bf16_f32 v41, v130, v131
  v_cvt_pk_bf16_f32 v42, v132, v133
  v_cvt_pk_bf16_f32 v43, v134, v135
  buffer_store_dwordx4 v[40:43], v6, s[4:7], s25 offen offset:0 sc1
  v_cvt_pk_bf16_f32 v44, v136, v137
  v_cvt_pk_bf16_f32 v45, v138, v139
  v_cvt_pk_bf16_f32 v46, v140, v141
  v_cvt_pk_bf16_f32 v47, v142, v143
  buffer_store_dwordx4 v[44:47], v6, s[4:7], s25 offen offset:512 sc1
  v_cvt_pk_bf16_f32 v40, v144, v145
  v_cvt_pk_bf16_f32 v41, v146, v147
  v_cvt_pk_bf16_f32 v42, v148, v149
  v_cvt_pk_bf16_f32 v43, v150, v151
  buffer_store_dwordx4 v[40:43], v6, s[4:7], s25 offen offset:1024 sc1
  v_cvt_pk_bf16_f32 v44, v152, v153
  v_cvt_pk_bf16_f32 v45, v154, v155
  v_cvt_pk_bf16_f32 v46, v156, v157
  v_cvt_pk_bf16_f32 v47, v158, v159
  buffer_store_dwordx4 v[44:47], v6, s[4:7], s25 offen offset:1536 sc1
  s_waitcnt vmcnt(0)
  s_barrier
  s_cmp_lg_u32 s13, 0
  s_cbranch_scc1 PB_70
  v_mov_b32 v8, 16
  v_mov_b32 v9, s26
  buffer_store_dword v8, v9, s[4:7], 0 offen sc1
PB_70:
  s_branch W1E_60
W1V_46:
  s_lshl_b32 s48, s48, 12
  s_add_u32 s31, s47, s48
  s_add_u32 s31, s31, 33554432
  s_add_u32 s26, s26, 256
  s_mov_b32 s8, s62
  s_and_b32 s9, s63, 0xffff
  s_mov_b32 s10, 5242880
  s_mov_b32 s11, 0x20000
  s_mov_b32 s51, 0
  v_and_b32 v2, 63, v0
  v_lshlrev_b32 v1, 4, v2
  v_lshrrev_b32 v3, 5, v2
  v_mul_lo_u32 v4, v3, s23
  v_and_b32 v3, 31, v2
  v_lshl_add_u32 v4, v3, 4, v4
  v_lshrrev_b32 v5, 4, v2
  v_and_b32 v6, 1, v5
  v_lshrrev_b32 v5, 1, v5
  v_bfe_u32 v7, v2, 2, 2
  v_lshl_add_u32 v7, v5, 3, v7
  v_lshlrev_b32 v7, 9, v7
  v_and_b32 v8, 3, v2
  v_lshl_add_u32 v8, v6, 2, v8
  v_lshlrev_b32 v9, 2, v8
  v_lshrrev_b32 v10, 2, v8
  v_lshlrev_b32 v10, 4, v10
  v_and_b32 v11, 1, v8
  v_lshl_add_u32 v10, v11, 3, v10
  v_bfe_u32 v11, v8, 1, 1
  v_lshl_add_u32 v10, v11, 2, v10
  s_cmp_lg_u32 s51, 0
  s_cselect_b64 vcc, -1, 0
  v_cndmask_b32 v9, v9, v10, vcc
  v_lshl_add_u32 v7, v9, 1, v7
  s_lshl_b32 s47, s13, 7
  v_add_u32 v7, s47, v7
  s_lshl_b32 s28, s13, 11
  s_mul_i32 s27, s23, s13
  s_lshl_b32 s27, s27, 2
  s_add_u32 s27, s27, s22
  s_lshl_b32 s49, s23, 1
  s_lshl_b32 s50, s23, 4
  s_mov_b32 s47, s27
  s_add_u32 m0, s28, 0
  s_nop 0
  buffer_load_dwordx4 v4, s[8:11], s47 offen lds
  s_add_u32 s47, s27, s49
  s_add_u32 m0, s28, 1024
  s_nop 0
  buffer_load_dwordx4 v4, s[8:11], s47 offen lds
  s_add_u32 s27, s27, s50
  s_mov_b32 s47, s27
  s_add_u32 m0, s28, 8192
  s_nop 0
  buffer_load_dwordx4 v4, s[8:11], s47 offen lds
  s_add_u32 s47, s27, s49
  s_add_u32 m0, s28, 9216
  s_nop 0
  buffer_load_dwordx4 v4, s[8:11], s47 offen lds
  s_add_u32 s27, s27, s50
  s_mov_b32 s47, s27
  s_add_u32 m0, s28, 16384
  s_nop 0
  buffer_load_dwordx4 v4, s[8:11], s47 offen lds
  s_add_u32 s47, s27, s49
  s_add_u32 m0, s28, 17408
  s_nop 0
  buffer_load_dwordx4 v4, s[8:11], s47 offen lds
  s_add_u32 s27, s27, s50
  s_mov_b32 s47, s27
  s_add_u32 m0, s28, 24576
  s_nop 0
  buffer_load_dwordx4 v4, s[8:11], s47 offen lds
  s_add_u32 s47, s27, s49
  s_add_u32 m0, s28, 25600
  s_nop 0
  buffer_load_dwordx4 v4, s[8:11], s47 offen lds
  s_add_u32 s27, s27, s50
  s_mov_b32 s47, s27
  s_add_u32 m0, s28, 32768
  s_nop 0
  buffer_load_dwordx4 v4, s[8:11], s47 offen lds
  s_add_u32 s47, s27, s49
  s_add_u32 m0, s28, 33792
  s_nop 0
  buffer_load_dwordx4 v4, s[8:11], s47 offen lds
  s_add_u32 s27, s27, s50
  s_mov_b32 s47, s27
  s_add_u32 m0, s28, 40960
  s_nop 0
  buffer_load_dwordx4 v4, s[8:11], s47 offen lds
  s_add_u32 s47, s27, s49
  s_add_u32 m0, s28, 41984
  s_nop 0
  buffer_load_dwordx4 v4, s[8:11], s47 offen lds
  s_add_u32 s27, s27, s50
  s_mov_b32 s47, s27
  s_add_u32 m0, s28, 49152
  s_nop 0
  buffer_load_dwordx4 v4, s[8:11], s47 offen lds
  s_add_u32 s47, s27, s49
  s_add_u32 m0, s28, 50176
  s_nop 0
  buffer_load_dwordx4 v4, s[8:11], s47 offen lds
  s_add_u32 s27, s27, s50
  s_mov_b32 s47, s27
  s_add_u32 m0, s28, 57344
  s_nop 0
  buffer_load_dwordx4 v4, s[8:11], s47 offen lds
  s_add_u32 s47, s27, s49
  s_add_u32 m0, s28, 58368
  s_nop 0
  buffer_load_dwordx4 v4, s[8:11], s47 offen lds
  s_add_u32 s27, s27, s50
  s_mov_b32 s47, s27
  s_add_u32 m0, s28, 65536
  s_nop 0
  buffer_load_dwordx4 v4, s[8:11], s47 offen lds
  s_add_u32 s47, s27, s49
  s_add_u32 m0, s28, 66560
  s_nop 0
  buffer_load_dwordx4 v4, s[8:11], s47 offen lds
  s_add_u32 s27, s27, s50
  s_mov_b32 s47, s27
  s_add_u32 m0, s28, 73728
  s_nop 0
  buffer_load_dwordx4 v4, s[8:11], s47 offen lds
  s_add_u32 s47, s27, s49
  s_add_u32 m0, s28, 74752
  s_nop 0
  buffer_load_dwordx4 v4, s[8:11], s47 offen lds
  s_add_u32 s27, s27, s50
  s_mov_b32 s47, s27
  s_add_u32 m0, s28, 81920
  s_nop 0
  buffer_load_dwordx4 v4, s[8:11], s47 offen lds
  s_add_u32 s47, s27, s49
  s_add_u32 m0, s28, 82944
  s_nop 0
  buffer_load_dwordx4 v4, s[8:11], s47 offen lds
  s_add_u32 s27, s27, s50
  s_mov_b32 s47, s27
  s_add_u32 m0, s28, 90112
  s_nop 0
  buffer_load_dwordx4 v4, s[8:11], s47 offen lds
  s_add_u32 s47, s27, s49
  s_add_u32 m0, s28, 91136
  s_nop 0
  buffer_load_dwordx4 v4, s[8:11], s47 offen lds
  s_add_u32 s27, s27, s50
  s_mov_b32 s47, s27
  s_add_u32 m0, s28, 98304
  s_nop 0
  buffer_load_dwordx4 v4, s[8:11], s47 offen lds
  s_add_u32 s47, s27, s49
  s_add_u32 m0, s28, 99328
  s_nop 0
  buffer_load_dwordx4 v4, s[8:11], s47 offen lds
  s_add_u32 s27, s27, s50
  s_mov_b32 s47, s27
  s_add_u32 m0, s28, 106496
  s_nop 0
  buffer_load_dwordx4 v4, s[8:11], s47 offen lds
  s_add_u32 s47, s27, s49
  s_add_u32 m0, s28, 107520
  s_nop 0
  buffer_load_dwordx4 v4, s[8:11], s47 offen lds
  s_add_u32 s27, s27, s50
  s_mov_b32 s47, s27
  s_add_u32 m0, s28, 114688
  s_nop 0
  buffer_load_dwordx4 v4, s[8:11], s47 offen lds
  s_add_u32 s47, s27, s49
  s_add_u32 m0, s28, 115712
  s_nop 0
  buffer_load_dwordx4 v4, s[8:11], s47 offen lds
  s_add_u32 s27, s27, s50
  s_mov_b32 s47, s27
  s_add_u32 m0, s28, 122880
  s_nop 0
  buffer_load_dwordx4 v4, s[8:11], s47 offen lds
  s_add_u32 s47, s27, s49
  s_add_u32 m0, s28, 123904
  s_nop 0
  buffer_load_dwordx4 v4, s[8:11], s47 offen lds
  s_add_u32 s27, s27, s50
  s_waitcnt vmcnt(30)
  s_barrier
  v_add_u32 v12, 0, v7
  ds_read_b64_tr_b16 a[0:1], v12 offset:0
  ds_read_b64_tr_b16 a[2:3], v12 offset:2048
  ds_read_b64_tr_b16 a[4:5], v12 offset:64
  ds_read_b64_tr_b16 a[6:7], v12 offset:2112
  s_waitcnt lgkmcnt(0)
  s_waitcnt vmcnt(28)
  s_barrier
  s_mov_b32 s47, s27
  s_add_u32 m0, s28, 0
  s_nop 0
  buffer_load_dwordx4 v4, s[8:11], s47 offen lds
  s_add_u32 s47, s27, s49
  s_add_u32 m0, s28, 1024
  s_nop 0
  buffer_load_dwordx4 v4, s[8:11], s47 offen lds
  s_add_u32 s27, s27, s50
  v_add_u32 v12, 8192, v7
  ds_read_b64_tr_b16 a[8:9], v12 offset:0
  ds_read_b64_tr_b16 a[10:11], v12 offset:2048
  ds_read_b64_tr_b16 a[12:13], v12 offset:64
  ds_read_b64_tr_b16 a[14:15], v12 offset:2112
  s_waitcnt lgkmcnt(0)
  s_waitcnt vmcnt(28)
  s_barrier
  s_mov_b32 s47, s27
  s_add_u32 m0, s28, 8192
  s_nop 0
  buffer_load_dwordx4 v4, s[8:11], s47 offen lds
  s_add_u32 s47, s27, s49
  s_add_u32 m0, s28, 9216
  s_nop 0
  buffer_load_dwordx4 v4, s[8:11], s47 offen lds
  s_add_u32 s27, s27, s50
  v_add_u32 v12, 16384, v7
  ds_read_b64_tr_b16 a[16:17], v12 offset:0
  ds_read_b64_tr_b16 a[18:19], v12 offset:2048
  ds_read_b64_tr_b16 a[20:21], v12 offset:64
  ds_read_b64_tr_b16 a[22:23], v12 offset:2112
  s_waitcnt lgkmcnt(0)
  s_waitcnt vmcnt(28)
  s_barrier
  s_mov_b32 s47, s27
  s_add_u32 m0, s28, 16384
  s_nop 0
  buffer_load_dwordx4 v4, s[8:11], s47 offen lds
  s_add_u32 s47, s27, s49
  s_add_u32 m0, s28, 17408
  s_nop 0
  buffer_load_dwordx4 v4, s[8:11], s47 offen lds
  s_add_u32 s27, s27, s50
  v_add_u32 v12, 24576, v7
  ds_read_b64_tr_b16 a[24:25], v12 offset:0
  ds_read_b64_tr_b16 a[26:27], v12 offset:2048
  ds_read_b64_tr_b16 a[28:29], v12 offset:64
  ds_read_b64_tr_b16 a[30:31], v12 offset:2112
  s_waitcnt lgkmcnt(0)
  s_waitcnt vmcnt(28)
  s_barrier
  s_mov_b32 s47, s27
  s_add_u32 m0, s28, 24576
  s_nop 0
  buffer_load_dwordx4 v4, s[8:11], s47 offen lds
  s_add_u32 s47, s27, s49
  s_add_u32 m0, s28, 25600
  s_nop 0
  buffer_load_dwordx4 v4, s[8:11], s47 offen lds
  s_add_u32 s27, s27, s50
  v_add_u32 v12, 32768, v7
  ds_read_b64_tr_b16 a[32:33], v12 offset:0
  ds_read_b64_tr_b16 a[34:35], v12 offset:2048
  ds_read_b64_tr_b16 a[36:37], v12 offset:64
  ds_read_b64_tr_b16 a[38:39], v12 offset:2112
  s_waitcnt lgkmcnt(0)
  s_waitcnt vmcnt(28)
  s_barrier
  s_mov_b32 s47, s27
  s_add_u32 m0, s28, 32768
  s_nop 0
  buffer_load_dwordx4 v4, s[8:11], s47 offen lds
  s_add_u32 s47, s27, s49
  s_add_u32 m0, s28, 33792
  s_nop 0
  buffer_load_dwordx4 v4, s[8:11], s47 offen lds
  s_add_u32 s27, s27, s50
  v_add_u32 v12, 40960, v7
  ds_read_b64_tr_b16 a[40:41], v12 offset:0
  ds_read_b64_tr_b16 a[42:43], v12 offset:2048
  ds_read_b64_tr_b16 a[44:45], v12 offset:64
  ds_read_b64_tr_b16 a[46:47], v12 offset:2112
  s_waitcnt lgkmcnt(0)
  s_waitcnt vmcnt(28)
  s_barrier
  s_mov_b32 s47, s27
  s_add_u32 m0, s28, 40960
  s_nop 0
  buffer_load_dwordx4 v4, s[8:11], s47 offen lds
  s_add_u32 s47, s27, s49
  s_add_u32 m0, s28, 41984
  s_nop 0
  buffer_load_dwordx4 v4, s[8:11], s47 offen lds
  s_add_u32 s27, s27, s50
  v_add_u32 v12, 49152, v7
  ds_read_b64_tr_b16 a[48:49], v12 offset:0
  ds_read_b64_tr_b16 a[50:51], v12 offset:2048
  ds_read_b64_tr_b16 a[52:53], v12 offset:64
  ds_read_b64_tr_b16 a[54:55], v12 offset:2112
  s_waitcnt lgkmcnt(0)
  s_waitcnt vmcnt(28)
  s_barrier
  s_mov_b32 s47, s27
  s_add_u32 m0, s28, 49152
  s_nop 0
  buffer_load_dwordx4 v4, s[8:11], s47 offen lds
  s_add_u32 s47, s27, s49
  s_add_u32 m0, s28, 50176
  s_nop 0
  buffer_load_dwordx4 v4, s[8:11], s47 offen lds
  s_add_u32 s27, s27, s50
  v_add_u32 v12, 57344, v7
  ds_read_b64_tr_b16 a[56:57], v12 offset:0
  ds_read_b64_tr_b16 a[58:59], v12 offset:2048
  ds_read_b64_tr_b16 a[60:61], v12 offset:64
  ds_read_b64_tr_b16 a[62:63], v12 offset:2112
  s_waitcnt lgkmcnt(0)
  s_waitcnt vmcnt(28)
  s_barrier
  s_mov_b32 s47, s27
  s_add_u32 m0, s28, 57344
  s_nop 0
  buffer_load_dwordx4 v4, s[8:11], s47 offen lds
  s_add_u32 s47, s27, s49
  s_add_u32 m0, s28, 58368
  s_nop 0
  buffer_load_dwordx4 v4, s[8:11], s47 offen lds
  s_add_u32 s27, s27, s50
  v_add_u32 v12, 65536, v7
  ds_read_b64_tr_b16 a[64:65], v12 offset:0
  ds_read_b64_tr_b16 a[66:67], v12 offset:2048
  ds_read_b64_tr_b16 a[68:69], v12 offset:64
  ds_read_b64_tr_b16 a[70:71], v12 offset:2112
  s_waitcnt lgkmcnt(0)
  s_waitcnt vmcnt(28)
  s_barrier
  s_mov_b32 s47, s27
  s_add_u32 m0, s28, 65536
  s_nop 0
  buffer_load_dwordx4 v4, s[8:11], s47 offen lds
  s_add_u32 s47, s27, s49
  s_add_u32 m0, s28, 66560
  s_nop 0
  buffer_load_dwordx4 v4, s[8:11], s47 offen lds
  s_add_u32 s27, s27, s50
  v_add_u32 v12, 73728, v7
  ds_read_b64_tr_b16 a[72:73], v12 offset:0
  ds_read_b64_tr_b16 a[74:75], v12 offset:2048
  ds_read_b64_tr_b16 a[76:77], v12 offset:64
  ds_read_b64_tr_b16 a[78:79], v12 offset:2112
  s_waitcnt lgkmcnt(0)
  s_waitcnt vmcnt(28)
  s_barrier
  s_mov_b32 s47, s27
  s_add_u32 m0, s28, 73728
  s_nop 0
  buffer_load_dwordx4 v4, s[8:11], s47 offen lds
  s_add_u32 s47, s27, s49
  s_add_u32 m0, s28, 74752
  s_nop 0
  buffer_load_dwordx4 v4, s[8:11], s47 offen lds
  s_add_u32 s27, s27, s50
  v_add_u32 v12, 81920, v7
  ds_read_b64_tr_b16 a[80:81], v12 offset:0
  ds_read_b64_tr_b16 a[82:83], v12 offset:2048
  ds_read_b64_tr_b16 a[84:85], v12 offset:64
  ds_read_b64_tr_b16 a[86:87], v12 offset:2112
  s_waitcnt lgkmcnt(0)
  s_waitcnt vmcnt(28)
  s_barrier
  s_mov_b32 s47, s27
  s_add_u32 m0, s28, 81920
  s_nop 0
  buffer_load_dwordx4 v4, s[8:11], s47 offen lds
  s_add_u32 s47, s27, s49
  s_add_u32 m0, s28, 82944
  s_nop 0
  buffer_load_dwordx4 v4, s[8:11], s47 offen lds
  s_add_u32 s27, s27, s50
  v_add_u32 v12, 90112, v7
  ds_read_b64_tr_b16 a[88:89], v12 offset:0
  ds_read_b64_tr_b16 a[90:91], v12 offset:2048
  ds_read_b64_tr_b16 a[92:93], v12 offset:64
  ds_read_b64_tr_b16 a[94:95], v12 offset:2112
  s_waitcnt lgkmcnt(0)
  s_waitcnt vmcnt(28)
  s_barrier
  s_mov_b32 s47, s27
  s_add_u32 m0, s28, 90112
  s_nop 0
  buffer_load_dwordx4 v4, s[8:11], s47 offen lds
  s_add_u32 s47, s27, s49
  s_add_u32 m0, s28, 91136
  s_nop 0
  buffer_load_dwordx4 v4, s[8:11], s47 offen lds
  s_add_u32 s27, s27, s50
  v_add_u32 v12, 98304, v7
  ds_read_b64_tr_b16 a[96:97], v12 offset:0
  ds_read_b64_tr_b16 a[98:99], v12 offset:2048
  ds_read_b64_tr_b16 a[100:101], v12 offset:64
  ds_read_b64_tr_b16 a[102:103], v12 offset:2112
  s_waitcnt lgkmcnt(0)
  s_waitcnt vmcnt(28)
  s_barrier
  s_mov_b32 s47, s27
  s_add_u32 m0, s28, 98304
  s_nop 0
  buffer_load_dwordx4 v4, s[8:11], s47 offen lds
  s_add_u32 s47, s27, s49
  s_add_u32 m0, s28, 99328
  s_nop 0
  buffer_load_dwordx4 v4, s[8:11], s47 offen lds
  s_add_u32 s27, s27, s50
  v_add_u32 v12, 106496, v7
  ds_read_b64_tr_b16 a[104:105], v12 offset:0
  ds_read_b64_tr_b16 a[106:107], v12 offset:2048
  ds_read_b64_tr_b16 a[108:109], v12 offset:64
  ds_read_b64_tr_b16 a[110:111], v12 offset:2112
  s_waitcnt lgkmcnt(0)
  s_waitcnt vmcnt(28)
  s_barrier
  s_mov_b32 s47, s27
  s_add_u32 m0, s28, 106496
  s_nop 0
  buffer_load_dwordx4 v4, s[8:11], s47 offen lds
  s_add_u32 s47, s27, s49
  s_add_u32 m0, s28, 107520
  s_nop 0
  buffer_load_dwordx4 v4, s[8:11], s47 offen lds
  s_add_u32 s27, s27, s50
  v_add_u32 v12, 114688, v7
  ds_read_b64_tr_b16 a[112:113], v12 offset:0
  ds_read_b64_tr_b16 a[114:115], v12 offset:2048
  ds_read_b64_tr_b16 a[116:117], v12 offset:64
  ds_read_b64_tr_b16 a[118:119], v12 offset:2112
  s_waitcnt lgkmcnt(0)
  s_waitcnt vmcnt(28)
  s_barrier
  s_mov_b32 s47, s27
  s_add_u32 m0, s28, 114688
  s_nop 0
  buffer_load_dwordx4 v4, s[8:11], s47 offen lds
  s_add_u32 s47, s27, s49
  s_add_u32 m0, s28, 115712
  s_nop 0
  buffer_load_dwordx4 v4, s[8:11], s47 offen lds
  s_add_u32 s27, s27, s50
  v_add_u32 v12, 122880, v7
  ds_read_b64_tr_b16 a[120:121], v12 offset:0
  ds_read_b64_tr_b16 a[122:123], v12 offset:2048
  ds_read_b64_tr_b16 a[124:125], v12 offset:64
  ds_read_b64_tr_b16 a[126:127], v12 offset:2112
  s_waitcnt lgkmcnt(0)
  s_waitcnt vmcnt(28)
  s_barrier
  s_mov_b32 s47, s27
  s_add_u32 m0, s28, 122880
  s_nop 0
  buffer_load_dwordx4 v4, s[8:11], s47 offen lds
  s_add_u32 s47, s27, s49
  s_add_u32 m0, s28, 123904
  s_nop 0
  buffer_load_dwordx4 v4, s[8:11], s47 offen lds
  s_add_u32 s27, s27, s50
  v_add_u32 v12, 0, v7
  ds_read_b64_tr_b16 a[128:129], v12 offset:0
  ds_read_b64_tr_b16 a[130:131], v12 offset:2048
  ds_read_b64_tr_b16 a[132:133], v12 offset:64
  ds_read_b64_tr_b16 a[134:135], v12 offset:2112
  s_waitcnt lgkmcnt(0)
  s_waitcnt vmcnt(28)
  s_barrier
  s_mov_b32 s47, s27
  s_add_u32 m0, s28, 0
  s_nop 0
  buffer_load_dwordx4 v4, s[8:11], s47 offen lds
  s_add_u32 s47, s27, s49
  s_add_u32 m0, s28, 1024
  s_nop 0
  buffer_load_dwordx4 v4, s[8:11], s47 offen lds
  s_add_u32 s27, s27, s50
  v_add_u32 v12, 8192, v7
  ds_read_b64_tr_b16 a[136:137], v12 offset:0
  ds_read_b64_tr_b16 a[138:139], v12 offset:2048
  ds_read_b64_tr_b16 a[140:141], v12 offset:64
  ds_read_b64_tr_b16 a[142:143], v12 offset:2112
  s_waitcnt lgkmcnt(0)
  s_waitcnt vmcnt(28)
  s_barrier
  s_mov_b32 s47, s27
  s_add_u32 m0, s28, 8192
  s_nop 0
  buffer_load_dwordx4 v4, s[8:11], s47 offen lds
  s_add_u32 s47, s27, s49
  s_add_u32 m0, s28, 9216
  s_nop 0
  buffer_load_dwordx4 v4, s[8:11], s47 offen lds
  s_add_u32 s27, s27, s50
  v_add_u32 v12, 16384, v7
  ds_read_b64_tr_b16 a[144:145], v12 offset:0
  ds_read_b64_tr_b16 a[146:147], v12 offset:2048
  ds_read_b64_tr_b16 a[148:149], v12 offset:64
  ds_read_b64_tr_b16 a[150:151], v12 offset:2112
  s_waitcnt lgkmcnt(0)
  s_waitcnt vmcnt(28)
  s_barrier
  s_mov_b32 s47, s27
  s_add_u32 m0, s28, 16384
  s_nop 0
  buffer_load_dwordx4 v4, s[8:11], s47 offen lds
  s_add_u32 s47, s27, s49
  s_add_u32 m0, s28, 17408
  s_nop 0
  buffer_load_dwordx4 v4, s[8:11], s47 offen lds
  s_add_u32 s27, s27, s50
  v_add_u32 v12, 24576, v7
  ds_read_b64_tr_b16 a[152:153], v12 offset:0
  ds_read_b64_tr_b16 a[154:155], v12 offset:2048
  ds_read_b64_tr_b16 a[156:157], v12 offset:64
  ds_read_b64_tr_b16 a[158:159], v12 offset:2112
  s_waitcnt lgkmcnt(0)
  s_waitcnt vmcnt(28)
  s_barrier
  s_mov_b32 s47, s27
  s_add_u32 m0, s28, 24576
  s_nop 0
  buffer_load_dwordx4 v4, s[8:11], s47 offen lds
  s_add_u32 s47, s27, s49
  s_add_u32 m0, s28, 25600
  s_nop 0
  buffer_load_dwordx4 v4, s[8:11], s47 offen lds
  s_add_u32 s27, s27, s50
  v_add_u32 v12, 32768, v7
  ds_read_b64_tr_b16 a[160:161], v12 offset:0
  ds_read_b64_tr_b16 a[162:163], v12 offset:2048
  ds_read_b64_tr_b16 a[164:165], v12 offset:64
  ds_read_b64_tr_b16 a[166:167], v12 offset:2112
  s_waitcnt lgkmcnt(0)
  s_waitcnt vmcnt(28)
  s_barrier
  s_mov_b32 s47, s27
  s_add_u32 m0, s28, 32768
  s_nop 0
  buffer_load_dwordx4 v4, s[8:11], s47 offen lds
  s_add_u32 s47, s27, s49
  s_add_u32 m0, s28, 33792
  s_nop 0
  buffer_load_dwordx4 v4, s[8:11], s47 offen lds
  s_add_u32 s27, s27, s50
  v_add_u32 v12, 40960, v7
  ds_read_b64_tr_b16 a[168:169], v12 offset:0
  ds_read_b64_tr_b16 a[170:171], v12 offset:2048
  ds_read_b64_tr_b16 a[172:173], v12 offset:64
  ds_read_b64_tr_b16 a[174:175], v12 offset:2112
  s_waitcnt lgkmcnt(0)
  s_waitcnt vmcnt(28)
  s_barrier
  s_mov_b32 s47, s27
  s_add_u32 m0, s28, 40960
  s_nop 0
  buffer_load_dwordx4 v4, s[8:11], s47 offen lds
  s_add_u32 s47, s27, s49
  s_add_u32 m0, s28, 41984
  s_nop 0
  buffer_load_dwordx4 v4, s[8:11], s47 offen lds
  s_add_u32 s27, s27, s50
  v_add_u32 v12, 49152, v7
  ds_read_b64_tr_b16 a[176:177], v12 offset:0
  ds_read_b64_tr_b16 a[178:179], v12 offset:2048
  ds_read_b64_tr_b16 a[180:181], v12 offset:64
  ds_read_b64_tr_b16 a[182:183], v12 offset:2112
  s_waitcnt lgkmcnt(0)
  s_waitcnt vmcnt(28)
  s_barrier
  s_mov_b32 s47, s27
  s_add_u32 m0, s28, 49152
  s_nop 0
  buffer_load_dwordx4 v4, s[8:11], s47 offen lds
  s_add_u32 s47, s27, s49
  s_add_u32 m0, s28, 50176
  s_nop 0
  buffer_load_dwordx4 v4, s[8:11], s47 offen lds
  s_add_u32 s27, s27, s50
  v_add_u32 v12, 57344, v7
  ds_read_b64_tr_b16 a[184:185], v12 offset:0
  ds_read_b64_tr_b16 a[186:187], v12 offset:2048
  ds_read_b64_tr_b16 a[188:189], v12 offset:64
  ds_read_b64_tr_b16 a[190:191], v12 offset:2112
  s_waitcnt lgkmcnt(0)
  s_waitcnt vmcnt(28)
  s_barrier
  s_mov_b32 s47, s27
  s_add_u32 m0, s28, 57344
  s_nop 0
  buffer_load_dwordx4 v4, s[8:11], s47 offen lds
  s_add_u32 s47, s27, s49
  s_add_u32 m0, s28, 58368
  s_nop 0
  buffer_load_dwordx4 v4, s[8:11], s47 offen lds
  s_add_u32 s27, s27, s50
  v_add_u32 v12, 65536, v7
  ds_read_b64_tr_b16 a[192:193], v12 offset:0
  ds_read_b64_tr_b16 a[194:195], v12 offset:2048
  ds_read_b64_tr_b16 a[196:197], v12 offset:64
  ds_read_b64_tr_b16 a[198:199], v12 offset:2112
  s_waitcnt lgkmcnt(0)
  s_waitcnt vmcnt(28)
  s_barrier
  v_add_u32 v12, 73728, v7
  ds_read_b64_tr_b16 a[200:201], v12 offset:0
  ds_read_b64_tr_b16 a[202:203], v12 offset:2048
  ds_read_b64_tr_b16 a[204:205], v12 offset:64
  ds_read_b64_tr_b16 a[206:207], v12 offset:2112
  s_waitcnt lgkmcnt(0)
  s_waitcnt vmcnt(26)
  s_barrier
  v_add_u32 v12, 81920, v7
  ds_read_b64_tr_b16 a[208:209], v12 offset:0
  ds_read_b64_tr_b16 a[210:211], v12 offset:2048
  ds_read_b64_tr_b16 a[212:213], v12 offset:64
  ds_read_b64_tr_b16 a[214:215], v12 offset:2112
  s_waitcnt lgkmcnt(0)
  s_waitcnt vmcnt(24)
  s_barrier
  v_add_u32 v12, 90112, v7
  ds_read_b64_tr_b16 a[216:217], v12 offset:0
  ds_read_b64_tr_b16 a[218:219], v12 offset:2048
  ds_read_b64_tr_b16 a[220:221], v12 offset:64
  ds_read_b64_tr_b16 a[222:223], v12 offset:2112
  s_waitcnt lgkmcnt(0)
  s_waitcnt vmcnt(22)
  s_barrier
  v_add_u32 v12, 98304, v7
  ds_read_b64_tr_b16 a[224:225], v12 offset:0
  ds_read_b64_tr_b16 a[226:227], v12 offset:2048
  ds_read_b64_tr_b16 a[228:229], v12 offset:64
  ds_read_b64_tr_b16 a[230:231], v12 offset:2112
  s_waitcnt lgkmcnt(0)
  s_waitcnt vmcnt(20)
  s_barrier
  v_add_u32 v12, 106496, v7
  ds_read_b64_tr_b16 a[232:233], v12 offset:0
  ds_read_b64_tr_b16 a[234:235], v12 offset:2048
  ds_read_b64_tr_b16 a[236:237], v12 offset:64
  ds_read_b64_tr_b16 a[238:239], v12 offset:2112
  s_waitcnt lgkmcnt(0)
  s_waitcnt vmcnt(18)
  s_barrier
  v_add_u32 v12, 114688, v7
  ds_read_b64_tr_b16 a[240:241], v12 offset:0
  ds_read_b64_tr_b16 a[242:243], v12 offset:2048
  ds_read_b64_tr_b16 a[244:245], v12 offset:64
  ds_read_b64_tr_b16 a[246:247], v12 offset:2112
  s_waitcnt lgkmcnt(0)
  s_waitcnt vmcnt(16)
  s_barrier
  v_add_u32 v12, 122880, v7
  ds_read_b64_tr_b16 a[248:249], v12 offset:0
  ds_read_b64_tr_b16 a[250:251], v12 offset:2048
  ds_read_b64_tr_b16 a[252:253], v12 offset:64
  ds_read_b64_tr_b16 a[254:255], v12 offset:2112
  s_waitcnt lgkmcnt(0)
  s_waitcnt vmcnt(14)
  s_barrier
  v_add_u32 v12, 0, v7
  ds_read_b64_tr_b16 v[192:193], v12 offset:0
  ds_read_b64_tr_b16 v[194:195], v12 offset:2048
  ds_read_b64_tr_b16 v[196:197], v12 offset:64
  ds_read_b64_tr_b16 v[198:199], v12 offset:2112
  s_waitcnt lgkmcnt(0)
  s_waitcnt vmcnt(12)
  s_barrier
  v_add_u32 v12, 8192, v7
  ds_read_b64_tr_b16 v[200:201], v12 offset:0
  ds_read_b64_tr_b16 v[202:203], v12 offset:2048
  ds_read_b64_tr_b16 v[204:205], v12 offset:64
  ds_read_b64_tr_b16 v[206:207], v12 offset:2112
  s_waitcnt lgkmcnt(0)
  s_waitcnt vmcnt(10)
  s_barrier
  v_add_u32 v12, 16384, v7
  ds_read_b64_tr_b16 v[208:209], v12 offset:0
  ds_read_b64_tr_b16 v[210:211], v12 offset:2048
  ds_read_b64_tr_b16 v[212:213], v12 offset:64
  ds_read_b64_tr_b16 v[214:215], v12 offset:2112
  s_waitcnt lgkmcnt(0)
  s_waitcnt vmcnt(8)
  s_barrier
  v_add_u32 v12, 24576, v7
  ds_read_b64_tr_b16 v[216:217], v12 offset:0
  ds_read_b64_tr_b16 v[218:219], v12 offset:2048
  ds_read_b64_tr_b16 v[220:221], v12 offset:64
  ds_read_b64_tr_b16 v[222:223], v12 offset:2112
  s_waitcnt lgkmcnt(0)
  s_waitcnt vmcnt(6)
  s_barrier
  v_add_u32 v12, 32768, v7
  ds_read_b64_tr_b16 v[224:225], v12 offset:0
  ds_read_b64_tr_b16 v[226:227], v12 offset:2048
  ds_read_b64_tr_b16 v[228:229], v12 offset:64
  ds_read_b64_tr_b16 v[230:231], v12 offset:2112
  s_waitcnt lgkmcnt(0)
  s_waitcnt vmcnt(4)
  s_barrier
  v_add_u32 v12, 40960, v7
  ds_read_b64_tr_b16 v[232:233], v12 offset:0
  ds_read_b64_tr_b16 v[234:235], v12 offset:2048
  ds_read_b64_tr_b16 v[236:237], v12 offset:64
  ds_read_b64_tr_b16 v[238:239], v12 offset:2112
  s_waitcnt lgkmcnt(0)
  s_waitcnt vmcnt(2)
  s_barrier
  v_add_u32 v12, 49152, v7
  ds_read_b64_tr_b16 v[240:241], v12 offset:0
  ds_read_b64_tr_b16 v[242:243], v12 offset:2048
  ds_read_b64_tr_b16 v[244:245], v12 offset:64
  ds_read_b64_tr_b16 v[246:247], v12 offset:2112
  s_waitcnt lgkmcnt(0)
  s_waitcnt vmcnt(0)
  s_barrier
  v_add_u32 v12, 57344, v7
  ds_read_b64_tr_b16 v[248:249], v12 offset:0
  ds_read_b64_tr_b16 v[250:251], v12 offset:2048
  ds_read_b64_tr_b16 v[252:253], v12 offset:64
  ds_read_b64_tr_b16 v[254:255], v12 offset:2112
  s_waitcnt lgkmcnt(0)
  s_barrier
  v_and_b32 v2, 63, v0
  v_and_b32 v3, 15, v2
  v_bfe_u32 v4, v2, 4, 1
  v_lshrrev_b32 v5, 5, v2
  v_lshlrev_b32 v6, 10, v4
  v_lshl_add_u32 v6, v5, 8, v6
  v_lshl_add_u32 v6, v3, 4, v6
  s_cmp_eq_u32 s3, 0
  s_cbranch_scc1 L_CF6
L_CR6:
  s_cmp_lg_u32 s13, 0
  s_cbranch_scc1 LNW_71
  v_mov_b32 v8, 1152
LNP_72:
  buffer_load_dword v9, v8, s[4:7], 0 offen sc1
  s_sub_u32 s74, s74, 1
  s_cbranch_scc1 L_TIMEOUT
  s_waitcnt vmcnt(0)
  v_cmp_gt_u32 vcc, 64, v9
  s_nop 0
  s_cbranch_vccz LNK_73
  s_sleep 12
  s_branch LNP_72
LNK_73:
LNW_71:
  s_barrier
  s_mul_i32 s30, s13, 10240
  s_mul_i32 s47, s24, 40960
  s_add_u32 s47, s47, s30
  s_add_u32 s27, s47, 3145728
  s_add_u32 s34, s27, 614400
  s_mov_b32 s29, 0
  s_mov_b32 s32, 0
  s_mov_b32 s33, 0
  s_barrier
  s_add_u32 s52, s33, s30
  s_add_u32 s53, s27, 0
  s_add_u32 m0, s52, 0
  s_nop 0
  buffer_load_dwordx4 v1, s[4:7], s53 offen offset:0 sc1 lds
  buffer_load_dwordx4 v1, s[4:7], s53 offen offset:1024 sc1 lds
  buffer_load_dwordx4 v1, s[4:7], s53 offen offset:2048 sc1 lds
  buffer_load_dwordx4 v1, s[4:7], s53 offen offset:3072 sc1 lds
  s_add_u32 s53, s27, 4096
  s_add_u32 m0, s52, 4096
  s_nop 0
  buffer_load_dwordx4 v1, s[4:7], s53 offen offset:0 sc1 lds
  buffer_load_dwordx4 v1, s[4:7], s53 offen offset:1024 sc1 lds
  buffer_load_dwordx4 v1, s[4:7], s53 offen offset:2048 sc1 lds
  buffer_load_dwordx4 v1, s[4:7], s53 offen offset:3072 sc1 lds
  s_add_u32 s53, s27, 8192
  s_add_u32 m0, s52, 8192
  s_nop 0
  buffer_load_dwordx4 v1, s[4:7], s53 offen offset:0 sc1 lds
  buffer_load_dwordx4 v1, s[4:7], s53 offen offset:1024 sc1 lds
  s_add_u32 s27, s27, 40960
  s_min_u32 s27, s27, s34
  s_add_u32 s33, s33, 40960
  s_cmp_eq_u32 s33, 122880
  s_cselect_b32 s33, 0, s33
  s_add_u32 s52, s33, s30
  s_add_u32 s53, s27, 0
  s_add_u32 m0, s52, 0
  s_nop 0
  buffer_load_dwordx4 v1, s[4:7], s53 offen offset:0 sc1 lds
  buffer_load_dwordx4 v1, s[4:7], s53 offen offset:1024 sc1 lds
  buffer_load_dwordx4 v1, s[4:7], s53 offen offset:2048 sc1 lds
  buffer_load_dwordx4 v1, s[4:7], s53 offen offset:3072 sc1 lds
  s_add_u32 s53, s27, 4096
  s_add_u32 m0, s52, 4096
  s_nop 0
  buffer_load_dwordx4 v1, s[4:7], s53 offen offset:0 sc1 lds
  buffer_load_dwordx4 v1, s[4:7], s53 offen offset:1024 sc1 lds
  buffer_load_dwordx4 v1, s[4:7], s53 offen offset:2048 sc1 lds
  buffer_load_dwordx4 v1, s[4:7], s53 offen offset:3072 sc1 lds
  s_add_u32 s53, s27, 8192
  s_add_u32 m0, s52, 8192
  s_nop 0
  buffer_load_dwordx4 v1, s[4:7], s53 offen offset:0 sc1 lds
  buffer_load_dwordx4 v1, s[4:7], s53 offen offset:1024 sc1 lds
  s_add_u32 s27, s27, 40960
  s_min_u32 s27, s27, s34
  s_add_u32 s33, s33, 40960
  s_cmp_eq_u32 s33, 122880
  s_cselect_b32 s33, 0, s33
  s_waitcnt vmcnt(10)
  s_barrier
  v_add_u32 v12, s32, v1
  ds_read_b128 v[16:19], v12 offset:0
  ds_read_b128 v[20:23], v12 offset:1024
  ds_read_b128 v[24:27], v12 offset:2048
  s_waitcnt lgkmcnt(2)
  v_mfma_f32_32x32x16_bf16 v[96:111], v[16:19], a[0:3], 0
  ds_read_b128 v[28:31], v12 offset:3072
  v_mfma_f32_32x32x16_bf16 v[112:127], v[16:19], a[4:7], 0
  s_add_u32 s52, s33, s30
  s_add_u32 s53, s27, 0
  s_add_u32 m0, s52, 0
  s_nop 0
  buffer_load_dwordx4 v1, s[4:7], s53 offen offset:0 sc1 lds
  s_waitcnt lgkmcnt(2)
  v_mfma_f32_32x32x16_bf16 v[96:111], v[20:23], a[8:11], v[96:111]
  ds_read_b128 v[16:19], v12 offset:4096
  v_mfma_f32_32x32x16_bf16 v[112:127], v[20:23], a[12:15], v[112:127]
  s_waitcnt lgkmcnt(2)
  v_mfma_f32_32x32x16_bf16 v[96:111], v[24:27], a[16:19], v[96:111]
  ds_read_b128 v[20:23], v12 offset:5120
  v_mfma_f32_32x32x16_bf16 v[112:127], v[24:27], a[20:23], v[112:127]
  buffer_load_dwordx4 v1, s[4:7], s53 offen offset:1024 sc1 lds
  s_waitcnt lgkmcnt(2)
  v_mfma_f32_32x32x16_bf16 v[96:111], v[28:31], a[24:27], v[96:111]
  ds_read_b128 v[24:27], v12 offset:6144
  v_mfma_f32_32x32x16_bf16 v[112:127], v[28:31], a[28:31], v[112:127]
  s_waitcnt lgkmcnt(2)
  v_mfma_f32_32x32x16_bf16 v[96:111], v[16:19], a[32:35], v[96:111]
  ds_read_b128 v[28:31], v12 offset:7168
  v_mfma_f32_32x32x16_bf16 v[112:127], v[16:19], a[36:39], v[112:127]
  buffer_load_dwordx4 v1, s[4:7], s53 offen offset:2048 sc1 lds
  s_waitcnt lgkmcnt(2)
  v_mfma_f32_32x32x16_bf16 v[96:111], v[20:23], a[40:43], v[96:111]
  ds_read_b128 v[16:19], v12 offset:8192
  v_mfma_f32_32x32x16_bf16 v[112:127], v[20:23], a[44:47], v[112:127]
  s_waitcnt lgkmcnt(2)
  v_mfma_f32_32x32x16_bf16 v[96:111], v[24:27], a[48:51], v[96:111]
  ds_read_b128 v[20:23], v12 offset:9216
  v_mfma_f32_32x32x16_bf16 v[112:127], v[24:27], a[52:55], v[112:127]
  buffer_load_dwordx4 v1, s[4:7], s53 offen offset:3072 sc1 lds
  s_waitcnt lgkmcnt(2)
  v_mfma_f32_32x32x16_bf16 v[96:111], v[28:31], a[56:59], v[96:111]
  ds_read_b128 v[24:27], v12 offset:10240
  v_mfma_f32_32x32x16_bf16 v[112:127], v[28:31], a[60:63], v[112:127]
  s_waitcnt lgkmcnt(2)
  v_mfma_f32_32x32x16_bf16 v[96:111], v[16:19], a[64:67], v[96:111]
  ds_read_b128 v[28:31], v12 offset:11264
  v_mfma_f32_32x32x16_bf16 v[112:127], v[16:19], a[68:71], v[112:127]
  s_add_u32 s53, s27, 4096
  s_add_u32 m0, s52, 4096
  s_nop 0
  buffer_load_dwordx4 v1, s[4:7], s53 offen offset:0 sc1 lds
  s_waitcnt lgkmcnt(2)
  v_mfma_f32_32x32x16_bf16 v[96:111], v[20:23], a[72:75], v[96:111]
  ds_read_b128 v[16:19], v12 offset:12288
  v_mfma_f32_32x32x16_bf16 v[112:127], v[20:23], a[76:79], v[112:127]
  s_waitcnt lgkmcnt(2)
  v_mfma_f32_32x32x16_bf16 v[96:111], v[24:27], a[80:83], v[96:111]
  ds_read_b128 v[20:23], v12 offset:13312
  v_mfma_f32_32x32x16_bf16 v[112:127], v[24:27], a[84:87], v[112:127]
  buffer_load_dwordx4 v1, s[4:7], s53 offen offset:1024 sc1 lds
  s_waitcnt lgkmcnt(2)
  v_mfma_f32_32x32x16_bf16 v[96:111], v[28:31], a[88:91], v[96:111]
  ds_read_b128 v[24:27], v12 offset:14336
  v_mfma_f32_32x32x16_bf16 v[112:127], v[28:31], a[92:95], v[112:127]
  s_waitcnt lgkmcnt(2)
  v_mfma_f32_32x32x16_bf16 v[96:111], v[16:19], a[96:99], v[96:111]
  ds_read_b128 v[28:31], v12 offset:15360
  v_mfma_f32_32x32x16_bf16 v[112:127], v[16:19], a[100:103], v[112:127]
  buffer_load_dwordx4 v1, s[4:7], s53 offen offset:2048 sc1 lds
  s_waitcnt lgkmcnt(2)
  v_mfma_f32_32x32x16_bf16 v[96:111], v[20:23], a[104:107], v[96:111]
  ds_read_b128 v[16:19], v12 offset:16384
  v_mfma_f32_32x32x16_bf16 v[112:127], v[20:23], a[108:111], v[112:127]
  s_waitcnt lgkmcnt(2)
  v_mfma_f32_32x32x16_bf16 v[96:111], v[24:27], a[112:115], v[96:111]
  ds_read_b128 v[20:23], v12 offset:17408
  v_mfma_f32_32x32x16_bf16 v[112:127], v[24:27], a[116:119], v[112:127]
  buffer_load_dwordx4 v1, s[4:7], s53 offen offset:3072 sc1 lds
  s_waitcnt lgkmcnt(2)
  v_mfma_f32_32x32x16_bf16 v[96:111], v[28:31], a[120:123], v[96:111]
  ds_read_b128 v[24:27], v12 offset:18432
  v_mfma_f32_32x32x16_bf16 v[112:127], v[28:31], a[124:127], v[112:127]
  s_waitcnt lgkmcnt(2)
  v_mfma_f32_32x32x16_bf16 v[96:111], v[16:19], a[128:131], v[96:111]
  ds_read_b128 v[28:31], v12 offset:19456
  v_mfma_f32_32x32x16_bf16 v[112:127], v[16:19], a[132:135], v[112:127]
  s_add_u32 s53, s27, 8192
  s_add_u32 m0, s52, 8192
  s_nop 0
  buffer_load_dwordx4 v1, s[4:7], s53 offen offset:0 sc1 lds
  s_waitcnt lgkmcnt(2)
  v_mfma_f32_32x32x16_bf16 v[96:111], v[20:23], a[136:139], v[96:111]
  ds_read_b128 v[16:19], v12 offset:20480
  v_mfma_f32_32x32x16_bf16 v[112:127], v[20:23], a[140:143], v[112:127]
  s_waitcnt lgkmcnt(2)
  v_mfma_f32_32x32x16_bf16 v[96:111], v[24:27], a[144:147], v[96:111]
  ds_read_b128 v[20:23], v12 offset:21504
  v_mfma_f32_32x32x16_bf16 v[112:127], v[24:27], a[148:151], v[112:127]
  buffer_load_dwordx4 v1, s[4:7], s53 offen offset:1024 sc1 lds
  s_add_u32 s27, s27, 40960
  s_min_u32 s27, s27, s34
  s_add_u32 s33, s33, 40960
  s_cmp_eq_u32 s33, 122880
  s_cselect_b32 s33, 0, s33
  s_waitcnt lgkmcnt(2)
  v_mfma_f32_32x32x16_bf16 v[96:111], v[28:31], a[152:155], v[96:111]
  ds_read_b128 v[24:27], v12 offset:22528
  v_mfma_f32_32x32x16_bf16 v[112:127], v[28:31], a[156:159], v[112:127]
  s_waitcnt lgkmcnt(2)
  v_mfma_f32_32x32x16_bf16 v[96:111], v[16:19], a[160:163], v[96:111]
  ds_read_b128 v[28:31], v12 offset:23552
  v_mfma_f32_32x32x16_bf16 v[112:127], v[16:19], a[164:167], v[112:127]
  s_waitcnt lgkmcnt(2)
  v_mfma_f32_32x32x16_bf16 v[96:111], v[20:23], a[168:171], v[96:111]
  ds_read_b128 v[16:19], v12 offset:24576
  v_mfma_f32_32x32x16_bf16 v[112:127], v[20:23], a[172:175], v[112:127]
  s_waitcnt lgkmcnt(2)
  v_mfma_f32_32x32x16_bf16 v[96:111], v[24:27], a[176:179], v[96:111]
  ds_read_b128 v[20:23], v12 offset:25600
  v_mfma_f32_32x32x16_bf16 v[112:127], v[24:27], a[180:183], v[112:127]
  s_waitcnt lgkmcnt(2)
  v_mfma_f32_32x32x16_bf16 v[96:111], v[28:31], a[184:187], v[96:111]
  ds_read_b128 v[24:27], v12 offset:26624
  v_mfma_f32_32x32x16_bf16 v[112:127], v[28:31], a[188:191], v[112:127]
  s_waitcnt lgkmcnt(2)
  v_mfma_f32_32x32x16_bf16 v[96:111], v[16:19], a[192:195], v[96:111]
  ds_read_b128 v[28:31], v12 offset:27648
  v_mfma_f32_32x32x16_bf16 v[112:127], v[16:19], a[196:199], v[112:127]
  s_waitcnt lgkmcnt(2)
  v_mfma_f32_32x32x16_bf16 v[96:111], v[20:23], a[200:203], v[96:111]
  ds_read_b128 v[16:19], v12 offset:28672
  v_mfma_f32_32x32x16_bf16 v[112:127], v[20:23], a[204:207], v[112:127]
  s_waitcnt lgkmcnt(2)
  v_mfma_f32_32x32x16_bf16 v[96:111], v[24:27], a[208:211], v[96:111]
  ds_read_b128 v[20:23], v12 offset:29696
  v_mfma_f32_32x32x16_bf16 v[112:127], v[24:27], a[212:215], v[112:127]
  s_waitcnt lgkmcnt(2)
  v_mfma_f32_32x32x16_bf16 v[96:111], v[28:31], a[216:219], v[96:111]
  ds_read_b128 v[24:27], v12 offset:30720
  v_mfma_f32_32x32x16_bf16 v[112:127], v[28:31], a[220:223], v[112:127]
  s_waitcnt lgkmcnt(2)
  v_mfma_f32_32x32x16_bf16 v[96:111], v[16:19], a[224:227], v[96:111]
  ds_read_b128 v[28:31], v12 offset:31744
  v_mfma_f32_32x32x16_bf16 v[112:127], v[16:19], a[228:231], v[112:127]
  s_waitcnt lgkmcnt(2)
  v_mfma_f32_32x32x16_bf16 v[96:111], v[20:23], a[232:235], v[96:111]
  ds_read_b128 v[16:19], v12 offset:32768
  v_mfma_f32_32x32x16_bf16 v[112:127], v[20:23], a[236:239], v[112:127]
  s_waitcnt lgkmcnt(2)
  v_mfma_f32_32x32x16_bf16 v[96:111], v[24:27], a[240:243], v[96:111]
  ds_read_b128 v[20:23], v12 offset:33792
  v_mfma_f32_32x32x16_bf16 v[112:127], v[24:27], a[244:247], v[112:127]
  s_waitcnt lgkmcnt(2)
  v_mfma_f32_32x32x16_bf16 v[96:111], v[28:31], a[248:251], v[96:111]
  ds_read_b128 v[24:27], v12 offset:34816
  v_mfma_f32_32x32x16_bf16 v[112:127], v[28:31], a[252:255], v[112:127]
  s_waitcnt lgkmcnt(2)
  v_mfma_f32_32x32x16_bf16 v[96:111], v[16:19], v[192:195], v[96:111]
  ds_read_b128 v[28:31], v12 offset:35840
  v_mfma_f32_32x32x16_bf16 v[112:127], v[16:19], v[196:199], v[112:127]
  s_waitcnt lgkmcnt(2)
  v_mfma_f32_32x32x16_bf16 v[96:111], v[20:23], v[200:203], v[96:111]
  ds_read_b128 v[16:19], v12 offset:36864
  v_mfma_f32_32x32x16_bf16 v[112:127], v[20:23], v[204:207], v[112:127]
  s_waitcnt lgkmcnt(2)
  v_mfma_f32_32x32x16_bf16 v[96:111], v[24:27], v[208:211], v[96:111]
  ds_read_b128 v[20:23], v12 offset:37888
  v_mfma_f32_32x32x16_bf16 v[112:127], v[24:27], v[212:215], v[112:127]
  s_waitcnt lgkmcnt(2)
  v_mfma_f32_32x32x16_bf16 v[96:111], v[28:31], v[216:219], v[96:111]
  ds_read_b128 v[24:27], v12 offset:38912
  v_mfma_f32_32x32x16_bf16 v[112:127], v[28:31], v[220:223], v[112:127]
  s_waitcnt lgkmcnt(2)
  v_mfma_f32_32x32x16_bf16 v[96:111], v[16:19], v[224:227], v[96:111]
  ds_read_b128 v[28:31], v12 offset:39936
  v_mfma_f32_32x32x16_bf16 v[112:127], v[16:19], v[228:231], v[112:127]
  s_waitcnt lgkmcnt(2)
  v_mfma_f32_32x32x16_bf16 v[96:111], v[20:23], v[232:235], v[96:111]
  v_mfma_f32_32x32x16_bf16 v[112:127], v[20:23], v[236:239], v[112:127]
  s_waitcnt lgkmcnt(1)
  v_mfma_f32_32x32x16_bf16 v[96:111], v[24:27], v[240:243], v[96:111]
  v_mfma_f32_32x32x16_bf16 v[112:127], v[24:27], v[244:247], v[112:127]
  s_waitcnt lgkmcnt(0)
  v_mfma_f32_32x32x16_bf16 v[96:111], v[28:31], v[248:251], v[96:111]
  v_mfma_f32_32x32x16_bf16 v[112:127], v[28:31], v[252:255], v[112:127]
  s_add_u32 s32, s32, 40960
  s_cmp_eq_u32 s32, 122880
  s_cselect_b32 s32, 0, s32
  s_add_u32 s29, s29, 1
  s_waitcnt vmcnt(10)
  s_barrier
  s_sub_u32 s49, s29, 2
  s_max_i32 s49, s49, 0
  s_cmp_lg_u32 s13, 0
  s_cbranch_scc1 PB_77
  v_mov_b32 v8, s49
  v_mov_b32 v9, s26
  buffer_store_dword v8, v9, s[4:7], 0 offen sc1
PB_77:
  s_add_u32 s47, s24, s29
  s_sub_u32 s47, s47, 1
  s_lshl_b32 s25, s47, 18
  s_add_u32 s25, s25, s31
  v_add_u32 v12, s32, v1
  ds_read_b128 v[16:19], v12 offset:0
  ds_read_b128 v[20:23], v12 offset:1024
  ds_read_b128 v[24:27], v12 offset:2048
  s_waitcnt lgkmcnt(2)
  v_mfma_f32_32x32x16_bf16 v[128:143], v[16:19], a[0:3], 0
  ds_read_b128 v[28:31], v12 offset:3072
  v_mfma_f32_32x32x16_bf16 v[144:159], v[16:19], a[4:7], 0
  s_add_u32 s52, s33, s30
  s_add_u32 s53, s27, 0
  s_add_u32 m0, s52, 0
  s_nop 0
  buffer_load_dwordx4 v1, s[4:7], s53 offen offset:0 sc1 lds
  s_waitcnt lgkmcnt(2)
  v_mfma_f32_32x32x16_bf16 v[128:143], v[20:23], a[8:11], v[128:143]
  ds_read_b128 v[16:19], v12 offset:4096
  v_mfma_f32_32x32x16_bf16 v[144:159], v[20:23], a[12:15], v[144:159]
  s_waitcnt lgkmcnt(2)
  v_mfma_f32_32x32x16_bf16 v[128:143], v[24:27], a[16:19], v[128:143]
  ds_read_b128 v[20:23], v12 offset:5120
  v_mfma_f32_32x32x16_bf16 v[144:159], v[24:27], a[20:23], v[144:159]
  buffer_load_dwordx4 v1, s[4:7], s53 offen offset:1024 sc1 lds
  s_waitcnt lgkmcnt(2)
  v_mfma_f32_32x32x16_bf16 v[128:143], v[28:31], a[24:27], v[128:143]
  ds_read_b128 v[24:27], v12 offset:6144
  v_mfma_f32_32x32x16_bf16 v[144:159], v[28:31], a[28:31], v[144:159]
  s_waitcnt lgkmcnt(2)
  v_mfma_f32_32x32x16_bf16 v[128:143], v[16:19], a[32:35], v[128:143]
  ds_read_b128 v[28:31], v12 offset:7168
  v_mfma_f32_32x32x16_bf16 v[144:159], v[16:19], a[36:39], v[144:159]
  buffer_load_dwordx4 v1, s[4:7], s53 offen offset:2048 sc1 lds
  s_waitcnt lgkmcnt(2)
  v_mfma_f32_32x32x16_bf16 v[128:143], v[20:23], a[40:43], v[128:143]
  ds_read_b128 v[16:19], v12 offset:8192
  v_mfma_f32_32x32x16_bf16 v[144:159], v[20:23], a[44:47], v[144:159]
  s_waitcnt lgkmcnt(2)
  v_mfma_f32_32x32x16_bf16 v[128:143], v[24:27], a[48:51], v[128:143]
  ds_read_b128 v[20:23], v12 offset:9216
  v_mfma_f32_32x32x16_bf16 v[144:159], v[24:27], a[52:55], v[144:159]
  buffer_load_dwordx4 v1, s[4:7], s53 offen offset:3072 sc1 lds
  s_waitcnt lgkmcnt(2)
  v_mfma_f32_32x32x16_bf16 v[128:143], v[28:31], a[56:59], v[128:143]
  ds_read_b128 v[24:27], v12 offset:10240
  v_mfma_f32_32x32x16_bf16 v[144:159], v[28:31], a[60:63], v[144:159]
  s_waitcnt lgkmcnt(2)
  v_mfma_f32_32x32x16_bf16 v[128:143], v[16:19], a[64:67], v[128:143]
  ds_read_b128 v[28:31], v12 offset:11264
  v_mfma_f32_32x32x16_bf16 v[144:159], v[16:19], a[68:71], v[144:159]
  s_add_u32 s53, s27, 4096
  s_add_u32 m0, s52, 4096
  s_nop 0
  buffer_load_dwordx4 v1, s[4:7], s53 offen offset:0 sc1 lds
  s_waitcnt lgkmcnt(2)
  v_mfma_f32_32x32x16_bf16 v[128:143], v[20:23], a[72:75], v[128:143]
  ds_read_b128 v[16:19], v12 offset:12288
  v_mfma_f32_32x32x16_bf16 v[144:159], v[20:23], a[76:79], v[144:159]
  s_waitcnt lgkmcnt(2)
  v_mfma_f32_32x32x16_bf16 v[128:143], v[24:27], a[80:83], v[128:143]
  ds_read_b128 v[20:23], v12 offset:13312
  v_mfma_f32_32x32x16_bf16 v[144:159], v[24:27], a[84:87], v[144:159]
  buffer_load_dwordx4 v1, s[4:7], s53 offen offset:1024 sc1 lds
  s_waitcnt lgkmcnt(2)
  v_mfma_f32_32x32x16_bf16 v[128:143], v[28:31], a[88:91], v[128:143]
  ds_read_b128 v[24:27], v12 offset:14336
  v_mfma_f32_32x32x16_bf16 v[144:159], v[28:31], a[92:95], v[144:159]
  s_waitcnt lgkmcnt(2)
  v_mfma_f32_32x32x16_bf16 v[128:143], v[16:19], a[96:99], v[128:143]
  ds_read_b128 v[28:31], v12 offset:15360
  v_mfma_f32_32x32x16_bf16 v[144:159], v[16:19], a[100:103], v[144:159]
  buffer_load_dwordx4 v1, s[4:7], s53 offen offset:2048 sc1 lds
  s_waitcnt lgkmcnt(2)
  v_mfma_f32_32x32x16_bf16 v[128:143], v[20:23], a[104:107], v[128:143]
  ds_read_b128 v[16:19], v12 offset:16384
  v_mfma_f32_32x32x16_bf16 v[144:159], v[20:23], a[108:111], v[144:159]
  s_waitcnt lgkmcnt(2)
  v_mfma_f32_32x32x16_bf16 v[128:143], v[24:27], a[112:115], v[128:143]
  ds_read_b128 v[20:23], v12 offset:17408
  v_mfma_f32_32x32x16_bf16 v[144:159], v[24:27], a[116:119], v[144:159]
  buffer_load_dwordx4 v1, s[4:7], s53 offen offset:3072 sc1 lds
  s_waitcnt lgkmcnt(2)
  v_mfma_f32_32x32x16_bf16 v[128:143], v[28:31], a[120:123], v[128:143]
  ds_read_b128 v[24:27], v12 offset:18432
  v_mfma_f32_32x32x16_bf16 v[144:159], v[28:31], a[124:127], v[144:159]
  s_waitcnt lgkmcnt(2)
  v_mfma_f32_32x32x16_bf16 v[128:143], v[16:19], a[128:131], v[128:143]
  ds_read_b128 v[28:31], v12 offset:19456
  v_mfma_f32_32x32x16_bf16 v[144:159], v[16:19], a[132:135], v[144:159]
  s_add_u32 s53, s27, 8192
  s_add_u32 m0, s52, 8192
  s_nop 0
  buffer_load_dwordx4 v1, s[4:7], s53 offen offset:0 sc1 lds
  s_waitcnt lgkmcnt(2)
  v_mfma_f32_32x32x16_bf16 v[128:143], v[20:23], a[136:139], v[128:143]
  ds_read_b128 v[16:19], v12 offset:20480
  v_mfma_f32_32x32x16_bf16 v[144:159], v[20:23], a[140:143], v[144:159]
  s_waitcnt lgkmcnt(2)
  v_mfma_f32_32x32x16_bf16 v[128:143], v[24:27], a[144:147], v[128:143]
  ds_read_b128 v[20:23], v12 offset:21504
  v_mfma_f32_32x32x16_bf16 v[144:159], v[24:27], a[148:151], v[144:159]
  buffer_load_dwordx4 v1, s[4:7], s53 offen offset:1024 sc1 lds
  s_add_u32 s27, s27, 40960
  s_min_u32 s27, s27, s34
  s_add_u32 s33, s33, 40960
  s_cmp_eq_u32 s33, 122880
  s_cselect_b32 s33, 0, s33
  s_waitcnt lgkmcnt(2)
  v_mfma_f32_32x32x16_bf16 v[128:143], v[28:31], a[152:155], v[128:143]
  ds_read_b128 v[24:27], v12 offset:22528
  v_mfma_f32_32x32x16_bf16 v[144:159], v[28:31], a[156:159], v[144:159]
  s_waitcnt lgkmcnt(2)
  v_mfma_f32_32x32x16_bf16 v[128:143], v[16:19], a[160:163], v[128:143]
  ds_read_b128 v[28:31], v12 offset:23552
  v_mfma_f32_32x32x16_bf16 v[144:159], v[16:19], a[164:167], v[144:159]
  s_waitcnt lgkmcnt(2)
  v_mfma_f32_32x32x16_bf16 v[128:143], v[20:23], a[168:171], v[128:143]
  ds_read_b128 v[16:19], v12 offset:24576
  v_mfma_f32_32x32x16_bf16 v[144:159], v[20:23], a[172:175], v[144:159]
  s_waitcnt lgkmcnt(2)
  v_mfma_f32_32x32x16_bf16 v[128:143], v[24:27], a[176:179], v[128:143]
  ds_read_b128 v[20:23], v12 offset:25600
  v_mfma_f32_32x32x16_bf16 v[144:159], v[24:27], a[180:183], v[144:159]
  s_waitcnt lgkmcnt(2)
  v_mfma_f32_32x32x16_bf16 v[128:143], v[28:31], a[184:187], v[128:143]
  ds_read_b128 v[24:27], v12 offset:26624
  v_mfma_f32_32x32x16_bf16 v[144:159], v[28:31], a[188:191], v[144:159]
  s_waitcnt lgkmcnt(2)
  v_mfma_f32_32x32x16_bf16 v[128:143], v[16:19], a[192:195], v[128:143]
  ds_read_b128 v[28:31], v12 offset:27648
  v_mfma_f32_32x32x16_bf16 v[144:159], v[16:19], a[196:199], v[144:159]
  s_waitcnt lgkmcnt(2)
  v_mfma_f32_32x32x16_bf16 v[128:143], v[20:23], a[200:203], v[128:143]
  ds_read_b128 v[16:19], v12 offset:28672
  v_mfma_f32_32x32x16_bf16 v[144:159], v[20:23], a[204:207], v[144:159]
  s_waitcnt lgkmcnt(2)
  v_mfma_f32_32x32x16_bf16 v[128:143], v[24:27], a[208:211], v[128:143]
  ds_read_b128 v[20:23], v12 offset:29696
  v_mfma_f32_32x32x16_bf16 v[144:159], v[24:27], a[212:215], v[144:159]
  s_waitcnt lgkmcnt(2)
  v_mfma_f32_32x32x16_bf16 v[128:143], v[28:31], a[216:219], v[128:143]
  ds_read_b128 v[24:27], v12 offset:30720
  v_mfma_f32_32x32x16_bf16 v[144:159], v[28:31], a[220:223], v[144:159]
  s_waitcnt lgkmcnt(2)
  v_mfma_f32_32x32x16_bf16 v[128:143], v[16:19], a[224:227], v[128:143]
  ds_read_b128 v[28:31], v12 offset:31744
  v_cvt_pk_bf16_f32 v40, v96, v97
  v_mfma_f32_32x32x16_bf16 v[144:159], v[16:19], a[228:231], v[144:159]
  v_cvt_pk_bf16_f32 v41, v98, v99
  s_waitcnt lgkmcnt(2)
  v_mfma_f32_32x32x16_bf16 v[128:143], v[20:23], a[232:235], v[128:143]
  ds_read_b128 v[16:19], v12 offset:32768
  v_cvt_pk_bf16_f32 v42, v104, v105
  v_mfma_f32_32x32x16_bf16 v[144:159], v[20:23], a[236:239], v[144:159]
  v_cvt_pk_bf16_f32 v43, v106, v107
  s_waitcnt lgkmcnt(2)
  v_mfma_f32_32x32x16_bf16 v[128:143], v[24:27], a[240:243], v[128:143]
  ds_read_b128 v[20:23], v12 offset:33792
  buffer_store_dwordx4 v[40:43], v6, s[4:7], s25 offen offset:0 sc1
  v_mfma_f32_32x32x16_bf16 v[144:159], v[24:27], a[244:247], v[144:159]
  v_cvt_pk_bf16_f32 v44, v100, v101
  s_waitcnt lgkmcnt(2)
  v_mfma_f32_32x32x16_bf16 v[128:143], v[28:31], a[248:251], v[128:143]
  ds_read_b128 v[24:27], v12 offset:34816
  v_cvt_pk_bf16_f32 v45, v102, v103
  v_mfma_f32_32x32x16_bf16 v[144:159], v[28:31], a[252:255], v[144:159]
  v_cvt_pk_bf16_f32 v46, v108, v109
  s_waitcnt lgkmcnt(2)
  v_mfma_f32_32x32x16_bf16 v[128:143], v[16:19], v[192:195], v[128:143]
  ds_read_b128 v[28:31], v12 offset:35840
  v_cvt_pk_bf16_f32 v47, v110, v111
  v_mfma_f32_32x32x16_bf16 v[144:159], v[16:19], v[196:199], v[144:159]
  buffer_store_dwordx4 v[44:47], v6, s[4:7], s25 offen offset:512 sc1
  s_waitcnt lgkmcnt(2)
  v_mfma_f32_32x32x16_bf16 v[128:143], v[20:23], v[200:203], v[128:143]
  ds_read_b128 v[16:19], v12 offset:36864
  v_cvt_pk_bf16_f32 v40, v112, v113
  v_mfma_f32_32x32x16_bf16 v[144:159], v[20:23], v[204:207], v[144:159]
  v_cvt_pk_bf16_f32 v41, v114, v115
  s_waitcnt lgkmcnt(2)
  v_mfma_f32_32x32x16_bf16 v[128:143], v[24:27], v[208:211], v[128:143]
  ds_read_b128 v[20:23], v12 offset:37888
  v_cvt_pk_bf16_f32 v42, v120, v121
  v_mfma_f32_32x32x16_bf16 v[144:159], v[24:27], v[212:215], v[144:159]
  v_cvt_pk_bf16_f32 v43, v122, v123
  s_waitcnt lgkmcnt(2)
  v_mfma_f32_32x32x16_bf16 v[128:143], v[28:31], v[216:219], v[128:143]
  ds_read_b128 v[24:27], v12 offset:38912
  buffer_store_dwordx4 v[40:43], v6, s[4:7], s25 offen offset:2048 sc1
  v_mfma_f32_32x32x16_bf16 v[144:159], v[28:31], v[220:223], v[144:159]
  v_cvt_pk_bf16_f32 v44, v116, v117
  s_waitcnt lgkmcnt(2)
  v_mfma_f32_32x32x16_bf16 v[128:143], v[16:19], v[224:227], v[128:143]
  ds_read_b128 v[28:31], v12 offset:39936
  v_cvt_pk_bf16_f32 v45, v118, v119
  v_mfma_f32_32x32x16_bf16 v[144:159], v[16:19], v[228:231], v[144:159]
  v_cvt_pk_bf16_f32 v46, v124, v125
  s_waitcnt lgkmcnt(2)
  v_mfma_f32_32x32x16_bf16 v[128:143], v[20:23], v[232:235], v[128:143]
  v_cvt_pk_bf16_f32 v47, v126, v127
  v_mfma_f32_32x32x16_bf16 v[144:159], v[20:23], v[236:239], v[144:159]
  buffer_store_dwordx4 v[44:47], v6, s[4:7], s25 offen offset:2560 sc1
  s_waitcnt lgkmcnt(1)
  v_mfma_f32_32x32x16_bf16 v[128:143], v[24:27], v[240:243], v[128:143]
  v_mfma_f32_32x32x16_bf16 v[144:159], v[24:27], v[244:247], v[144:159]
  s_waitcnt lgkmcnt(0)
  v_mfma_f32_32x32x16_bf16 v[128:143], v[28:31], v[248:251], v[128:143]
  v_mfma_f32_32x32x16_bf16 v[144:159], v[28:31], v[252:255], v[144:159]
  s_add_u32 s32, s32, 40960
  s_cmp_eq_u32 s32, 122880
  s_cselect_b32 s32, 0, s32
  s_add_u32 s29, s29, 1
W1T_74:
  s_waitcnt vmcnt(14)
  s_barrier
  s_sub_u32 s49, s29, 2
  s_max_i32 s49, s49, 0
  s_cmp_lg_u32 s13, 0
  s_cbranch_scc1 PB_78
  v_mov_b32 v8, s49
  v_mov_b32 v9, s26
  buffer_store_dword v8, v9, s[4:7], 0 offen sc1
PB_78:
  s_add_u32 s47, s24, s29
  s_sub_u32 s47, s47, 1
  s_lshl_b32 s25, s47, 18
  s_add_u32 s25, s25, s31
  v_add_u32 v12, s32, v1
  ds_read_b128 v[16:19], v12 offset:0
  ds_read_b128 v[20:23], v12 offset:1024
  ds_read_b128 v[24:27], v12 offset:2048
  s_waitcnt lgkmcnt(2)
  v_mfma_f32_32x32x16_bf16 v[96:111], v[16:19], a[0:3], 0
  ds_read_b128 v[28:31], v12 offset:3072
  v_mfma_f32_32x32x16_bf16 v[112:127], v[16:19], a[4:7], 0
  s_add_u32 s52, s33, s30
  s_add_u32 s53, s27, 0
  s_add_u32 m0, s52, 0
  s_nop 0
  buffer_load_dwordx4 v1, s[4:7], s53 offen offset:0 sc1 lds
  s_waitcnt lgkmcnt(2)
  v_mfma_f32_32x32x16_bf16 v[96:111], v[20:23], a[8:11], v[96:111]
  ds_read_b128 v[16:19], v12 offset:4096
  v_mfma_f32_32x32x16_bf16 v[112:127], v[20:23], a[12:15], v[112:127]
  s_waitcnt lgkmcnt(2)
  v_mfma_f32_32x32x16_bf16 v[96:111], v[24:27], a[16:19], v[96:111]
  ds_read_b128 v[20:23], v12 offset:5120
  v_mfma_f32_32x32x16_bf16 v[112:127], v[24:27], a[20:23], v[112:127]
  buffer_load_dwordx4 v1, s[4:7], s53 offen offset:1024 sc1 lds
  s_waitcnt lgkmcnt(2)
  v_mfma_f32_32x32x16_bf16 v[96:111], v[28:31], a[24:27], v[96:111]
  ds_read_b128 v[24:27], v12 offset:6144
  v_mfma_f32_32x32x16_bf16 v[112:127], v[28:31], a[28:31], v[112:127]
  s_waitcnt lgkmcnt(2)
  v_mfma_f32_32x32x16_bf16 v[96:111], v[16:19], a[32:35], v[96:111]
  ds_read_b128 v[28:31], v12 offset:7168
  v_mfma_f32_32x32x16_bf16 v[112:127], v[16:19], a[36:39], v[112:127]
  buffer_load_dwordx4 v1, s[4:7], s53 offen offset:2048 sc1 lds
  s_waitcnt lgkmcnt(2)
  v_mfma_f32_32x32x16_bf16 v[96:111], v[20:23], a[40:43], v[96:111]
  ds_read_b128 v[16:19], v12 offset:8192
  v_mfma_f32_32x32x16_bf16 v[112:127], v[20:23], a[44:47], v[112:127]
  s_waitcnt lgkmcnt(2)
  v_mfma_f32_32x32x16_bf16 v[96:111], v[24:27], a[48:51], v[96:111]
  ds_read_b128 v[20:23], v12 offset:9216
  v_mfma_f32_32x32x16_bf16 v[112:127], v[24:27], a[52:55], v[112:127]
  buffer_load_dwordx4 v1, s[4:7], s53 offen offset:3072 sc1 lds
  s_waitcnt lgkmcnt(2)
  v_mfma_f32_32x32x16_bf16 v[96:111], v[28:31], a[56:59], v[96:111]
  ds_read_b128 v[24:27], v12 offset:10240
  v_mfma_f32_32x32x16_bf16 v[112:127], v[28:31], a[60:63], v[112:127]
  s_waitcnt lgkmcnt(2)
  v_mfma_f32_32x32x16_bf16 v[96:111], v[16:19], a[64:67], v[96:111]
  ds_read_b128 v[28:31], v12 offset:11264
  v_mfma_f32_32x32x16_bf16 v[112:127], v[16:19], a[68:71], v[112:127]
  s_add_u32 s53, s27, 4096
  s_add_u32 m0, s52, 4096
  s_nop 0
  buffer_load_dwordx4 v1, s[4:7], s53 offen offset:0 sc1 lds
  s_waitcnt lgkmcnt(2)
  v_mfma_f32_32x32x16_bf16 v[96:111], v[20:23], a[72:75], v[96:111]
  ds_read_b128 v[16:19], v12 offset:12288
  v_mfma_f32_32x32x16_bf16 v[112:127], v[20:23], a[76:79], v[112:127]
  s_waitcnt lgkmcnt(2)
  v_mfma_f32_32x32x16_bf16 v[96:111], v[24:27], a[80:83], v[96:111]
  ds_read_b128 v[20:23], v12 offset:13312
  v_mfma_f32_32x32x16_bf16 v[112:127], v[24:27], a[84:87], v[112:127]
  buffer_load_dwordx4 v1, s[4:7], s53 offen offset:1024 sc1 lds
  s_waitcnt lgkmcnt(2)
  v_mfma_f32_32x32x16_bf16 v[96:111], v[28:31], a[88:91], v[96:111]
  ds_read_b128 v[24:27], v12 offset:14336
  v_mfma_f32_32x32x16_bf16 v[112:127], v[28:31], a[92:95], v[112:127]
  s_waitcnt lgkmcnt(2)
  v_mfma_f32_32x32x16_bf16 v[96:111], v[16:19], a[96:99], v[96:111]
  ds_read_b128 v[28:31], v12 offset:15360
  v_mfma_f32_32x32x16_bf16 v[112:127], v[16:19], a[100:103], v[112:127]
  buffer_load_dwordx4 v1, s[4:7], s53 offen offset:2048 sc1 lds
  s_waitcnt lgkmcnt(2)
  v_mfma_f32_32x32x16_bf16 v[96:111], v[20:23], a[104:107], v[96:111]
  ds_read_b128 v[16:19], v12 offset:16384
  v_mfma_f32_32x32x16_bf16 v[112:127], v[20:23], a[108:111], v[112:127]
  s_waitcnt lgkmcnt(2)
  v_mfma_f32_32x32x16_bf16 v[96:111], v[24:27], a[112:115], v[96:111]
  ds_read_b128 v[20:23], v12 offset:17408
  v_mfma_f32_32x32x16_bf16 v[112:127], v[24:27], a[116:119], v[112:127]
  buffer_load_dwordx4 v1, s[4:7], s53 offen offset:3072 sc1 lds
  s_waitcnt lgkmcnt(2)
  v_mfma_f32_32x32x16_bf16 v[96:111], v[28:31], a[120:123], v[96:111]
  ds_read_b128 v[24:27], v12 offset:18432
  v_mfma_f32_32x32x16_bf16 v[112:127], v[28:31], a[124:127], v[112:127]
  s_waitcnt lgkmcnt(2)
  v_mfma_f32_32x32x16_bf16 v[96:111], v[16:19], a[128:131], v[96:111]
  ds_read_b128 v[28:31], v12 offset:19456
  v_mfma_f32_32x32x16_bf16 v[112:127], v[16:19], a[132:135], v[112:127]
  s_add_u32 s53, s27, 8192
  s_add_u32 m0, s52, 8192
  s_nop 0
  buffer_load_dwordx4 v1, s[4:7], s53 offen offset:0 sc1 lds
  s_waitcnt lgkmcnt(2)
  v_mfma_f32_32x32x16_bf16 v[96:111], v[20:23], a[136:139], v[96:111]
  ds_read_b128 v[16:19], v12 offset:20480
  v_mfma_f32_32x32x16_bf16 v[112:127], v[20:23], a[140:143], v[112:127]
  s_waitcnt lgkmcnt(2)
  v_mfma_f32_32x32x16_bf16 v[96:111], v[24:27], a[144:147], v[96:111]
  ds_read_b128 v[20:23], v12 offset:21504
  v_mfma_f32_32x32x16_bf16 v[112:127], v[24:27], a[148:151], v[112:127]
  buffer_load_dwordx4 v1, s[4:7], s53 offen offset:1024 sc1 lds
  s_add_u32 s27, s27, 40960
  s_min_u32 s27, s27, s34
  s_add_u32 s33, s33, 40960
  s_cmp_eq_u32 s33, 122880
  s_cselect_b32 s33, 0, s33
  s_waitcnt lgkmcnt(2)
  v_mfma_f32_32x32x16_bf16 v[96:111], v[28:31], a[152:155], v[96:111]
  ds_read_b128 v[24:27], v12 offset:22528
  v_mfma_f32_32x32x16_bf16 v[112:127], v[28:31], a[156:159], v[112:127]
  s_waitcnt lgkmcnt(2)
  v_mfma_f32_32x32x16_bf16 v[96:111], v[16:19], a[160:163], v[96:111]
  ds_read_b128 v[28:31], v12 offset:23552
  v_mfma_f32_32x32x16_bf16 v[112:127], v[16:19], a[164:167], v[112:127]
  s_waitcnt lgkmcnt(2)
  v_mfma_f32_32x32x16_bf16 v[96:111], v[20:23], a[168:171], v[96:111]
  ds_read_b128 v[16:19], v12 offset:24576
  v_mfma_f32_32x32x16_bf16 v[112:127], v[20:23], a[172:175], v[112:127]
  s_waitcnt lgkmcnt(2)
  v_mfma_f32_32x32x16_bf16 v[96:111], v[24:27], a[176:179], v[96:111]
  ds_read_b128 v[20:23], v12 offset:25600
  v_mfma_f32_32x32x16_bf16 v[112:127], v[24:27], a[180:183], v[112:127]
  s_waitcnt lgkmcnt(2)
  v_mfma_f32_32x32x16_bf16 v[96:111], v[28:31], a[184:187], v[96:111]
  ds_read_b128 v[24:27], v12 offset:26624
  v_mfma_f32_32x32x16_bf16 v[112:127], v[28:31], a[188:191], v[112:127]
  s_waitcnt lgkmcnt(2)
  v_mfma_f32_32x32x16_bf16 v[96:111], v[16:19], a[192:195], v[96:111]
  ds_read_b128 v[28:31], v12 offset:27648
  v_mfma_f32_32x32x16_bf16 v[112:127], v[16:19], a[196:199], v[112:127]
  s_waitcnt lgkmcnt(2)
  v_mfma_f32_32x32x16_bf16 v[96:111], v[20:23], a[200:203], v[96:111]
  ds_read_b128 v[16:19], v12 offset:28672
  v_mfma_f32_32x32x16_bf16 v[112:127], v[20:23], a[204:207], v[112:127]
  s_waitcnt lgkmcnt(2)
  v_mfma_f32_32x32x16_bf16 v[96:111], v[24:27], a[208:211], v[96:111]
  ds_read_b128 v[20:23], v12 offset:29696
  v_mfma_f32_32x32x16_bf16 v[112:127], v[24:27], a[212:215], v[112:127]
  s_waitcnt lgkmcnt(2)
  v_mfma_f32_32x32x16_bf16 v[96:111], v[28:31], a[216:219], v[96:111]
  ds_read_b128 v[24:27], v12 offset:30720
  v_mfma_f32_32x32x16_bf16 v[112:127], v[28:31], a[220:223], v[112:127]
  s_waitcnt lgkmcnt(2)
  v_mfma_f32_32x32x16_bf16 v[96:111], v[16:19], a[224:227], v[96:111]
  ds_read_b128 v[28:31], v12 offset:31744
  v_cvt_pk_bf16_f32 v40, v128, v129
  v_mfma_f32_32x32x16_bf16 v[112:127], v[16:19], a[228:231], v[112:127]
  v_cvt_pk_bf16_f32 v41, v130, v131
  s_waitcnt lgkmcnt(2)
  v_mfma_f32_32x32x16_bf16 v[96:111], v[20:23], a[232:235], v[96:111]
  ds_read_b128 v[16:19], v12 offset:32768
  v_cvt_pk_bf16_f32 v42, v136, v137
  v_mfma_f32_32x32x16_bf16 v[112:127], v[20:23], a[236:239], v[112:127]
  v_cvt_pk_bf16_f32 v43, v138, v139
  s_waitcnt lgkmcnt(2)
  v_mfma_f32_32x32x16_bf16 v[96:111], v[24:27], a[240:243], v[96:111]
  ds_read_b128 v[20:23], v12 offset:33792
  buffer_store_dwordx4 v[40:43], v6, s[4:7], s25 offen offset:0 sc1
  v_mfma_f32_32x32x16_bf16 v[112:127], v[24:27], a[244:247], v[112:127]
  v_cvt_pk_bf16_f32 v44, v132, v133
  s_waitcnt lgkmcnt(2)
  v_mfma_f32_32x32x16_bf16 v[96:111], v[28:31], a[248:251], v[96:111]
  ds_read_b128 v[24:27], v12 offset:34816
  v_cvt_pk_bf16_f32 v45, v134, v135
  v_mfma_f32_32x32x16_bf16 v[112:127], v[28:31], a[252:255], v[112:127]
  v_cvt_pk_bf16_f32 v46, v140, v141
  s_waitcnt lgkmcnt(2)
  v_mfma_f32_32x32x16_bf16 v[96:111], v[16:19], v[192:195], v[96:111]
  ds_read_b128 v[28:31], v12 offset:35840
  v_cvt_pk_bf16_f32 v47, v142, v143
  v_mfma_f32_32x32x16_bf16 v[112:127], v[16:19], v[196:199], v[112:127]
  buffer_store_dwordx4 v[44:47], v6, s[4:7], s25 offen offset:512 sc1
  s_waitcnt lgkmcnt(2)
  v_mfma_f32_32x32x16_bf16 v[96:111], v[20:23], v[200:203], v[96:111]
  ds_read_b128 v[16:19], v12 offset:36864
  v_cvt_pk_bf16_f32 v40, v144, v145
  v_mfma_f32_32x32x16_bf16 v[112:127], v[20:23], v[204:207], v[112:127]
  v_cvt_pk_bf16_f32 v41, v146, v147
  s_waitcnt lgkmcnt(2)
  v_mfma_f32_32x32x16_bf16 v[96:111], v[24:27], v[208:211], v[96:111]
  ds_read_b128 v[20:23], v12 offset:37888
  v_cvt_pk_bf16_f32 v42, v152, v153
  v_mfma_f32_32x32x16_bf16 v[112:127], v[24:27], v[212:215], v[112:127]
  v_cvt_pk_bf16_f32 v43, v154, v155
  s_waitcnt lgkmcnt(2)
  v_mfma_f32_32x32x16_bf16 v[96:111], v[28:31], v[216:219], v[96:111]
  ds_read_b128 v[24:27], v12 offset:38912
  buffer_store_dwordx4 v[40:43], v6, s[4:7], s25 offen offset:2048 sc1
  v_mfma_f32_32x32x16_bf16 v[112:127], v[28:31], v[220:223], v[112:127]
  v_cvt_pk_bf16_f32 v44, v148, v149
  s_waitcnt lgkmcnt(2)
  v_mfma_f32_32x32x16_bf16 v[96:111], v[16:19], v[224:227], v[96:111]
  ds_read_b128 v[28:31], v12 offset:39936
  v_cvt_pk_bf16_f32 v45, v150, v151
  v_mfma_f32_32x32x16_bf16 v[112:127], v[16:19], v[228:231], v[112:127]
  v_cvt_pk_bf16_f32 v46, v156, v157
  s_waitcnt lgkmcnt(2)
  v_mfma_f32_32x32x16_bf16 v[96:111], v[20:23], v[232:235], v[96:111]
  v_cvt_pk_bf16_f32 v47, v158, v159
  v_mfma_f32_32x32x16_bf16 v[112:127], v[20:23], v[236:239], v[112:127]
  buffer_store_dwordx4 v[44:47], v6, s[4:7], s25 offen offset:2560 sc1
  s_waitcnt lgkmcnt(1)
  v_mfma_f32_32x32x16_bf16 v[96:111], v[24:27], v[240:243], v[96:111]
  v_mfma_f32_32x32x16_bf16 v[112:127], v[24:27], v[244:247], v[112:127]
  s_waitcnt lgkmcnt(0)
  v_mfma_f32_32x32x16_bf16 v[96:111], v[28:31], v[248:251], v[96:111]
  v_mfma_f32_32x32x16_bf16 v[112:127], v[28:31], v[252:255], v[112:127]
  s_add_u32 s32, s32, 40960
  s_cmp_eq_u32 s32, 122880
  s_cselect_b32 s32, 0, s32
  s_add_u32 s29, s29, 1
  s_waitcnt vmcnt(14)
  s_barrier
  s_sub_u32 s49, s29, 2
  s_max_i32 s49, s49, 0
  s_cmp_lg_u32 s13, 0
  s_cbranch_scc1 PB_79
  v_mov_b32 v8, s49
  v_mov_b32 v9, s26
  buffer_store_dword v8, v9, s[4:7], 0 offen sc1
PB_79:
  s_add_u32 s47, s24, s29
  s_sub_u32 s47, s47, 1
  s_lshl_b32 s25, s47, 18
  s_add_u32 s25, s25, s31
  v_add_u32 v12, s32, v1
  ds_read_b128 v[16:19], v12 offset:0
  ds_read_b128 v[20:23], v12 offset:1024
  ds_read_b128 v[24:27], v12 offset:2048
  s_waitcnt lgkmcnt(2)
  v_mfma_f32_32x32x16_bf16 v[128:143], v[16:19], a[0:3], 0
  ds_read_b128 v[28:31], v12 offset:3072
  v_mfma_f32_32x32x16_bf16 v[144:159], v[16:19], a[4:7], 0
  s_add_u32 s52, s33, s30
  s_add_u32 s53, s27, 0
  s_add_u32 m0, s52, 0
  s_nop 0
  buffer_load_dwordx4 v1, s[4:7], s53 offen offset:0 sc1 lds
  s_waitcnt lgkmcnt(2)
  v_mfma_f32_32x32x16_bf16 v[128:143], v[20:23], a[8:11], v[128:143]
  ds_read_b128 v[16:19], v12 offset:4096
  v_mfma_f32_32x32x16_bf16 v[144:159], v[20:23], a[12:15], v[144:159]
  s_waitcnt lgkmcnt(2)
  v_mfma_f32_32x32x16_bf16 v[128:143], v[24:27], a[16:19], v[128:143]
  ds_read_b128 v[20:23], v12 offset:5120
  v_mfma_f32_32x32x16_bf16 v[144:159], v[24:27], a[20:23], v[144:159]
  buffer_load_dwordx4 v1, s[4:7], s53 offen offset:1024 sc1 lds
  s_waitcnt lgkmcnt(2)
  v_mfma_f32_32x32x16_bf16 v[128:143], v[28:31], a[24:27], v[128:143]
  ds_read_b128 v[24:27], v12 offset:6144
  v_mfma_f32_32x32x16_bf16 v[144:159], v[28:31], a[28:31], v[144:159]
  s_waitcnt lgkmcnt(2)
  v_mfma_f32_32x32x16_bf16 v[128:143], v[16:19], a[32:35], v[128:143]
  ds_read_b128 v[28:31], v12 offset:7168
  v_mfma_f32_32x32x16_bf16 v[144:159], v[16:19], a[36:39], v[144:159]
  buffer_load_dwordx4 v1, s[4:7], s53 offen offset:2048 sc1 lds
  s_waitcnt lgkmcnt(2)
  v_mfma_f32_32x32x16_bf16 v[128:143], v[20:23], a[40:43], v[128:143]
  ds_read_b128 v[16:19], v12 offset:8192
  v_mfma_f32_32x32x16_bf16 v[144:159], v[20:23], a[44:47], v[144:159]
  s_waitcnt lgkmcnt(2)
  v_mfma_f32_32x32x16_bf16 v[128:143], v[24:27], a[48:51], v[128:143]
  ds_read_b128 v[20:23], v12 offset:9216
  v_mfma_f32_32x32x16_bf16 v[144:159], v[24:27], a[52:55], v[144:159]
  buffer_load_dwordx4 v1, s[4:7], s53 offen offset:3072 sc1 lds
  s_waitcnt lgkmcnt(2)
  v_mfma_f32_32x32x16_bf16 v[128:143], v[28:31], a[56:59], v[128:143]
  ds_read_b128 v[24:27], v12 offset:10240
  v_mfma_f32_32x32x16_bf16 v[144:159], v[28:31], a[60:63], v[144:159]
  s_waitcnt lgkmcnt(2)
  v_mfma_f32_32x32x16_bf16 v[128:143], v[16:19], a[64:67], v[128:143]
  ds_read_b128 v[28:31], v12 offset:11264
  v_mfma_f32_32x32x16_bf16 v[144:159], v[16:19], a[68:71], v[144:159]
  s_add_u32 s53, s27, 4096
  s_add_u32 m0, s52, 4096
  s_nop 0
  buffer_load_dwordx4 v1, s[4:7], s53 offen offset:0 sc1 lds
  s_waitcnt lgkmcnt(2)
  v_mfma_f32_32x32x16_bf16 v[128:143], v[20:23], a[72:75], v[128:143]
  ds_read_b128 v[16:19], v12 offset:12288
  v_mfma_f32_32x32x16_bf16 v[144:159], v[20:23], a[76:79], v[144:159]
  s_waitcnt lgkmcnt(2)
  v_mfma_f32_32x32x16_bf16 v[128:143], v[24:27], a[80:83], v[128:143]
  ds_read_b128 v[20:23], v12 offset:13312
  v_mfma_f32_32x32x16_bf16 v[144:159], v[24:27], a[84:87], v[144:159]
  buffer_load_dwordx4 v1, s[4:7], s53 offen offset:1024 sc1 lds
  s_waitcnt lgkmcnt(2)
  v_mfma_f32_32x32x16_bf16 v[128:143], v[28:31], a[88:91], v[128:143]
  ds_read_b128 v[24:27], v12 offset:14336
  v_mfma_f32_32x32x16_bf16 v[144:159], v[28:31], a[92:95], v[144:159]
  s_waitcnt lgkmcnt(2)
  v_mfma_f32_32x32x16_bf16 v[128:143], v[16:19], a[96:99], v[128:143]
  ds_read_b128 v[28:31], v12 offset:15360
  v_mfma_f32_32x32x16_bf16 v[144:159], v[16:19], a[100:103], v[144:159]
  buffer_load_dwordx4 v1, s[4:7], s53 offen offset:2048 sc1 lds
  s_waitcnt lgkmcnt(2)
  v_mfma_f32_32x32x16_bf16 v[128:143], v[20:23], a[104:107], v[128:143]
  ds_read_b128 v[16:19], v12 offset:16384
  v_mfma_f32_32x32x16_bf16 v[144:159], v[20:23], a[108:111], v[144:159]
  s_waitcnt lgkmcnt(2)
  v_mfma_f32_32x32x16_bf16 v[128:143], v[24:27], a[112:115], v[128:143]
  ds_read_b128 v[20:23], v12 offset:17408
  v_mfma_f32_32x32x16_bf16 v[144:159], v[24:27], a[116:119], v[144:159]
  buffer_load_dwordx4 v1, s[4:7], s53 offen offset:3072 sc1 lds
  s_waitcnt lgkmcnt(2)
  v_mfma_f32_32x32x16_bf16 v[128:143], v[28:31], a[120:123], v[128:143]
  ds_read_b128 v[24:27], v12 offset:18432
  v_mfma_f32_32x32x16_bf16 v[144:159], v[28:31], a[124:127], v[144:159]
  s_waitcnt lgkmcnt(2)
  v_mfma_f32_32x32x16_bf16 v[128:143], v[16:19], a[128:131], v[128:143]
  ds_read_b128 v[28:31], v12 offset:19456
  v_mfma_f32_32x32x16_bf16 v[144:159], v[16:19], a[132:135], v[144:159]
  s_add_u32 s53, s27, 8192
  s_add_u32 m0, s52, 8192
  s_nop 0
  buffer_load_dwordx4 v1, s[4:7], s53 offen offset:0 sc1 lds
  s_waitcnt lgkmcnt(2)
  v_mfma_f32_32x32x16_bf16 v[128:143], v[20:23], a[136:139], v[128:143]
  ds_read_b128 v[16:19], v12 offset:20480
  v_mfma_f32_32x32x16_bf16 v[144:159], v[20:23], a[140:143], v[144:159]
  s_waitcnt lgkmcnt(2)
  v_mfma_f32_32x32x16_bf16 v[128:143], v[24:27], a[144:147], v[128:143]
  ds_read_b128 v[20:23], v12 offset:21504
  v_mfma_f32_32x32x16_bf16 v[144:159], v[24:27], a[148:151], v[144:159]
  buffer_load_dwordx4 v1, s[4:7], s53 offen offset:1024 sc1 lds
  s_add_u32 s27, s27, 40960
  s_min_u32 s27, s27, s34
  s_add_u32 s33, s33, 40960
  s_cmp_eq_u32 s33, 122880
  s_cselect_b32 s33, 0, s33
  s_waitcnt lgkmcnt(2)
  v_mfma_f32_32x32x16_bf16 v[128:143], v[28:31], a[152:155], v[128:143]
  ds_read_b128 v[24:27], v12 offset:22528
  v_mfma_f32_32x32x16_bf16 v[144:159], v[28:31], a[156:159], v[144:159]
  s_waitcnt lgkmcnt(2)
  v_mfma_f32_32x32x16_bf16 v[128:143], v[16:19], a[160:163], v[128:143]
  ds_read_b128 v[28:31], v12 offset:23552
  v_mfma_f32_32x32x16_bf16 v[144:159], v[16:19], a[164:167], v[144:159]
  s_waitcnt lgkmcnt(2)
  v_mfma_f32_32x32x16_bf16 v[128:143], v[20:23], a[168:171], v[128:143]
  ds_read_b128 v[16:19], v12 offset:24576
  v_mfma_f32_32x32x16_bf16 v[144:159], v[20:23], a[172:175], v[144:159]
  s_waitcnt lgkmcnt(2)
  v_mfma_f32_32x32x16_bf16 v[128:143], v[24:27], a[176:179], v[128:143]
  ds_read_b128 v[20:23], v12 offset:25600
  v_mfma_f32_32x32x16_bf16 v[144:159], v[24:27], a[180:183], v[144:159]
  s_waitcnt lgkmcnt(2)
  v_mfma_f32_32x32x16_bf16 v[128:143], v[28:31], a[184:187], v[128:143]
  ds_read_b128 v[24:27], v12 offset:26624
  v_mfma_f32_32x32x16_bf16 v[144:159], v[28:31], a[188:191], v[144:159]
  s_waitcnt lgkmcnt(2)
  v_mfma_f32_32x32x16_bf16 v[128:143], v[16:19], a[192:195], v[128:143]
  ds_read_b128 v[28:31], v12 offset:27648
  v_mfma_f32_32x32x16_bf16 v[144:159], v[16:19], a[196:199], v[144:159]
  s_waitcnt lgkmcnt(2)
  v_mfma_f32_32x32x16_bf16 v[128:143], v[20:23], a[200:203], v[128:143]
  ds_read_b128 v[16:19], v12 offset:28672
  v_mfma_f32_32x32x16_bf16 v[144:159], v[20:23], a[204:207], v[144:159]
  s_waitcnt lgkmcnt(2)
  v_mfma_f32_32x32x16_bf16 v[128:143], v[24:27], a[208:211], v[128:143]
  ds_read_b128 v[20:23], v12 offset:29696
  v_mfma_f32_32x32x16_bf16 v[144:159], v[24:27], a[212:215], v[144:159]
  s_waitcnt lgkmcnt(2)
  v_mfma_f32_32x32x16_bf16 v[128:143], v[28:31], a[216:219], v[128:143]
  ds_read_b128 v[24:27], v12 offset:30720
  v_mfma_f32_32x32x16_bf16 v[144:159], v[28:31], a[220:223], v[144:159]
  s_waitcnt lgkmcnt(2)
  v_mfma_f32_32x32x16_bf16 v[128:143], v[16:19], a[224:227], v[128:143]
  ds_read_b128 v[28:31], v12 offset:31744
  v_cvt_pk_bf16_f32 v40, v96, v97
  v_mfma_f32_32x32x16_bf16 v[144:159], v[16:19], a[228:231], v[144:159]
  v_cvt_pk_bf16_f32 v41, v98, v99
  s_waitcnt lgkmcnt(2)
  v_mfma_f32_32x32x16_bf16 v[128:143], v[20:23], a[232:235], v[128:143]
  ds_read_b128 v[16:19], v12 offset:32768
  v_cvt_pk_bf16_f32 v42, v104, v105
  v_mfma_f32_32x32x16_bf16 v[144:159], v[20:23], a[236:239], v[144:159]
  v_cvt_pk_bf16_f32 v43, v106, v107
  s_waitcnt lgkmcnt(2)
  v_mfma_f32_32x32x16_bf16 v[128:143], v[24:27], a[240:243], v[128:143]
  ds_read_b128 v[20:23], v12 offset:33792
  buffer_store_dwordx4 v[40:43], v6, s[4:7], s25 offen offset:0 sc1
  v_mfma_f32_32x32x16_bf16 v[144:159], v[24:27], a[244:247], v[144:159]
  v_cvt_pk_bf16_f32 v44, v100, v101
  s_waitcnt lgkmcnt(2)
  v_mfma_f32_32x32x16_bf16 v[128:143], v[28:31], a[248:251], v[128:143]
  ds_read_b128 v[24:27], v12 offset:34816
  v_cvt_pk_bf16_f32 v45, v102, v103
  v_mfma_f32_32x32x16_bf16 v[144:159], v[28:31], a[252:255], v[144:159]
  v_cvt_pk_bf16_f32 v46, v108, v109
  s_waitcnt lgkmcnt(2)
  v_mfma_f32_32x32x16_bf16 v[128:143], v[16:19], v[192:195], v[128:143]
  ds_read_b128 v[28:31], v12 offset:35840
  v_cvt_pk_bf16_f32 v47, v110, v111
  v_mfma_f32_32x32x16_bf16 v[144:159], v[16:19], v[196:199], v[144:159]
  buffer_store_dwordx4 v[44:47], v6, s[4:7], s25 offen offset:512 sc1
  s_waitcnt lgkmcnt(2)
  v_mfma_f32_32x32x16_bf16 v[128:143], v[20:23], v[200:203], v[128:143]
  ds_read_b128 v[16:19], v12 offset:36864
  v_cvt_pk_bf16_f32 v40, v112, v113
  v_mfma_f32_32x32x16_bf16 v[144:159], v[20:23], v[204:207], v[144:159]
  v_cvt_pk_bf16_f32 v41, v114, v115
  s_waitcnt lgkmcnt(2)
  v_mfma_f32_32x32x16_bf16 v[128:143], v[24:27], v[208:211], v[128:143]
  ds_read_b128 v[20:23], v12 offset:37888
  v_cvt_pk_bf16_f32 v42, v120, v121
  v_mfma_f32_32x32x16_bf16 v[144:159], v[24:27], v[212:215], v[144:159]
  v_cvt_pk_bf16_f32 v43, v122, v123
  s_waitcnt lgkmcnt(2)
  v_mfma_f32_32x32x16_bf16 v[128:143], v[28:31], v[216:219], v[128:143]
  ds_read_b128 v[24:27], v12 offset:38912
  buffer_store_dwordx4 v[40:43], v6, s[4:7], s25 offen offset:2048 sc1
  v_mfma_f32_32x32x16_bf16 v[144:159], v[28:31], v[220:223], v[144:159]
  v_cvt_pk_bf16_f32 v44, v116, v117
  s_waitcnt lgkmcnt(2)
  v_mfma_f32_32x32x16_bf16 v[128:143], v[16:19], v[224:227], v[128:143]
  ds_read_b128 v[28:31], v12 offset:39936
  v_cvt_pk_bf16_f32 v45, v118, v119
  v_mfma_f32_32x32x16_bf16 v[144:159], v[16:19], v[228:231], v[144:159]
  v_cvt_pk_bf16_f32 v46, v124, v125
  s_waitcnt lgkmcnt(2)
  v_mfma_f32_32x32x16_bf16 v[128:143], v[20:23], v[232:235], v[128:143]
  v_cvt_pk_bf16_f32 v47, v126, v127
  v_mfma_f32_32x32x16_bf16 v[144:159], v[20:23], v[236:239], v[144:159]
  buffer_store_dwordx4 v[44:47], v6, s[4:7], s25 offen offset:2560 sc1
  s_waitcnt lgkmcnt(1)
  v_mfma_f32_32x32x16_bf16 v[128:143], v[24:27], v[240:243], v[128:143]
  v_mfma_f32_32x32x16_bf16 v[144:159], v[24:27], v[244:247], v[144:159]
  s_waitcnt lgkmcnt(0)
  v_mfma_f32_32x32x16_bf16 v[128:143], v[28:31], v[248:251], v[128:143]
  v_mfma_f32_32x32x16_bf16 v[144:159], v[28:31], v[252:255], v[144:159]
  s_add_u32 s32, s32, 40960
  s_cmp_eq_u32 s32, 122880
  s_cselect_b32 s32, 0, s32
  s_add_u32 s29, s29, 1
  s_cmp_lt_u32 s29, 16
  s_cbranch_scc1 W1T_74
  s_add_u32 s47, s24, s29
  s_sub_u32 s47, s47, 1
  s_lshl_b32 s25, s47, 18
  s_add_u32 s25, s25, s31
  s_nop 0
  v_cvt_pk_bf16_f32 v40, v128, v129
  v_cvt_pk_bf16_f32 v41, v130, v131
  v_cvt_pk_bf16_f32 v42, v136, v137
  v_cvt_pk_bf16_f32 v43, v138, v139
  buffer_store_dwordx4 v[40:43], v6, s[4:7], s25 offen offset:0 sc1
  v_cvt_pk_bf16_f32 v44, v132, v133
  v_cvt_pk_bf16_f32 v45, v134, v135
  v_cvt_pk_bf16_f32 v46, v140, v141
  v_cvt_pk_bf16_f32 v47, v142, v143
  buffer_store_dwordx4 v[44:47], v6, s[4:7], s25 offen offset:512 sc1
  v_cvt_pk_bf16_f32 v40, v144, v145
  v_cvt_pk_bf16_f32 v41, v146, v147
  v_cvt_pk_bf16_f32 v42, v152, v153
  v_cvt_pk_bf16_f32 v43, v154, v155
  buffer_store_dwordx4 v[40:43], v6, s[4:7], s25 offen offset:2048 sc1
  v_cvt_pk_bf16_f32 v44, v148, v149
  v_cvt_pk_bf16_f32 v45, v150, v151
  v_cvt_pk_bf16_f32 v46, v156, v157
  v_cvt_pk_bf16_f32 v47, v158, v159
  buffer_store_dwordx4 v[44:47], v6, s[4:7], s25 offen offset:2560 sc1
  s_waitcnt vmcnt(0)
  s_barrier
  s_cmp_lg_u32 s13, 0
  s_cbranch_scc1 PB_80
  v_mov_b32 v8, 16
  v_mov_b32 v9, s26
  buffer_store_dword v8, v9, s[4:7], 0 offen sc1
PB_80:
W1E_60:
  s_branch NW2_44
NW1_43:
  s_cmp_eq_u32 s3, 0
  s_cbranch_scc1 L_CF7
L_CR7:
NW2_44:
  s_cmp_ge_u32 s84, 4
  s_cbranch_scc1 RX_83
  s_cmp_ge_u32 s85, 28
  s_cbranch_scc1 L_DONE
  s_cmp_ge_u32 s85, 20
  s_cbranch_scc1 RA_81
  s_mul_i32 s20, s84, 20
  s_add_u32 s20, s20, s85
  s_branch RB_82
RX_83:
  s_sub_u32 s47, s84, 4
  s_lshl_b32 s47, s47, 5
  s_add_u32 s47, s47, s85
  s_cmp_ge_u32 s47, 80
  s_cbranch_scc1 L_DONE
  s_add_u32 s20, s47, 80
RB_82:
  s_barrier
  s_mul_i32 s47, s20, 13108
  s_lshr_b32 s22, s47, 18
  s_mul_i32 s47, s22, 20
  s_sub_u32 s21, s20, s47
  v_and_b32 v2, 63, v0
  v_lshlrev_b32 v1, 4, v2
  v_lshrrev_b32 v3, 2, v2
  v_and_b32 v4, 3, v2
  v_bfe_u32 v5, v3, 2, 1
  v_lshlrev_b32 v5, 4, v5
  v_lshrrev_b32 v6, 3, v3
  v_lshl_add_u32 v5, v6, 2, v5
  v_and_b32 v6, 3, v3
  v_add_u32 v5, v5, v6
  s_movk_i32 s47, 1280
  v_mul_lo_u32 v5, v5, s47
  v_lshl_add_u32 v5, v4, 4, v5
  v_mul_lo_u32 v6, v3, s47
  v_lshl_add_u32 v6, v4, 4, v6
  v_lshrrev_b32 v7, 4, v2
  v_lshlrev_b32 v7, 3, v7
  v_bfe_u32 v8, v2, 2, 2
  v_add_u32 v7, v7, v8
  v_lshlrev_b32 v7, 6, v7
  v_and_b32 v8, 3, v2
  v_lshl_add_u32 v7, v8, 4, v7
  s_lshl_b32 s24, s13, 15
  v_add_u32 v7, s24, v7
  s_mov_b32 s8, s64
  s_and_b32 s9, s65, 0xffff
  s_mov_b32 s10, 5242880
  s_mov_b32 s11, 0x20000
  s_mov_b32 s16, s70
  s_and_b32 s17, s71, 0xffff
  s_mov_b32 s18, 2211840
  s_mov_b32 s19, 0x20000
  s_lshl_b32 s47, s21, 6
  s_mul_i32 s25, s13, 1310720
  s_add_u32 s25, s25, s47
  s_mul_i32 s26, s13, 573440
  s_add_u32 s26, s26, s47
  s_add_u32 s47, s25, 0
  s_add_u32 m0, s24, 0
  s_nop 0
  buffer_load_dwordx4 v5, s[8:11], s47 offen lds
  s_add_u32 s47, s25, 10240
  s_add_u32 m0, s24, 1024
  s_nop 0
  buffer_load_dwordx4 v5, s[8:11], s47 offen lds
  s_add_u32 s47, s25, 40960
  s_add_u32 m0, s24, 2048
  s_nop 0
  buffer_load_dwordx4 v5, s[8:11], s47 offen lds
  s_add_u32 s47, s25, 51200
  s_add_u32 m0, s24, 3072
  s_nop 0
  buffer_load_dwordx4 v5, s[8:11], s47 offen lds
  s_add_u32 s47, s25, 81920
  s_add_u32 m0, s24, 4096
  s_nop 0
  buffer_load_dwordx4 v5, s[8:11], s47 offen lds
  s_add_u32 s47, s25, 92160
  s_add_u32 m0, s24, 5120
  s_nop 0
  buffer_load_dwordx4 v5, s[8:11], s47 offen lds
  s_add_u32 s47, s25, 122880
  s_add_u32 m0, s24, 6144
  s_nop 0
  buffer_load_dwordx4 v5, s[8:11], s47 offen lds
  s_add_u32 s47, s25, 133120
  s_add_u32 m0, s24, 7168
  s_nop 0
  buffer_load_dwordx4 v5, s[8:11], s47 offen lds
  s_add_u32 s47, s25, 163840
  s_add_u32 m0, s24, 8192
  s_nop 0
  buffer_load_dwordx4 v5, s[8:11], s47 offen lds
  s_add_u32 s47, s25, 174080
  s_add_u32 m0, s24, 9216
  s_nop 0
  buffer_load_dwordx4 v5, s[8:11], s47 offen lds
  s_add_u32 s47, s25, 204800
  s_add_u32 m0, s24, 10240
  s_nop 0
  buffer_load_dwordx4 v5, s[8:11], s47 offen lds
  s_add_u32 s47, s25, 215040
  s_add_u32 m0, s24, 11264
  s_nop 0
  buffer_load_dwordx4 v5, s[8:11], s47 offen lds
  s_add_u32 s47, s25, 245760
  s_add_u32 m0, s24, 12288
  s_nop 0
  buffer_load_dwordx4 v5, s[8:11], s47 offen lds
  s_add_u32 s47, s25, 256000
  s_add_u32 m0, s24, 13312
  s_nop 0
  buffer_load_dwordx4 v5, s[8:11], s47 offen lds
  s_add_u32 s47, s25, 286720
  s_add_u32 m0, s24, 14336
  s_nop 0
  buffer_load_dwordx4 v5, s[8:11], s47 offen lds
  s_add_u32 s47, s25, 296960
  s_add_u32 m0, s24, 15360
  s_nop 0
  buffer_load_dwordx4 v5, s[8:11], s47 offen lds
  s_add_u32 s47, s25, 327680
  s_add_u32 m0, s24, 16384
  s_nop 0
  buffer_load_dwordx4 v5, s[8:11], s47 offen lds
  s_add_u32 s47, s25, 337920
  s_add_u32 m0, s24, 17408
  s_nop 0
  buffer_load_dwordx4 v5, s[8:11], s47 offen lds
  s_add_u32 s47, s25, 368640
  s_add_u32 m0, s24, 18432
  s_nop 0
  buffer_load_dwordx4 v5, s[8:11], s47 offen lds
  s_add_u32 s47, s25, 378880
  s_add_u32 m0, s24, 19456
  s_nop 0
  buffer_load_dwordx4 v5, s[8:11], s47 offen lds
  s_add_u32 s47, s25, 409600
  s_add_u32 m0, s24, 20480
  s_nop 0
  buffer_load_dwordx4 v5, s[8:11], s47 offen lds
  s_add_u32 s47, s25, 419840
  s_add_u32 m0, s24, 21504
  s_nop 0
  buffer_load_dwordx4 v5, s[8:11], s47 offen lds
  s_add_u32 s47, s25, 450560
  s_add_u32 m0, s24, 22528
  s_nop 0
  buffer_load_dwordx4 v5, s[8:11], s47 offen lds
  s_add_u32 s47, s25, 460800
  s_add_u32 m0, s24, 23552
  s_nop 0
  buffer_load_dwordx4 v5, s[8:11], s47 offen lds
  s_add_u32 s47, s25, 491520
  s_add_u32 m0, s24, 24576
  s_nop 0
  buffer_load_dwordx4 v5, s[8:11], s47 offen lds
  s_add_u32 s47, s25, 501760
  s_add_u32 m0, s24, 25600
  s_nop 0
  buffer_load_dwordx4 v5, s[8:11], s47 offen lds
  s_add_u32 s47, s25, 532480
  s_add_u32 m0, s24, 26624
  s_nop 0
  buffer_load_dwordx4 v5, s[8:11], s47 offen lds
  s_add_u32 s47, s25, 542720
  s_add_u32 m0, s24, 27648
  s_nop 0
  buffer_load_dwordx4 v5, s[8:11], s47 offen lds
  s_add_u32 s47, s25, 573440
  s_add_u32 m0, s24, 28672
  s_nop 0
  buffer_load_dwordx4 v5, s[8:11], s47 offen lds
  s_add_u32 s47, s25, 583680
  s_add_u32 m0, s24, 29696
  s_nop 0
  buffer_load_dwordx4 v5, s[8:11], s47 offen lds
  s_add_u32 s47, s25, 614400
  s_add_u32 m0, s24, 30720
  s_nop 0
  buffer_load_dwordx4 v5, s[8:11], s47 offen lds
  s_add_u32 s47, s25, 624640
  s_add_u32 m0, s24, 31744
  s_nop 0
  buffer_load_dwordx4 v5, s[8:11], s47 offen lds
  s_waitcnt vmcnt(30)
  ds_read_b64_tr_b16 a[0:1], v7 offset:0
  ds_read_b64_tr_b16 a[2:3], v7 offset:256
  ds_read_b64_tr_b16 a[4:5], v7 offset:8
  ds_read_b64_tr_b16 a[6:7], v7 offset:264
  s_waitcnt lgkmcnt(0)
  s_add_u32 s47, s25, 655360
  s_add_u32 m0, s24, 0
  s_nop 0
  buffer_load_dwordx4 v5, s[8:11], s47 offen lds
  s_add_u32 s47, s25, 665600
  s_add_u32 m0, s24, 1024
  s_nop 0
  buffer_load_dwordx4 v5, s[8:11], s47 offen lds
  s_waitcnt vmcnt(30)
  ds_read_b64_tr_b16 a[8:9], v7 offset:2048
  ds_read_b64_tr_b16 a[10:11], v7 offset:2304
  ds_read_b64_tr_b16 a[12:13], v7 offset:2056
  ds_read_b64_tr_b16 a[14:15], v7 offset:2312
  s_waitcnt lgkmcnt(0)
  s_add_u32 s47, s25, 696320
  s_add_u32 m0, s24, 2048
  s_nop 0
  buffer_load_dwordx4 v5, s[8:11], s47 offen lds
  s_add_u32 s47, s25, 706560
  s_add_u32 m0, s24, 3072
  s_nop 0
  buffer_load_dwordx4 v5, s[8:11], s47 offen lds
  s_waitcnt vmcnt(30)
  ds_read_b64_tr_b16 a[16:17], v7 offset:4096
  ds_read_b64_tr_b16 a[18:19], v7 offset:4352
  ds_read_b64_tr_b16 a[20:21], v7 offset:4104
  ds_read_b64_tr_b16 a[22:23], v7 offset:4360
  s_waitcnt lgkmcnt(0)
  s_add_u32 s47, s25, 737280
  s_add_u32 m0, s24, 4096
  s_nop 0
  buffer_load_dwordx4 v5, s[8:11], s47 offen lds
  s_add_u32 s47, s25, 747520
  s_add_u32 m0, s24, 5120
  s_nop 0
  buffer_load_dwordx4 v5, s[8:11], s47 offen lds
  s_waitcnt vmcnt(30)
  ds_read_b64_tr_b16 a[24:25], v7 offset:6144
  ds_read_b64_tr_b16 a[26:27], v7 offset:6400
  ds_read_b64_tr_b16 a[28:29], v7 offset:6152
  ds_read_b64_tr_b16 a[30:31], v7 offset:6408
  s_waitcnt lgkmcnt(0)
  s_add_u32 s47, s25, 778240
  s_add_u32 m0, s24, 6144
  s_nop 0
  buffer_load_dwordx4 v5, s[8:11], s47 offen lds
  s_add_u32 s47, s25, 788480
  s_add_u32 m0, s24, 7168
  s_nop 0
  buffer_load_dwordx4 v5, s[8:11], s47 offen lds
  s_waitcnt vmcnt(30)
  ds_read_b64_tr_b16 a[32:33], v7 offset:8192
  ds_read_b64_tr_b16 a[34:35], v7 offset:8448
  ds_read_b64_tr_b16 a[36:37], v7 offset:8200
  ds_read_b64_tr_b16 a[38:39], v7 offset:8456
  s_waitcnt lgkmcnt(0)
  s_add_u32 s47, s25, 819200
  s_add_u32 m0, s24, 8192
  s_nop 0
  buffer_load_dwordx4 v5, s[8:11], s47 offen lds
  s_add_u32 s47, s25, 829440
  s_add_u32 m0, s24, 9216
  s_nop 0
  buffer_load_dwordx4 v5, s[8:11], s47 offen lds
  s_waitcnt vmcnt(30)
  ds_read_b64_tr_b16 a[40:41], v7 offset:10240
  ds_read_b64_tr_b16 a[42:43], v7 offset:10496
  ds_read_b64_tr_b16 a[44:45], v7 offset:10248
  ds_read_b64_tr_b16 a[46:47], v7 offset:10504
  s_waitcnt lgkmcnt(0)
  s_add_u32 s47, s25, 860160
  s_add_u32 m0, s24, 10240
  s_nop 0
  buffer_load_dwordx4 v5, s[8:11], s47 offen lds
  s_add_u32 s47, s25, 870400
  s_add_u32 m0, s24, 11264
  s_nop 0
  buffer_load_dwordx4 v5, s[8:11], s47 offen lds
  s_waitcnt vmcnt(30)
  ds_read_b64_tr_b16 a[48:49], v7 offset:12288
  ds_read_b64_tr_b16 a[50:51], v7 offset:12544
  ds_read_b64_tr_b16 a[52:53], v7 offset:12296
  ds_read_b64_tr_b16 a[54:55], v7 offset:12552
  s_waitcnt lgkmcnt(0)
  s_add_u32 s47, s25, 901120
  s_add_u32 m0, s24, 12288
  s_nop 0
  buffer_load_dwordx4 v5, s[8:11], s47 offen lds
  s_add_u32 s47, s25, 911360
  s_add_u32 m0, s24, 13312
  s_nop 0
  buffer_load_dwordx4 v5, s[8:11], s47 offen lds
  s_waitcnt vmcnt(30)
  ds_read_b64_tr_b16 a[56:57], v7 offset:14336
  ds_read_b64_tr_b16 a[58:59], v7 offset:14592
  ds_read_b64_tr_b16 a[60:61], v7 offset:14344
  ds_read_b64_tr_b16 a[62:63], v7 offset:14600
  s_waitcnt lgkmcnt(0)
  s_add_u32 s47, s25, 942080
  s_add_u32 m0, s24, 14336
  s_nop 0
  buffer_load_dwordx4 v5, s[8:11], s47 offen lds
  s_add_u32 s47, s25, 952320
  s_add_u32 m0, s24, 15360
  s_nop 0
  buffer_load_dwordx4 v5, s[8:11], s47 offen lds
  s_waitcnt vmcnt(30)
  ds_read_b64_tr_b16 a[64:65], v7 offset:16384
  ds_read_b64_tr_b16 a[66:67], v7 offset:16640
  ds_read_b64_tr_b16 a[68:69], v7 offset:16392
  ds_read_b64_tr_b16 a[70:71], v7 offset:16648
  s_waitcnt lgkmcnt(0)
  s_add_u32 s47, s25, 983040
  s_add_u32 m0, s24, 16384
  s_nop 0
  buffer_load_dwordx4 v5, s[8:11], s47 offen lds
  s_add_u32 s47, s25, 993280
  s_add_u32 m0, s24, 17408
  s_nop 0
  buffer_load_dwordx4 v5, s[8:11], s47 offen lds
  s_waitcnt vmcnt(30)
  ds_read_b64_tr_b16 a[72:73], v7 offset:18432
  ds_read_b64_tr_b16 a[74:75], v7 offset:18688
  ds_read_b64_tr_b16 a[76:77], v7 offset:18440
  ds_read_b64_tr_b16 a[78:79], v7 offset:18696
  s_waitcnt lgkmcnt(0)
  s_add_u32 s47, s25, 1024000
  s_add_u32 m0, s24, 18432
  s_nop 0
  buffer_load_dwordx4 v5, s[8:11], s47 offen lds
  s_add_u32 s47, s25, 1034240
  s_add_u32 m0, s24, 19456
  s_nop 0
  buffer_load_dwordx4 v5, s[8:11], s47 offen lds
  s_waitcnt vmcnt(30)
  ds_read_b64_tr_b16 a[80:81], v7 offset:20480
  ds_read_b64_tr_b16 a[82:83], v7 offset:20736
  ds_read_b64_tr_b16 a[84:85], v7 offset:20488
  ds_read_b64_tr_b16 a[86:87], v7 offset:20744
  s_waitcnt lgkmcnt(0)
  s_add_u32 s47, s25, 1064960
  s_add_u32 m0, s24, 20480
  s_nop 0
  buffer_load_dwordx4 v5, s[8:11], s47 offen lds
  s_add_u32 s47, s25, 1075200
  s_add_u32 m0, s24, 21504
  s_nop 0
  buffer_load_dwordx4 v5, s[8:11], s47 offen lds
  s_waitcnt vmcnt(30)
  ds_read_b64_tr_b16 a[88:89], v7 offset:22528
  ds_read_b64_tr_b16 a[90:91], v7 offset:22784
  ds_read_b64_tr_b16 a[92:93], v7 offset:22536
  ds_read_b64_tr_b16 a[94:95], v7 offset:22792
  s_waitcnt lgkmcnt(0)
  s_add_u32 s47, s25, 1105920
  s_add_u32 m0, s24, 22528
  s_nop 0
  buffer_load_dwordx4 v5, s[8:11], s47 offen lds
  s_add_u32 s47, s25, 1116160
  s_add_u32 m0, s24, 23552
  s_nop 0
  buffer_load_dwordx4 v5, s[8:11], s47 offen lds
  s_waitcnt vmcnt(30)
  ds_read_b64_tr_b16 a[96:97], v7 offset:24576
  ds_read_b64_tr_b16 a[98:99], v7 offset:24832
  ds_read_b64_tr_b16 a[100:101], v7 offset:24584
  ds_read_b64_tr_b16 a[102:103], v7 offset:24840
  s_waitcnt lgkmcnt(0)
  s_add_u32 s47, s25, 1146880
  s_add_u32 m0, s24, 24576
  s_nop 0
  buffer_load_dwordx4 v5, s[8:11], s47 offen lds
  s_add_u32 s47, s25, 1157120
  s_add_u32 m0, s24, 25600
  s_nop 0
  buffer_load_dwordx4 v5, s[8:11], s47 offen lds
  s_waitcnt vmcnt(30)
  ds_read_b64_tr_b16 a[104:105], v7 offset:26624
  ds_read_b64_tr_b16 a[106:107], v7 offset:26880
  ds_read_b64_tr_b16 a[108:109], v7 offset:26632
  ds_read_b64_tr_b16 a[110:111], v7 offset:26888
  s_waitcnt lgkmcnt(0)
  s_add_u32 s47, s25, 1187840
  s_add_u32 m0, s24, 26624
  s_nop 0
  buffer_load_dwordx4 v5, s[8:11], s47 offen lds
  s_add_u32 s47, s25, 1198080
  s_add_u32 m0, s24, 27648
  s_nop 0
  buffer_load_dwordx4 v5, s[8:11], s47 offen lds
  s_waitcnt vmcnt(30)
  ds_read_b64_tr_b16 a[112:113], v7 offset:28672
  ds_read_b64_tr_b16 a[114:115], v7 offset:28928
  ds_read_b64_tr_b16 a[116:117], v7 offset:28680
  ds_read_b64_tr_b16 a[118:119], v7 offset:28936
  s_waitcnt lgkmcnt(0)
  s_add_u32 s47, s25, 1228800
  s_add_u32 m0, s24, 28672
  s_nop 0
  buffer_load_dwordx4 v5, s[8:11], s47 offen lds
  s_add_u32 s47, s25, 1239040
  s_add_u32 m0, s24, 29696
  s_nop 0
  buffer_load_dwordx4 v5, s[8:11], s47 offen lds
  s_waitcnt vmcnt(30)
  ds_read_b64_tr_b16 a[120:121], v7 offset:30720
  ds_read_b64_tr_b16 a[122:123], v7 offset:30976
  ds_read_b64_tr_b16 a[124:125], v7 offset:30728
  ds_read_b64_tr_b16 a[126:127], v7 offset:30984
  s_waitcnt lgkmcnt(0)
  s_add_u32 s47, s25, 1269760
  s_add_u32 m0, s24, 30720
  s_nop 0
  buffer_load_dwordx4 v5, s[8:11], s47 offen lds
  s_add_u32 s47, s25, 1280000
  s_add_u32 m0, s24, 31744
  s_nop 0
  buffer_load_dwordx4 v5, s[8:11], s47 offen lds
  s_waitcnt vmcnt(30)
  ds_read_b64_tr_b16 a[128:129], v7 offset:0
  ds_read_b64_tr_b16 a[130:131], v7 offset:256
  ds_read_b64_tr_b16 a[132:133], v7 offset:8
  ds_read_b64_tr_b16 a[134:135], v7 offset:264
  s_waitcnt lgkmcnt(0)
  s_add_u32 s47, s26, 0
  s_add_u32 m0, s24, 0
  s_nop 0
  buffer_load_dwordx4 v6, s[16:19], s47 offen lds
  s_add_u32 s47, s26, 20480
  s_add_u32 m0, s24, 1024
  s_nop 0
  buffer_load_dwordx4 v6, s[16:19], s47 offen lds
  s_waitcnt vmcnt(30)
  ds_read_b64_tr_b16 a[136:137], v7 offset:2048
  ds_read_b64_tr_b16 a[138:139], v7 offset:2304
  ds_read_b64_tr_b16 a[140:141], v7 offset:2056
  ds_read_b64_tr_b16 a[142:143], v7 offset:2312
  s_waitcnt lgkmcnt(0)
  s_add_u32 s47, s26, 40960
  s_add_u32 m0, s24, 2048
  s_nop 0
  buffer_load_dwordx4 v6, s[16:19], s47 offen lds
  s_add_u32 s47, s26, 61440
  s_add_u32 m0, s24, 3072
  s_nop 0
  buffer_load_dwordx4 v6, s[16:19], s47 offen lds
  s_waitcnt vmcnt(30)
  ds_read_b64_tr_b16 a[144:145], v7 offset:4096
  ds_read_b64_tr_b16 a[146:147], v7 offset:4352
  ds_read_b64_tr_b16 a[148:149], v7 offset:4104
  ds_read_b64_tr_b16 a[150:151], v7 offset:4360
  s_waitcnt lgkmcnt(0)
  s_add_u32 s47, s26, 81920
  s_add_u32 m0, s24, 4096
  s_nop 0
  buffer_load_dwordx4 v6, s[16:19], s47 offen lds
  s_add_u32 s47, s26, 102400
  s_add_u32 m0, s24, 5120
  s_nop 0
  buffer_load_dwordx4 v6, s[16:19], s47 offen lds
  s_waitcnt vmcnt(30)
  ds_read_b64_tr_b16 a[152:153], v7 offset:6144
  ds_read_b64_tr_b16 a[154:155], v7 offset:6400
  ds_read_b64_tr_b16 a[156:157], v7 offset:6152
  ds_read_b64_tr_b16 a[158:159], v7 offset:6408
  s_waitcnt lgkmcnt(0)
  s_add_u32 s47, s26, 122880
  s_add_u32 m0, s24, 6144
  s_nop 0
  buffer_load_dwordx4 v6, s[16:19], s47 offen lds
  s_add_u32 s47, s26, 143360
  s_add_u32 m0, s24, 7168
  s_nop 0
  buffer_load_dwordx4 v6, s[16:19], s47 offen lds
  s_waitcnt vmcnt(30)
  ds_read_b64_tr_b16 a[160:161], v7 offset:8192
  ds_read_b64_tr_b16 a[162:163], v7 offset:8448
  ds_read_b64_tr_b16 a[164:165], v7 offset:8200
  ds_read_b64_tr_b16 a[166:167], v7 offset:8456
  s_waitcnt lgkmcnt(0)
  s_add_u32 s47, s26, 163840
  s_add_u32 m0, s24, 8192
  s_nop 0
  buffer_load_dwordx4 v6, s[16:19], s47 offen lds
  s_add_u32 s47, s26, 184320
  s_add_u32 m0, s24, 9216
  s_nop 0
  buffer_load_dwordx4 v6, s[16:19], s47 offen lds
  s_waitcnt vmcnt(30)
  ds_read_b64_tr_b16 a[168:169], v7 offset:10240
  ds_read_b64_tr_b16 a[170:171], v7 offset:10496
  ds_read_b64_tr_b16 a[172:173], v7 offset:10248
  ds_read_b64_tr_b16 a[174:175], v7 offset:10504
  s_waitcnt lgkmcnt(0)
  s_add_u32 s47, s26, 204800
  s_add_u32 m0, s24, 10240
  s_nop 0
  buffer_load_dwordx4 v6, s[16:19], s47 offen lds
  s_add_u32 s47, s26, 225280
  s_add_u32 m0, s24, 11264
  s_nop 0
  buffer_load_dwordx4 v6, s[16:19], s47 offen lds
  s_waitcnt vmcnt(30)
  ds_read_b64_tr_b16 a[176:177], v7 offset:12288
  ds_read_b64_tr_b16 a[178:179], v7 offset:12544
  ds_read_b64_tr_b16 a[180:181], v7 offset:12296
  ds_read_b64_tr_b16 a[182:183], v7 offset:12552
  s_waitcnt lgkmcnt(0)
  s_add_u32 s47, s26, 245760
  s_add_u32 m0, s24, 12288
  s_nop 0
  buffer_load_dwordx4 v6, s[16:19], s47 offen lds
  s_add_u32 s47, s26, 266240
  s_add_u32 m0, s24, 13312
  s_nop 0
  buffer_load_dwordx4 v6, s[16:19], s47 offen lds
  s_waitcnt vmcnt(30)
  ds_read_b64_tr_b16 a[184:185], v7 offset:14336
  ds_read_b64_tr_b16 a[186:187], v7 offset:14592
  ds_read_b64_tr_b16 a[188:189], v7 offset:14344
  ds_read_b64_tr_b16 a[190:191], v7 offset:14600
  s_waitcnt lgkmcnt(0)
  s_add_u32 s47, s26, 286720
  s_add_u32 m0, s24, 14336
  s_nop 0
  buffer_load_dwordx4 v6, s[16:19], s47 offen lds
  s_add_u32 s47, s26, 307200
  s_add_u32 m0, s24, 15360
  s_nop 0
  buffer_load_dwordx4 v6, s[16:19], s47 offen lds
  s_waitcnt vmcnt(30)
  ds_read_b64_tr_b16 a[192:193], v7 offset:16384
  ds_read_b64_tr_b16 a[194:195], v7 offset:16640
  ds_read_b64_tr_b16 a[196:197], v7 offset:16392
  ds_read_b64_tr_b16 a[198:199], v7 offset:16648
  s_waitcnt lgkmcnt(0)
  s_add_u32 s47, s26, 327680
  s_add_u32 m0, s24, 16384
  s_nop 0
  buffer_load_dwordx4 v6, s[16:19], s47 offen lds
  s_add_u32 s47, s26, 348160
  s_add_u32 m0, s24, 17408
  s_nop 0
  buffer_load_dwordx4 v6, s[16:19], s47 offen lds
  s_waitcnt vmcnt(30)
  ds_read_b64_tr_b16 a[200:201], v7 offset:18432
  ds_read_b64_tr_b16 a[202:203], v7 offset:18688
  ds_read_b64_tr_b16 a[204:205], v7 offset:18440
  ds_read_b64_tr_b16 a[206:207], v7 offset:18696
  s_waitcnt lgkmcnt(0)
  s_add_u32 s47, s26, 368640
  s_add_u32 m0, s24, 18432
  s_nop 0
  buffer_load_dwordx4 v6, s[16:19], s47 offen lds
  s_add_u32 s47, s26, 389120
  s_add_u32 m0, s24, 19456
  s_nop 0
  buffer_load_dwordx4 v6, s[16:19], s47 offen lds
  s_waitcnt vmcnt(30)
  ds_read_b64_tr_b16 a[208:209], v7 offset:20480
  ds_read_b64_tr_b16 a[210:211], v7 offset:20736
  ds_read_b64_tr_b16 a[212:213], v7 offset:20488
  ds_read_b64_tr_b16 a[214:215], v7 offset:20744
  s_waitcnt lgkmcnt(0)
  s_add_u32 s47, s26, 409600
  s_add_u32 m0, s24, 20480
  s_nop 0
  buffer_load_dwordx4 v6, s[16:19], s47 offen lds
  s_add_u32 s47, s26, 430080
  s_add_u32 m0, s24, 21504
  s_nop 0
  buffer_load_dwordx4 v6, s[16:19], s47 offen lds
  s_waitcnt vmcnt(30)
  ds_read_b64_tr_b16 a[216:217], v7 offset:22528
  ds_read_b64_tr_b16 a[218:219], v7 offset:22784
  ds_read_b64_tr_b16 a[220:221], v7 offset:22536
  ds_read_b64_tr_b16 a[222:223], v7 offset:22792
  s_waitcnt lgkmcnt(0)
  s_add_u32 s47, s26, 450560
  s_add_u32 m0, s24, 22528
  s_nop 0
  buffer_load_dwordx4 v6, s[16:19], s47 offen lds
  s_add_u32 s47, s26, 471040
  s_add_u32 m0, s24, 23552
  s_nop 0
  buffer_load_dwordx4 v6, s[16:19], s47 offen lds
  s_waitcnt vmcnt(30)
  ds_read_b64_tr_b16 a[224:225], v7 offset:24576
  ds_read_b64_tr_b16 a[226:227], v7 offset:24832
  ds_read_b64_tr_b16 a[228:229], v7 offset:24584
  ds_read_b64_tr_b16 a[230:231], v7 offset:24840
  s_waitcnt lgkmcnt(0)
  s_add_u32 s47, s26, 491520
  s_add_u32 m0, s24, 24576
  s_nop 0
  buffer_load_dwordx4 v6, s[16:19], s47 offen lds
  s_add_u32 s47, s26, 512000
  s_add_u32 m0, s24, 25600
  s_nop 0
  buffer_load_dwordx4 v6, s[16:19], s47 offen lds
  s_waitcnt vmcnt(30)
  ds_read_b64_tr_b16 a[232:233], v7 offset:26624
  ds_read_b64_tr_b16 a[234:235], v7 offset:26880
  ds_read_b64_tr_b16 a[236:237], v7 offset:26632
  ds_read_b64_tr_b16 a[238:239], v7 offset:26888
  s_waitcnt lgkmcnt(0)
  s_add_u32 s47, s26, 532480
  s_add_u32 m0, s24, 26624
  s_nop 0
  buffer_load_dwordx4 v6, s[16:19], s47 offen lds
  s_add_u32 s47, s26, 552960
  s_add_u32 m0, s24, 27648
  s_nop 0
  buffer_load_dwordx4 v6, s[16:19], s47 offen lds
  s_waitcnt vmcnt(30)
  ds_read_b64_tr_b16 a[240:241], v7 offset:28672
  ds_read_b64_tr_b16 a[242:243], v7 offset:28928
  ds_read_b64_tr_b16 a[244:245], v7 offset:28680
  ds_read_b64_tr_b16 a[246:247], v7 offset:28936
  s_waitcnt lgkmcnt(0)
  s_waitcnt vmcnt(28)
  ds_read_b64_tr_b16 a[248:249], v7 offset:30720
  ds_read_b64_tr_b16 a[250:251], v7 offset:30976
  ds_read_b64_tr_b16 a[252:253], v7 offset:30728
  ds_read_b64_tr_b16 a[254:255], v7 offset:30984
  s_waitcnt lgkmcnt(0)
  s_waitcnt vmcnt(26)
  ds_read_b64_tr_b16 v[144:145], v7 offset:0
  ds_read_b64_tr_b16 v[146:147], v7 offset:256
  ds_read_b64_tr_b16 v[148:149], v7 offset:8
  ds_read_b64_tr_b16 v[150:151], v7 offset:264
  s_waitcnt lgkmcnt(0)
  s_waitcnt vmcnt(24)
  ds_read_b64_tr_b16 v[152:153], v7 offset:2048
  ds_read_b64_tr_b16 v[154:155], v7 offset:2304
  ds_read_b64_tr_b16 v[156:157], v7 offset:2056
  ds_read_b64_tr_b16 v[158:159], v7 offset:2312
  s_waitcnt lgkmcnt(0)
  s_waitcnt vmcnt(22)
  ds_read_b64_tr_b16 v[160:161], v7 offset:4096
  ds_read_b64_tr_b16 v[162:163], v7 offset:4352
  ds_read_b64_tr_b16 v[164:165], v7 offset:4104
  ds_read_b64_tr_b16 v[166:167], v7 offset:4360
  s_waitcnt lgkmcnt(0)
  s_waitcnt vmcnt(20)
  ds_read_b64_tr_b16 v[168:169], v7 offset:6144
  ds_read_b64_tr_b16 v[170:171], v7 offset:6400
  ds_read_b64_tr_b16 v[172:173], v7 offset:6152
  ds_read_b64_tr_b16 v[174:175], v7 offset:6408
  s_waitcnt lgkmcnt(0)
  s_waitcnt vmcnt(18)
  ds_read_b64_tr_b16 v[176:177], v7 offset:8192
  ds_read_b64_tr_b16 v[178:179], v7 offset:8448
  ds_read_b64_tr_b16 v[180:181], v7 offset:8200
  ds_read_b64_tr_b16 v[182:183], v7 offset:8456
  s_waitcnt lgkmcnt(0)
  s_waitcnt vmcnt(16)
  ds_read_b64_tr_b16 v[184:185], v7 offset:10240
  ds_read_b64_tr_b16 v[186:187], v7 offset:10496
  ds_read_b64_tr_b16 v[188:189], v7 offset:10248
  ds_read_b64_tr_b16 v[190:191], v7 offset:10504
  s_waitcnt lgkmcnt(0)
  s_waitcnt vmcnt(14)
  ds_read_b64_tr_b16 v[192:193], v7 offset:12288
  ds_read_b64_tr_b16 v[194:195], v7 offset:12544
  ds_read_b64_tr_b16 v[196:197], v7 offset:12296
  ds_read_b64_tr_b16 v[198:199], v7 offset:12552
  s_waitcnt lgkmcnt(0)
  s_waitcnt vmcnt(12)
  ds_read_b64_tr_b16 v[200:201], v7 offset:14336
  ds_read_b64_tr_b16 v[202:203], v7 offset:14592
  ds_read_b64_tr_b16 v[204:205], v7 offset:14344
  ds_read_b64_tr_b16 v[206:207], v7 offset:14600
  s_waitcnt lgkmcnt(0)
  s_waitcnt vmcnt(10)
  ds_read_b64_tr_b16 v[208:209], v7 offset:16384
  ds_read_b64_tr_b16 v[210:211], v7 offset:16640
  ds_read_b64_tr_b16 v[212:213], v7 offset:16392
  ds_read_b64_tr_b16 v[214:215], v7 offset:16648
  s_waitcnt lgkmcnt(0)
  s_waitcnt vmcnt(8)
  ds_read_b64_tr_b16 v[216:217], v7 offset:18432
  ds_read_b64_tr_b16 v[218:219], v7 offset:18688
  ds_read_b64_tr_b16 v[220:221], v7 offset:18440
  ds_read_b64_tr_b16 v[222:223], v7 offset:18696
  s_waitcnt lgkmcnt(0)
  s_waitcnt vmcnt(6)
  ds_read_b64_tr_b16 v[224:225], v7 offset:20480
  ds_read_b64_tr_b16 v[226:227], v7 offset:20736
  ds_read_b64_tr_b16 v[228:229], v7 offset:20488
  ds_read_b64_tr_b16 v[230:231], v7 offset:20744
  s_waitcnt lgkmcnt(0)
  s_waitcnt vmcnt(4)
  ds_read_b64_tr_b16 v[232:233], v7 offset:22528
  ds_read_b64_tr_b16 v[234:235], v7 offset:22784
  ds_read_b64_tr_b16 v[236:237], v7 offset:22536
  ds_read_b64_tr_b16 v[238:239], v7 offset:22792
  s_waitcnt lgkmcnt(0)
  s_waitcnt vmcnt(2)
  ds_read_b64_tr_b16 v[240:241], v7 offset:24576
  ds_read_b64_tr_b16 v[242:243], v7 offset:24832
  ds_read_b64_tr_b16 v[244:245], v7 offset:24584
  ds_read_b64_tr_b16 v[246:247], v7 offset:24840
  s_waitcnt lgkmcnt(0)
  s_waitcnt vmcnt(0)
  ds_read_b64_tr_b16 v[248:249], v7 offset:26624
  ds_read_b64_tr_b16 v[250:251], v7 offset:26880
  ds_read_b64_tr_b16 v[252:253], v7 offset:26632
  ds_read_b64_tr_b16 v[254:255], v7 offset:26888
  s_waitcnt lgkmcnt(0)
  s_barrier
  s_mov_b32 s8, s56
  s_and_b32 s9, s57, 0xffff
  s_mov_b32 s10, 2621440
  s_mov_b32 s11, 0x20000
  s_mov_b32 s16, s72
  s_and_b32 s17, s73, 0xffff
  s_mov_b32 s18, 2621440
  s_mov_b32 s19, 0x20000
  s_mov_b32 s30, s22
  s_mov_b32 s32, 0
  v_and_b32 v4, 7, v2
  v_min_u32 v4, 6, v4
  v_lshlrev_b32 v4, 2, v4
  s_lshl_b32 s47, s13, 12
  v_add_u32 v5, s47, v1
  v_add_u32 v5, 131072, v5
  v_add_u32 v6, 131072, v1
  s_cmp_ge_u32 s30, 4
  s_cbranch_scc1 OUX_84
  v_and_b32 v3, 15, v2
  s_movk_i32 s47, 1280
  v_mul_lo_u32 v3, v3, s47
  v_lshrrev_b32 v8, 4, v2
  v_lshl_add_u32 v3, v8, 4, v3
  s_lshl_b32 s47, s21, 6
  v_add_u32 v3, s47, v3
  v_mov_b32 v7, v3
  v_mov_b32 v10, v1
OUT_86:
  s_lshr_b32 s27, s22, 1
  s_lshr_b32 s47, s27, 4
  s_add_u32 s49, s47, 1
  s_cmp_ge_u32 s32, s49
  s_cbranch_scc1 OPK_87
  s_lshl_b32 s47, s47, 5
  s_add_u32 s47, s47, 768
  v_add_u32 v8, s47, v4
  s_and_b32 s48, s27, 15
  s_add_u32 s48, s48, 1
OP1_88:
  buffer_load_dword v9, v8, s[4:7], 0 offen sc1
  s_sub_u32 s74, s74, 1
  s_cbranch_scc1 L_TIMEOUT
  s_waitcnt vmcnt(0)
  v_cmp_gt_u32 vcc, s48, v9
  s_nop 0
  s_cbranch_vccz BK_89
  s_sleep 2
  s_branch OP1_88
BK_89:
  v_cmp_gt_u32 vcc, 16, v9
  s_nop 0
  s_cbranch_vccnz OPK_87
  s_mov_b32 s32, s49
OPK_87:
  s_mul_i32 s47, s22, 20480
  buffer_load_dwordx4 v[12:15], v3, s[8:11], s47 offen
  s_mul_i32 s29, s22, 57344
  s_add_u32 s29, s29, 83886080
  s_mul_i32 s47, s13, 14
  s_add_u32 s47, s47, 0
  s_min_u32 s47, s47, 53
  s_lshl_b32 s47, s47, 10
  s_add_u32 s47, s47, s29
  buffer_load_dwordx4 v[64:67], v10, s[4:7], s47 offen sc1
  s_mul_i32 s47, s13, 14
  s_add_u32 s47, s47, 1
  s_min_u32 s47, s47, 53
  s_lshl_b32 s47, s47, 10
  s_add_u32 s47, s47, s29
  buffer_load_dwordx4 v[68:71], v10, s[4:7], s47 offen sc1
  s_mul_i32 s47, s13, 14
  s_add_u32 s47, s47, 2
  s_min_u32 s47, s47, 53
  s_lshl_b32 s47, s47, 10
  s_add_u32 s47, s47, s29
  buffer_load_dwordx4 v[72:75], v10, s[4:7], s47 offen sc1
  s_mul_i32 s47, s13, 14
  s_add_u32 s47, s47, 3
  s_min_u32 s47, s47, 53
  s_lshl_b32 s47, s47, 10
  s_add_u32 s47, s47, s29
  buffer_load_dwordx4 v[76:79], v10, s[4:7], s47 offen sc1
  s_mul_i32 s47, s13, 14
  s_add_u32 s47, s47, 4
  s_min_u32 s47, s47, 53
  s_lshl_b32 s47, s47, 10
  s_add_u32 s47, s47, s29
  buffer_load_dwordx4 v[80:83], v10, s[4:7], s47 offen sc1
  s_mul_i32 s47, s13, 14
  s_add_u32 s47, s47, 5
  s_min_u32 s47, s47, 53
  s_lshl_b32 s47, s47, 10
  s_add_u32 s47, s47, s29
  buffer_load_dwordx4 v[84:87], v10, s[4:7], s47 offen sc1
  s_mul_i32 s47, s13, 14
  s_add_u32 s47, s47, 6
  s_min_u32 s47, s47, 53
  s_lshl_b32 s47, s47, 10
  s_add_u32 s47, s47, s29
  buffer_load_dwordx4 v[88:91], v10, s[4:7], s47 offen sc1
  s_mul_i32 s47, s13, 14
  s_add_u32 s47, s47, 7
  s_min_u32 s47, s47, 53
  s_lshl_b32 s47, s47, 10
  s_add_u32 s47, s47, s29
  buffer_load_dwordx4 v[92:95], v10, s[4:7], s47 offen sc1
  s_mul_i32 s47, s13, 14
  s_add_u32 s47, s47, 8
  s_min_u32 s47, s47, 53
  s_lshl_b32 s47, s47, 10
  s_add_u32 s47, s47, s29
  buffer_load_dwordx4 v[96:99], v10, s[4:7], s47 offen sc1
  s_mul_i32 s47, s13, 14
  s_add_u32 s47, s47, 9
  s_min_u32 s47, s47, 53
  s_lshl_b32 s47, s47, 10
  s_add_u32 s47, s47, s29
  buffer_load_dwordx4 v[100:103], v10, s[4:7], s47 offen sc1
  s_mul_i32 s47, s13, 14
  s_add_u32 s47, s47, 10
  s_min_u32 s47, s47, 53
  s_lshl_b32 s47, s47, 10
  s_add_u32 s47, s47, s29
  buffer_load_dwordx4 v[104:107], v10, s[4:7], s47 offen sc1
  s_mul_i32 s47, s13, 14
  s_add_u32 s47, s47, 11
  s_min_u32 s47, s47, 53
  s_lshl_b32 s47, s47, 10
  s_add_u32 s47, s47, s29
  buffer_load_dwordx4 v[108:111], v10, s[4:7], s47 offen sc1
  s_mul_i32 s47, s13, 14
  s_add_u32 s47, s47, 12
  s_min_u32 s47, s47, 53
  s_lshl_b32 s47, s47, 10
  s_add_u32 s47, s47, s29
  buffer_load_dwordx4 v[112:115], v10, s[4:7], s47 offen sc1
  s_mul_i32 s47, s13, 14
  s_add_u32 s47, s47, 13
  s_min_u32 s47, s47, 53
  s_lshl_b32 s47, s47, 10
  s_add_u32 s47, s47, s29
  buffer_load_dwordx4 v[116:119], v10, s[4:7], s47 offen sc1
  s_waitcnt vmcnt(13)
  v_mfma_f32_16x16x32_bf16 v[32:35], v[144:147], v[64:67], 0
  v_mfma_f32_16x16x32_bf16 v[36:39], v[148:151], v[64:67], 0
  s_waitcnt vmcnt(12)
  v_mfma_f32_16x16x32_bf16 v[32:35], v[152:155], v[68:71], v[32:35]
  v_mfma_f32_16x16x32_bf16 v[36:39], v[156:159], v[68:71], v[36:39]
  s_waitcnt vmcnt(11)
  v_mfma_f32_16x16x32_bf16 v[32:35], v[160:163], v[72:75], v[32:35]
  v_mfma_f32_16x16x32_bf16 v[36:39], v[164:167], v[72:75], v[36:39]
  s_waitcnt vmcnt(10)
  v_mfma_f32_16x16x32_bf16 v[32:35], v[168:171], v[76:79], v[32:35]
  v_mfma_f32_16x16x32_bf16 v[36:39], v[172:175], v[76:79], v[36:39]
  s_waitcnt vmcnt(9)
  v_mfma_f32_16x16x32_bf16 v[32:35], v[176:179], v[80:83], v[32:35]
  v_mfma_f32_16x16x32_bf16 v[36:39], v[180:183], v[80:83], v[36:39]
  s_waitcnt vmcnt(8)
  v_mfma_f32_16x16x32_bf16 v[32:35], v[184:187], v[84:87], v[32:35]
  v_mfma_f32_16x16x32_bf16 v[36:39], v[188:191], v[84:87], v[36:39]
  s_waitcnt vmcnt(7)
  v_mfma_f32_16x16x32_bf16 v[32:35], v[192:195], v[88:91], v[32:35]
  v_mfma_f32_16x16x32_bf16 v[36:39], v[196:199], v[88:91], v[36:39]
  s_waitcnt vmcnt(6)
  v_mfma_f32_16x16x32_bf16 v[32:35], v[200:203], v[92:95], v[32:35]
  v_mfma_f32_16x16x32_bf16 v[36:39], v[204:207], v[92:95], v[36:39]
  s_waitcnt vmcnt(5)
  v_mfma_f32_16x16x32_bf16 v[32:35], v[208:211], v[96:99], v[32:35]
  v_mfma_f32_16x16x32_bf16 v[36:39], v[212:215], v[96:99], v[36:39]
  s_waitcnt vmcnt(4)
  v_mfma_f32_16x16x32_bf16 v[32:35], v[216:219], v[100:103], v[32:35]
  v_mfma_f32_16x16x32_bf16 v[36:39], v[220:223], v[100:103], v[36:39]
  s_waitcnt vmcnt(3)
  v_mfma_f32_16x16x32_bf16 v[32:35], v[224:227], v[104:107], v[32:35]
  v_mfma_f32_16x16x32_bf16 v[36:39], v[228:231], v[104:107], v[36:39]
  s_waitcnt vmcnt(2)
  v_mfma_f32_16x16x32_bf16 v[32:35], v[232:235], v[108:111], v[32:35]
  v_mfma_f32_16x16x32_bf16 v[36:39], v[236:239], v[108:111], v[36:39]
  s_waitcnt vmcnt(1)
  v_mfma_f32_16x16x32_bf16 v[32:35], v[240:243], v[112:115], v[32:35]
  v_mfma_f32_16x16x32_bf16 v[36:39], v[244:247], v[112:115], v[36:39]
  s_waitcnt vmcnt(0)
  v_mfma_f32_16x16x32_bf16 v[32:35], v[248:251], v[116:119], v[32:35]
  v_mfma_f32_16x16x32_bf16 v[36:39], v[252:255], v[116:119], v[36:39]
  s_lshl_b32 s47, s27, 7
  s_add_u32 s47, s47, 8192
  s_mov_b32 s50, 32
  s_cmp_lg_u32 s13, 0
  s_cbranch_scc1 OPW_90
  v_mov_b32 v8, s47
OP2_91:
  buffer_load_dword v9, v8, s[4:7], 0 offen sc1
  s_sub_u32 s74, s74, 1
  s_cbranch_scc1 L_TIMEOUT
  s_waitcnt vmcnt(0)
  v_cmp_gt_u32 vcc, s50, v9
  s_nop 0
  s_cbranch_vccz BK_92
  s_sleep 2
  s_branch OP2_91
BK_92:
OPW_90:
  s_barrier
  s_lshl_b32 s28, s22, 7
  s_lshl_b32 s47, s13, 5
  s_add_u32 s28, s28, s47
  s_lshl_b32 s28, s28, 10
  s_add_u32 s28, s28, 100663296
  s_add_u32 s47, s28, 0
  buffer_load_dwordx4 v[64:67], v10, s[4:7], s47 offen offset:0 sc1
  s_add_u32 s47, s28, 0
  buffer_load_dwordx4 v[68:71], v10, s[4:7], s47 offen offset:1024 sc1
  s_add_u32 s47, s28, 0
  buffer_load_dwordx4 v[72:75], v10, s[4:7], s47 offen offset:2048 sc1
  s_add_u32 s47, s28, 0
  buffer_load_dwordx4 v[76:79], v10, s[4:7], s47 offen offset:3072 sc1
  s_add_u32 s47, s28, 4096
  buffer_load_dwordx4 v[80:83], v10, s[4:7], s47 offen offset:0 sc1
  s_add_u32 s47, s28, 4096
  buffer_load_dwordx4 v[84:87], v10, s[4:7], s47 offen offset:1024 sc1
  s_add_u32 s47, s28, 4096
  buffer_load_dwordx4 v[88:91], v10, s[4:7], s47 offen offset:2048 sc1
  s_add_u32 s47, s28, 4096
  buffer_load_dwordx4 v[92:95], v10, s[4:7], s47 offen offset:3072 sc1
  s_add_u32 s47, s28, 8192
  buffer_load_dwordx4 v[96:99], v10, s[4:7], s47 offen offset:0 sc1
  s_add_u32 s47, s28, 8192
  buffer_load_dwordx4 v[100:103], v10, s[4:7], s47 offen offset:1024 sc1
  s_add_u32 s47, s28, 8192
  buffer_load_dwordx4 v[104:107], v10, s[4:7], s47 offen offset:2048 sc1
  s_add_u32 s47, s28, 8192
  buffer_load_dwordx4 v[108:111], v10, s[4:7], s47 offen offset:3072 sc1
  s_add_u32 s47, s28, 12288
  buffer_load_dwordx4 v[112:115], v10, s[4:7], s47 offen offset:0 sc1
  s_add_u32 s47, s28, 12288
  buffer_load_dwordx4 v[116:119], v10, s[4:7], s47 offen offset:1024 sc1
  s_add_u32 s47, s28, 12288
  buffer_load_dwordx4 v[120:123], v10, s[4:7], s47 offen offset:2048 sc1
  s_add_u32 s47, s28, 12288
  buffer_load_dwordx4 v[124:127], v10, s[4:7], s47 offen offset:3072 sc1
  s_waitcnt vmcnt(15)
  v_mfma_f32_16x16x32_bf16 v[48:51], a[0:3], v[64:67], 0
  v_mfma_f32_16x16x32_bf16 v[52:55], a[4:7], v[64:67], 0
  s_add_u32 s47, s28, 16384
  buffer_load_dwordx4 v[64:67], v10, s[4:7], s47 offen offset:0 sc1
  s_waitcnt vmcnt(15)
  v_mfma_f32_16x16x32_bf16 v[48:51], a[8:11], v[68:71], v[48:51]
  v_mfma_f32_16x16x32_bf16 v[52:55], a[12:15], v[68:71], v[52:55]
  s_add_u32 s47, s28, 16384
  buffer_load_dwordx4 v[68:71], v10, s[4:7], s47 offen offset:1024 sc1
  s_waitcnt vmcnt(15)
  v_mfma_f32_16x16x32_bf16 v[48:51], a[16:19], v[72:75], v[48:51]
  v_mfma_f32_16x16x32_bf16 v[52:55], a[20:23], v[72:75], v[52:55]
  s_add_u32 s47, s28, 16384
  buffer_load_dwordx4 v[72:75], v10, s[4:7], s47 offen offset:2048 sc1
  s_waitcnt vmcnt(15)
  v_mfma_f32_16x16x32_bf16 v[48:51], a[24:27], v[76:79], v[48:51]
  v_mfma_f32_16x16x32_bf16 v[52:55], a[28:31], v[76:79], v[52:55]
  s_add_u32 s47, s28, 16384
  buffer_load_dwordx4 v[76:79], v10, s[4:7], s47 offen offset:3072 sc1
  s_waitcnt vmcnt(15)
  v_mfma_f32_16x16x32_bf16 v[48:51], a[32:35], v[80:83], v[48:51]
  v_mfma_f32_16x16x32_bf16 v[52:55], a[36:39], v[80:83], v[52:55]
  s_add_u32 s47, s28, 20480
  buffer_load_dwordx4 v[80:83], v10, s[4:7], s47 offen offset:0 sc1
  s_waitcnt vmcnt(15)
  v_mfma_f32_16x16x32_bf16 v[48:51], a[40:43], v[84:87], v[48:51]
  v_mfma_f32_16x16x32_bf16 v[52:55], a[44:47], v[84:87], v[52:55]
  s_add_u32 s47, s28, 20480
  buffer_load_dwordx4 v[84:87], v10, s[4:7], s47 offen offset:1024 sc1
  s_waitcnt vmcnt(15)
  v_mfma_f32_16x16x32_bf16 v[48:51], a[48:51], v[88:91], v[48:51]
  v_mfma_f32_16x16x32_bf16 v[52:55], a[52:55], v[88:91], v[52:55]
  s_add_u32 s47, s28, 20480
  buffer_load_dwordx4 v[88:91], v10, s[4:7], s47 offen offset:2048 sc1
  s_waitcnt vmcnt(15)
  v_mfma_f32_16x16x32_bf16 v[48:51], a[56:59], v[92:95], v[48:51]
  v_mfma_f32_16x16x32_bf16 v[52:55], a[60:63], v[92:95], v[52:55]
  s_add_u32 s47, s28, 20480
  buffer_load_dwordx4 v[92:95], v10, s[4:7], s47 offen offset:3072 sc1
  s_waitcnt vmcnt(15)
  v_mfma_f32_16x16x32_bf16 v[48:51], a[64:67], v[96:99], v[48:51]
  v_mfma_f32_16x16x32_bf16 v[52:55], a[68:71], v[96:99], v[52:55]
  s_add_u32 s47, s28, 24576
  buffer_load_dwordx4 v[96:99], v10, s[4:7], s47 offen offset:0 sc1
  s_waitcnt vmcnt(15)
  v_mfma_f32_16x16x32_bf16 v[48:51], a[72:75], v[100:103], v[48:51]
  v_mfma_f32_16x16x32_bf16 v[52:55], a[76:79], v[100:103], v[52:55]
  s_add_u32 s47, s28, 24576
  buffer_load_dwordx4 v[100:103], v10, s[4:7], s47 offen offset:1024 sc1
  s_waitcnt vmcnt(15)
  v_mfma_f32_16x16x32_bf16 v[48:51], a[80:83], v[104:107], v[48:51]
  v_mfma_f32_16x16x32_bf16 v[52:55], a[84:87], v[104:107], v[52:55]
  s_add_u32 s47, s28, 24576
  buffer_load_dwordx4 v[104:107], v10, s[4:7], s47 offen offset:2048 sc1
  s_waitcnt vmcnt(15)
  v_mfma_f32_16x16x32_bf16 v[48:51], a[88:91], v[108:111], v[48:51]
  v_mfma_f32_16x16x32_bf16 v[52:55], a[92:95], v[108:111], v[52:55]
  s_add_u32 s47, s28, 24576
  buffer_load_dwordx4 v[108:111], v10, s[4:7], s47 offen offset:3072 sc1
  s_waitcnt vmcnt(15)
  v_mfma_f32_16x16x32_bf16 v[48:51], a[96:99], v[112:115], v[48:51]
  v_mfma_f32_16x16x32_bf16 v[52:55], a[100:103], v[112:115], v[52:55]
  s_add_u32 s47, s28, 28672
  buffer_load_dwordx4 v[112:115], v10, s[4:7], s47 offen offset:0 sc1
  s_waitcnt vmcnt(15)
  v_mfma_f32_16x16x32_bf16 v[48:51], a[104:107], v[116:119], v[48:51]
  v_mfma_f32_16x16x32_bf16 v[52:55], a[108:111], v[116:119], v[52:55]
  s_add_u32 s47, s28, 28672
  buffer_load_dwordx4 v[116:119], v10, s[4:7], s47 offen offset:1024 sc1
  s_waitcnt vmcnt(15)
  v_mfma_f32_16x16x32_bf16 v[48:51], a[112:115], v[120:123], v[48:51]
  v_mfma_f32_16x16x32_bf16 v[52:55], a[116:119], v[120:123], v[52:55]
  s_add_u32 s47, s28, 28672
  buffer_load_dwordx4 v[120:123], v10, s[4:7], s47 offen offset:2048 sc1
  s_waitcnt vmcnt(15)
  v_mfma_f32_16x16x32_bf16 v[48:51], a[120:123], v[124:127], v[48:51]
  v_mfma_f32_16x16x32_bf16 v[52:55], a[124:127], v[124:127], v[52:55]
  s_add_u32 s47, s28, 28672
  buffer_load_dwordx4 v[124:127], v10, s[4:7], s47 offen offset:3072 sc1
  s_waitcnt vmcnt(15)
  v_mfma_f32_16x16x32_bf16 v[48:51], a[128:131], v[64:67], v[48:51]
  v_mfma_f32_16x16x32_bf16 v[52:55], a[132:135], v[64:67], v[52:55]
  s_waitcnt vmcnt(14)
  v_mfma_f32_16x16x32_bf16 v[48:51], a[136:139], v[68:71], v[48:51]
  v_mfma_f32_16x16x32_bf16 v[52:55], a[140:143], v[68:71], v[52:55]
  s_waitcnt vmcnt(13)
  v_mfma_f32_16x16x32_bf16 v[48:51], a[144:147], v[72:75], v[48:51]
  v_mfma_f32_16x16x32_bf16 v[52:55], a[148:151], v[72:75], v[52:55]
  s_waitcnt vmcnt(12)
  v_mfma_f32_16x16x32_bf16 v[48:51], a[152:155], v[76:79], v[48:51]
  v_mfma_f32_16x16x32_bf16 v[52:55], a[156:159], v[76:79], v[52:55]
  s_waitcnt vmcnt(11)
  v_mfma_f32_16x16x32_bf16 v[48:51], a[160:163], v[80:83], v[48:51]
  v_mfma_f32_16x16x32_bf16 v[52:55], a[164:167], v[80:83], v[52:55]
  s_waitcnt vmcnt(10)
  v_mfma_f32_16x16x32_bf16 v[48:51], a[168:171], v[84:87], v[48:51]
  v_mfma_f32_16x16x32_bf16 v[52:55], a[172:175], v[84:87], v[52:55]
  s_waitcnt vmcnt(9)
  v_mfma_f32_16x16x32_bf16 v[48:51], a[176:179], v[88:91], v[48:51]
  v_mfma_f32_16x16x32_bf16 v[52:55], a[180:183], v[88:91], v[52:55]
  s_waitcnt vmcnt(8)
  v_mfma_f32_16x16x32_bf16 v[48:51], a[184:187], v[92:95], v[48:51]
  v_mfma_f32_16x16x32_bf16 v[52:55], a[188:191], v[92:95], v[52:55]
  s_waitcnt vmcnt(7)
  v_mfma_f32_16x16x32_bf16 v[48:51], a[192:195], v[96:99], v[48:51]
  v_mfma_f32_16x16x32_bf16 v[52:55], a[196:199], v[96:99], v[52:55]
  s_waitcnt vmcnt(6)
  v_mfma_f32_16x16x32_bf16 v[48:51], a[200:203], v[100:103], v[48:51]
  v_mfma_f32_16x16x32_bf16 v[52:55], a[204:207], v[100:103], v[52:55]
  s_waitcnt vmcnt(5)
  v_mfma_f32_16x16x32_bf16 v[48:51], a[208:211], v[104:107], v[48:51]
  v_mfma_f32_16x16x32_bf16 v[52:55], a[212:215], v[104:107], v[52:55]
  s_waitcnt vmcnt(4)
  v_mfma_f32_16x16x32_bf16 v[48:51], a[216:219], v[108:111], v[48:51]
  v_mfma_f32_16x16x32_bf16 v[52:55], a[220:223], v[108:111], v[52:55]
  s_waitcnt vmcnt(3)
  v_mfma_f32_16x16x32_bf16 v[48:51], a[224:227], v[112:115], v[48:51]
  v_mfma_f32_16x16x32_bf16 v[52:55], a[228:231], v[112:115], v[52:55]
  s_waitcnt vmcnt(2)
  v_mfma_f32_16x16x32_bf16 v[48:51], a[232:235], v[116:119], v[48:51]
  v_mfma_f32_16x16x32_bf16 v[52:55], a[236:239], v[116:119], v[52:55]
  s_waitcnt vmcnt(1)
  v_mfma_f32_16x16x32_bf16 v[48:51], a[240:243], v[120:123], v[48:51]
  v_mfma_f32_16x16x32_bf16 v[52:55], a[244:247], v[120:123], v[52:55]
  s_waitcnt vmcnt(0)
  v_mfma_f32_16x16x32_bf16 v[48:51], a[248:251], v[124:127], v[48:51]
  v_mfma_f32_16x16x32_bf16 v[52:55], a[252:255], v[124:127], v[52:55]
  s_barrier
  s_nop 5
  ds_write_b128 v5, v[48:51] offset:0
  ds_write_b128 v5, v[52:55] offset:1024
  ds_write_b128 v5, v[32:35] offset:2048
  ds_write_b128 v5, v[36:39] offset:3072
  s_waitcnt lgkmcnt(0)
  s_barrier
  s_cmp_lg_u32 s13, 0
  s_cbranch_scc1 ONX_93
  ds_read_b128 v[64:67], v6 offset:4096
  ds_read_b128 v[68:71], v6 offset:5120
  ds_read_b128 v[72:75], v6 offset:6144
  ds_read_b128 v[76:79], v6 offset:7168
  ds_read_b128 v[80:83], v6 offset:8192
  ds_read_b128 v[84:87], v6 offset:9216
  ds_read_b128 v[88:91], v6 offset:10240
  ds_read_b128 v[92:95], v6 offset:11264
  ds_read_b128 v[96:99], v6 offset:12288
  ds_read_b128 v[100:103], v6 offset:13312
  ds_read_b128 v[104:107], v6 offset:14336
  ds_read_b128 v[108:111], v6 offset:15360
  s_waitcnt lgkmcnt(8)
  v_add_f32 v48, v48, v64
  v_add_f32 v49, v49, v65
  v_add_f32 v50, v50, v66
  v_add_f32 v51, v51, v67
  v_add_f32 v52, v52, v68
  v_add_f32 v53, v53, v69
  v_add_f32 v54, v54, v70
  v_add_f32 v55, v55, v71
  v_add_f32 v32, v32, v72
  v_add_f32 v33, v33, v73
  v_add_f32 v34, v34, v74
  v_add_f32 v35, v35, v75
  v_add_f32 v36, v36, v76
  v_add_f32 v37, v37, v77
  v_add_f32 v38, v38, v78
  v_add_f32 v39, v39, v79
  s_waitcnt lgkmcnt(4)
  v_add_f32 v48, v48, v80
  v_add_f32 v49, v49, v81
  v_add_f32 v50, v50, v82
  v_add_f32 v51, v51, v83
  v_add_f32 v52, v52, v84
  v_add_f32 v53, v53, v85
  v_add_f32 v54, v54, v86
  v_add_f32 v55, v55, v87
  v_add_f32 v32, v32, v88
  v_add_f32 v33, v33, v89
  v_add_f32 v34, v34, v90
  v_add_f32 v35, v35, v91
  v_add_f32 v36, v36, v92
  v_add_f32 v37, v37, v93
  v_add_f32 v38, v38, v94
  v_add_f32 v39, v39, v95
  s_waitcnt lgkmcnt(0)
  v_add_f32 v48, v48, v96
  v_add_f32 v49, v49, v97
  v_add_f32 v50, v50, v98
  v_add_f32 v51, v51, v99
  v_add_f32 v52, v52, v100
  v_add_f32 v53, v53, v101
  v_add_f32 v54, v54, v102
  v_add_f32 v55, v55, v103
  v_add_f32 v32, v32, v104
  v_add_f32 v33, v33, v105
  v_add_f32 v34, v34, v106
  v_add_f32 v35, v35, v107
  v_add_f32 v36, v36, v108
  v_add_f32 v37, v37, v109
  v_add_f32 v38, v38, v110
  v_add_f32 v39, v39, v111
  s_waitcnt vmcnt(46)
  v_cvt_pk_bf16_f32 v16, v48, v49
  v_cvt_pk_bf16_f32 v17, v32, v33
  v_lshlrev_b32 v18, 16, v16
  v_and_b32 v19, 0xffff0000, v16
  v_lshlrev_b32 v20, 16, v12
  v_and_b32 v21, 0xffff0000, v12
  v_add_f32 v18, v18, v20
  v_add_f32 v19, v19, v21
  v_cvt_pk_bf16_f32 v16, v18, v19
  v_lshlrev_b32 v18, 16, v16
  v_and_b32 v19, 0xffff0000, v16
  v_lshlrev_b32 v20, 16, v17
  v_and_b32 v21, 0xffff0000, v17
  v_add_f32 v18, v18, v20
  v_add_f32 v19, v19, v21
  v_cvt_pk_bf16_f32 v24, v18, v19
  v_cvt_pk_bf16_f32 v16, v50, v51
  v_cvt_pk_bf16_f32 v17, v34, v35
  v_lshlrev_b32 v18, 16, v16
  v_and_b32 v19, 0xffff0000, v16
  v_lshlrev_b32 v20, 16, v13
  v_and_b32 v21, 0xffff0000, v13
  v_add_f32 v18, v18, v20
  v_add_f32 v19, v19, v21
  v_cvt_pk_bf16_f32 v16, v18, v19
  v_lshlrev_b32 v18, 16, v16
  v_and_b32 v19, 0xffff0000, v16
  v_lshlrev_b32 v20, 16, v17
  v_and_b32 v21, 0xffff0000, v17
  v_add_f32 v18, v18, v20
  v_add_f32 v19, v19, v21
  v_cvt_pk_bf16_f32 v25, v18, v19
  v_cvt_pk_bf16_f32 v16, v52, v53
  v_cvt_pk_bf16_f32 v17, v36, v37
  v_lshlrev_b32 v18, 16, v16
  v_and_b32 v19, 0xffff0000, v16
  v_lshlrev_b32 v20, 16, v14
  v_and_b32 v21, 0xffff0000, v14
  v_add_f32 v18, v18, v20
  v_add_f32 v19, v19, v21
  v_cvt_pk_bf16_f32 v16, v18, v19
  v_lshlrev_b32 v18, 16, v16
  v_and_b32 v19, 0xffff0000, v16
  v_lshlrev_b32 v20, 16, v17
  v_and_b32 v21, 0xffff0000, v17
  v_add_f32 v18, v18, v20
  v_add_f32 v19, v19, v21
  v_cvt_pk_bf16_f32 v26, v18, v19
  v_cvt_pk_bf16_f32 v16, v54, v55
  v_cvt_pk_bf16_f32 v17, v38, v39
  v_lshlrev_b32 v18, 16, v16
  v_and_b32 v19, 0xffff0000, v16
  v_lshlrev_b32 v20, 16, v15
  v_and_b32 v21, 0xffff0000, v15
  v_add_f32 v18, v18, v20
  v_add_f32 v19, v19, v21
  v_cvt_pk_bf16_f32 v16, v18, v19
  v_lshlrev_b32 v18, 16, v16
  v_and_b32 v19, 0xffff0000, v16
  v_lshlrev_b32 v20, 16, v17
  v_and_b32 v21, 0xffff0000, v17
  v_add_f32 v18, v18, v20
  v_add_f32 v19, v19, v21
  v_cvt_pk_bf16_f32 v27, v18, v19
  s_mul_i32 s47, s22, 20480
  buffer_store_dwordx4 v[24:27], v7, s[16:19], s47 offen
ONX_93:
  s_add_u32 s22, s22, 4
  s_cmp_lt_u32 s22, 124
  s_cbranch_scc1 OUT_86
  s_branch OUF_85
OUX_84:
  s_cmp_lg_u32 s13, 0
  s_cbranch_scc1 OUB_95
  v_mov_b32 v8, 15744
OUW_94:
  buffer_load_dword v9, v8, s[4:7], 0 offen sc1
  s_sub_u32 s74, s74, 1
  s_cbranch_scc1 L_TIMEOUT
  s_waitcnt vmcnt(0)
  v_cmp_gt_u32 vcc, 32, v9
  s_nop 0
  s_cbranch_vccz OUK_96
  s_sleep 100
  s_branch OUW_94
OUK_96:
OUB_95:
  s_barrier
OUF_85:
  s_and_b32 s31, s30, 1
  v_and_b32 v3, 7, v2
  s_lshl_b32 s47, s31, 3
  v_add_u32 v3, s47, v3
  s_movk_i32 s47, 1280
  v_mul_lo_u32 v3, v3, s47
  v_lshrrev_b32 v8, 4, v2
  v_lshl_add_u32 v3, v8, 4, v3
  s_lshl_b32 s47, s21, 6
  v_add_u32 v3, s47, v3
  v_bfe_u32 v8, v2, 3, 1
  v_lshlrev_b32 v8, 30, v8
  v_or_b32 v7, v3, v8
  v_bfe_u32 v10, v2, 3, 1
  v_lshlrev_b32 v10, 10, v10
  v_lshrrev_b32 v11, 4, v2
  v_lshl_add_u32 v10, v11, 8, v10
  v_and_b32 v11, 7, v2
  v_lshl_add_u32 v10, v11, 4, v10
  s_lshl_b32 s47, s31, 7
  v_add_u32 v10, s47, v10
  s_lshr_b32 s22, s30, 1
  s_add_u32 s22, s22, 124
  s_lshr_b32 s27, s22, 1
  s_lshr_b32 s47, s27, 4
  s_add_u32 s49, s47, 1
  s_cmp_ge_u32 s32, s49
  s_cbranch_scc1 OPK_97
  s_lshl_b32 s47, s47, 5
  s_add_u32 s47, s47, 768
  v_add_u32 v8, s47, v4
  s_and_b32 s48, s27, 15
  s_add_u32 s48, s48, 1
OP1_98:
  buffer_load_dword v9, v8, s[4:7], 0 offen sc1
  s_sub_u32 s74, s74, 1
  s_cbranch_scc1 L_TIMEOUT
  s_waitcnt vmcnt(0)
  v_cmp_gt_u32 vcc, s48, v9
  s_nop 0
  s_cbranch_vccz BK_99
  s_sleep 2
  s_branch OP1_98
BK_99:
  v_cmp_gt_u32 vcc, 16, v9
  s_nop 0
  s_cbranch_vccnz OPK_97
  s_mov_b32 s32, s49
OPK_97:
  s_mul_i32 s47, s22, 20480
  buffer_load_dwordx4 v[12:15], v3, s[8:11], s47 offen
  s_mul_i32 s29, s22, 57344
  s_add_u32 s29, s29, 83886080
  s_mul_i32 s47, s13, 14
  s_add_u32 s47, s47, 0
  s_min_u32 s47, s47, 52
  s_lshl_b32 s47, s47, 10
  s_add_u32 s47, s47, s29
  buffer_load_dwordx4 v[64:67], v10, s[4:7], s47 offen sc1
  s_mul_i32 s47, s13, 14
  s_add_u32 s47, s47, 2
  s_min_u32 s47, s47, 52
  s_lshl_b32 s47, s47, 10
  s_add_u32 s47, s47, s29
  buffer_load_dwordx4 v[68:71], v10, s[4:7], s47 offen sc1
  s_mul_i32 s47, s13, 14
  s_add_u32 s47, s47, 4
  s_min_u32 s47, s47, 52
  s_lshl_b32 s47, s47, 10
  s_add_u32 s47, s47, s29
  buffer_load_dwordx4 v[72:75], v10, s[4:7], s47 offen sc1
  s_mul_i32 s47, s13, 14
  s_add_u32 s47, s47, 6
  s_min_u32 s47, s47, 52
  s_lshl_b32 s47, s47, 10
  s_add_u32 s47, s47, s29
  buffer_load_dwordx4 v[76:79], v10, s[4:7], s47 offen sc1
  s_mul_i32 s47, s13, 14
  s_add_u32 s47, s47, 8
  s_min_u32 s47, s47, 52
  s_lshl_b32 s47, s47, 10
  s_add_u32 s47, s47, s29
  buffer_load_dwordx4 v[80:83], v10, s[4:7], s47 offen sc1
  s_mul_i32 s47, s13, 14
  s_add_u32 s47, s47, 10
  s_min_u32 s47, s47, 52
  s_lshl_b32 s47, s47, 10
  s_add_u32 s47, s47, s29
  buffer_load_dwordx4 v[84:87], v10, s[4:7], s47 offen sc1
  s_mul_i32 s47, s13, 14
  s_add_u32 s47, s47, 12
  s_min_u32 s47, s47, 52
  s_lshl_b32 s47, s47, 10
  s_add_u32 s47, s47, s29
  buffer_load_dwordx4 v[88:91], v10, s[4:7], s47 offen sc1
  s_waitcnt vmcnt(6)
  v_mfma_f32_16x16x32_bf16 v[32:35], v[144:147], v[64:67], 0
  v_mfma_f32_16x16x32_bf16 v[36:39], v[148:151], v[64:67], 0
  v_mfma_f32_16x16x32_bf16 v[40:43], v[152:155], v[64:67], 0
  v_mfma_f32_16x16x32_bf16 v[44:47], v[156:159], v[64:67], 0
  s_waitcnt vmcnt(5)
  v_mfma_f32_16x16x32_bf16 v[32:35], v[160:163], v[68:71], v[32:35]
  v_mfma_f32_16x16x32_bf16 v[36:39], v[164:167], v[68:71], v[36:39]
  v_mfma_f32_16x16x32_bf16 v[40:43], v[168:171], v[68:71], v[40:43]
  v_mfma_f32_16x16x32_bf16 v[44:47], v[172:175], v[68:71], v[44:47]
  s_waitcnt vmcnt(4)
  v_mfma_f32_16x16x32_bf16 v[32:35], v[176:179], v[72:75], v[32:35]
  v_mfma_f32_16x16x32_bf16 v[36:39], v[180:183], v[72:75], v[36:39]
  v_mfma_f32_16x16x32_bf16 v[40:43], v[184:187], v[72:75], v[40:43]
  v_mfma_f32_16x16x32_bf16 v[44:47], v[188:191], v[72:75], v[44:47]
  s_waitcnt vmcnt(3)
  v_mfma_f32_16x16x32_bf16 v[32:35], v[192:195], v[76:79], v[32:35]
  v_mfma_f32_16x16x32_bf16 v[36:39], v[196:199], v[76:79], v[36:39]
  v_mfma_f32_16x16x32_bf16 v[40:43], v[200:203], v[76:79], v[40:43]
  v_mfma_f32_16x16x32_bf16 v[44:47], v[204:207], v[76:79], v[44:47]
  s_waitcnt vmcnt(2)
  v_mfma_f32_16x16x32_bf16 v[32:35], v[208:211], v[80:83], v[32:35]
  v_mfma_f32_16x16x32_bf16 v[36:39], v[212:215], v[80:83], v[36:39]
  v_mfma_f32_16x16x32_bf16 v[40:43], v[216:219], v[80:83], v[40:43]
  v_mfma_f32_16x16x32_bf16 v[44:47], v[220:223], v[80:83], v[44:47]
  s_waitcnt vmcnt(1)
  v_mfma_f32_16x16x32_bf16 v[32:35], v[224:227], v[84:87], v[32:35]
  v_mfma_f32_16x16x32_bf16 v[36:39], v[228:231], v[84:87], v[36:39]
  v_mfma_f32_16x16x32_bf16 v[40:43], v[232:235], v[84:87], v[40:43]
  v_mfma_f32_16x16x32_bf16 v[44:47], v[236:239], v[84:87], v[44:47]
  s_waitcnt vmcnt(0)
  v_mfma_f32_16x16x32_bf16 v[32:35], v[240:243], v[88:91], v[32:35]
  v_mfma_f32_16x16x32_bf16 v[36:39], v[244:247], v[88:91], v[36:39]
  v_mfma_f32_16x16x32_bf16 v[40:43], v[248:251], v[88:91], v[40:43]
  v_mfma_f32_16x16x32_bf16 v[44:47], v[252:255], v[88:91], v[44:47]
  s_lshl_b32 s47, s27, 7
  s_add_u32 s47, s47, 8192
  s_mov_b32 s50, 32
  s_cmp_lg_u32 s13, 0
  s_cbranch_scc1 OPW_100
  v_mov_b32 v8, s47
OP2_101:
  buffer_load_dword v9, v8, s[4:7], 0 offen sc1
  s_sub_u32 s74, s74, 1
  s_cbranch_scc1 L_TIMEOUT
  s_waitcnt vmcnt(0)
  v_cmp_gt_u32 vcc, s50, v9
  s_nop 0
  s_cbranch_vccz BK_102
  s_sleep 2
  s_branch OP2_101
BK_102:
OPW_100:
  s_barrier
  s_lshl_b32 s28, s22, 7
  s_lshl_b32 s47, s13, 5
  s_add_u32 s28, s28, s47
  s_lshl_b32 s28, s28, 10
  s_add_u32 s28, s28, 100663296
  s_add_u32 s47, s28, 0
  buffer_load_dwordx4 v[64:67], v10, s[4:7], s47 offen offset:0 sc1
  s_add_u32 s47, s28, 0
  buffer_load_dwordx4 v[68:71], v10, s[4:7], s47 offen offset:2048 sc1
  s_add_u32 s47, s28, 4096
  buffer_load_dwordx4 v[72:75], v10, s[4:7], s47 offen offset:0 sc1
  s_add_u32 s47, s28, 4096
  buffer_load_dwordx4 v[76:79], v10, s[4:7], s47 offen offset:2048 sc1
  s_add_u32 s47, s28, 8192
  buffer_load_dwordx4 v[80:83], v10, s[4:7], s47 offen offset:0 sc1
  s_add_u32 s47, s28, 8192
  buffer_load_dwordx4 v[84:87], v10, s[4:7], s47 offen offset:2048 sc1
  s_add_u32 s47, s28, 12288
  buffer_load_dwordx4 v[88:91], v10, s[4:7], s47 offen offset:0 sc1
  s_add_u32 s47, s28, 12288
  buffer_load_dwordx4 v[92:95], v10, s[4:7], s47 offen offset:2048 sc1
  s_add_u32 s47, s28, 16384
  buffer_load_dwordx4 v[96:99], v10, s[4:7], s47 offen offset:0 sc1
  s_add_u32 s47, s28, 16384
  buffer_load_dwordx4 v[100:103], v10, s[4:7], s47 offen offset:2048 sc1
  s_add_u32 s47, s28, 20480
  buffer_load_dwordx4 v[104:107], v10, s[4:7], s47 offen offset:0 sc1
  s_add_u32 s47, s28, 20480
  buffer_load_dwordx4 v[108:111], v10, s[4:7], s47 offen offset:2048 sc1
  s_add_u32 s47, s28, 24576
  buffer_load_dwordx4 v[112:115], v10, s[4:7], s47 offen offset:0 sc1
  s_add_u32 s47, s28, 24576
  buffer_load_dwordx4 v[116:119], v10, s[4:7], s47 offen offset:2048 sc1
  s_add_u32 s47, s28, 28672
  buffer_load_dwordx4 v[120:123], v10, s[4:7], s47 offen offset:0 sc1
  s_add_u32 s47, s28, 28672
  buffer_load_dwordx4 v[124:127], v10, s[4:7], s47 offen offset:2048 sc1
  s_waitcnt vmcnt(15)
  v_mfma_f32_16x16x32_bf16 v[48:51], a[0:3], v[64:67], 0
  v_mfma_f32_16x16x32_bf16 v[52:55], a[4:7], v[64:67], 0
  v_mfma_f32_16x16x32_bf16 v[56:59], a[8:11], v[64:67], 0
  v_mfma_f32_16x16x32_bf16 v[60:63], a[12:15], v[64:67], 0
  s_waitcnt vmcnt(14)
  v_mfma_f32_16x16x32_bf16 v[48:51], a[16:19], v[68:71], v[48:51]
  v_mfma_f32_16x16x32_bf16 v[52:55], a[20:23], v[68:71], v[52:55]
  v_mfma_f32_16x16x32_bf16 v[56:59], a[24:27], v[68:71], v[56:59]
  v_mfma_f32_16x16x32_bf16 v[60:63], a[28:31], v[68:71], v[60:63]
  s_waitcnt vmcnt(13)
  v_mfma_f32_16x16x32_bf16 v[48:51], a[32:35], v[72:75], v[48:51]
  v_mfma_f32_16x16x32_bf16 v[52:55], a[36:39], v[72:75], v[52:55]
  v_mfma_f32_16x16x32_bf16 v[56:59], a[40:43], v[72:75], v[56:59]
  v_mfma_f32_16x16x32_bf16 v[60:63], a[44:47], v[72:75], v[60:63]
  s_waitcnt vmcnt(12)
  v_mfma_f32_16x16x32_bf16 v[48:51], a[48:51], v[76:79], v[48:51]
  v_mfma_f32_16x16x32_bf16 v[52:55], a[52:55], v[76:79], v[52:55]
  v_mfma_f32_16x16x32_bf16 v[56:59], a[56:59], v[76:79], v[56:59]
  v_mfma_f32_16x16x32_bf16 v[60:63], a[60:63], v[76:79], v[60:63]
  s_waitcnt vmcnt(11)
  v_mfma_f32_16x16x32_bf16 v[48:51], a[64:67], v[80:83], v[48:51]
  v_mfma_f32_16x16x32_bf16 v[52:55], a[68:71], v[80:83], v[52:55]
  v_mfma_f32_16x16x32_bf16 v[56:59], a[72:75], v[80:83], v[56:59]
  v_mfma_f32_16x16x32_bf16 v[60:63], a[76:79], v[80:83], v[60:63]
  s_waitcnt vmcnt(10)
  v_mfma_f32_16x16x32_bf16 v[48:51], a[80:83], v[84:87], v[48:51]
  v_mfma_f32_16x16x32_bf16 v[52:55], a[84:87], v[84:87], v[52:55]
  v_mfma_f32_16x16x32_bf16 v[56:59], a[88:91], v[84:87], v[56:59]
  v_mfma_f32_16x16x32_bf16 v[60:63], a[92:95], v[84:87], v[60:63]
  s_waitcnt vmcnt(9)
  v_mfma_f32_16x16x32_bf16 v[48:51], a[96:99], v[88:91], v[48:51]
  v_mfma_f32_16x16x32_bf16 v[52:55], a[100:103], v[88:91], v[52:55]
  v_mfma_f32_16x16x32_bf16 v[56:59], a[104:107], v[88:91], v[56:59]
  v_mfma_f32_16x16x32_bf16 v[60:63], a[108:111], v[88:91], v[60:63]
  s_waitcnt vmcnt(8)
  v_mfma_f32_16x16x32_bf16 v[48:51], a[112:115], v[92:95], v[48:51]
  v_mfma_f32_16x16x32_bf16 v[52:55], a[116:119], v[92:95], v[52:55]
  v_mfma_f32_16x16x32_bf16 v[56:59], a[120:123], v[92:95], v[56:59]
  v_mfma_f32_16x16x32_bf16 v[60:63], a[124:127], v[92:95], v[60:63]
  s_waitcnt vmcnt(7)
  v_mfma_f32_16x16x32_bf16 v[48:51], a[128:131], v[96:99], v[48:51]
  v_mfma_f32_16x16x32_bf16 v[52:55], a[132:135], v[96:99], v[52:55]
  v_mfma_f32_16x16x32_bf16 v[56:59], a[136:139], v[96:99], v[56:59]
  v_mfma_f32_16x16x32_bf16 v[60:63], a[140:143], v[96:99], v[60:63]
  s_waitcnt vmcnt(6)
  v_mfma_f32_16x16x32_bf16 v[48:51], a[144:147], v[100:103], v[48:51]
  v_mfma_f32_16x16x32_bf16 v[52:55], a[148:151], v[100:103], v[52:55]
  v_mfma_f32_16x16x32_bf16 v[56:59], a[152:155], v[100:103], v[56:59]
  v_mfma_f32_16x16x32_bf16 v[60:63], a[156:159], v[100:103], v[60:63]
  s_waitcnt vmcnt(5)
  v_mfma_f32_16x16x32_bf16 v[48:51], a[160:163], v[104:107], v[48:51]
  v_mfma_f32_16x16x32_bf16 v[52:55], a[164:167], v[104:107], v[52:55]
  v_mfma_f32_16x16x32_bf16 v[56:59], a[168:171], v[104:107], v[56:59]
  v_mfma_f32_16x16x32_bf16 v[60:63], a[172:175], v[104:107], v[60:63]
  s_waitcnt vmcnt(4)
  v_mfma_f32_16x16x32_bf16 v[48:51], a[176:179], v[108:111], v[48:51]
  v_mfma_f32_16x16x32_bf16 v[52:55], a[180:183], v[108:111], v[52:55]
  v_mfma_f32_16x16x32_bf16 v[56:59], a[184:187], v[108:111], v[56:59]
  v_mfma_f32_16x16x32_bf16 v[60:63], a[188:191], v[108:111], v[60:63]
  s_waitcnt vmcnt(3)
  v_mfma_f32_16x16x32_bf16 v[48:51], a[192:195], v[112:115], v[48:51]
  v_mfma_f32_16x16x32_bf16 v[52:55], a[196:199], v[112:115], v[52:55]
  v_mfma_f32_16x16x32_bf16 v[56:59], a[200:203], v[112:115], v[56:59]
  v_mfma_f32_16x16x32_bf16 v[60:63], a[204:207], v[112:115], v[60:63]
  s_waitcnt vmcnt(2)
  v_mfma_f32_16x16x32_bf16 v[48:51], a[208:211], v[116:119], v[48:51]
  v_mfma_f32_16x16x32_bf16 v[52:55], a[212:215], v[116:119], v[52:55]
  v_mfma_f32_16x16x32_bf16 v[56:59], a[216:219], v[116:119], v[56:59]
  v_mfma_f32_16x16x32_bf16 v[60:63], a[220:223], v[116:119], v[60:63]
  s_waitcnt vmcnt(1)
  v_mfma_f32_16x16x32_bf16 v[48:51], a[224:227], v[120:123], v[48:51]
  v_mfma_f32_16x16x32_bf16 v[52:55], a[228:231], v[120:123], v[52:55]
  v_mfma_f32_16x16x32_bf16 v[56:59], a[232:235], v[120:123], v[56:59]
  v_mfma_f32_16x16x32_bf16 v[60:63], a[236:239], v[120:123], v[60:63]
  s_waitcnt vmcnt(0)
  v_mfma_f32_16x16x32_bf16 v[48:51], a[240:243], v[124:127], v[48:51]
  v_mfma_f32_16x16x32_bf16 v[52:55], a[244:247], v[124:127], v[52:55]
  v_mfma_f32_16x16x32_bf16 v[56:59], a[248:251], v[124:127], v[56:59]
  v_mfma_f32_16x16x32_bf16 v[60:63], a[252:255], v[124:127], v[60:63]
  s_nop 6
  v_add_f32_dpp v48, v56, v48 row_ror:8 row_mask:0xf bank_mask:0xf
  v_add_f32_dpp v49, v57, v49 row_ror:8 row_mask:0xf bank_mask:0xf
  v_add_f32_dpp v50, v58, v50 row_ror:8 row_mask:0xf bank_mask:0xf
  v_add_f32_dpp v51, v59, v51 row_ror:8 row_mask:0xf bank_mask:0xf
  v_add_f32_dpp v52, v60, v52 row_ror:8 row_mask:0xf bank_mask:0xf
  v_add_f32_dpp v53, v61, v53 row_ror:8 row_mask:0xf bank_mask:0xf
  v_add_f32_dpp v54, v62, v54 row_ror:8 row_mask:0xf bank_mask:0xf
  v_add_f32_dpp v55, v63, v55 row_ror:8 row_mask:0xf bank_mask:0xf
  v_add_f32_dpp v32, v40, v32 row_ror:8 row_mask:0xf bank_mask:0xf
  v_add_f32_dpp v33, v41, v33 row_ror:8 row_mask:0xf bank_mask:0xf
  v_add_f32_dpp v34, v42, v34 row_ror:8 row_mask:0xf bank_mask:0xf
  v_add_f32_dpp v35, v43, v35 row_ror:8 row_mask:0xf bank_mask:0xf
  v_add_f32_dpp v36, v44, v36 row_ror:8 row_mask:0xf bank_mask:0xf
  v_add_f32_dpp v37, v45, v37 row_ror:8 row_mask:0xf bank_mask:0xf
  v_add_f32_dpp v38, v46, v38 row_ror:8 row_mask:0xf bank_mask:0xf
  v_add_f32_dpp v39, v47, v39 row_ror:8 row_mask:0xf bank_mask:0xf
  s_barrier
  ds_write_b128 v5, v[48:51] offset:0
  ds_write_b128 v5, v[52:55] offset:1024
  ds_write_b128 v5, v[32:35] offset:2048
  ds_write_b128 v5, v[36:39] offset:3072
  s_waitcnt lgkmcnt(0)
  s_barrier
  s_cmp_lg_u32 s13, 0
  s_cbranch_scc1 ONX_103
  ds_read_b128 v[64:67], v6 offset:4096
  ds_read_b128 v[68:71], v6 offset:5120
  ds_read_b128 v[72:75], v6 offset:6144
  ds_read_b128 v[76:79], v6 offset:7168
  ds_read_b128 v[80:83], v6 offset:8192
  ds_read_b128 v[84:87], v6 offset:9216
  ds_read_b128 v[88:91], v6 offset:10240
  ds_read_b128 v[92:95], v6 offset:11264
  ds_read_b128 v[96:99], v6 offset:12288
  ds_read_b128 v[100:103], v6 offset:13312
  ds_read_b128 v[104:107], v6 offset:14336
  ds_read_b128 v[108:111], v6 offset:15360
  s_waitcnt lgkmcnt(8)
  v_add_f32 v48, v48, v64
  v_add_f32 v49, v49, v65
  v_add_f32 v50, v50, v66
  v_add_f32 v51, v51, v67
  v_add_f32 v52, v52, v68
  v_add_f32 v53, v53, v69
  v_add_f32 v54, v54, v70
  v_add_f32 v55, v55, v71
  v_add_f32 v32, v32, v72
  v_add_f32 v33, v33, v73
  v_add_f32 v34, v34, v74
  v_add_f32 v35, v35, v75
  v_add_f32 v36, v36, v76
  v_add_f32 v37, v37, v77
  v_add_f32 v38, v38, v78
  v_add_f32 v39, v39, v79
  s_waitcnt lgkmcnt(4)
  v_add_f32 v48, v48, v80
  v_add_f32 v49, v49, v81
  v_add_f32 v50, v50, v82
  v_add_f32 v51, v51, v83
  v_add_f32 v52, v52, v84
  v_add_f32 v53, v53, v85
  v_add_f32 v54, v54, v86
  v_add_f32 v55, v55, v87
  v_add_f32 v32, v32, v88
  v_add_f32 v33, v33, v89
  v_add_f32 v34, v34, v90
  v_add_f32 v35, v35, v91
  v_add_f32 v36, v36, v92
  v_add_f32 v37, v37, v93
  v_add_f32 v38, v38, v94
  v_add_f32 v39, v39, v95
  s_waitcnt lgkmcnt(0)
  v_add_f32 v48, v48, v96
  v_add_f32 v49, v49, v97
  v_add_f32 v50, v50, v98
  v_add_f32 v51, v51, v99
  v_add_f32 v52, v52, v100
  v_add_f32 v53, v53, v101
  v_add_f32 v54, v54, v102
  v_add_f32 v55, v55, v103
  v_add_f32 v32, v32, v104
  v_add_f32 v33, v33, v105
  v_add_f32 v34, v34, v106
  v_add_f32 v35, v35, v107
  v_add_f32 v36, v36, v108
  v_add_f32 v37, v37, v109
  v_add_f32 v38, v38, v110
  v_add_f32 v39, v39, v111
  s_waitcnt vmcnt(23)
  v_cvt_pk_bf16_f32 v16, v48, v49
  v_cvt_pk_bf16_f32 v17, v32, v33
  v_lshlrev_b32 v18, 16, v16
  v_and_b32 v19, 0xffff0000, v16
  v_lshlrev_b32 v20, 16, v12
  v_and_b32 v21, 0xffff0000, v12
  v_add_f32 v18, v18, v20
  v_add_f32 v19, v19, v21
  v_cvt_pk_bf16_f32 v16, v18, v19
  v_lshlrev_b32 v18, 16, v16
  v_and_b32 v19, 0xffff0000, v16
  v_lshlrev_b32 v20, 16, v17
  v_and_b32 v21, 0xffff0000, v17
  v_add_f32 v18, v18, v20
  v_add_f32 v19, v19, v21
  v_cvt_pk_bf16_f32 v24, v18, v19
  v_cvt_pk_bf16_f32 v16, v50, v51
  v_cvt_pk_bf16_f32 v17, v34, v35
  v_lshlrev_b32 v18, 16, v16
  v_and_b32 v19, 0xffff0000, v16
  v_lshlrev_b32 v20, 16, v13
  v_and_b32 v21, 0xffff0000, v13
  v_add_f32 v18, v18, v20
  v_add_f32 v19, v19, v21
  v_cvt_pk_bf16_f32 v16, v18, v19
  v_lshlrev_b32 v18, 16, v16
  v_and_b32 v19, 0xffff0000, v16
  v_lshlrev_b32 v20, 16, v17
  v_and_b32 v21, 0xffff0000, v17
  v_add_f32 v18, v18, v20
  v_add_f32 v19, v19, v21
  v_cvt_pk_bf16_f32 v25, v18, v19
  v_cvt_pk_bf16_f32 v16, v52, v53
  v_cvt_pk_bf16_f32 v17, v36, v37
  v_lshlrev_b32 v18, 16, v16
  v_and_b32 v19, 0xffff0000, v16
  v_lshlrev_b32 v20, 16, v14
  v_and_b32 v21, 0xffff0000, v14
  v_add_f32 v18, v18, v20
  v_add_f32 v19, v19, v21
  v_cvt_pk_bf16_f32 v16, v18, v19
  v_lshlrev_b32 v18, 16, v16
  v_and_b32 v19, 0xffff0000, v16
  v_lshlrev_b32 v20, 16, v17
  v_and_b32 v21, 0xffff0000, v17
  v_add_f32 v18, v18, v20
  v_add_f32 v19, v19, v21
  v_cvt_pk_bf16_f32 v26, v18, v19
  v_cvt_pk_bf16_f32 v16, v54, v55
  v_cvt_pk_bf16_f32 v17, v38, v39
  v_lshlrev_b32 v18, 16, v16
  v_and_b32 v19, 0xffff0000, v16
  v_lshlrev_b32 v20, 16, v15
  v_and_b32 v21, 0xffff0000, v15
  v_add_f32 v18, v18, v20
  v_add_f32 v19, v19, v21
  v_cvt_pk_bf16_f32 v16, v18, v19
  v_lshlrev_b32 v18, 16, v16
  v_and_b32 v19, 0xffff0000, v16
  v_lshlrev_b32 v20, 16, v17
  v_and_b32 v21, 0xffff0000, v17
  v_add_f32 v18, v18, v20
  v_add_f32 v19, v19, v21
  v_cvt_pk_bf16_f32 v27, v18, v19
  s_mul_i32 s47, s22, 20480
  buffer_store_dwordx4 v[24:27], v7, s[16:19], s47 offen
ONX_103:
  s_waitcnt vmcnt(0)
  s_branch L_DONE
RA_81:
  s_lshl_b32 s20, s84, 3
  s_add_u32 s20, s20, s85
  s_sub_u32 s20, s20, 20
  s_barrier
  s_mov_b32 s88, 0x3e0293ee
  s_mov_b32 s89, 0x3f803f80
  s_mov_b32 s90, 0x3f003f00
  v_and_b32 v2, 63, v0
  v_lshlrev_b32 v1, 4, v2
  v_and_b32 v3, 15, v2
  v_lshrrev_b32 v4, 4, v2
  v_lshl_add_u32 v5, v4, 2, 0
  v_cmp_le_u32 s[36:37], v5, v3
  v_lshl_add_u32 v5, v4, 2, 1
  v_cmp_le_u32 s[38:39], v5, v3
  v_lshl_add_u32 v5, v4, 2, 2
  v_cmp_le_u32 s[40:41], v5, v3
  v_lshl_add_u32 v5, v4, 2, 3
  v_cmp_le_u32 s[42:43], v5, v3
  v_cmp_gt_u32 s[44:45], 32, v2
  v_cmp_le_u32 s[52:53], 32, v2
  v_lshrrev_b32 v5, 1, v4
  v_lshl_add_u32 v5, v5, 4, v3
  v_lshlrev_b32 v5, 4, v5
  v_and_b32 v6, 1, v4
  v_lshl_add_u32 v6, v6, 3, v5
  s_lshl_b32 s47, s13, 11
  v_add_u32 v6, s47, v6
  v_lshrrev_b32 v5, 2, v3
  v_lshl_add_u32 v5, v4, 3, v5
  v_lshlrev_b32 v5, 4, v5
  v_and_b32 v7, 1, v3
  v_lshl_add_u32 v7, v7, 3, v5
  v_add_u32 v7, s47, v7
  s_and_b32 s22, s20, 7
  s_lshl_b32 s22, s22, 2
  s_add_u32 s22, s22, s13
  s_lshr_b32 s21, s20, 3
  v_and_b32 v8, 3, v2
ATT_104:
  s_lshr_b32 s48, s21, 4
  s_lshl_b32 s48, s48, 6
  s_lshr_b32 s49, s22, 1
  s_lshl_b32 s49, s49, 2
  s_add_u32 s48, s48, s49
  s_add_u32 s49, s48, 0
  v_mov_b32 v9, s49
  s_add_u32 s49, s48, 256
  v_mov_b32 v10, s49
  v_cmp_eq_u32 vcc, 2, v8
  s_nop 1
  v_cndmask_b32 v9, v9, v10, vcc
  s_add_u32 s49, s48, 512
  v_mov_b32 v10, s49
  v_cmp_eq_u32 vcc, 3, v8
  s_nop 1
  v_cndmask_b32 v9, v9, v10, vcc
  s_and_b32 s47, s21, 15
  s_add_u32 s47, s47, 1
ATP_106:
  buffer_load_dword v10, v9, s[4:7], 0 offen sc1
  s_sub_u32 s74, s74, 1
  s_cbranch_scc1 L_TIMEOUT
  s_waitcnt vmcnt(0)
  v_cmp_gt_u32 vcc, s47, v10
  s_nop 0
  s_cbranch_vccz BK_107
  s_sleep 2
  s_branch ATP_106
BK_107:
  s_lshl_b32 s23, s21, 5
  s_add_u32 s23, s23, s22
  s_lshl_b32 s48, s23, 13
  s_add_u32 s47, s48, 50331648
  buffer_load_dwordx4 v[32:35], v1, s[4:7], s47 offen offset:0 sc1
  buffer_load_dwordx4 v[36:39], v1, s[4:7], s47 offen offset:1024 sc1
  buffer_load_dwordx4 v[40:43], v1, s[4:7], s47 offen offset:2048 sc1
  buffer_load_dwordx4 v[44:47], v1, s[4:7], s47 offen offset:3072 sc1
  s_add_u32 s47, s48, 50335744
  buffer_load_dwordx4 v[48:51], v1, s[4:7], s47 offen offset:0 sc1
  buffer_load_dwordx4 v[52:55], v1, s[4:7], s47 offen offset:1024 sc1
  buffer_load_dwordx4 v[56:59], v1, s[4:7], s47 offen offset:2048 sc1
  buffer_load_dwordx4 v[60:63], v1, s[4:7], s47 offen offset:3072 sc1
  s_add_u32 s47, s48, 16777216
  buffer_load_dwordx4 v[64:67], v1, s[4:7], s47 offen offset:0 sc1
  buffer_load_dwordx4 v[68:71], v1, s[4:7], s47 offen offset:1024 sc1
  buffer_load_dwordx4 v[72:75], v1, s[4:7], s47 offen offset:2048 sc1
  buffer_load_dwordx4 v[76:79], v1, s[4:7], s47 offen offset:3072 sc1
  s_add_u32 s47, s48, 16781312
  buffer_load_dwordx4 v[80:83], v1, s[4:7], s47 offen offset:0 sc1
  buffer_load_dwordx4 v[84:87], v1, s[4:7], s47 offen offset:1024 sc1
  buffer_load_dwordx4 v[88:91], v1, s[4:7], s47 offen offset:2048 sc1
  buffer_load_dwordx4 v[92:95], v1, s[4:7], s47 offen offset:3072 sc1
  s_add_u32 s47, s48, 33554432
  buffer_load_dwordx4 v[96:99], v1, s[4:7], s47 offen offset:0 sc1
  buffer_load_dwordx4 v[100:103], v1, s[4:7], s47 offen offset:1024 sc1
  buffer_load_dwordx4 v[104:107], v1, s[4:7], s47 offen offset:2048 sc1
  buffer_load_dwordx4 v[108:111], v1, s[4:7], s47 offen offset:3072 sc1
  s_add_u32 s47, s48, 33558528
  buffer_load_dwordx4 v[112:115], v1, s[4:7], s47 offen offset:0 sc1
  buffer_load_dwordx4 v[116:119], v1, s[4:7], s47 offen offset:1024 sc1
  buffer_load_dwordx4 v[120:123], v1, s[4:7], s47 offen offset:2048 sc1
  buffer_load_dwordx4 v[124:127], v1, s[4:7], s47 offen offset:3072 sc1
  s_waitcnt vmcnt(8)
  v_mfma_f32_16x16x32_bf16 v[160:163], v[64:67], v[32:35], 0
  v_mfma_f32_16x16x32_bf16 v[160:163], v[68:71], v[36:39], v[160:163]
  v_mfma_f32_16x16x32_bf16 v[160:163], v[72:75], v[40:43], v[160:163]
  v_mfma_f32_16x16x32_bf16 v[160:163], v[76:79], v[44:47], v[160:163]
  v_mfma_f32_16x16x32_bf16 v[224:227], v[64:67], v[48:51], 0
  v_mfma_f32_16x16x32_bf16 v[228:231], v[80:83], v[48:51], 0
  v_mfma_f32_16x16x32_bf16 v[224:227], v[68:71], v[52:55], v[224:227]
  v_mfma_f32_16x16x32_bf16 v[228:231], v[84:87], v[52:55], v[228:231]
  v_mfma_f32_16x16x32_bf16 v[224:227], v[72:75], v[56:59], v[224:227]
  v_mfma_f32_16x16x32_bf16 v[228:231], v[88:91], v[56:59], v[228:231]
  v_mfma_f32_16x16x32_bf16 v[224:227], v[76:79], v[60:63], v[224:227]
  v_mfma_f32_16x16x32_bf16 v[228:231], v[92:95], v[60:63], v[228:231]
  s_waitcnt vmcnt(0)
  s_lshl_b32 s47, s22, 7
  s_add_u32 s47, s47, 4096
  s_add_u32 s50, s21, 1
  v_mov_b32 v9, s47
ATM_108:
  buffer_load_dword v10, v9, s[4:7], 0 offen sc1
  s_sub_u32 s74, s74, 1
  s_cbranch_scc1 L_TIMEOUT
  s_waitcnt vmcnt(0)
  v_cmp_gt_u32 vcc, s50, v10
  s_nop 0
  s_cbranch_vccz BK_109
  s_sleep 2
  s_branch ATM_108
BK_109:
  s_lshl_b32 s47, s23, 12
  s_add_u32 s47, s47, 67108864
  buffer_load_dwordx4 v[16:19], v1, s[4:7], s47 offen offset:0 sc1
  buffer_load_dwordx4 v[20:23], v1, s[4:7], s47 offen offset:1024 sc1
  buffer_load_dwordx4 v[24:27], v1, s[4:7], s47 offen offset:2048 sc1
  buffer_load_dwordx4 v[28:31], v1, s[4:7], s47 offen offset:3072 sc1
  s_waitcnt vmcnt(3)
  ds_write_b64 v6, v[16:17] offset:0
  v_cndmask_b32 v144, 0, v18, s[44:45]
  v_cndmask_b32 v145, 0, v19, s[44:45]
  v_cndmask_b32 v152, 0, v18, s[52:53]
  v_cndmask_b32 v153, 0, v19, s[52:53]
  s_waitcnt vmcnt(2)
  ds_write_b64 v6, v[20:21] offset:512
  v_cndmask_b32 v146, 0, v22, s[44:45]
  v_cndmask_b32 v147, 0, v23, s[44:45]
  v_cndmask_b32 v154, 0, v22, s[52:53]
  v_cndmask_b32 v155, 0, v23, s[52:53]
  s_waitcnt vmcnt(1)
  ds_write_b64 v6, v[24:25] offset:1024
  v_cndmask_b32 v148, 0, v26, s[44:45]
  v_cndmask_b32 v149, 0, v27, s[44:45]
  v_cndmask_b32 v156, 0, v26, s[52:53]
  v_cndmask_b32 v157, 0, v27, s[52:53]
  s_waitcnt vmcnt(0)
  ds_write_b64 v6, v[28:29] offset:1536
  v_cndmask_b32 v150, 0, v30, s[44:45]
  v_cndmask_b32 v151, 0, v31, s[44:45]
  v_cndmask_b32 v158, 0, v30, s[52:53]
  v_cndmask_b32 v159, 0, v31, s[52:53]
  s_waitcnt lgkmcnt(0)
  ds_read_b64_tr_b16 v[128:129], v7 offset:0
  ds_read_b64_tr_b16 v[130:131], v7 offset:64
  ds_read_b64_tr_b16 v[132:133], v7 offset:512
  ds_read_b64_tr_b16 v[134:135], v7 offset:576
  ds_read_b64_tr_b16 v[136:137], v7 offset:1024
  ds_read_b64_tr_b16 v[138:139], v7 offset:1088
  ds_read_b64_tr_b16 v[140:141], v7 offset:1536
  ds_read_b64_tr_b16 v[142:143], v7 offset:1600
  s_waitcnt lgkmcnt(0)
  v_mov_b32 v15, 0xf149f2ca
  v_mfma_f32_16x16x32_bf16 v[168:171], v[128:131], v[32:35], 0
  v_mfma_f32_16x16x32_bf16 v[232:235], v[128:131], v[48:51], 0
  v_mfma_f32_16x16x32_bf16 v[168:171], v[132:135], v[36:39], v[168:171]
  v_mfma_f32_16x16x32_bf16 v[232:235], v[132:135], v[52:55], v[232:235]
  v_mfma_f32_16x16x32_bf16 v[168:171], v[136:139], v[40:43], v[168:171]
  v_mfma_f32_16x16x32_bf16 v[232:235], v[136:139], v[56:59], v[232:235]
  v_mfma_f32_16x16x32_bf16 v[168:171], v[140:143], v[44:47], v[168:171]
  v_mfma_f32_16x16x32_bf16 v[232:235], v[140:143], v[60:63], v[232:235]
  v_cndmask_b32 v160, v15, v160, s[36:37]
  v_cndmask_b32 v161, v15, v161, s[38:39]
  v_cndmask_b32 v162, v15, v162, s[40:41]
  v_cndmask_b32 v163, v15, v163, s[42:43]
  v_max3_f32 v172, v160, v161, v162
  s_nop 1
  v_max3_f32 v172, v172, v163, v168
  v_max3_f32 v172, v172, v169, v170
  v_max_f32 v172, v172, v171
  v_mov_b32 v173, v172
  s_nop 1
  v_permlane32_swap_b32 v172, v173
  v_max_f32 v172, v172, v173
  v_mov_b32 v173, v172
  s_nop 1
  v_permlane16_swap_b32 v172, v173
  v_max_f32 v172, v172, v173
  v_mul_f32 v172, s88, v172
  v_fma_f32 v160, v160, s88, -v172
  v_fma_f32 v161, v161, s88, -v172
  v_fma_f32 v162, v162, s88, -v172
  v_fma_f32 v163, v163, s88, -v172
  v_fma_f32 v168, v168, s88, -v172
  v_fma_f32 v169, v169, s88, -v172
  v_fma_f32 v170, v170, s88, -v172
  v_fma_f32 v171, v171, s88, -v172
  v_exp_f32 v160, v160
  v_exp_f32 v161, v161
  v_exp_f32 v162, v162
  v_exp_f32 v163, v163
  v_exp_f32 v168, v168
  v_exp_f32 v169, v169
  v_exp_f32 v170, v170
  v_exp_f32 v171, v171
  v_cvt_pk_bf16_f32 v176, v160, v161
  v_cvt_pk_bf16_f32 v177, v162, v163
  v_mov_b32 v178, 0
  v_mov_b32 v179, 0
  v_cvt_pk_bf16_f32 v180, v168, v169
  v_cvt_pk_bf16_f32 v181, v170, v171
  v_mfma_f32_16x16x32_bf16 v[192:195], v[96:99], v[176:179], 0
  v_mfma_f32_16x16x32_bf16 v[196:199], v[100:103], v[176:179], 0
  v_mfma_f32_16x16x32_bf16 v[200:203], v[104:107], v[176:179], 0
  v_mfma_f32_16x16x32_bf16 v[204:207], v[108:111], v[176:179], 0
  v_mfma_f32_16x16x32_bf16 v[208:211], v[112:115], v[176:179], 0
  v_mfma_f32_16x16x32_bf16 v[212:215], v[116:119], v[176:179], 0
  v_mfma_f32_16x16x32_bf16 v[216:219], v[120:123], v[176:179], 0
  v_mfma_f32_16x16x32_bf16 v[220:223], v[124:127], v[176:179], 0
  v_mfma_f32_16x16x16_bf16 v[192:195], v[144:145], v[180:181], v[192:195]
  v_mfma_f32_16x16x16_bf16 v[196:199], v[152:153], v[180:181], v[196:199]
  v_mfma_f32_16x16x16_bf16 v[200:203], v[146:147], v[180:181], v[200:203]
  v_mfma_f32_16x16x16_bf16 v[204:207], v[154:155], v[180:181], v[204:207]
  v_mfma_f32_16x16x16_bf16 v[208:211], v[148:149], v[180:181], v[208:211]
  v_mfma_f32_16x16x16_bf16 v[212:215], v[156:157], v[180:181], v[212:215]
  v_mfma_f32_16x16x16_bf16 v[216:219], v[150:151], v[180:181], v[216:219]
  v_mfma_f32_16x16x16_bf16 v[220:223], v[158:159], v[180:181], v[220:223]
  v_dot2_f32_bf16 v174, v180, s90, 0
  v_dot2_f32_bf16 v175, v176, s89, 0
  v_dot2_f32_bf16 v174, v181, s90, v174
  v_dot2_f32_bf16 v175, v177, s89, v175
  v_dot2_f32_bf16 v174, v178, s89, v174
  v_dot2_f32_bf16 v175, v179, s89, v175
  s_nop 2
  v_add_f32 v174, v174, v175
  v_mov_b32 v175, v174
  s_nop 1
  v_permlane32_swap_b32 v174, v175
  v_add_f32 v174, v174, v175
  v_mov_b32 v175, v174
  s_nop 1
  v_permlane16_swap_b32 v174, v175
  v_add_f32 v174, v174, v175
  v_rcp_f32 v174, v174
  s_lshl_b32 s47, s21, 1
  s_add_u32 s47, s47, 0
  s_lshl_b32 s47, s47, 7
  s_lshl_b32 s49, s22, 2
  s_add_u32 s47, s47, s49
  s_lshl_b32 s47, s47, 10
  s_add_u32 s47, s47, 100663296
  v_mul_f32 v192, v192, v174
  v_mul_f32 v193, v193, v174
  v_mul_f32 v194, v194, v174
  v_mul_f32 v195, v195, v174
  v_mul_f32 v196, v196, v174
  v_mul_f32 v197, v197, v174
  v_mul_f32 v198, v198, v174
  v_mul_f32 v199, v199, v174
  v_cvt_pk_bf16_f32 v192, v192, v193
  v_cvt_pk_bf16_f32 v193, v194, v195
  v_cvt_pk_bf16_f32 v194, v196, v197
  v_cvt_pk_bf16_f32 v195, v198, v199
  buffer_store_dwordx4 v[192:195], v1, s[4:7], s47 offen offset:0 sc1
  v_mul_f32 v200, v200, v174
  v_mul_f32 v201, v201, v174
  v_mul_f32 v202, v202, v174
  v_mul_f32 v203, v203, v174
  v_mul_f32 v204, v204, v174
  v_mul_f32 v205, v205, v174
  v_mul_f32 v206, v206, v174
  v_mul_f32 v207, v207, v174
  v_cvt_pk_bf16_f32 v200, v200, v201
  v_cvt_pk_bf16_f32 v201, v202, v203
  v_cvt_pk_bf16_f32 v202, v204, v205
  v_cvt_pk_bf16_f32 v203, v206, v207
  buffer_store_dwordx4 v[200:203], v1, s[4:7], s47 offen offset:1024 sc1
  v_mul_f32 v208, v208, v174
  v_mul_f32 v209, v209, v174
  v_mul_f32 v210, v210, v174
  v_mul_f32 v211, v211, v174
  v_mul_f32 v212, v212, v174
  v_mul_f32 v213, v213, v174
  v_mul_f32 v214, v214, v174
  v_mul_f32 v215, v215, v174
  v_cvt_pk_bf16_f32 v208, v208, v209
  v_cvt_pk_bf16_f32 v209, v210, v211
  v_cvt_pk_bf16_f32 v210, v212, v213
  v_cvt_pk_bf16_f32 v211, v214, v215
  buffer_store_dwordx4 v[208:211], v1, s[4:7], s47 offen offset:2048 sc1
  v_mul_f32 v216, v216, v174
  v_mul_f32 v217, v217, v174
  v_mul_f32 v218, v218, v174
  v_mul_f32 v219, v219, v174
  v_mul_f32 v220, v220, v174
  v_mul_f32 v221, v221, v174
  v_mul_f32 v222, v222, v174
  v_mul_f32 v223, v223, v174
  v_cvt_pk_bf16_f32 v216, v216, v217
  v_cvt_pk_bf16_f32 v217, v218, v219
  v_cvt_pk_bf16_f32 v218, v220, v221
  v_cvt_pk_bf16_f32 v219, v222, v223
  buffer_store_dwordx4 v[216:219], v1, s[4:7], s47 offen offset:3072 sc1
  v_cndmask_b32 v228, v15, v228, s[36:37]
  v_cndmask_b32 v229, v15, v229, s[38:39]
  v_cndmask_b32 v230, v15, v230, s[40:41]
  v_cndmask_b32 v231, v15, v231, s[42:43]
  v_max3_f32 v172, v224, v225, v226
  v_max3_f32 v172, v172, v227, v228
  v_max3_f32 v172, v172, v229, v230
  v_max3_f32 v172, v172, v231, v232
  v_max3_f32 v172, v172, v233, v234
  v_max_f32 v172, v172, v235
  v_mov_b32 v173, v172
  s_nop 1
  v_permlane32_swap_b32 v172, v173
  v_max_f32 v172, v172, v173
  v_mov_b32 v173, v172
  s_nop 1
  v_permlane16_swap_b32 v172, v173
  v_max_f32 v172, v172, v173
  v_mul_f32 v172, s88, v172
  v_fma_f32 v224, v224, s88, -v172
  v_fma_f32 v225, v225, s88, -v172
  v_fma_f32 v226, v226, s88, -v172
  v_fma_f32 v227, v227, s88, -v172
  v_fma_f32 v228, v228, s88, -v172
  v_fma_f32 v229, v229, s88, -v172
  v_fma_f32 v230, v230, s88, -v172
  v_fma_f32 v231, v231, s88, -v172
  v_fma_f32 v232, v232, s88, -v172
  v_fma_f32 v233, v233, s88, -v172
  v_fma_f32 v234, v234, s88, -v172
  v_fma_f32 v235, v235, s88, -v172
  v_exp_f32 v224, v224
  v_exp_f32 v225, v225
  v_exp_f32 v226, v226
  v_exp_f32 v227, v227
  v_exp_f32 v228, v228
  v_exp_f32 v229, v229
  v_exp_f32 v230, v230
  v_exp_f32 v231, v231
  v_exp_f32 v232, v232
  v_exp_f32 v233, v233
  v_exp_f32 v234, v234
  v_exp_f32 v235, v235
  v_cvt_pk_bf16_f32 v176, v224, v225
  v_cvt_pk_bf16_f32 v177, v226, v227
  v_cvt_pk_bf16_f32 v178, v228, v229
  v_cvt_pk_bf16_f32 v179, v230, v231
  v_cvt_pk_bf16_f32 v180, v232, v233
  v_cvt_pk_bf16_f32 v181, v234, v235
  v_mfma_f32_16x16x32_bf16 v[192:195], v[96:99], v[176:179], 0
  v_mfma_f32_16x16x32_bf16 v[196:199], v[100:103], v[176:179], 0
  v_mfma_f32_16x16x32_bf16 v[200:203], v[104:107], v[176:179], 0
  v_mfma_f32_16x16x32_bf16 v[204:207], v[108:111], v[176:179], 0
  v_mfma_f32_16x16x32_bf16 v[208:211], v[112:115], v[176:179], 0
  v_mfma_f32_16x16x32_bf16 v[212:215], v[116:119], v[176:179], 0
  v_mfma_f32_16x16x32_bf16 v[216:219], v[120:123], v[176:179], 0
  v_mfma_f32_16x16x32_bf16 v[220:223], v[124:127], v[176:179], 0
  v_mfma_f32_16x16x16_bf16 v[192:195], v[144:145], v[180:181], v[192:195]
  v_mfma_f32_16x16x16_bf16 v[196:199], v[152:153], v[180:181], v[196:199]
  v_mfma_f32_16x16x16_bf16 v[200:203], v[146:147], v[180:181], v[200:203]
  v_mfma_f32_16x16x16_bf16 v[204:207], v[154:155], v[180:181], v[204:207]
  v_mfma_f32_16x16x16_bf16 v[208:211], v[148:149], v[180:181], v[208:211]
  v_mfma_f32_16x16x16_bf16 v[212:215], v[156:157], v[180:181], v[212:215]
  v_mfma_f32_16x16x16_bf16 v[216:219], v[150:151], v[180:181], v[216:219]
  v_mfma_f32_16x16x16_bf16 v[220:223], v[158:159], v[180:181], v[220:223]
  v_dot2_f32_bf16 v174, v180, s90, 0
  v_dot2_f32_bf16 v175, v176, s89, 0
  v_dot2_f32_bf16 v174, v181, s90, v174
  v_dot2_f32_bf16 v175, v177, s89, v175
  v_dot2_f32_bf16 v174, v178, s89, v174
  v_dot2_f32_bf16 v175, v179, s89, v175
  s_nop 2
  v_add_f32 v174, v174, v175
  v_mov_b32 v175, v174
  s_nop 1
  v_permlane32_swap_b32 v174, v175
  v_add_f32 v174, v174, v175
  v_mov_b32 v175, v174
  s_nop 1
  v_permlane16_swap_b32 v174, v175
  v_add_f32 v174, v174, v175
  v_rcp_f32 v174, v174
  s_lshl_b32 s47, s21, 1
  s_add_u32 s47, s47, 1
  s_lshl_b32 s47, s47, 7
  s_lshl_b32 s49, s22, 2
  s_add_u32 s47, s47, s49
  s_lshl_b32 s47, s47, 10
  s_add_u32 s47, s47, 100663296
  v_mul_f32 v192, v192, v174
  v_mul_f32 v193, v193, v174
  v_mul_f32 v194, v194, v174
  v_mul_f32 v195, v195, v174
  v_mul_f32 v196, v196, v174
  v_mul_f32 v197, v197, v174
  v_mul_f32 v198, v198, v174
  v_mul_f32 v199, v199, v174
  v_cvt_pk_bf16_f32 v192, v192, v193
  v_cvt_pk_bf16_f32 v193, v194, v195
  v_cvt_pk_bf16_f32 v194, v196, v197
  v_cvt_pk_bf16_f32 v195, v198, v199
  buffer_store_dwordx4 v[192:195], v1, s[4:7], s47 offen offset:0 sc1
  v_mul_f32 v200, v200, v174
  v_mul_f32 v201, v201, v174
  v_mul_f32 v202, v202, v174
  v_mul_f32 v203, v203, v174
  v_mul_f32 v204, v204, v174
  v_mul_f32 v205, v205, v174
  v_mul_f32 v206, v206, v174
  v_mul_f32 v207, v207, v174
  v_cvt_pk_bf16_f32 v200, v200, v201
  v_cvt_pk_bf16_f32 v201, v202, v203
  v_cvt_pk_bf16_f32 v202, v204, v205
  v_cvt_pk_bf16_f32 v203, v206, v207
  buffer_store_dwordx4 v[200:203], v1, s[4:7], s47 offen offset:1024 sc1
  v_mul_f32 v208, v208, v174
  v_mul_f32 v209, v209, v174
  v_mul_f32 v210, v210, v174
  v_mul_f32 v211, v211, v174
  v_mul_f32 v212, v212, v174
  v_mul_f32 v213, v213, v174
  v_mul_f32 v214, v214, v174
  v_mul_f32 v215, v215, v174
  v_cvt_pk_bf16_f32 v208, v208, v209
  v_cvt_pk_bf16_f32 v209, v210, v211
  v_cvt_pk_bf16_f32 v210, v212, v213
  v_cvt_pk_bf16_f32 v211, v214, v215
  buffer_store_dwordx4 v[208:211], v1, s[4:7], s47 offen offset:2048 sc1
  v_mul_f32 v216, v216, v174
  v_mul_f32 v217, v217, v174
  v_mul_f32 v218, v218, v174
  v_mul_f32 v219, v219, v174
  v_mul_f32 v220, v220, v174
  v_mul_f32 v221, v221, v174
  v_mul_f32 v222, v222, v174
  v_mul_f32 v223, v223, v174
  v_cvt_pk_bf16_f32 v216, v216, v217
  v_cvt_pk_bf16_f32 v217, v218, v219
  v_cvt_pk_bf16_f32 v218, v220, v221
  v_cvt_pk_bf16_f32 v219, v222, v223
  buffer_store_dwordx4 v[216:219], v1, s[4:7], s47 offen offset:3072 sc1
  s_waitcnt vmcnt(0)
  s_lshl_b32 s47, s21, 7
  s_add_u32 s47, s47, 8192
  v_mov_b32 v12, s47
  v_mov_b32 v13, 1
  s_mov_b64 exec, 1
  buffer_atomic_add v13, v12, s[4:7], 0 offen
  s_mov_b64 exec, -1
  s_add_u32 s21, s21, 4
  s_cmp_lt_u32 s21, 64
  s_cbranch_scc1 ATT_104
  s_waitcnt vmcnt(0)
L_DONE:
L_END:
  s_endpgm
L_CF1:
  v_mbcnt_lo_u32_b32 v8, -1, 0
  v_mbcnt_hi_u32_b32 v8, -1, v8
  v_and_b32 v8, 7, v8
  v_and_b32 v9, 3, v8
  v_lshlrev_b32 v9, 2, v9
  v_lshrrev_b32 v8, 2, v8
  v_lshl_add_u32 v9, v8, 7, v9
  v_mov_b32 v8, 252
L_CP1:
  global_load_dword v10, v9, s[76:77] sc1
  global_load_dword v11, v8, s[76:77] sc1
  s_sub_u32 s74, s74, 1
  s_cbranch_scc1 L_TIMEOUT
  s_waitcnt vmcnt(0)
  v_readfirstlane_b32 s88, v11
  s_mov_b32 s86, 1
  s_mov_b32 s100, 0
  v_readlane_b32 s89, v10, 0
  s_nop 0
  s_add_u32 s88, s88, s89
  s_cmp_eq_u32 s89, 32
  s_cselect_b32 s86, s86, 0
  s_cmp_ge_u32 s2, 256
  s_cselect_b32 s89, s89, 0
  s_add_u32 s100, s100, s89
  v_readlane_b32 s89, v10, 1
  s_nop 0
  s_add_u32 s88, s88, s89
  s_cmp_eq_u32 s89, 32
  s_cselect_b32 s86, s86, 0
  s_cmp_ge_u32 s2, 512
  s_cselect_b32 s89, s89, 0
  s_add_u32 s100, s100, s89
  v_readlane_b32 s89, v10, 2
  s_nop 0
  s_add_u32 s88, s88, s89
  s_cmp_eq_u32 s89, 32
  s_cselect_b32 s86, s86, 0
  s_cmp_ge_u32 s2, 768
  s_cselect_b32 s89, s89, 0
  s_add_u32 s100, s100, s89
  v_readlane_b32 s89, v10, 3
  s_nop 0
  s_add_u32 s88, s88, s89
  s_cmp_eq_u32 s89, 32
  s_cselect_b32 s86, s86, 0
  s_cmp_ge_u32 s2, 1024
  s_cselect_b32 s89, s89, 0
  s_add_u32 s100, s100, s89
  v_readlane_b32 s89, v10, 4
  s_nop 0
  s_add_u32 s88, s88, s89
  s_cmp_eq_u32 s89, 32
  s_cselect_b32 s86, s86, 0
  s_cmp_ge_u32 s2, 1280
  s_cselect_b32 s89, s89, 0
  s_add_u32 s100, s100, s89
  v_readlane_b32 s89, v10, 5
  s_nop 0
  s_add_u32 s88, s88, s89
  s_cmp_eq_u32 s89, 32
  s_cselect_b32 s86, s86, 0
  s_cmp_ge_u32 s2, 1536
  s_cselect_b32 s89, s89, 0
  s_add_u32 s100, s100, s89
  v_readlane_b32 s89, v10, 6
  s_nop 0
  s_add_u32 s88, s88, s89
  s_cmp_eq_u32 s89, 32
  s_cselect_b32 s86, s86, 0
  s_cmp_ge_u32 s2, 1792
  s_cselect_b32 s89, s89, 0
  s_add_u32 s100, s100, s89
  v_readlane_b32 s89, v10, 7
  s_nop 0
  s_add_u32 s88, s88, s89
  s_cmp_eq_u32 s89, 32
  s_cselect_b32 s86, s86, 0
  s_cmp_ge_u32 s2, 2048
  s_cselect_b32 s89, s89, 0
  s_add_u32 s100, s100, s89
  s_cmp_ge_u32 s88, 256
  s_cbranch_scc1 L_CK1
  s_sleep 8
  s_branch L_CP1
L_CK1:
  s_mov_b32 s3, 1
  s_cmp_eq_u32 s86, 0
  s_cbranch_scc1 L_FALLBACK
  s_branch L_CR1
L_CF2:
  v_mbcnt_lo_u32_b32 v62, -1, 0
  v_mbcnt_hi_u32_b32 v62, -1, v62
  v_and_b32 v62, 7, v62
  v_and_b32 v63, 3, v62
  v_lshlrev_b32 v63, 2, v63
  v_lshrrev_b32 v62, 2, v62
  v_lshl_add_u32 v63, v62, 7, v63
  v_mov_b32 v62, 252
L_CP2:
  global_load_dword v64, v63, s[76:77] sc1
  global_load_dword v65, v62, s[76:77] sc1
  s_sub_u32 s74, s74, 1
  s_cbranch_scc1 L_TIMEOUT
  s_waitcnt vmcnt(0)
  v_readfirstlane_b32 s88, v65
  s_mov_b32 s86, 1
  s_mov_b32 s100, 0
  v_readlane_b32 s89, v64, 0
  s_nop 0
  s_add_u32 s88, s88, s89
  s_cmp_eq_u32 s89, 32
  s_cselect_b32 s86, s86, 0
  s_cmp_ge_u32 s2, 256
  s_cselect_b32 s89, s89, 0
  s_add_u32 s100, s100, s89
  v_readlane_b32 s89, v64, 1
  s_nop 0
  s_add_u32 s88, s88, s89
  s_cmp_eq_u32 s89, 32
  s_cselect_b32 s86, s86, 0
  s_cmp_ge_u32 s2, 512
  s_cselect_b32 s89, s89, 0
  s_add_u32 s100, s100, s89
  v_readlane_b32 s89, v64, 2
  s_nop 0
  s_add_u32 s88, s88, s89
  s_cmp_eq_u32 s89, 32
  s_cselect_b32 s86, s86, 0
  s_cmp_ge_u32 s2, 768
  s_cselect_b32 s89, s89, 0
  s_add_u32 s100, s100, s89
  v_readlane_b32 s89, v64, 3
  s_nop 0
  s_add_u32 s88, s88, s89
  s_cmp_eq_u32 s89, 32
  s_cselect_b32 s86, s86, 0
  s_cmp_ge_u32 s2, 1024
  s_cselect_b32 s89, s89, 0
  s_add_u32 s100, s100, s89
  v_readlane_b32 s89, v64, 4
  s_nop 0
  s_add_u32 s88, s88, s89
  s_cmp_eq_u32 s89, 32
  s_cselect_b32 s86, s86, 0
  s_cmp_ge_u32 s2, 1280
  s_cselect_b32 s89, s89, 0
  s_add_u32 s100, s100, s89
  v_readlane_b32 s89, v64, 5
  s_nop 0
  s_add_u32 s88, s88, s89
  s_cmp_eq_u32 s89, 32
  s_cselect_b32 s86, s86, 0
  s_cmp_ge_u32 s2, 1536
  s_cselect_b32 s89, s89, 0
  s_add_u32 s100, s100, s89
  v_readlane_b32 s89, v64, 6
  s_nop 0
  s_add_u32 s88, s88, s89
  s_cmp_eq_u32 s89, 32
  s_cselect_b32 s86, s86, 0
  s_cmp_ge_u32 s2, 1792
  s_cselect_b32 s89, s89, 0
  s_add_u32 s100, s100, s89
  v_readlane_b32 s89, v64, 7
  s_nop 0
  s_add_u32 s88, s88, s89
  s_cmp_eq_u32 s89, 32
  s_cselect_b32 s86, s86, 0
  s_cmp_ge_u32 s2, 2048
  s_cselect_b32 s89, s89, 0
  s_add_u32 s100, s100, s89
  s_cmp_ge_u32 s88, 256
  s_cbranch_scc1 L_CK2
  s_sleep 8
  s_branch L_CP2
L_CK2:
  s_mov_b32 s3, 1
  s_cmp_eq_u32 s86, 0
  s_cbranch_scc1 L_FALLBACK
  s_branch L_CR2
L_CF3:
  v_mbcnt_lo_u32_b32 v144, -1, 0
  v_mbcnt_hi_u32_b32 v144, -1, v144
  v_and_b32 v144, 7, v144
  v_and_b32 v145, 3, v144
  v_lshlrev_b32 v145, 2, v145
  v_lshrrev_b32 v144, 2, v144
  v_lshl_add_u32 v145, v144, 7, v145
  v_mov_b32 v144, 252
L_CP3:
  global_load_dword v146, v145, s[76:77] sc1
  global_load_dword v147, v144, s[76:77] sc1
  s_sub_u32 s74, s74, 1
  s_cbranch_scc1 L_TIMEOUT
  s_waitcnt vmcnt(0)
  v_readfirstlane_b32 s88, v147
  s_mov_b32 s86, 1
  s_mov_b32 s100, 0
  v_readlane_b32 s89, v146, 0
  s_nop 0
  s_add_u32 s88, s88, s89
  s_cmp_eq_u32 s89, 32
  s_cselect_b32 s86, s86, 0
  s_cmp_ge_u32 s2, 256
  s_cselect_b32 s89, s89, 0
  s_add_u32 s100, s100, s89
  v_readlane_b32 s89, v146, 1
  s_nop 0
  s_add_u32 s88, s88, s89
  s_cmp_eq_u32 s89, 32
  s_cselect_b32 s86, s86, 0
  s_cmp_ge_u32 s2, 512
  s_cselect_b32 s89, s89, 0
  s_add_u32 s100, s100, s89
  v_readlane_b32 s89, v146, 2
  s_nop 0
  s_add_u32 s88, s88, s89
  s_cmp_eq_u32 s89, 32
  s_cselect_b32 s86, s86, 0
  s_cmp_ge_u32 s2, 768
  s_cselect_b32 s89, s89, 0
  s_add_u32 s100, s100, s89
  v_readlane_b32 s89, v146, 3
  s_nop 0
  s_add_u32 s88, s88, s89
  s_cmp_eq_u32 s89, 32
  s_cselect_b32 s86, s86, 0
  s_cmp_ge_u32 s2, 1024
  s_cselect_b32 s89, s89, 0
  s_add_u32 s100, s100, s89
  v_readlane_b32 s89, v146, 4
  s_nop 0
  s_add_u32 s88, s88, s89
  s_cmp_eq_u32 s89, 32
  s_cselect_b32 s86, s86, 0
  s_cmp_ge_u32 s2, 1280
  s_cselect_b32 s89, s89, 0
  s_add_u32 s100, s100, s89
  v_readlane_b32 s89, v146, 5
  s_nop 0
  s_add_u32 s88, s88, s89
  s_cmp_eq_u32 s89, 32
  s_cselect_b32 s86, s86, 0
  s_cmp_ge_u32 s2, 1536
  s_cselect_b32 s89, s89, 0
  s_add_u32 s100, s100, s89
  v_readlane_b32 s89, v146, 6
  s_nop 0
  s_add_u32 s88, s88, s89
  s_cmp_eq_u32 s89, 32
  s_cselect_b32 s86, s86, 0
  s_cmp_ge_u32 s2, 1792
  s_cselect_b32 s89, s89, 0
  s_add_u32 s100, s100, s89
  v_readlane_b32 s89, v146, 7
  s_nop 0
  s_add_u32 s88, s88, s89
  s_cmp_eq_u32 s89, 32
  s_cselect_b32 s86, s86, 0
  s_cmp_ge_u32 s2, 2048
  s_cselect_b32 s89, s89, 0
  s_add_u32 s100, s100, s89
  s_cmp_ge_u32 s88, 256
  s_cbranch_scc1 L_CK3
  s_sleep 8
  s_branch L_CP3
L_CK3:
  s_mov_b32 s3, 1
  s_cmp_eq_u32 s86, 0
  s_cbranch_scc1 L_FALLBACK
  s_branch L_CR3
L_CF4:
  v_mbcnt_lo_u32_b32 v8, -1, 0
  v_mbcnt_hi_u32_b32 v8, -1, v8
  v_and_b32 v8, 7, v8
  v_and_b32 v9, 3, v8
  v_lshlrev_b32 v9, 2, v9
  v_lshrrev_b32 v8, 2, v8
  v_lshl_add_u32 v9, v8, 7, v9
  v_mov_b32 v8, 252
L_CP4:
  global_load_dword v10, v9, s[76:77] sc1
  global_load_dword v11, v8, s[76:77] sc1
  s_sub_u32 s74, s74, 1
  s_cbranch_scc1 L_TIMEOUT
  s_waitcnt vmcnt(0)
  v_readfirstlane_b32 s88, v11
  s_mov_b32 s86, 1
  s_mov_b32 s100, 0
  v_readlane_b32 s89, v10, 0
  s_nop 0
  s_add_u32 s88, s88, s89
  s_cmp_eq_u32 s89, 32
  s_cselect_b32 s86, s86, 0
  s_cmp_ge_u32 s2, 256
  s_cselect_b32 s89, s89, 0
  s_add_u32 s100, s100, s89
  v_readlane_b32 s89, v10, 1
  s_nop 0
  s_add_u32 s88, s88, s89
  s_cmp_eq_u32 s89, 32
  s_cselect_b32 s86, s86, 0
  s_cmp_ge_u32 s2, 512
  s_cselect_b32 s89, s89, 0
  s_add_u32 s100, s100, s89
  v_readlane_b32 s89, v10, 2
  s_nop 0
  s_add_u32 s88, s88, s89
  s_cmp_eq_u32 s89, 32
  s_cselect_b32 s86, s86, 0
  s_cmp_ge_u32 s2, 768
  s_cselect_b32 s89, s89, 0
  s_add_u32 s100, s100, s89
  v_readlane_b32 s89, v10, 3
  s_nop 0
  s_add_u32 s88, s88, s89
  s_cmp_eq_u32 s89, 32
  s_cselect_b32 s86, s86, 0
  s_cmp_ge_u32 s2, 1024
  s_cselect_b32 s89, s89, 0
  s_add_u32 s100, s100, s89
  v_readlane_b32 s89, v10, 4
  s_nop 0
  s_add_u32 s88, s88, s89
  s_cmp_eq_u32 s89, 32
  s_cselect_b32 s86, s86, 0
  s_cmp_ge_u32 s2, 1280
  s_cselect_b32 s89, s89, 0
  s_add_u32 s100, s100, s89
  v_readlane_b32 s89, v10, 5
  s_nop 0
  s_add_u32 s88, s88, s89
  s_cmp_eq_u32 s89, 32
  s_cselect_b32 s86, s86, 0
  s_cmp_ge_u32 s2, 1536
  s_cselect_b32 s89, s89, 0
  s_add_u32 s100, s100, s89
  v_readlane_b32 s89, v10, 6
  s_nop 0
  s_add_u32 s88, s88, s89
  s_cmp_eq_u32 s89, 32
  s_cselect_b32 s86, s86, 0
  s_cmp_ge_u32 s2, 1792
  s_cselect_b32 s89, s89, 0
  s_add_u32 s100, s100, s89
  v_readlane_b32 s89, v10, 7
  s_nop 0
  s_add_u32 s88, s88, s89
  s_cmp_eq_u32 s89, 32
  s_cselect_b32 s86, s86, 0
  s_cmp_ge_u32 s2, 2048
  s_cselect_b32 s89, s89, 0
  s_add_u32 s100, s100, s89
  s_cmp_ge_u32 s88, 256
  s_cbranch_scc1 L_CK4
  s_sleep 8
  s_branch L_CP4
L_CK4:
  s_mov_b32 s3, 1
  s_cmp_eq_u32 s86, 0
  s_cbranch_scc1 L_FALLBACK
  s_branch L_CR4
L_CF5:
  v_mbcnt_lo_u32_b32 v8, -1, 0
  v_mbcnt_hi_u32_b32 v8, -1, v8
  v_and_b32 v8, 7, v8
  v_and_b32 v9, 3, v8
  v_lshlrev_b32 v9, 2, v9
  v_lshrrev_b32 v8, 2, v8
  v_lshl_add_u32 v9, v8, 7, v9
  v_mov_b32 v8, 252
L_CP5:
  global_load_dword v10, v9, s[76:77] sc1
  global_load_dword v11, v8, s[76:77] sc1
  s_sub_u32 s74, s74, 1
  s_cbranch_scc1 L_TIMEOUT
  s_waitcnt vmcnt(0)
  v_readfirstlane_b32 s88, v11
  s_mov_b32 s86, 1
  s_mov_b32 s100, 0
  v_readlane_b32 s89, v10, 0
  s_nop 0
  s_add_u32 s88, s88, s89
  s_cmp_eq_u32 s89, 32
  s_cselect_b32 s86, s86, 0
  s_cmp_ge_u32 s2, 256
  s_cselect_b32 s89, s89, 0
  s_add_u32 s100, s100, s89
  v_readlane_b32 s89, v10, 1
  s_nop 0
  s_add_u32 s88, s88, s89
  s_cmp_eq_u32 s89, 32
  s_cselect_b32 s86, s86, 0
  s_cmp_ge_u32 s2, 512
  s_cselect_b32 s89, s89, 0
  s_add_u32 s100, s100, s89
  v_readlane_b32 s89, v10, 2
  s_nop 0
  s_add_u32 s88, s88, s89
  s_cmp_eq_u32 s89, 32
  s_cselect_b32 s86, s86, 0
  s_cmp_ge_u32 s2, 768
  s_cselect_b32 s89, s89, 0
  s_add_u32 s100, s100, s89
  v_readlane_b32 s89, v10, 3
  s_nop 0
  s_add_u32 s88, s88, s89
  s_cmp_eq_u32 s89, 32
  s_cselect_b32 s86, s86, 0
  s_cmp_ge_u32 s2, 1024
  s_cselect_b32 s89, s89, 0
  s_add_u32 s100, s100, s89
  v_readlane_b32 s89, v10, 4
  s_nop 0
  s_add_u32 s88, s88, s89
  s_cmp_eq_u32 s89, 32
  s_cselect_b32 s86, s86, 0
  s_cmp_ge_u32 s2, 1280
  s_cselect_b32 s89, s89, 0
  s_add_u32 s100, s100, s89
  v_readlane_b32 s89, v10, 5
  s_nop 0
  s_add_u32 s88, s88, s89
  s_cmp_eq_u32 s89, 32
  s_cselect_b32 s86, s86, 0
  s_cmp_ge_u32 s2, 1536
  s_cselect_b32 s89, s89, 0
  s_add_u32 s100, s100, s89
  v_readlane_b32 s89, v10, 6
  s_nop 0
  s_add_u32 s88, s88, s89
  s_cmp_eq_u32 s89, 32
  s_cselect_b32 s86, s86, 0
  s_cmp_ge_u32 s2, 1792
  s_cselect_b32 s89, s89, 0
  s_add_u32 s100, s100, s89
  v_readlane_b32 s89, v10, 7
  s_nop 0
  s_add_u32 s88, s88, s89
  s_cmp_eq_u32 s89, 32
  s_cselect_b32 s86, s86, 0
  s_cmp_ge_u32 s2, 2048
  s_cselect_b32 s89, s89, 0
  s_add_u32 s100, s100, s89
  s_cmp_ge_u32 s88, 256
  s_cbranch_scc1 L_CK5
  s_sleep 8
  s_branch L_CP5
L_CK5:
  s_mov_b32 s3, 1
  s_cmp_eq_u32 s86, 0
  s_cbranch_scc1 L_FALLBACK
  s_branch L_CR5
L_CF6:
  v_mbcnt_lo_u32_b32 v8, -1, 0
  v_mbcnt_hi_u32_b32 v8, -1, v8
  v_and_b32 v8, 7, v8
  v_and_b32 v9, 3, v8
  v_lshlrev_b32 v9, 2, v9
  v_lshrrev_b32 v8, 2, v8
  v_lshl_add_u32 v9, v8, 7, v9
  v_mov_b32 v8, 252
L_CP6:
  global_load_dword v10, v9, s[76:77] sc1
  global_load_dword v11, v8, s[76:77] sc1
  s_sub_u32 s74, s74, 1
  s_cbranch_scc1 L_TIMEOUT
  s_waitcnt vmcnt(0)
  v_readfirstlane_b32 s88, v11
  s_mov_b32 s86, 1
  s_mov_b32 s100, 0
  v_readlane_b32 s89, v10, 0
  s_nop 0
  s_add_u32 s88, s88, s89
  s_cmp_eq_u32 s89, 32
  s_cselect_b32 s86, s86, 0
  s_cmp_ge_u32 s2, 256
  s_cselect_b32 s89, s89, 0
  s_add_u32 s100, s100, s89
  v_readlane_b32 s89, v10, 1
  s_nop 0
  s_add_u32 s88, s88, s89
  s_cmp_eq_u32 s89, 32
  s_cselect_b32 s86, s86, 0
  s_cmp_ge_u32 s2, 512
  s_cselect_b32 s89, s89, 0
  s_add_u32 s100, s100, s89
  v_readlane_b32 s89, v10, 2
  s_nop 0
  s_add_u32 s88, s88, s89
  s_cmp_eq_u32 s89, 32
  s_cselect_b32 s86, s86, 0
  s_cmp_ge_u32 s2, 768
  s_cselect_b32 s89, s89, 0
  s_add_u32 s100, s100, s89
  v_readlane_b32 s89, v10, 3
  s_nop 0
  s_add_u32 s88, s88, s89
  s_cmp_eq_u32 s89, 32
  s_cselect_b32 s86, s86, 0
  s_cmp_ge_u32 s2, 1024
  s_cselect_b32 s89, s89, 0
  s_add_u32 s100, s100, s89
  v_readlane_b32 s89, v10, 4
  s_nop 0
  s_add_u32 s88, s88, s89
  s_cmp_eq_u32 s89, 32
  s_cselect_b32 s86, s86, 0
  s_cmp_ge_u32 s2, 1280
  s_cselect_b32 s89, s89, 0
  s_add_u32 s100, s100, s89
  v_readlane_b32 s89, v10, 5
  s_nop 0
  s_add_u32 s88, s88, s89
  s_cmp_eq_u32 s89, 32
  s_cselect_b32 s86, s86, 0
  s_cmp_ge_u32 s2, 1536
  s_cselect_b32 s89, s89, 0
  s_add_u32 s100, s100, s89
  v_readlane_b32 s89, v10, 6
  s_nop 0
  s_add_u32 s88, s88, s89
  s_cmp_eq_u32 s89, 32
  s_cselect_b32 s86, s86, 0
  s_cmp_ge_u32 s2, 1792
  s_cselect_b32 s89, s89, 0
  s_add_u32 s100, s100, s89
  v_readlane_b32 s89, v10, 7
  s_nop 0
  s_add_u32 s88, s88, s89
  s_cmp_eq_u32 s89, 32
  s_cselect_b32 s86, s86, 0
  s_cmp_ge_u32 s2, 2048
  s_cselect_b32 s89, s89, 0
  s_add_u32 s100, s100, s89
  s_cmp_ge_u32 s88, 256
  s_cbranch_scc1 L_CK6
  s_sleep 8
  s_branch L_CP6
L_CK6:
  s_mov_b32 s3, 1
  s_cmp_eq_u32 s86, 0
  s_cbranch_scc1 L_FALLBACK
  s_branch L_CR6
L_CF7:
  v_mbcnt_lo_u32_b32 v8, -1, 0
  v_mbcnt_hi_u32_b32 v8, -1, v8
  v_and_b32 v8, 7, v8
  v_and_b32 v9, 3, v8
  v_lshlrev_b32 v9, 2, v9
  v_lshrrev_b32 v8, 2, v8
  v_lshl_add_u32 v9, v8, 7, v9
  v_mov_b32 v8, 252
L_CP7:
  global_load_dword v10, v9, s[76:77] sc1
  global_load_dword v11, v8, s[76:77] sc1
  s_sub_u32 s74, s74, 1
  s_cbranch_scc1 L_TIMEOUT
  s_waitcnt vmcnt(0)
  v_readfirstlane_b32 s88, v11
  s_mov_b32 s86, 1
  s_mov_b32 s100, 0
  v_readlane_b32 s89, v10, 0
  s_nop 0
  s_add_u32 s88, s88, s89
  s_cmp_eq_u32 s89, 32
  s_cselect_b32 s86, s86, 0
  s_cmp_ge_u32 s2, 256
  s_cselect_b32 s89, s89, 0
  s_add_u32 s100, s100, s89
  v_readlane_b32 s89, v10, 1
  s_nop 0
  s_add_u32 s88, s88, s89
  s_cmp_eq_u32 s89, 32
  s_cselect_b32 s86, s86, 0
  s_cmp_ge_u32 s2, 512
  s_cselect_b32 s89, s89, 0
  s_add_u32 s100, s100, s89
  v_readlane_b32 s89, v10, 2
  s_nop 0
  s_add_u32 s88, s88, s89
  s_cmp_eq_u32 s89, 32
  s_cselect_b32 s86, s86, 0
  s_cmp_ge_u32 s2, 768
  s_cselect_b32 s89, s89, 0
  s_add_u32 s100, s100, s89
  v_readlane_b32 s89, v10, 3
  s_nop 0
  s_add_u32 s88, s88, s89
  s_cmp_eq_u32 s89, 32
  s_cselect_b32 s86, s86, 0
  s_cmp_ge_u32 s2, 1024
  s_cselect_b32 s89, s89, 0
  s_add_u32 s100, s100, s89
  v_readlane_b32 s89, v10, 4
  s_nop 0
  s_add_u32 s88, s88, s89
  s_cmp_eq_u32 s89, 32
  s_cselect_b32 s86, s86, 0
  s_cmp_ge_u32 s2, 1280
  s_cselect_b32 s89, s89, 0
  s_add_u32 s100, s100, s89
  v_readlane_b32 s89, v10, 5
  s_nop 0
  s_add_u32 s88, s88, s89
  s_cmp_eq_u32 s89, 32
  s_cselect_b32 s86, s86, 0
  s_cmp_ge_u32 s2, 1536
  s_cselect_b32 s89, s89, 0
  s_add_u32 s100, s100, s89
  v_readlane_b32 s89, v10, 6
  s_nop 0
  s_add_u32 s88, s88, s89
  s_cmp_eq_u32 s89, 32
  s_cselect_b32 s86, s86, 0
  s_cmp_ge_u32 s2, 1792
  s_cselect_b32 s89, s89, 0
  s_add_u32 s100, s100, s89
  v_readlane_b32 s89, v10, 7
  s_nop 0
  s_add_u32 s88, s88, s89
  s_cmp_eq_u32 s89, 32
  s_cselect_b32 s86, s86, 0
  s_cmp_ge_u32 s2, 2048
  s_cselect_b32 s89, s89, 0
  s_add_u32 s100, s100, s89
  s_cmp_ge_u32 s88, 256
  s_cbranch_scc1 L_CK7
  s_sleep 8
  s_branch L_CP7
L_CK7:
  s_mov_b32 s3, 1
  s_cmp_eq_u32 s86, 0
  s_cbranch_scc1 L_FALLBACK
  s_branch L_CR7
L_FALLBACK:
  s_waitcnt vmcnt(0) lgkmcnt(0)
  s_barrier
  s_mov_b32 s86, 0
  s_and_b32 s88, s2, 255
  s_add_u32 s88, s88, s100
  s_lshr_b32 s84, s88, 5
  s_and_b32 s85, s88, 31
  v_mbcnt_lo_u32_b32 v0, -1, 0
  v_mbcnt_hi_u32_b32 v0, -1, v0
  s_lshl_b32 s88, s13, 6
  v_add_u32 v0, s88, v0
  s_branch L_DISPATCH
L_TIMEOUT:
  v_mov_b32 v8, 0xdead
  v_mov_b32 v10, 64
  global_store_dword v10, v8, s[76:77]
  s_waitcnt vmcnt(0)
  s_endpgm

.section .rodata,"a"
.p2align 6
.amdhsa_kernel parallel_sum__memory_aug_recurrent_mem_tr__dense_activation_mish__prompt_kernel
  .amdhsa_next_free_vgpr 512
  .amdhsa_next_free_sgpr 102
  .amdhsa_accum_offset 256
  .amdhsa_group_segment_fixed_size 0
  .amdhsa_kernarg_size 112
  .amdhsa_user_sgpr_count 2
  .amdhsa_user_sgpr_kernarg_segment_ptr 1
  .amdhsa_system_sgpr_workgroup_id_x 1
.end_amdhsa_kernel
```
